```python
import torch

def _softmax(x, axis=-1):
    return torch.softmax(x, dim=axis)
def _gelu(x):
    return torch.nn.functional.gelu(x, approximate="tanh")
def _silu(x):
    return torch.nn.functional.silu(x)
def _sigmoid(x):
    return torch.sigmoid(x)
def _layernorm(x, axis=-1, eps=1e-5):
    m = x.mean(dim=axis, keepdim=True)
    v = x.var(dim=axis, keepdim=True, unbiased=False)
    return (x - m) / torch.sqrt(v + eps)
def _scatter_add(tgt, idx, src, axis=0):
    return tgt.clone().index_add_(axis, idx, src)
def _segment_sum(src, seg, n):
    out = torch.zeros((n,) + src.shape[1:], dtype=src.dtype)
    return out.index_add_(0, seg, src)
def _pad(x, pw):
    flat = tuple(v for pair in reversed(pw) for v in pair)
    return torch.nn.functional.pad(x, flat)

kernel_name = 'recurrent_scan__mha_block_cached__mixer_s_mlp__prompt'

def setup_inputs():

    _w = (lambda a: (lambda t: t.to(torch.bfloat16) if t.is_floating_point() else t)(torch.as_tensor(a)))
    def _A_setup():
        B, Sq, D = 1, 2048, 512
        H, Sk, Dh = 32, 2048, 128
        return {
            "x": _w((lambda *s: torch.randn(*s, dtype=torch.bfloat16) * 0.05)(B, Sq, D)),
            "k_cache": _w((lambda *s: torch.randn(*s, dtype=torch.bfloat16) * 0.8)(B, H, Sk, Dh)),
            "v_cache": _w((lambda *s: torch.randn(*s, dtype=torch.bfloat16) * 0.8)(B, H, Sk, Dh)),
            "wq": _w((lambda *s: torch.randn(*s, dtype=torch.bfloat16) * 0.8)(D, H * Dh) * (D ** -0.5)),
            "wo": _w((lambda *s: torch.randn(*s, dtype=torch.bfloat16) * 0.8)(H * Dh, D) * ((H * Dh) ** -0.5)),
        }
    _A_in = _A_setup()

    def _B_setup():
        B, S, D, F = 1, 2048, 512, 1792
        return {
            "x":  _w((lambda *s: torch.randn(*s, dtype=torch.bfloat16) * 0.05)(B, S, D)),
            "w1": _w((lambda *s: torch.randn(*s, dtype=torch.bfloat16) * 3.2)(D, D) * (D ** -0.5)),
            "w2": _w((lambda *s: torch.randn(*s, dtype=torch.bfloat16) * 3.2)(D, D) * (D ** -0.5)),
            "w3": _w((lambda *s: torch.randn(*s, dtype=torch.bfloat16) * 3.2)(D, F) * (D ** -0.5)),
            "w4": _w((lambda *s: torch.randn(*s, dtype=torch.bfloat16) * 3.2)(F, D) * (F ** -0.5)),
        }
    _B_in = _B_setup()

    return {
        "A_x": _A_in["x"],
        "A_k_cache": _A_in["k_cache"],
        "A_v_cache": _A_in["v_cache"],
        "A_wq": _A_in["wq"],
        "A_wo": _A_in["wo"],
        "B_x": _B_in["x"],
        "B_w1": _B_in["w1"],
        "B_w2": _B_in["w2"],
        "B_w3": _B_in["w3"],
        "B_w4": _B_in["w4"],
    }

def reference(A_x, A_k_cache, A_v_cache, A_wq, A_wo, B_x, B_w1, B_w2, B_w3, B_w4):
    def _A_ref(x, k_cache, v_cache, wq, wo):
        B, Sq, D = x.shape
        H, Dh = 32, 128
        q = (lambda x, *d: x.permute(*d))((x @ wq).reshape(B, Sq, H, Dh), 0, 2, 1, 3)
        scores = torch.einsum("bhqd,bhkd->bhqk", q, k_cache) * (Dh ** -0.5)
        p = _softmax(scores, axis=-1)
        o = torch.einsum("bhqk,bhkd->bhqd", p, v_cache)
        return (lambda x, *d: x.permute(*d))(o, 0, 2, 1, 3).reshape(B, Sq, H * Dh) @ wo

    def _B_ref(x, w1, w2, w3, w4):
        B, S, D = x.shape
        h = _gelu(_layernorm(x, axis=-1) @ w1)
        c = D // 4
        g0 = _pad(h[:, :, 0*c:1*c], ((0, 0), (1, 0), (0, 0)))[:, :S, :]
        g1 = _pad(h[:, :, 1*c:2*c], ((0, 0), (0, 1), (0, 0)))[:, 1:, :]
        g2 = _pad(h[:, :, 2*c:3*c], ((0, 0), (2, 0), (0, 0)))[:, :S, :]
        g3 = _pad(h[:, :, 3*c:   ], ((0, 0), (0, 2), (0, 0)))[:, 2:, :]
        hs = torch.concatenate([g0, g1, g2, g3], axis=-1) @ w2
        x1 = x + hs
        h2 = _gelu(_layernorm(x1, axis=-1) @ w3) @ w4
        return x1 + h2

    x = A_x
    xn = _layernorm(x, axis=-1)
    s = _A_ref(xn, A_k_cache, A_v_cache, A_wq, A_wo)
    g = _silu(_B_ref(xn, B_w1, B_w2, B_w3, B_w4))
    return x + s * g
```

```asm
; @launch grid=(256,1,1) block=(256,1,1) lds=163840
.amdgcn_target "amdgcn-amd-amdhsa--gfx950"
.text
.globl recurrent_scan__mha_block_cached__mixer_s_mlp__prompt_kernel
.p2align 8
.type recurrent_scan__mha_block_cached__mixer_s_mlp__prompt_kernel,@function
recurrent_scan__mha_block_cached__mixer_s_mlp__prompt_kernel:
    s_memrealtime s[68:69]
    s_cmp_ge_u32 s2, 256
    s_cbranch_scc1 recurrent_scan__mha_block_cached__mixer_s_mlp__prompt_kernel_end
    s_load_dwordx2 s[4:5], s[0:1], 0
    s_load_dwordx2 s[34:35], s[0:1], 96
    s_load_dwordx2 s[6:7], s[0:1], 88
    s_load_dwordx2 s[42:43], s[0:1], 48
    s_load_dwordx2 s[62:63], s[0:1], 24
    s_load_dwordx2 s[64:65], s[0:1], 8
    s_load_dwordx2 s[66:67], s[0:1], 16
    v_and_b32 v1, 63, v0
    v_lshrrev_b32 v2, 6, v0
    v_and_b32 v20, 15, v1
    v_readfirstlane_b32 s3, v2
    v_lshrrev_b32 v21, 4, v1
    v_lshlrev_b32 v19, 4, v1
    s_and_b32 s38, s2, 7
    s_lshl_b32 s38, s38, 2
    s_lshr_b32 s39, s2, 3
    s_and_b32 s39, s39, 3
    s_add_u32 s38, s38, s39
    s_lshr_b32 s39, s2, 5
    v_lshrrev_b32 v64, 5, v1
    v_lshl_add_u32 v64, v2, 1, v64
    s_lshl_b32 s40, s2, 3
    v_add_u32 v64, s40, v64
    v_and_b32 v65, 31, v1
    v_lshlrev_b32 v66, 10, v64
    v_lshl_add_u32 v66, v65, 4, v66
    s_lshl_b32 s61, s3, 14
    s_add_u32 s61, s61, 98304
    v_lshrrev_b32 v22, 2, v20
    v_and_b32 v23, 3, v20
    v_lshl_add_u32 v24, v21, 2, v22
    v_lshrrev_b32 v25, 1, v24
    v_and_b32 v25, 3, v25
    v_lshlrev_b32 v24, 7, v24
    v_lshl_add_u32 v24, v23, 3, v24
    v_add_u32 v24, s61, v24
    v_xor_b32 v26, 0, v25
    v_lshl_add_u32 v228, v26, 5, v24
    v_xor_b32 v26, 1, v25
    v_lshl_add_u32 v229, v26, 5, v24
    v_xor_b32 v26, 2, v25
    v_lshl_add_u32 v230, v26, 5, v24
    v_xor_b32 v26, 3, v25
    v_lshl_add_u32 v231, v26, 5, v24
    v_lshrrev_b32 v24, 3, v1
    v_and_b32 v25, 7, v1
    v_lshlrev_b32 v26, 1, v21
    v_xor_b32 v25, v25, v26
    v_lshlrev_b32 v25, 4, v25
    v_lshl_add_u32 v232, v24, 10, v25
    s_waitcnt lgkmcnt(0)
    s_mov_b32 s20, s4
    s_mov_b32 s21, s5
    s_mov_b32 s22, 0x200000
    s_mov_b32 s23, 0x20000
    buffer_load_dwordx4 v[72:75], v66, s[20:23], 0 offen
    buffer_load_dwordx4 v[76:79], v66, s[20:23], 0 offen offset:512
    s_mov_b32 s48, s6
    s_mov_b32 s49, s7
    s_mov_b32 s50, 0x100
    s_mov_b32 s51, 0x20000
    s_cmp_lg_u32 s2, 0
    s_cbranch_scc1 L_nononce
    s_cmp_lg_u32 s3, 0
    s_cbranch_scc1 L_nononce
    s_or_b32 s40, s68, 1
    v_mov_b32 v30, s40
    v_mov_b32 v31, 0
    s_mov_b64 exec, 1
    buffer_store_dword v30, v31, s[48:51], 0 offen sc1
    s_mov_b64 exec, -1
L_nononce:
    v_mov_b32 v29, 0
    buffer_load_dword v28, v29, s[48:51], 0 offen sc1
    v_lshlrev_b32 v27, 6, v1
    s_lshl_b32 s40, s2, 2
    s_add_u32 s40, s40, s3
    s_lshl_b32 s40, s40, 12
    s_mov_b32 s56, s62
    s_mov_b32 s57, s63
    s_mov_b32 s58, 0x400000
    s_mov_b32 s59, 0x20000
    buffer_load_dword v3, v27, s[56:59], s40 offen
    v_mov_b32 v26, 0x80000000
    v_cmp_gt_u32 vcc, 8, v1
    s_lshr_b32 s40, s40, 3
    s_nop 0
    v_cndmask_b32 v27, v26, v27, vcc
    s_mov_b32 s16, s42
    s_mov_b32 s17, s43
    s_mov_b32 s18, 0x80000
    s_mov_b32 s19, 0x20000
    buffer_load_dword v3, v27, s[16:19], s40 offen
    s_lshl_b32 s40, s38, 8
    s_add_u32 s52, s62, s40
    s_addc_u32 s53, s63, 0
    s_sub_u32 s54, 0x400000, s40
    s_mov_b32 s55, 0x20000
    s_lshl_b32 s62, s3, 17
    s_lshl_b32 s40, s39, 7
    s_add_u32 s62, s62, s40
    s_add_u32 s44, s34, 0x2200000
    s_addc_u32 s45, s35, 0
    s_mov_b32 s46, 0x40000
    s_mov_b32 s47, 0x20000
    s_lshl_b32 s40, s38, 19
    s_add_u32 s8, s64, s40
    s_addc_u32 s9, s65, 0
    s_mov_b32 s10, 0x80000
    s_mov_b32 s11, 0x20000
    s_add_u32 s12, s66, s40
    s_addc_u32 s13, s67, 0
    s_mov_b32 s14, 0x80000
    s_mov_b32 s15, 0x20000
    s_load_dwordx2 s[66:67], s[0:1], 56
    s_load_dwordx2 s[4:5], s[0:1], 32
    s_load_dwordx2 s[6:7], s[0:1], 64
    s_load_dwordx2 s[64:65], s[0:1], 72
    v_lshrrev_b32 v22, 2, v20
    v_and_b32 v23, 3, v20
    v_lshl_add_u32 v24, v22, 3, v23
    v_lshlrev_b32 v24, 8, v24
    v_xor_b32 v25, v21, v20
    v_xor_b32 v26, 0, v25
    v_lshl_add_u32 v4, v26, 4, v24
    v_xor_b32 v26, 4, v25
    v_lshl_add_u32 v5, v26, 4, v24
    v_xor_b32 v26, 8, v25
    v_lshl_add_u32 v6, v26, 4, v24
    v_xor_b32 v26, 12, v25
    v_lshl_add_u32 v7, v26, 4, v24
    v_lshl_add_u32 v24, v21, 3, v22
    v_lshlrev_b32 v24, 8, v24
    v_lshl_add_u32 v24, v23, 3, v24
    v_and_b32 v25, 1, v21
    v_lshl_or_b32 v25, v25, 2, v22
    v_xor_b32 v26, 0, v25
    v_lshl_add_u32 v236, v26, 5, v24
    v_add_u32 v8, 65536, v236
    v_xor_b32 v26, 1, v25
    v_lshl_add_u32 v237, v26, 5, v24
    v_add_u32 v9, 65536, v237
    v_xor_b32 v26, 2, v25
    v_lshl_add_u32 v238, v26, 5, v24
    v_add_u32 v10, 65536, v238
    v_xor_b32 v26, 3, v25
    v_lshl_add_u32 v239, v26, 5, v24
    v_add_u32 v11, 65536, v239
    v_xor_b32 v26, 4, v25
    v_lshl_add_u32 v240, v26, 5, v24
    v_add_u32 v12, 65536, v240
    v_xor_b32 v26, 5, v25
    v_lshl_add_u32 v241, v26, 5, v24
    v_add_u32 v13, 65536, v241
    v_xor_b32 v26, 6, v25
    v_lshl_add_u32 v242, v26, 5, v24
    v_add_u32 v14, 65536, v242
    v_xor_b32 v26, 7, v25
    v_lshl_add_u32 v243, v26, 5, v24
    v_add_u32 v15, 65536, v243
    s_lshl_b32 s40, s3, 2
    v_or_b32 v25, s40, v21
    v_xor_b32 v25, v25, v20
    v_lshlrev_b32 v25, 4, v25
    v_lshl_add_u32 v25, v21, 8, v25
    s_lshl_b32 s41, s3, 11
    v_add_u32 v16, s41, v25
    s_and_b32 s40, s3, 1
    s_lshl_b32 s40, s40, 2
    v_or_b32 v25, s40, v21
    v_lshlrev_b32 v25, 1, v25
    v_xor_b32 v25, v25, v20
    v_lshlrev_b32 v25, 4, v25
    v_lshl_add_u32 v26, v21, 8, v25
    v_add_u32 v17, s41, v26
    v_lshl_add_u32 v27, v21, 13, v25
    s_lshl_b32 s42, s3, 16
    v_add_u32 v18, s42, v27
    s_add_u32 s30, s41, 0
    s_add_u32 s31, s41, 65536
    v_lshrrev_b32 v24, 5, v1
    v_lshl_add_u32 v24, v2, 1, v24
    v_mul_u32_u24 v24, 1040, v24
    v_lshl_add_u32 v67, v65, 4, v24
    v_and_b32 v24, 7, v1
    v_lshrrev_b32 v25, 3, v1
    v_lshl_add_u32 v25, v2, 4, v25
    v_mul_u32_u24 v26, 1040, v24
    v_lshl_add_u32 v68, v25, 4, v26
    v_lshrrev_b32 v27, 2, v25
    v_lshl_add_u32 v26, v27, 6, v26
    v_and_b32 v27, 3, v25
    v_lshl_add_u32 v69, v27, 3, v26
    s_lshr_b32 s40, s2, 1
    s_lshl_b32 s40, s40, 14
    s_and_b32 s41, s2, 1
    s_lshl_b32 s41, s41, 7
    s_add_u32 s40, s40, s41
    v_lshlrev_b32 v25, 8, v25
    v_lshl_add_u32 v25, v24, 4, v25
    v_add_u32 v70, s40, v25
    s_mov_b32 s24, s34
    s_mov_b32 s25, s35
    s_mov_b32 s26, 0x400000
    s_mov_b32 s27, 0x20000
    s_waitcnt vmcnt(3)
    v_lshlrev_b32 v80, 16, v72
    v_and_b32 v81, 0xffff0000, v72
    v_lshlrev_b32 v82, 16, v73
    v_and_b32 v83, 0xffff0000, v73
    v_lshlrev_b32 v84, 16, v74
    v_and_b32 v85, 0xffff0000, v74
    v_lshlrev_b32 v86, 16, v75
    v_and_b32 v87, 0xffff0000, v75
    v_lshlrev_b32 v88, 16, v76
    v_and_b32 v89, 0xffff0000, v76
    v_lshlrev_b32 v90, 16, v77
    v_and_b32 v91, 0xffff0000, v77
    v_lshlrev_b32 v92, 16, v78
    v_and_b32 v93, 0xffff0000, v78
    v_lshlrev_b32 v94, 16, v79
    v_and_b32 v95, 0xffff0000, v79
    v_pk_add_f32 v[98:99], v[80:81], v[82:83]
    v_pk_add_f32 v[98:99], v[98:99], v[84:85]
    v_pk_add_f32 v[98:99], v[98:99], v[86:87]
    v_pk_add_f32 v[98:99], v[98:99], v[88:89]
    v_pk_add_f32 v[98:99], v[98:99], v[90:91]
    v_pk_add_f32 v[98:99], v[98:99], v[92:93]
    v_pk_add_f32 v[98:99], v[98:99], v[94:95]
    v_add_f32 v96, v98, v99
    s_nop 1
    v_add_f32 v96, v96, v96 row_ror:8 row_mask:0xf bank_mask:0xf
    s_nop 1
    v_add_f32 v96, v96, v96 row_ror:4 row_mask:0xf bank_mask:0xf
    s_nop 1
    v_add_f32 v96, v96, v96 row_ror:2 row_mask:0xf bank_mask:0xf
    s_nop 1
    v_add_f32 v96, v96, v96 row_ror:1 row_mask:0xf bank_mask:0xf
    v_mov_b32 v98, v96
    s_nop 1
    v_permlane16_swap_b32 v96, v98
    v_add_f32 v96, v96, v98
    v_mul_f32 v96, 0x3b000000, v96
    v_pk_add_f32 v[98:99], v[80:81], v[96:97] op_sel:[0,0] op_sel_hi:[1,0] neg_lo:[0,1] neg_hi:[0,1]
    v_pk_mul_f32 v[100:101], v[98:99], v[98:99]
    v_pk_add_f32 v[98:99], v[82:83], v[96:97] op_sel:[0,0] op_sel_hi:[1,0] neg_lo:[0,1] neg_hi:[0,1]
    v_pk_fma_f32 v[100:101], v[98:99], v[98:99], v[100:101]
    v_pk_add_f32 v[98:99], v[84:85], v[96:97] op_sel:[0,0] op_sel_hi:[1,0] neg_lo:[0,1] neg_hi:[0,1]
    v_pk_fma_f32 v[100:101], v[98:99], v[98:99], v[100:101]
    v_pk_add_f32 v[98:99], v[86:87], v[96:97] op_sel:[0,0] op_sel_hi:[1,0] neg_lo:[0,1] neg_hi:[0,1]
    v_pk_fma_f32 v[100:101], v[98:99], v[98:99], v[100:101]
    v_pk_add_f32 v[98:99], v[88:89], v[96:97] op_sel:[0,0] op_sel_hi:[1,0] neg_lo:[0,1] neg_hi:[0,1]
    v_pk_fma_f32 v[100:101], v[98:99], v[98:99], v[100:101]
    v_pk_add_f32 v[98:99], v[90:91], v[96:97] op_sel:[0,0] op_sel_hi:[1,0] neg_lo:[0,1] neg_hi:[0,1]
    v_pk_fma_f32 v[100:101], v[98:99], v[98:99], v[100:101]
    v_pk_add_f32 v[98:99], v[92:93], v[96:97] op_sel:[0,0] op_sel_hi:[1,0] neg_lo:[0,1] neg_hi:[0,1]
    v_pk_fma_f32 v[100:101], v[98:99], v[98:99], v[100:101]
    v_pk_add_f32 v[98:99], v[94:95], v[96:97] op_sel:[0,0] op_sel_hi:[1,0] neg_lo:[0,1] neg_hi:[0,1]
    v_pk_fma_f32 v[100:101], v[98:99], v[98:99], v[100:101]
    v_add_f32 v97, v100, v101
    s_nop 1
    v_add_f32 v97, v97, v97 row_ror:8 row_mask:0xf bank_mask:0xf
    s_nop 1
    v_add_f32 v97, v97, v97 row_ror:4 row_mask:0xf bank_mask:0xf
    s_nop 1
    v_add_f32 v97, v97, v97 row_ror:2 row_mask:0xf bank_mask:0xf
    s_nop 1
    v_add_f32 v97, v97, v97 row_ror:1 row_mask:0xf bank_mask:0xf
    v_mov_b32 v98, v97
    s_nop 1
    v_permlane16_swap_b32 v97, v98
    v_add_f32 v97, v97, v98
    v_mul_f32 v97, 0x3b000000, v97
    v_cvt_pk_bf16_f32 v100, v96, v96
    v_and_b32 v100, 0xffff0000, v100
    v_cvt_pk_bf16_f32 v97, v97, v97
    v_and_b32 v97, 0xffff0000, v97
    v_add_f32 v97, 0x3727c5ac, v97
    v_cvt_pk_bf16_f32 v97, v97, v97
    v_and_b32 v97, 0xffff0000, v97
    v_sqrt_f32 v97, v97
    s_nop 0
    v_cvt_pk_bf16_f32 v97, v97, v97
    v_and_b32 v97, 0xffff0000, v97
    v_rcp_f32 v97, v97
    v_pk_add_f32 v[80:81], v[80:81], v[100:101] op_sel:[0,0] op_sel_hi:[1,0] neg_lo:[0,1] neg_hi:[0,1]
    v_pk_add_f32 v[82:83], v[82:83], v[100:101] op_sel:[0,0] op_sel_hi:[1,0] neg_lo:[0,1] neg_hi:[0,1]
    v_pk_add_f32 v[84:85], v[84:85], v[100:101] op_sel:[0,0] op_sel_hi:[1,0] neg_lo:[0,1] neg_hi:[0,1]
    v_pk_add_f32 v[86:87], v[86:87], v[100:101] op_sel:[0,0] op_sel_hi:[1,0] neg_lo:[0,1] neg_hi:[0,1]
    v_pk_add_f32 v[88:89], v[88:89], v[100:101] op_sel:[0,0] op_sel_hi:[1,0] neg_lo:[0,1] neg_hi:[0,1]
    v_pk_add_f32 v[90:91], v[90:91], v[100:101] op_sel:[0,0] op_sel_hi:[1,0] neg_lo:[0,1] neg_hi:[0,1]
    v_pk_add_f32 v[92:93], v[92:93], v[100:101] op_sel:[0,0] op_sel_hi:[1,0] neg_lo:[0,1] neg_hi:[0,1]
    v_pk_add_f32 v[94:95], v[94:95], v[100:101] op_sel:[0,0] op_sel_hi:[1,0] neg_lo:[0,1] neg_hi:[0,1]
    v_cvt_pk_bf16_f32 v72, v80, v81
    v_cvt_pk_bf16_f32 v73, v82, v83
    v_cvt_pk_bf16_f32 v74, v84, v85
    v_cvt_pk_bf16_f32 v75, v86, v87
    v_cvt_pk_bf16_f32 v76, v88, v89
    v_cvt_pk_bf16_f32 v77, v90, v91
    v_cvt_pk_bf16_f32 v78, v92, v93
    v_cvt_pk_bf16_f32 v79, v94, v95
    v_lshlrev_b32 v80, 16, v72
    v_and_b32 v81, 0xffff0000, v72
    v_lshlrev_b32 v82, 16, v73
    v_and_b32 v83, 0xffff0000, v73
    v_lshlrev_b32 v84, 16, v74
    v_and_b32 v85, 0xffff0000, v74
    v_lshlrev_b32 v86, 16, v75
    v_and_b32 v87, 0xffff0000, v75
    v_lshlrev_b32 v88, 16, v76
    v_and_b32 v89, 0xffff0000, v76
    v_lshlrev_b32 v90, 16, v77
    v_and_b32 v91, 0xffff0000, v77
    v_lshlrev_b32 v92, 16, v78
    v_and_b32 v93, 0xffff0000, v78
    v_lshlrev_b32 v94, 16, v79
    v_and_b32 v95, 0xffff0000, v79
    v_pk_mul_f32 v[80:81], v[80:81], v[96:97] op_sel:[0,1] op_sel_hi:[1,1]
    v_pk_mul_f32 v[82:83], v[82:83], v[96:97] op_sel:[0,1] op_sel_hi:[1,1]
    v_pk_mul_f32 v[84:85], v[84:85], v[96:97] op_sel:[0,1] op_sel_hi:[1,1]
    v_pk_mul_f32 v[86:87], v[86:87], v[96:97] op_sel:[0,1] op_sel_hi:[1,1]
    v_pk_mul_f32 v[88:89], v[88:89], v[96:97] op_sel:[0,1] op_sel_hi:[1,1]
    v_pk_mul_f32 v[90:91], v[90:91], v[96:97] op_sel:[0,1] op_sel_hi:[1,1]
    v_pk_mul_f32 v[92:93], v[92:93], v[96:97] op_sel:[0,1] op_sel_hi:[1,1]
    v_pk_mul_f32 v[94:95], v[94:95], v[96:97] op_sel:[0,1] op_sel_hi:[1,1]
    v_cvt_pk_bf16_f32 v72, v80, v81
    v_cvt_pk_bf16_f32 v73, v82, v83
    v_cvt_pk_bf16_f32 v74, v84, v85
    v_cvt_pk_bf16_f32 v75, v86, v87
    v_cvt_pk_bf16_f32 v76, v88, v89
    v_cvt_pk_bf16_f32 v77, v90, v91
    v_cvt_pk_bf16_f32 v78, v92, v93
    v_cvt_pk_bf16_f32 v79, v94, v95
    ds_write_b128 v67, v[72:75]
    ds_write_b128 v67, v[76:79] offset:512
    s_nop 1
    v_lshlrev_b32 v80, 16, v72
    v_and_b32 v81, 0xffff0000, v72
    v_lshlrev_b32 v82, 16, v73
    v_and_b32 v83, 0xffff0000, v73
    v_lshlrev_b32 v84, 16, v74
    v_and_b32 v85, 0xffff0000, v74
    v_lshlrev_b32 v86, 16, v75
    v_and_b32 v87, 0xffff0000, v75
    v_lshlrev_b32 v88, 16, v76
    v_and_b32 v89, 0xffff0000, v76
    v_lshlrev_b32 v90, 16, v77
    v_and_b32 v91, 0xffff0000, v77
    v_lshlrev_b32 v92, 16, v78
    v_and_b32 v93, 0xffff0000, v78
    v_lshlrev_b32 v94, 16, v79
    v_and_b32 v95, 0xffff0000, v79
    v_pk_add_f32 v[98:99], v[80:81], v[82:83]
    v_pk_add_f32 v[98:99], v[98:99], v[84:85]
    v_pk_add_f32 v[98:99], v[98:99], v[86:87]
    v_pk_add_f32 v[98:99], v[98:99], v[88:89]
    v_pk_add_f32 v[98:99], v[98:99], v[90:91]
    v_pk_add_f32 v[98:99], v[98:99], v[92:93]
    v_pk_add_f32 v[98:99], v[98:99], v[94:95]
    v_add_f32 v96, v98, v99
    s_nop 1
    v_add_f32 v96, v96, v96 row_ror:8 row_mask:0xf bank_mask:0xf
    s_nop 1
    v_add_f32 v96, v96, v96 row_ror:4 row_mask:0xf bank_mask:0xf
    s_nop 1
    v_add_f32 v96, v96, v96 row_ror:2 row_mask:0xf bank_mask:0xf
    s_nop 1
    v_add_f32 v96, v96, v96 row_ror:1 row_mask:0xf bank_mask:0xf
    v_mov_b32 v98, v96
    s_nop 1
    v_permlane16_swap_b32 v96, v98
    v_add_f32 v96, v96, v98
    v_mul_f32 v96, 0x3b000000, v96
    v_pk_add_f32 v[98:99], v[80:81], v[96:97] op_sel:[0,0] op_sel_hi:[1,0] neg_lo:[0,1] neg_hi:[0,1]
    v_pk_mul_f32 v[100:101], v[98:99], v[98:99]
    v_pk_add_f32 v[98:99], v[82:83], v[96:97] op_sel:[0,0] op_sel_hi:[1,0] neg_lo:[0,1] neg_hi:[0,1]
    v_pk_fma_f32 v[100:101], v[98:99], v[98:99], v[100:101]
    v_pk_add_f32 v[98:99], v[84:85], v[96:97] op_sel:[0,0] op_sel_hi:[1,0] neg_lo:[0,1] neg_hi:[0,1]
    v_pk_fma_f32 v[100:101], v[98:99], v[98:99], v[100:101]
    v_pk_add_f32 v[98:99], v[86:87], v[96:97] op_sel:[0,0] op_sel_hi:[1,0] neg_lo:[0,1] neg_hi:[0,1]
    v_pk_fma_f32 v[100:101], v[98:99], v[98:99], v[100:101]
    v_pk_add_f32 v[98:99], v[88:89], v[96:97] op_sel:[0,0] op_sel_hi:[1,0] neg_lo:[0,1] neg_hi:[0,1]
    v_pk_fma_f32 v[100:101], v[98:99], v[98:99], v[100:101]
    v_pk_add_f32 v[98:99], v[90:91], v[96:97] op_sel:[0,0] op_sel_hi:[1,0] neg_lo:[0,1] neg_hi:[0,1]
    v_pk_fma_f32 v[100:101], v[98:99], v[98:99], v[100:101]
    v_pk_add_f32 v[98:99], v[92:93], v[96:97] op_sel:[0,0] op_sel_hi:[1,0] neg_lo:[0,1] neg_hi:[0,1]
    v_pk_fma_f32 v[100:101], v[98:99], v[98:99], v[100:101]
    v_pk_add_f32 v[98:99], v[94:95], v[96:97] op_sel:[0,0] op_sel_hi:[1,0] neg_lo:[0,1] neg_hi:[0,1]
    v_pk_fma_f32 v[100:101], v[98:99], v[98:99], v[100:101]
    v_add_f32 v97, v100, v101
    s_nop 1
    v_add_f32 v97, v97, v97 row_ror:8 row_mask:0xf bank_mask:0xf
    s_nop 1
    v_add_f32 v97, v97, v97 row_ror:4 row_mask:0xf bank_mask:0xf
    s_nop 1
    v_add_f32 v97, v97, v97 row_ror:2 row_mask:0xf bank_mask:0xf
    s_nop 1
    v_add_f32 v97, v97, v97 row_ror:1 row_mask:0xf bank_mask:0xf
    v_mov_b32 v98, v97
    s_nop 1
    v_permlane16_swap_b32 v97, v98
    v_add_f32 v97, v97, v98
    v_mul_f32 v97, 0x3b000000, v97
    v_cvt_pk_bf16_f32 v100, v96, v96
    v_and_b32 v100, 0xffff0000, v100
    v_cvt_pk_bf16_f32 v97, v97, v97
    v_and_b32 v97, 0xffff0000, v97
    v_add_f32 v97, 0x3727c5ac, v97
    v_cvt_pk_bf16_f32 v97, v97, v97
    v_and_b32 v97, 0xffff0000, v97
    v_sqrt_f32 v97, v97
    s_nop 0
    v_cvt_pk_bf16_f32 v97, v97, v97
    v_and_b32 v97, 0xffff0000, v97
    v_rcp_f32 v97, v97
    v_pk_add_f32 v[80:81], v[80:81], v[100:101] op_sel:[0,0] op_sel_hi:[1,0] neg_lo:[0,1] neg_hi:[0,1]
    v_pk_add_f32 v[82:83], v[82:83], v[100:101] op_sel:[0,0] op_sel_hi:[1,0] neg_lo:[0,1] neg_hi:[0,1]
    v_pk_add_f32 v[84:85], v[84:85], v[100:101] op_sel:[0,0] op_sel_hi:[1,0] neg_lo:[0,1] neg_hi:[0,1]
    v_pk_add_f32 v[86:87], v[86:87], v[100:101] op_sel:[0,0] op_sel_hi:[1,0] neg_lo:[0,1] neg_hi:[0,1]
    v_pk_add_f32 v[88:89], v[88:89], v[100:101] op_sel:[0,0] op_sel_hi:[1,0] neg_lo:[0,1] neg_hi:[0,1]
    v_pk_add_f32 v[90:91], v[90:91], v[100:101] op_sel:[0,0] op_sel_hi:[1,0] neg_lo:[0,1] neg_hi:[0,1]
    v_pk_add_f32 v[92:93], v[92:93], v[100:101] op_sel:[0,0] op_sel_hi:[1,0] neg_lo:[0,1] neg_hi:[0,1]
    v_pk_add_f32 v[94:95], v[94:95], v[100:101] op_sel:[0,0] op_sel_hi:[1,0] neg_lo:[0,1] neg_hi:[0,1]
    v_cvt_pk_bf16_f32 v72, v80, v81
    v_cvt_pk_bf16_f32 v73, v82, v83
    v_cvt_pk_bf16_f32 v74, v84, v85
    v_cvt_pk_bf16_f32 v75, v86, v87
    v_cvt_pk_bf16_f32 v76, v88, v89
    v_cvt_pk_bf16_f32 v77, v90, v91
    v_cvt_pk_bf16_f32 v78, v92, v93
    v_cvt_pk_bf16_f32 v79, v94, v95
    v_lshlrev_b32 v80, 16, v72
    v_and_b32 v81, 0xffff0000, v72
    v_lshlrev_b32 v82, 16, v73
    v_and_b32 v83, 0xffff0000, v73
    v_lshlrev_b32 v84, 16, v74
    v_and_b32 v85, 0xffff0000, v74
    v_lshlrev_b32 v86, 16, v75
    v_and_b32 v87, 0xffff0000, v75
    v_lshlrev_b32 v88, 16, v76
    v_and_b32 v89, 0xffff0000, v76
    v_lshlrev_b32 v90, 16, v77
    v_and_b32 v91, 0xffff0000, v77
    v_lshlrev_b32 v92, 16, v78
    v_and_b32 v93, 0xffff0000, v78
    v_lshlrev_b32 v94, 16, v79
    v_and_b32 v95, 0xffff0000, v79
    v_pk_mul_f32 v[80:81], v[80:81], v[96:97] op_sel:[0,1] op_sel_hi:[1,1]
    v_pk_mul_f32 v[82:83], v[82:83], v[96:97] op_sel:[0,1] op_sel_hi:[1,1]
    v_pk_mul_f32 v[84:85], v[84:85], v[96:97] op_sel:[0,1] op_sel_hi:[1,1]
    v_pk_mul_f32 v[86:87], v[86:87], v[96:97] op_sel:[0,1] op_sel_hi:[1,1]
    v_pk_mul_f32 v[88:89], v[88:89], v[96:97] op_sel:[0,1] op_sel_hi:[1,1]
    v_pk_mul_f32 v[90:91], v[90:91], v[96:97] op_sel:[0,1] op_sel_hi:[1,1]
    v_pk_mul_f32 v[92:93], v[92:93], v[96:97] op_sel:[0,1] op_sel_hi:[1,1]
    v_pk_mul_f32 v[94:95], v[94:95], v[96:97] op_sel:[0,1] op_sel_hi:[1,1]
    v_cvt_pk_bf16_f32 v72, v80, v81
    v_cvt_pk_bf16_f32 v73, v82, v83
    v_cvt_pk_bf16_f32 v74, v84, v85
    v_cvt_pk_bf16_f32 v75, v86, v87
    v_cvt_pk_bf16_f32 v76, v88, v89
    v_cvt_pk_bf16_f32 v77, v90, v91
    v_cvt_pk_bf16_f32 v78, v92, v93
    v_cvt_pk_bf16_f32 v79, v94, v95
    ds_write_b128 v67, v[72:75] offset:8320
    ds_write_b128 v67, v[76:79] offset:8832
    s_waitcnt lgkmcnt(0)
    s_barrier
    ds_read_b128 v[80:83], v68
    ds_read_b128 v[84:87], v68 offset:128
    v_add_u32 v24, 8320, v69
    ds_read2_b64 v[88:91], v24 offset0:0 offset1:4
    ds_read2_b64 v[92:95], v24 offset0:16 offset1:20
    s_mov_b32 s40, 2048
    s_mov_b32 s41, 0x200000
    s_mov_b32 s43, 0x200800
    s_waitcnt lgkmcnt(2)
    buffer_store_dwordx4 v[80:83], v70, s[24:27], 0 offen sc1
    buffer_store_dwordx4 v[84:87], v70, s[24:27], s40 offen sc1
    s_waitcnt lgkmcnt(0)
    buffer_store_dwordx4 v[88:91], v70, s[24:27], s41 offen sc1
    buffer_store_dwordx4 v[92:95], v70, s[24:27], s43 offen sc1
    s_waitcnt lgkmcnt(0)
    s_lshl_b32 s41, s38, 16
    s_add_u32 s20, s34, 0x200000
    s_addc_u32 s21, s35, 0
    s_add_u32 s20, s20, s41
    s_addc_u32 s21, s21, 0
    s_mov_b32 s22, 0x10000
    s_mov_b32 s23, 0x20000
    s_lshl_b32 s40, s3, 12
    v_add_u32 v233, s40, v19
    s_lshl_b32 s40, s39, 4
    s_lshl_b32 s41, s3, 2
    s_add_u32 s40, s40, s41
    s_lshl_b32 s41, s40, 14
    s_add_u32 s56, s34, s41
    s_addc_u32 s57, s35, 0
    s_mov_b32 s58, 0x10000
    s_mov_b32 s59, 0x20000
    s_waitcnt vmcnt(0)
    v_readfirstlane_b32 s36, v28
    s_mov_b32 s37, 0
L_nonce_chk:
    s_cmp_eq_u32 s36, 0
    s_cbranch_scc1 L_nonce_spin
    s_sub_u32 s40, s68, s36
    s_add_u32 s40, s40, 4096
    s_cmp_lt_u32 s40, 8192
    s_cbranch_scc1 L_nonce_ok
    s_cmp_gt_u32 s37, 512
    s_cbranch_scc1 L_nonce_ok
L_nonce_spin:
    buffer_load_dword v28, v29, s[48:51], 0 offen sc1
    s_add_u32 s37, s37, 1
    s_cmp_gt_u32 s37, 0x20000
    s_cbranch_scc1 recurrent_scan__mha_block_cached__mixer_s_mlp__prompt_kernel_end
    s_waitcnt vmcnt(0)
    v_readfirstlane_b32 s36, v28
    s_branch L_nonce_chk
L_nonce_ok:
    s_barrier
    s_cmp_lg_u32 s3, 0
    s_cbranch_scc1 L_pub_f0
    s_lshl_b32 s60, s2, 7
    s_add_u32 s60, s60, 0
    v_mov_b32 v30, s60
    v_mov_b32 v31, s36
    s_mov_b64 exec, 1
    buffer_store_dword v31, v30, s[44:47], 0 offen sc1
    s_mov_b64 exec, -1
L_pub_f0:
    s_lshl_b32 s40, s38, 3
    v_min_u32 v29, 7, v1
    v_add_u32 v29, s40, v29
    v_lshlrev_b32 v29, 7, v29
    buffer_load_dword v28, v29, s[44:47], 0 offen sc1
    s_lshl_b32 s40, s39, 5
    v_min_u32 v31, 31, v1
    v_add_u32 v31, s40, v31
    v_lshlrev_b32 v31, 7, v31
    buffer_load_dword v30, v31, s[44:47], 0 offen sc1
    v_mov_b32 v164, 0
    s_add_u32 m0, s61, 0
    s_add_u32 s63, s62, 0
    buffer_load_dwordx4 v232, s[16:19], s63 offen lds
    v_mov_b32 v165, 0
    v_mov_b32 v166, 0
    v_mov_b32 v167, 0
    v_mov_b32 v168, 0
    v_mov_b32 v169, 0
    v_mov_b32 v170, 0
    v_mov_b32 v171, 0
    v_mov_b32 v172, 0
    v_mov_b32 v173, 0
    v_mov_b32 v174, 0
    v_mov_b32 v175, 0
    s_add_u32 m0, s61, 1024
    s_add_u32 s63, s62, 8192
    buffer_load_dwordx4 v232, s[16:19], s63 offen lds
    v_mov_b32 v176, 0
    v_mov_b32 v177, 0
    v_mov_b32 v178, 0
    v_mov_b32 v179, 0
    v_mov_b32 v180, 0
    v_mov_b32 v181, 0
    v_mov_b32 v182, 0
    v_mov_b32 v183, 0
    v_mov_b32 v184, 0
    v_mov_b32 v185, 0
    v_mov_b32 v186, 0
    s_add_u32 m0, s61, 2048
    s_add_u32 s63, s62, 16384
    buffer_load_dwordx4 v232, s[16:19], s63 offen lds
    v_mov_b32 v187, 0
    v_mov_b32 v188, 0
    v_mov_b32 v189, 0
    v_mov_b32 v190, 0
    v_mov_b32 v191, 0
    v_mov_b32 v192, 0
    v_mov_b32 v193, 0
    v_mov_b32 v194, 0
    v_mov_b32 v195, 0
    v_mov_b32 v196, 0
    v_mov_b32 v197, 0
    s_add_u32 m0, s61, 3072
    s_add_u32 s63, s62, 24576
    buffer_load_dwordx4 v232, s[16:19], s63 offen lds
    v_mov_b32 v198, 0
    v_mov_b32 v199, 0
    v_mov_b32 v200, 0
    v_mov_b32 v201, 0
    v_mov_b32 v202, 0
    v_mov_b32 v203, 0
    v_mov_b32 v204, 0
    v_mov_b32 v205, 0
    v_mov_b32 v206, 0
    v_mov_b32 v207, 0
    v_mov_b32 v208, 0
    s_add_u32 m0, s61, 4096
    s_add_u32 s63, s62, 32768
    buffer_load_dwordx4 v232, s[16:19], s63 offen lds
    v_mov_b32 v209, 0
    v_mov_b32 v210, 0
    v_mov_b32 v211, 0
    v_mov_b32 v212, 0
    v_mov_b32 v213, 0
    v_mov_b32 v214, 0
    v_mov_b32 v215, 0
    v_mov_b32 v216, 0
    v_mov_b32 v217, 0
    v_mov_b32 v218, 0
    v_mov_b32 v219, 0
    s_add_u32 m0, s61, 5120
    s_add_u32 s63, s62, 40960
    buffer_load_dwordx4 v232, s[16:19], s63 offen lds
    v_mov_b32 v220, 0
    v_mov_b32 v221, 0
    v_mov_b32 v222, 0
    v_mov_b32 v223, 0
    v_mov_b32 v224, 0
    v_mov_b32 v225, 0
    v_mov_b32 v226, 0
    v_mov_b32 v227, 0
    v_accvgpr_write_b32 a0, 0
    v_accvgpr_write_b32 a1, 0
    v_accvgpr_write_b32 a2, 0
    s_add_u32 m0, s61, 6144
    s_add_u32 s63, s62, 49152
    buffer_load_dwordx4 v232, s[16:19], s63 offen lds
    v_accvgpr_write_b32 a3, 0
    v_accvgpr_write_b32 a4, 0
    v_accvgpr_write_b32 a5, 0
    v_accvgpr_write_b32 a6, 0
    v_accvgpr_write_b32 a7, 0
    v_accvgpr_write_b32 a8, 0
    v_accvgpr_write_b32 a9, 0
    v_accvgpr_write_b32 a10, 0
    v_accvgpr_write_b32 a11, 0
    v_accvgpr_write_b32 a12, 0
    v_accvgpr_write_b32 a13, 0
    s_add_u32 m0, s61, 7168
    s_add_u32 s63, s62, 57344
    buffer_load_dwordx4 v232, s[16:19], s63 offen lds
    v_accvgpr_write_b32 a14, 0
    v_accvgpr_write_b32 a15, 0
    v_accvgpr_write_b32 a16, 0
    v_accvgpr_write_b32 a17, 0
    v_accvgpr_write_b32 a18, 0
    v_accvgpr_write_b32 a19, 0
    v_accvgpr_write_b32 a20, 0
    v_accvgpr_write_b32 a21, 0
    v_accvgpr_write_b32 a22, 0
    v_accvgpr_write_b32 a23, 0
    v_accvgpr_write_b32 a24, 0
    s_add_u32 m0, s61, 8192
    s_add_u32 s63, s62, 65536
    buffer_load_dwordx4 v232, s[16:19], s63 offen lds
    v_accvgpr_write_b32 a25, 0
    v_accvgpr_write_b32 a26, 0
    v_accvgpr_write_b32 a27, 0
    v_accvgpr_write_b32 a28, 0
    v_accvgpr_write_b32 a29, 0
    v_accvgpr_write_b32 a30, 0
    v_accvgpr_write_b32 a31, 0
    v_accvgpr_write_b32 a32, 0
    v_accvgpr_write_b32 a33, 0
    v_accvgpr_write_b32 a34, 0
    v_accvgpr_write_b32 a35, 0
    s_add_u32 m0, s61, 9216
    s_add_u32 s63, s62, 73728
    buffer_load_dwordx4 v232, s[16:19], s63 offen lds
    v_accvgpr_write_b32 a36, 0
    v_accvgpr_write_b32 a37, 0
    v_accvgpr_write_b32 a38, 0
    v_accvgpr_write_b32 a39, 0
    v_accvgpr_write_b32 a40, 0
    v_accvgpr_write_b32 a41, 0
    v_accvgpr_write_b32 a42, 0
    v_accvgpr_write_b32 a43, 0
    v_accvgpr_write_b32 a44, 0
    v_accvgpr_write_b32 a45, 0
    v_accvgpr_write_b32 a46, 0
    s_add_u32 m0, s61, 10240
    s_add_u32 s63, s62, 81920
    buffer_load_dwordx4 v232, s[16:19], s63 offen lds
    v_accvgpr_write_b32 a47, 0
    v_accvgpr_write_b32 a48, 0
    v_accvgpr_write_b32 a49, 0
    v_accvgpr_write_b32 a50, 0
    v_accvgpr_write_b32 a51, 0
    v_accvgpr_write_b32 a52, 0
    v_accvgpr_write_b32 a53, 0
    v_accvgpr_write_b32 a54, 0
    v_accvgpr_write_b32 a55, 0
    v_accvgpr_write_b32 a56, 0
    v_accvgpr_write_b32 a57, 0
    s_add_u32 m0, s61, 11264
    s_add_u32 s63, s62, 90112
    buffer_load_dwordx4 v232, s[16:19], s63 offen lds
    v_accvgpr_write_b32 a58, 0
    v_accvgpr_write_b32 a59, 0
    v_accvgpr_write_b32 a60, 0
    v_accvgpr_write_b32 a61, 0
    v_accvgpr_write_b32 a62, 0
    v_accvgpr_write_b32 a63, 0
    v_accvgpr_write_b32 a64, 0
    v_accvgpr_write_b32 a65, 0
    v_accvgpr_write_b32 a66, 0
    v_accvgpr_write_b32 a67, 0
    v_accvgpr_write_b32 a68, 0
    s_add_u32 m0, s61, 12288
    s_add_u32 s63, s62, 98304
    buffer_load_dwordx4 v232, s[16:19], s63 offen lds
    v_accvgpr_write_b32 a69, 0
    v_accvgpr_write_b32 a70, 0
    v_accvgpr_write_b32 a71, 0
    v_accvgpr_write_b32 a72, 0
    v_accvgpr_write_b32 a73, 0
    v_accvgpr_write_b32 a74, 0
    v_accvgpr_write_b32 a75, 0
    v_accvgpr_write_b32 a76, 0
    v_accvgpr_write_b32 a77, 0
    v_accvgpr_write_b32 a78, 0
    v_accvgpr_write_b32 a79, 0
    s_add_u32 m0, s61, 13312
    s_add_u32 s63, s62, 106496
    buffer_load_dwordx4 v232, s[16:19], s63 offen lds
    v_accvgpr_write_b32 a80, 0
    v_accvgpr_write_b32 a81, 0
    v_accvgpr_write_b32 a82, 0
    v_accvgpr_write_b32 a83, 0
    v_accvgpr_write_b32 a84, 0
    v_accvgpr_write_b32 a85, 0
    v_accvgpr_write_b32 a86, 0
    v_accvgpr_write_b32 a87, 0
    v_accvgpr_write_b32 a88, 0
    v_accvgpr_write_b32 a89, 0
    v_accvgpr_write_b32 a90, 0
    s_add_u32 m0, s61, 14336
    s_add_u32 s63, s62, 114688
    buffer_load_dwordx4 v232, s[16:19], s63 offen lds
    v_accvgpr_write_b32 a91, 0
    v_accvgpr_write_b32 a92, 0
    v_accvgpr_write_b32 a93, 0
    v_accvgpr_write_b32 a94, 0
    v_accvgpr_write_b32 a95, 0
    v_accvgpr_write_b32 a96, 0
    v_accvgpr_write_b32 a97, 0
    v_accvgpr_write_b32 a98, 0
    v_accvgpr_write_b32 a99, 0
    v_accvgpr_write_b32 a100, 0
    v_accvgpr_write_b32 a101, 0
    s_add_u32 m0, s61, 15360
    s_add_u32 s63, s62, 122880
    buffer_load_dwordx4 v232, s[16:19], s63 offen lds
    v_accvgpr_write_b32 a102, 0
    v_accvgpr_write_b32 a103, 0
    v_accvgpr_write_b32 a104, 0
    v_accvgpr_write_b32 a105, 0
    v_accvgpr_write_b32 a106, 0
    v_accvgpr_write_b32 a107, 0
    v_accvgpr_write_b32 a108, 0
    v_accvgpr_write_b32 a109, 0
    v_accvgpr_write_b32 a110, 0
    v_accvgpr_write_b32 a111, 0
    v_accvgpr_write_b32 a112, 0
    v_accvgpr_write_b32 a113, 0
    v_accvgpr_write_b32 a114, 0
    v_accvgpr_write_b32 a115, 0
    v_accvgpr_write_b32 a116, 0
    v_accvgpr_write_b32 a117, 0
    v_accvgpr_write_b32 a118, 0
    v_accvgpr_write_b32 a119, 0
    v_accvgpr_write_b32 a120, 0
    v_accvgpr_write_b32 a121, 0
    v_accvgpr_write_b32 a122, 0
    v_accvgpr_write_b32 a123, 0
    v_accvgpr_write_b32 a124, 0
    v_accvgpr_write_b32 a125, 0
    v_accvgpr_write_b32 a126, 0
    v_accvgpr_write_b32 a127, 0
    v_lshlrev_b32 v26, 6, v1
    s_lshr_b32 s40, s2, 3
    s_lshl_b32 s40, s40, 2
    s_add_u32 s40, s40, s3
    s_lshl_b32 s40, s40, 12
    s_mov_b32 s48, s66
    s_mov_b32 s49, s67
    s_mov_b32 s50, 0x80000
    s_mov_b32 s51, 0x20000
    buffer_load_dword v3, v26, s[48:51], s40 offen
    s_waitcnt vmcnt(18)
    v_cmp_ne_u32 vcc, s36, v28
    s_nop 4
    s_cmp_eq_u64 vcc, 0
    s_cbranch_scc1 L_pok_f0a
    s_mov_b32 s37, 0
L_spin_f0a:
    buffer_load_dword v28, v29, s[44:47], 0 offen sc1
    s_add_u32 s37, s37, 1
    s_cmp_gt_u32 s37, 0x20000
    s_cbranch_scc1 recurrent_scan__mha_block_cached__mixer_s_mlp__prompt_kernel_end
    s_waitcnt vmcnt(0)
    v_cmp_ne_u32 vcc, s36, v28
    s_nop 4
    s_cmp_lg_u64 vcc, 0
    s_cbranch_scc1 L_spin_f0a
L_pok_f0a:
    s_mov_b32 s33, 0
    buffer_load_dwordx4 a[192:195], v233, s[20:23], s33 offen sc1
    s_mov_b32 s33, 16384
    buffer_load_dwordx4 a[196:199], v233, s[20:23], s33 offen sc1
    s_mov_b32 s33, 32768
    buffer_load_dwordx4 a[200:203], v233, s[20:23], s33 offen sc1
    s_mov_b32 s33, 49152
    buffer_load_dwordx4 a[204:207], v233, s[20:23], s33 offen sc1
    s_mov_b32 s33, 1024
    buffer_load_dwordx4 a[208:211], v233, s[20:23], s33 offen sc1
    s_mov_b32 s33, 17408
    buffer_load_dwordx4 a[212:215], v233, s[20:23], s33 offen sc1
    s_mov_b32 s33, 33792
    buffer_load_dwordx4 a[216:219], v233, s[20:23], s33 offen sc1
    s_mov_b32 s33, 50176
    buffer_load_dwordx4 a[220:223], v233, s[20:23], s33 offen sc1
    s_mov_b32 s33, 2048
    buffer_load_dwordx4 a[224:227], v233, s[20:23], s33 offen sc1
    s_mov_b32 s33, 18432
    buffer_load_dwordx4 a[228:231], v233, s[20:23], s33 offen sc1
    s_mov_b32 s33, 34816
    buffer_load_dwordx4 a[232:235], v233, s[20:23], s33 offen sc1
    s_mov_b32 s33, 51200
    buffer_load_dwordx4 a[236:239], v233, s[20:23], s33 offen sc1
    s_mov_b32 s33, 3072
    buffer_load_dwordx4 a[240:243], v233, s[20:23], s33 offen sc1
    s_mov_b32 s33, 19456
    buffer_load_dwordx4 a[244:247], v233, s[20:23], s33 offen sc1
    s_mov_b32 s33, 35840
    buffer_load_dwordx4 a[248:251], v233, s[20:23], s33 offen sc1
    s_mov_b32 s33, 52224
    buffer_load_dwordx4 a[252:255], v233, s[20:23], s33 offen sc1
    s_waitcnt vmcnt(33)
    v_cmp_ne_u32 vcc, s36, v30
    s_nop 4
    s_cmp_eq_u64 vcc, 0
    s_cbranch_scc1 L_pok_f0b
    s_mov_b32 s37, 0
L_spin_f0b:
    buffer_load_dword v30, v31, s[44:47], 0 offen sc1
    s_add_u32 s37, s37, 1
    s_cmp_gt_u32 s37, 0x20000
    s_cbranch_scc1 recurrent_scan__mha_block_cached__mixer_s_mlp__prompt_kernel_end
    s_waitcnt vmcnt(0)
    v_cmp_ne_u32 vcc, s36, v30
    s_nop 4
    s_cmp_lg_u64 vcc, 0
    s_cbranch_scc1 L_spin_f0b
L_pok_f0b:
    s_add_u32 m0, s30, 0
    s_mov_b32 s63, 0
    buffer_load_dwordx4 v18, s[52:55], s63 offen lds
    s_add_u32 m0, s30, 1024
    s_mov_b32 s63, 32768
    buffer_load_dwordx4 v18, s[52:55], s63 offen lds
    s_add_u32 m0, s30, 8192
    s_mov_b32 s63, 262144
    buffer_load_dwordx4 v18, s[52:55], s63 offen lds
    s_add_u32 m0, s30, 9216
    s_mov_b32 s63, 294912
    buffer_load_dwordx4 v18, s[52:55], s63 offen lds
    s_add_u32 m0, s30, 16384
    s_mov_b32 s63, 524288
    buffer_load_dwordx4 v18, s[52:55], s63 offen lds
    s_add_u32 m0, s30, 17408
    s_mov_b32 s63, 557056
    buffer_load_dwordx4 v18, s[52:55], s63 offen lds
    s_add_u32 m0, s30, 24576
    s_mov_b32 s63, 786432
    buffer_load_dwordx4 v18, s[52:55], s63 offen lds
    s_add_u32 m0, s30, 25600
    s_mov_b32 s63, 819200
    buffer_load_dwordx4 v18, s[52:55], s63 offen lds
    s_add_u32 m0, s30, 65536
    s_mov_b32 s63, 1048576
    buffer_load_dwordx4 v18, s[52:55], s63 offen lds
    s_add_u32 m0, s30, 66560
    s_mov_b32 s63, 1081344
    buffer_load_dwordx4 v18, s[52:55], s63 offen lds
    s_add_u32 m0, s30, 73728
    s_mov_b32 s63, 1310720
    buffer_load_dwordx4 v18, s[52:55], s63 offen lds
    s_add_u32 m0, s30, 74752
    s_mov_b32 s63, 1343488
    buffer_load_dwordx4 v18, s[52:55], s63 offen lds
    s_add_u32 m0, s30, 81920
    s_mov_b32 s63, 1572864
    buffer_load_dwordx4 v18, s[52:55], s63 offen lds
    s_add_u32 m0, s30, 82944
    s_mov_b32 s63, 1605632
    buffer_load_dwordx4 v18, s[52:55], s63 offen lds
    s_add_u32 m0, s30, 90112
    s_mov_b32 s63, 1835008
    buffer_load_dwordx4 v18, s[52:55], s63 offen lds
    s_add_u32 m0, s30, 91136
    s_mov_b32 s63, 1867776
    buffer_load_dwordx4 v18, s[52:55], s63 offen lds
    s_add_u32 m0, s30, 32768
    s_mov_b32 s63, 2097152
    buffer_load_dwordx4 v18, s[52:55], s63 offen lds
    s_add_u32 m0, s30, 33792
    s_mov_b32 s63, 2129920
    buffer_load_dwordx4 v18, s[52:55], s63 offen lds
    s_add_u32 m0, s30, 40960
    s_mov_b32 s63, 2359296
    buffer_load_dwordx4 v18, s[52:55], s63 offen lds
    s_add_u32 m0, s30, 41984
    s_mov_b32 s63, 2392064
    buffer_load_dwordx4 v18, s[52:55], s63 offen lds
    s_add_u32 m0, s30, 49152
    s_mov_b32 s63, 2621440
    buffer_load_dwordx4 v18, s[52:55], s63 offen lds
    s_add_u32 m0, s30, 50176
    s_mov_b32 s63, 2654208
    buffer_load_dwordx4 v18, s[52:55], s63 offen lds
    s_add_u32 m0, s30, 57344
    s_mov_b32 s63, 2883584
    buffer_load_dwordx4 v18, s[52:55], s63 offen lds
    s_add_u32 m0, s30, 58368
    s_mov_b32 s63, 2916352
    buffer_load_dwordx4 v18, s[52:55], s63 offen lds
    s_waitcnt vmcnt(53)
    ds_read_b64_tr_b16 v[128:129], v228 offset:0
    ds_read_b64_tr_b16 v[130:131], v228 offset:2048
    ds_read_b64_tr_b16 v[132:133], v229 offset:0
    ds_read_b64_tr_b16 v[134:135], v229 offset:2048
    ds_read_b64_tr_b16 v[136:137], v230 offset:0
    ds_read_b64_tr_b16 v[138:139], v230 offset:2048
    ds_read_b64_tr_b16 v[140:141], v231 offset:0
    ds_read_b64_tr_b16 v[142:143], v231 offset:2048
    s_waitcnt vmcnt(36)
    s_waitcnt lgkmcnt(0)
    v_mfma_f32_16x16x32_bf16 v[164:167], v[128:131], a[192:195], v[164:167]
    s_mov_b32 s63, 0
    buffer_load_dwordx4 v[32:35], v19, s[56:59], s63 offen sc1
    ds_read_b64_tr_b16 v[144:145], v228 offset:4096
    v_mfma_f32_16x16x32_bf16 v[180:183], v[128:131], a[196:199], v[180:183]
    v_mfma_f32_16x16x32_bf16 v[196:199], v[128:131], a[200:203], v[196:199]
    ds_read_b64_tr_b16 v[146:147], v228 offset:6144
    v_mfma_f32_16x16x32_bf16 v[212:215], v[128:131], a[204:207], v[212:215]
    v_mfma_f32_16x16x32_bf16 v[168:171], v[132:135], a[192:195], v[168:171]
    s_mov_b32 s63, 16384
    buffer_load_dwordx4 v[36:39], v19, s[56:59], s63 offen sc1
    ds_read_b64_tr_b16 v[148:149], v229 offset:4096
    v_mfma_f32_16x16x32_bf16 v[184:187], v[132:135], a[196:199], v[184:187]
    v_mfma_f32_16x16x32_bf16 v[200:203], v[132:135], a[200:203], v[200:203]
    ds_read_b64_tr_b16 v[150:151], v229 offset:6144
    v_mfma_f32_16x16x32_bf16 v[216:219], v[132:135], a[204:207], v[216:219]
    v_mfma_f32_16x16x32_bf16 v[172:175], v[136:139], a[192:195], v[172:175]
    s_mov_b32 s63, 32768
    buffer_load_dwordx4 v[40:43], v19, s[56:59], s63 offen sc1
    ds_read_b64_tr_b16 v[152:153], v230 offset:4096
    v_mfma_f32_16x16x32_bf16 v[188:191], v[136:139], a[196:199], v[188:191]
    v_mfma_f32_16x16x32_bf16 v[204:207], v[136:139], a[200:203], v[204:207]
    ds_read_b64_tr_b16 v[154:155], v230 offset:6144
    v_mfma_f32_16x16x32_bf16 v[220:223], v[136:139], a[204:207], v[220:223]
    v_mfma_f32_16x16x32_bf16 v[176:179], v[140:143], a[192:195], v[176:179]
    s_mov_b32 s63, 49152
    buffer_load_dwordx4 v[44:47], v19, s[56:59], s63 offen sc1
    ds_read_b64_tr_b16 v[156:157], v231 offset:4096
    v_mfma_f32_16x16x32_bf16 v[192:195], v[140:143], a[196:199], v[192:195]
    v_mfma_f32_16x16x32_bf16 v[208:211], v[140:143], a[200:203], v[208:211]
    ds_read_b64_tr_b16 v[158:159], v231 offset:6144
    v_mfma_f32_16x16x32_bf16 v[224:227], v[140:143], a[204:207], v[224:227]
    s_waitcnt vmcnt(36)
    s_waitcnt lgkmcnt(0)
    v_mfma_f32_16x16x32_bf16 v[164:167], v[144:147], a[208:211], v[164:167]
    s_mov_b32 s63, 1024
    buffer_load_dwordx4 v[48:51], v19, s[56:59], s63 offen sc1
    ds_read_b64_tr_b16 v[128:129], v228 offset:8192
    v_mfma_f32_16x16x32_bf16 v[180:183], v[144:147], a[212:215], v[180:183]
    v_mfma_f32_16x16x32_bf16 v[196:199], v[144:147], a[216:219], v[196:199]
    ds_read_b64_tr_b16 v[130:131], v228 offset:10240
    v_mfma_f32_16x16x32_bf16 v[212:215], v[144:147], a[220:223], v[212:215]
    v_mfma_f32_16x16x32_bf16 v[168:171], v[148:151], a[208:211], v[168:171]
    s_mov_b32 s63, 17408
    buffer_load_dwordx4 v[52:55], v19, s[56:59], s63 offen sc1
    ds_read_b64_tr_b16 v[132:133], v229 offset:8192
    v_mfma_f32_16x16x32_bf16 v[184:187], v[148:151], a[212:215], v[184:187]
    v_mfma_f32_16x16x32_bf16 v[200:203], v[148:151], a[216:219], v[200:203]
    ds_read_b64_tr_b16 v[134:135], v229 offset:10240
    v_mfma_f32_16x16x32_bf16 v[216:219], v[148:151], a[220:223], v[216:219]
    v_mfma_f32_16x16x32_bf16 v[172:175], v[152:155], a[208:211], v[172:175]
    s_mov_b32 s63, 33792
    buffer_load_dwordx4 v[56:59], v19, s[56:59], s63 offen sc1
    ds_read_b64_tr_b16 v[136:137], v230 offset:8192
    v_mfma_f32_16x16x32_bf16 v[188:191], v[152:155], a[212:215], v[188:191]
    v_mfma_f32_16x16x32_bf16 v[204:207], v[152:155], a[216:219], v[204:207]
    ds_read_b64_tr_b16 v[138:139], v230 offset:10240
    v_mfma_f32_16x16x32_bf16 v[220:223], v[152:155], a[220:223], v[220:223]
    v_mfma_f32_16x16x32_bf16 v[176:179], v[156:159], a[208:211], v[176:179]
    s_mov_b32 s63, 50176
    buffer_load_dwordx4 v[60:63], v19, s[56:59], s63 offen sc1
    ds_read_b64_tr_b16 v[140:141], v231 offset:8192
    v_mfma_f32_16x16x32_bf16 v[192:195], v[156:159], a[212:215], v[192:195]
    v_mfma_f32_16x16x32_bf16 v[208:211], v[156:159], a[216:219], v[208:211]
    ds_read_b64_tr_b16 v[142:143], v231 offset:10240
    v_mfma_f32_16x16x32_bf16 v[224:227], v[156:159], a[220:223], v[224:227]
    s_waitcnt vmcnt(36)
    s_waitcnt lgkmcnt(0)
    v_mfma_f32_16x16x32_bf16 v[164:167], v[128:131], a[224:227], v[164:167]
    s_mov_b32 s63, 2048
    buffer_load_dwordx4 v[64:67], v19, s[56:59], s63 offen sc1
    ds_read_b64_tr_b16 v[144:145], v228 offset:12288
    v_mfma_f32_16x16x32_bf16 v[180:183], v[128:131], a[228:231], v[180:183]
    v_mfma_f32_16x16x32_bf16 v[196:199], v[128:131], a[232:235], v[196:199]
    ds_read_b64_tr_b16 v[146:147], v228 offset:14336
    v_mfma_f32_16x16x32_bf16 v[212:215], v[128:131], a[236:239], v[212:215]
    v_mfma_f32_16x16x32_bf16 v[168:171], v[132:135], a[224:227], v[168:171]
    s_mov_b32 s63, 18432
    buffer_load_dwordx4 v[68:71], v19, s[56:59], s63 offen sc1
    ds_read_b64_tr_b16 v[148:149], v229 offset:12288
    v_mfma_f32_16x16x32_bf16 v[184:187], v[132:135], a[228:231], v[184:187]
    v_mfma_f32_16x16x32_bf16 v[200:203], v[132:135], a[232:235], v[200:203]
    ds_read_b64_tr_b16 v[150:151], v229 offset:14336
    v_mfma_f32_16x16x32_bf16 v[216:219], v[132:135], a[236:239], v[216:219]
    v_mfma_f32_16x16x32_bf16 v[172:175], v[136:139], a[224:227], v[172:175]
    s_mov_b32 s63, 34816
    buffer_load_dwordx4 v[72:75], v19, s[56:59], s63 offen sc1
    ds_read_b64_tr_b16 v[152:153], v230 offset:12288
    v_mfma_f32_16x16x32_bf16 v[188:191], v[136:139], a[228:231], v[188:191]
    v_mfma_f32_16x16x32_bf16 v[204:207], v[136:139], a[232:235], v[204:207]
    ds_read_b64_tr_b16 v[154:155], v230 offset:14336
    v_mfma_f32_16x16x32_bf16 v[220:223], v[136:139], a[236:239], v[220:223]
    v_mfma_f32_16x16x32_bf16 v[176:179], v[140:143], a[224:227], v[176:179]
    s_mov_b32 s63, 51200
    buffer_load_dwordx4 v[76:79], v19, s[56:59], s63 offen sc1
    ds_read_b64_tr_b16 v[156:157], v231 offset:12288
    v_mfma_f32_16x16x32_bf16 v[192:195], v[140:143], a[228:231], v[192:195]
    v_mfma_f32_16x16x32_bf16 v[208:211], v[140:143], a[232:235], v[208:211]
    ds_read_b64_tr_b16 v[158:159], v231 offset:14336
    v_mfma_f32_16x16x32_bf16 v[224:227], v[140:143], a[236:239], v[224:227]
    s_waitcnt vmcnt(36)
    s_waitcnt lgkmcnt(0)
    v_mfma_f32_16x16x32_bf16 v[164:167], v[144:147], a[240:243], v[164:167]
    s_mov_b32 s63, 3072
    buffer_load_dwordx4 v[80:83], v19, s[56:59], s63 offen sc1
    v_mfma_f32_16x16x32_bf16 v[180:183], v[144:147], a[244:247], v[180:183]
    v_mfma_f32_16x16x32_bf16 v[196:199], v[144:147], a[248:251], v[196:199]
    v_mfma_f32_16x16x32_bf16 v[212:215], v[144:147], a[252:255], v[212:215]
    v_mfma_f32_16x16x32_bf16 v[168:171], v[148:151], a[240:243], v[168:171]
    s_mov_b32 s63, 19456
    buffer_load_dwordx4 v[84:87], v19, s[56:59], s63 offen sc1
    v_mfma_f32_16x16x32_bf16 v[184:187], v[148:151], a[244:247], v[184:187]
    v_mfma_f32_16x16x32_bf16 v[200:203], v[148:151], a[248:251], v[200:203]
    v_mfma_f32_16x16x32_bf16 v[216:219], v[148:151], a[252:255], v[216:219]
    v_mfma_f32_16x16x32_bf16 v[172:175], v[152:155], a[240:243], v[172:175]
    s_mov_b32 s63, 35840
    buffer_load_dwordx4 v[88:91], v19, s[56:59], s63 offen sc1
    v_mfma_f32_16x16x32_bf16 v[188:191], v[152:155], a[244:247], v[188:191]
    v_mfma_f32_16x16x32_bf16 v[204:207], v[152:155], a[248:251], v[204:207]
    v_mfma_f32_16x16x32_bf16 v[220:223], v[152:155], a[252:255], v[220:223]
    v_mfma_f32_16x16x32_bf16 v[176:179], v[156:159], a[240:243], v[176:179]
    s_mov_b32 s63, 52224
    buffer_load_dwordx4 v[92:95], v19, s[56:59], s63 offen sc1
    v_mfma_f32_16x16x32_bf16 v[192:195], v[156:159], a[244:247], v[192:195]
    v_mfma_f32_16x16x32_bf16 v[208:211], v[156:159], a[248:251], v[208:211]
    v_mfma_f32_16x16x32_bf16 v[224:227], v[156:159], a[252:255], v[224:227]
    s_nop 7
    s_barrier
    v_add_u32 v24, s61, v19
    ds_write_b128 v24, v[164:167] offset:0
    ds_write_b128 v24, v[168:171] offset:1024
    ds_write_b128 v24, v[172:175] offset:2048
    ds_write_b128 v24, v[176:179] offset:3072
    ds_write_b128 v24, v[180:183] offset:4096
    ds_write_b128 v24, v[184:187] offset:5120
    ds_write_b128 v24, v[188:191] offset:6144
    ds_write_b128 v24, v[192:195] offset:7168
    ds_write_b128 v24, v[196:199] offset:8192
    ds_write_b128 v24, v[200:203] offset:9216
    ds_write_b128 v24, v[204:207] offset:10240
    ds_write_b128 v24, v[208:211] offset:11264
    ds_write_b128 v24, v[212:215] offset:12288
    ds_write_b128 v24, v[216:219] offset:13312
    ds_write_b128 v24, v[220:223] offset:14336
    ds_write_b128 v24, v[224:227] offset:15360
    s_waitcnt lgkmcnt(0)
    s_barrier
    s_lshl_b32 s60, s3, 12
    v_add_u32 v24, s60, v19
    s_mov_b32 s63, 4096
    buffer_load_dwordx4 v[96:99], v19, s[56:59], s63 offen sc1
    v_add_u32 v25, 98304, v24
    v_add_u32 v26, 131072, v24
    ds_read_b128 v[164:167], v25 offset:0
    ds_read_b128 v[168:171], v25 offset:1024
    ds_read_b128 v[172:175], v25 offset:2048
    ds_read_b128 v[176:179], v25 offset:3072
    ds_read_b128 v[180:183], v25 offset:16384
    ds_read_b128 v[184:187], v25 offset:17408
    ds_read_b128 v[188:191], v25 offset:18432
    ds_read_b128 v[192:195], v25 offset:19456
    ds_read_b128 v[196:199], v26 offset:0
    ds_read_b128 v[200:203], v26 offset:1024
    ds_read_b128 v[204:207], v26 offset:2048
    ds_read_b128 v[208:211], v26 offset:3072
    ds_read_b128 v[212:215], v26 offset:16384
    ds_read_b128 v[216:219], v26 offset:17408
    ds_read_b128 v[220:223], v26 offset:18432
    ds_read_b128 v[224:227], v26 offset:19456
    s_waitcnt lgkmcnt(0)
    v_pk_add_f32 v[164:165], v[164:165], v[180:181]
    v_pk_add_f32 v[196:197], v[196:197], v[212:213]
    v_pk_add_f32 v[166:167], v[166:167], v[182:183]
    v_pk_add_f32 v[198:199], v[198:199], v[214:215]
    v_pk_add_f32 v[168:169], v[168:169], v[184:185]
    v_pk_add_f32 v[200:201], v[200:201], v[216:217]
    v_pk_add_f32 v[170:171], v[170:171], v[186:187]
    s_mov_b32 s63, 20480
    buffer_load_dwordx4 v[100:103], v19, s[56:59], s63 offen sc1
    v_pk_add_f32 v[202:203], v[202:203], v[218:219]
    v_pk_add_f32 v[172:173], v[172:173], v[188:189]
    v_pk_add_f32 v[204:205], v[204:205], v[220:221]
    v_pk_add_f32 v[174:175], v[174:175], v[190:191]
    v_pk_add_f32 v[206:207], v[206:207], v[222:223]
    v_pk_add_f32 v[176:177], v[176:177], v[192:193]
    v_pk_add_f32 v[208:209], v[208:209], v[224:225]
    v_pk_add_f32 v[178:179], v[178:179], v[194:195]
    v_pk_add_f32 v[210:211], v[210:211], v[226:227]
    s_mov_b32 s63, 36864
    buffer_load_dwordx4 v[104:107], v19, s[56:59], s63 offen sc1
    v_pk_add_f32 v[164:165], v[164:165], v[196:197]
    v_pk_add_f32 v[166:167], v[166:167], v[198:199]
    v_pk_add_f32 v[168:169], v[168:169], v[200:201]
    v_pk_add_f32 v[170:171], v[170:171], v[202:203]
    v_pk_add_f32 v[172:173], v[172:173], v[204:205]
    v_pk_add_f32 v[174:175], v[174:175], v[206:207]
    v_pk_add_f32 v[176:177], v[176:177], v[208:209]
    v_pk_add_f32 v[178:179], v[178:179], v[210:211]
    v_mov_b32 v24, 0xbdd2d3e8
    s_mov_b32 s63, 53248
    buffer_load_dwordx4 v[108:111], v19, s[56:59], s63 offen sc1
    v_mov_b32 v25, 0xc0135761
    v_mov_b32 v26, 1.0
    v_mov_b32 v27, 1.0
    v_cvt_pk_bf16_f32 v180, v164, v165
    v_cvt_pk_bf16_f32 v181, v166, v167
    v_cvt_pk_bf16_f32 v182, v168, v169
    v_cvt_pk_bf16_f32 v183, v170, v171
    v_cvt_pk_bf16_f32 v184, v172, v173
    v_cvt_pk_bf16_f32 v185, v174, v175
    s_mov_b32 s63, 5120
    buffer_load_dwordx4 v[112:115], v19, s[56:59], s63 offen sc1
    v_cvt_pk_bf16_f32 v186, v176, v177
    v_cvt_pk_bf16_f32 v187, v178, v179
    v_lshlrev_b32 v164, 16, v180
    v_and_b32 v165, 0xffff0000, v180
    v_lshlrev_b32 v166, 16, v181
    v_and_b32 v167, 0xffff0000, v181
    v_lshlrev_b32 v168, 16, v182
    v_and_b32 v169, 0xffff0000, v182
    v_lshlrev_b32 v170, 16, v183
    s_mov_b32 s63, 21504
    buffer_load_dwordx4 v[116:119], v19, s[56:59], s63 offen sc1
    v_and_b32 v171, 0xffff0000, v183
    v_lshlrev_b32 v172, 16, v184
    v_and_b32 v173, 0xffff0000, v184
    v_lshlrev_b32 v174, 16, v185
    v_and_b32 v175, 0xffff0000, v185
    v_lshlrev_b32 v176, 16, v186
    v_and_b32 v177, 0xffff0000, v186
    v_lshlrev_b32 v178, 16, v187
    v_and_b32 v179, 0xffff0000, v187
    s_mov_b32 s63, 37888
    buffer_load_dwordx4 v[120:123], v19, s[56:59], s63 offen sc1
    v_pk_mul_f32 v[180:181], v[164:165], v[164:165]
    v_pk_mul_f32 v[182:183], v[166:167], v[166:167]
    v_pk_mul_f32 v[184:185], v[168:169], v[168:169]
    v_pk_mul_f32 v[186:187], v[170:171], v[170:171]
    v_pk_mul_f32 v[188:189], v[172:173], v[172:173]
    v_pk_mul_f32 v[190:191], v[174:175], v[174:175]
    v_pk_mul_f32 v[192:193], v[176:177], v[176:177]
    v_pk_mul_f32 v[194:195], v[178:179], v[178:179]
    v_pk_fma_f32 v[180:181], v[180:181], v[24:25], v[24:25] op_sel:[0,0,1] op_sel_hi:[1,0,1]
    s_mov_b32 s63, 54272
    buffer_load_dwordx4 v[124:127], v19, s[56:59], s63 offen sc1
    v_pk_fma_f32 v[182:183], v[182:183], v[24:25], v[24:25] op_sel:[0,0,1] op_sel_hi:[1,0,1]
    v_pk_fma_f32 v[184:185], v[184:185], v[24:25], v[24:25] op_sel:[0,0,1] op_sel_hi:[1,0,1]
    v_pk_fma_f32 v[186:187], v[186:187], v[24:25], v[24:25] op_sel:[0,0,1] op_sel_hi:[1,0,1]
    v_pk_fma_f32 v[188:189], v[188:189], v[24:25], v[24:25] op_sel:[0,0,1] op_sel_hi:[1,0,1]
    v_pk_fma_f32 v[190:191], v[190:191], v[24:25], v[24:25] op_sel:[0,0,1] op_sel_hi:[1,0,1]
    v_pk_fma_f32 v[192:193], v[192:193], v[24:25], v[24:25] op_sel:[0,0,1] op_sel_hi:[1,0,1]
    v_pk_fma_f32 v[194:195], v[194:195], v[24:25], v[24:25] op_sel:[0,0,1] op_sel_hi:[1,0,1]
    v_pk_mul_f32 v[180:181], v[180:181], v[164:165]
    v_pk_mul_f32 v[182:183], v[182:183], v[166:167]
    s_waitcnt vmcnt(16)
    v_pk_mul_f32 v[184:185], v[184:185], v[168:169]
    v_pk_mul_f32 v[186:187], v[186:187], v[170:171]
    v_pk_mul_f32 v[188:189], v[188:189], v[172:173]
    v_pk_mul_f32 v[190:191], v[190:191], v[174:175]
    v_pk_mul_f32 v[192:193], v[192:193], v[176:177]
    v_pk_mul_f32 v[194:195], v[194:195], v[178:179]
    v_exp_f32 v180, v180
    v_exp_f32 v181, v181
    v_exp_f32 v182, v182
    s_mov_b32 s63, 6144
    buffer_load_dwordx4 a[128:131], v19, s[56:59], s63 offen sc1
    v_exp_f32 v183, v183
    v_exp_f32 v184, v184
    v_exp_f32 v185, v185
    v_exp_f32 v186, v186
    v_exp_f32 v187, v187
    v_exp_f32 v188, v188
    v_exp_f32 v189, v189
    v_exp_f32 v190, v190
    v_exp_f32 v191, v191
    s_mov_b32 s63, 22528
    buffer_load_dwordx4 a[132:135], v19, s[56:59], s63 offen sc1
    v_exp_f32 v192, v192
    v_exp_f32 v193, v193
    v_exp_f32 v194, v194
    v_exp_f32 v195, v195
    v_pk_add_f32 v[180:181], v[180:181], v[26:27]
    v_pk_add_f32 v[182:183], v[182:183], v[26:27]
    v_pk_add_f32 v[184:185], v[184:185], v[26:27]
    v_pk_add_f32 v[186:187], v[186:187], v[26:27]
    v_pk_add_f32 v[188:189], v[188:189], v[26:27]
    s_mov_b32 s63, 38912
    buffer_load_dwordx4 a[136:139], v19, s[56:59], s63 offen sc1
    v_pk_add_f32 v[190:191], v[190:191], v[26:27]
    v_pk_add_f32 v[192:193], v[192:193], v[26:27]
    v_pk_add_f32 v[194:195], v[194:195], v[26:27]
    v_rcp_f32 v180, v180
    v_rcp_f32 v181, v181
    v_rcp_f32 v182, v182
    v_rcp_f32 v183, v183
    v_rcp_f32 v184, v184
    v_rcp_f32 v185, v185
    s_mov_b32 s63, 55296
    buffer_load_dwordx4 a[140:143], v19, s[56:59], s63 offen sc1
    v_rcp_f32 v186, v186
    v_rcp_f32 v187, v187
    v_rcp_f32 v188, v188
    v_rcp_f32 v189, v189
    v_rcp_f32 v190, v190
    v_rcp_f32 v191, v191
    v_rcp_f32 v192, v192
    v_rcp_f32 v193, v193
    v_rcp_f32 v194, v194
    s_mov_b32 s63, 7168
    buffer_load_dwordx4 a[144:147], v19, s[56:59], s63 offen sc1
    v_rcp_f32 v195, v195
    v_pk_mul_f32 v[164:165], v[164:165], v[180:181]
    v_pk_mul_f32 v[166:167], v[166:167], v[182:183]
    v_pk_mul_f32 v[168:169], v[168:169], v[184:185]
    v_pk_mul_f32 v[170:171], v[170:171], v[186:187]
    v_pk_mul_f32 v[172:173], v[172:173], v[188:189]
    v_pk_mul_f32 v[174:175], v[174:175], v[190:191]
    v_pk_mul_f32 v[176:177], v[176:177], v[192:193]
    v_pk_mul_f32 v[178:179], v[178:179], v[194:195]
    s_mov_b32 s63, 23552
    buffer_load_dwordx4 a[148:151], v19, s[56:59], s63 offen sc1
    v_cvt_pk_bf16_f32 v196, v164, v165
    v_cvt_pk_bf16_f32 v197, v166, v167
    v_cvt_pk_bf16_f32 v198, v168, v169
    v_cvt_pk_bf16_f32 v199, v170, v171
    v_cvt_pk_bf16_f32 v200, v172, v173
    v_cvt_pk_bf16_f32 v201, v174, v175
    v_cvt_pk_bf16_f32 v202, v176, v177
    v_cvt_pk_bf16_f32 v203, v178, v179
    s_mov_b32 s63, 39936
    buffer_load_dwordx4 a[152:155], v19, s[56:59], s63 offen sc1
    s_mov_b32 s63, 56320
    buffer_load_dwordx4 a[156:159], v19, s[56:59], s63 offen sc1
    s_mov_b32 s63, 8192
    buffer_load_dwordx4 a[160:163], v19, s[56:59], s63 offen sc1
    s_mov_b32 s63, 24576
    buffer_load_dwordx4 a[164:167], v19, s[56:59], s63 offen sc1
    s_mov_b32 s63, 40960
    buffer_load_dwordx4 a[168:171], v19, s[56:59], s63 offen sc1
    s_mov_b32 s63, 57344
    buffer_load_dwordx4 a[172:175], v19, s[56:59], s63 offen sc1
    s_mov_b32 s63, 9216
    buffer_load_dwordx4 a[176:179], v19, s[56:59], s63 offen sc1
    s_mov_b32 s63, 25600
    buffer_load_dwordx4 a[180:183], v19, s[56:59], s63 offen sc1
    s_mov_b32 s63, 41984
    buffer_load_dwordx4 a[184:187], v19, s[56:59], s63 offen sc1
    s_mov_b32 s63, 58368
    buffer_load_dwordx4 a[188:191], v19, s[56:59], s63 offen sc1
    s_lshl_b32 s41, s38, 16
    s_add_u32 s24, s34, 0x400000
    s_addc_u32 s25, s35, 0
    s_add_u32 s24, s24, s41
    s_addc_u32 s25, s25, 0
    s_mov_b32 s26, 0x10000
    s_mov_b32 s27, 0x20000
    s_lshl_b32 s41, s3, 14
    s_lshl_b32 s43, s39, 11
    s_add_u32 s41, s41, s43
    s_add_u32 s43, s41, 1024
    buffer_store_dwordx4 v[196:199], v19, s[24:27], s41 offen sc1
    buffer_store_dwordx4 v[200:203], v19, s[24:27], s43 offen sc1
    s_waitcnt vmcnt(26)
    s_barrier
    ds_read_b64_tr_b16 a[192:193], v236 offset:0
    ds_read_b64_tr_b16 a[194:195], v236 offset:1024
    ds_read_b64_tr_b16 a[196:197], v237 offset:0
    ds_read_b64_tr_b16 a[198:199], v237 offset:1024
    ds_read_b64_tr_b16 a[200:201], v238 offset:0
    ds_read_b64_tr_b16 a[202:203], v238 offset:1024
    ds_read_b64_tr_b16 a[204:205], v239 offset:0
    ds_read_b64_tr_b16 a[206:207], v239 offset:1024
    ds_read_b64_tr_b16 a[208:209], v240 offset:0
    ds_read_b64_tr_b16 a[210:211], v240 offset:1024
    ds_read_b64_tr_b16 a[212:213], v241 offset:0
    ds_read_b64_tr_b16 a[214:215], v241 offset:1024
    ds_read_b64_tr_b16 a[216:217], v242 offset:0
    ds_read_b64_tr_b16 a[218:219], v242 offset:1024
    ds_read_b64_tr_b16 a[220:221], v243 offset:0
    ds_read_b64_tr_b16 a[222:223], v243 offset:1024
    s_waitcnt lgkmcnt(14)
    v_mfma_f32_16x16x32_bf16 a[0:3], a[192:195], v[32:35], a[0:3]
    ds_read_b64_tr_b16 a[224:225], v236 offset:8192
    v_mfma_f32_16x16x32_bf16 a[4:7], a[192:195], v[36:39], a[4:7]
    s_add_u32 m0, s30, 98304
    s_mov_b32 s63, 3145728
    buffer_load_dwordx4 v18, s[52:55], s63 offen lds
    v_mfma_f32_16x16x32_bf16 a[8:11], a[192:195], v[40:43], a[8:11]
    ds_read_b64_tr_b16 a[226:227], v236 offset:9216
    v_mfma_f32_16x16x32_bf16 a[12:15], a[192:195], v[44:47], a[12:15]
    s_waitcnt lgkmcnt(14)
    v_mfma_f32_16x16x32_bf16 a[16:19], a[196:199], v[32:35], a[16:19]
    ds_read_b64_tr_b16 a[228:229], v237 offset:8192
    v_mfma_f32_16x16x32_bf16 a[20:23], a[196:199], v[36:39], a[20:23]
    s_add_u32 m0, s30, 99328
    s_mov_b32 s63, 3178496
    buffer_load_dwordx4 v18, s[52:55], s63 offen lds
    v_mfma_f32_16x16x32_bf16 a[24:27], a[196:199], v[40:43], a[24:27]
    ds_read_b64_tr_b16 a[230:231], v237 offset:9216
    v_mfma_f32_16x16x32_bf16 a[28:31], a[196:199], v[44:47], a[28:31]
    s_waitcnt lgkmcnt(14)
    v_mfma_f32_16x16x32_bf16 a[32:35], a[200:203], v[32:35], a[32:35]
    ds_read_b64_tr_b16 a[232:233], v238 offset:8192
    v_mfma_f32_16x16x32_bf16 a[36:39], a[200:203], v[36:39], a[36:39]
    s_add_u32 m0, s30, 106496
    s_mov_b32 s63, 3407872
    buffer_load_dwordx4 v18, s[52:55], s63 offen lds
    v_mfma_f32_16x16x32_bf16 a[40:43], a[200:203], v[40:43], a[40:43]
    ds_read_b64_tr_b16 a[234:235], v238 offset:9216
    v_mfma_f32_16x16x32_bf16 a[44:47], a[200:203], v[44:47], a[44:47]
    s_waitcnt lgkmcnt(14)
    v_mfma_f32_16x16x32_bf16 a[48:51], a[204:207], v[32:35], a[48:51]
    ds_read_b64_tr_b16 a[236:237], v239 offset:8192
    v_mfma_f32_16x16x32_bf16 a[52:55], a[204:207], v[36:39], a[52:55]
    s_add_u32 m0, s30, 107520
    s_mov_b32 s63, 3440640
    buffer_load_dwordx4 v18, s[52:55], s63 offen lds
    v_mfma_f32_16x16x32_bf16 a[56:59], a[204:207], v[40:43], a[56:59]
    ds_read_b64_tr_b16 a[238:239], v239 offset:9216
    v_mfma_f32_16x16x32_bf16 a[60:63], a[204:207], v[44:47], a[60:63]
    s_waitcnt lgkmcnt(14)
    v_mfma_f32_16x16x32_bf16 a[64:67], a[208:211], v[32:35], a[64:67]
    ds_read_b64_tr_b16 a[240:241], v240 offset:8192
    v_mfma_f32_16x16x32_bf16 a[68:71], a[208:211], v[36:39], a[68:71]
    s_add_u32 m0, s30, 114688
    s_mov_b32 s63, 3670016
    buffer_load_dwordx4 v18, s[52:55], s63 offen lds
    v_mfma_f32_16x16x32_bf16 a[72:75], a[208:211], v[40:43], a[72:75]
    ds_read_b64_tr_b16 a[242:243], v240 offset:9216
    v_mfma_f32_16x16x32_bf16 a[76:79], a[208:211], v[44:47], a[76:79]
    s_waitcnt lgkmcnt(14)
    v_mfma_f32_16x16x32_bf16 a[80:83], a[212:215], v[32:35], a[80:83]
    ds_read_b64_tr_b16 a[244:245], v241 offset:8192
    v_mfma_f32_16x16x32_bf16 a[84:87], a[212:215], v[36:39], a[84:87]
    s_add_u32 m0, s30, 115712
    s_mov_b32 s63, 3702784
    buffer_load_dwordx4 v18, s[52:55], s63 offen lds
    v_mfma_f32_16x16x32_bf16 a[88:91], a[212:215], v[40:43], a[88:91]
    ds_read_b64_tr_b16 a[246:247], v241 offset:9216
    v_mfma_f32_16x16x32_bf16 a[92:95], a[212:215], v[44:47], a[92:95]
    s_waitcnt lgkmcnt(14)
    v_mfma_f32_16x16x32_bf16 a[96:99], a[216:219], v[32:35], a[96:99]
    ds_read_b64_tr_b16 a[248:249], v242 offset:8192
    v_mfma_f32_16x16x32_bf16 a[100:103], a[216:219], v[36:39], a[100:103]
    s_add_u32 m0, s30, 122880
    s_mov_b32 s63, 3932160
    buffer_load_dwordx4 v18, s[52:55], s63 offen lds
    v_mfma_f32_16x16x32_bf16 a[104:107], a[216:219], v[40:43], a[104:107]
    ds_read_b64_tr_b16 a[250:251], v242 offset:9216
    v_mfma_f32_16x16x32_bf16 a[108:111], a[216:219], v[44:47], a[108:111]
    s_waitcnt lgkmcnt(14)
    v_mfma_f32_16x16x32_bf16 a[112:115], a[220:223], v[32:35], a[112:115]
    ds_read_b64_tr_b16 a[252:253], v243 offset:8192
    v_mfma_f32_16x16x32_bf16 a[116:119], a[220:223], v[36:39], a[116:119]
    s_add_u32 m0, s30, 123904
    s_mov_b32 s63, 3964928
    buffer_load_dwordx4 v18, s[52:55], s63 offen lds
    v_mfma_f32_16x16x32_bf16 a[120:123], a[220:223], v[40:43], a[120:123]
    ds_read_b64_tr_b16 a[254:255], v243 offset:9216
    v_mfma_f32_16x16x32_bf16 a[124:127], a[220:223], v[44:47], a[124:127]
    s_waitcnt lgkmcnt(14)
    v_mfma_f32_16x16x32_bf16 a[0:3], a[224:227], v[48:51], a[0:3]
    ds_read_b64_tr_b16 a[192:193], v236 offset:16384
    v_mfma_f32_16x16x32_bf16 a[4:7], a[224:227], v[52:55], a[4:7]
    s_mov_b32 s63, 10240
    buffer_load_dwordx4 v[128:131], v19, s[56:59], s63 offen sc1
    v_mfma_f32_16x16x32_bf16 a[8:11], a[224:227], v[56:59], a[8:11]
    ds_read_b64_tr_b16 a[194:195], v236 offset:17408
    v_mfma_f32_16x16x32_bf16 a[12:15], a[224:227], v[60:63], a[12:15]
    s_waitcnt lgkmcnt(14)
    v_mfma_f32_16x16x32_bf16 a[16:19], a[228:231], v[48:51], a[16:19]
    ds_read_b64_tr_b16 a[196:197], v237 offset:16384
    v_mfma_f32_16x16x32_bf16 a[20:23], a[228:231], v[52:55], a[20:23]
    s_mov_b32 s63, 26624
    buffer_load_dwordx4 v[132:135], v19, s[56:59], s63 offen sc1
    v_mfma_f32_16x16x32_bf16 a[24:27], a[228:231], v[56:59], a[24:27]
    ds_read_b64_tr_b16 a[198:199], v237 offset:17408
    v_mfma_f32_16x16x32_bf16 a[28:31], a[228:231], v[60:63], a[28:31]
    s_waitcnt lgkmcnt(14)
    v_mfma_f32_16x16x32_bf16 a[32:35], a[232:235], v[48:51], a[32:35]
    ds_read_b64_tr_b16 a[200:201], v238 offset:16384
    v_mfma_f32_16x16x32_bf16 a[36:39], a[232:235], v[52:55], a[36:39]
    s_mov_b32 s63, 43008
    buffer_load_dwordx4 v[136:139], v19, s[56:59], s63 offen sc1
    v_mfma_f32_16x16x32_bf16 a[40:43], a[232:235], v[56:59], a[40:43]
    ds_read_b64_tr_b16 a[202:203], v238 offset:17408
    v_mfma_f32_16x16x32_bf16 a[44:47], a[232:235], v[60:63], a[44:47]
    s_waitcnt lgkmcnt(14)
    v_mfma_f32_16x16x32_bf16 a[48:51], a[236:239], v[48:51], a[48:51]
    ds_read_b64_tr_b16 a[204:205], v239 offset:16384
    v_mfma_f32_16x16x32_bf16 a[52:55], a[236:239], v[52:55], a[52:55]
    s_mov_b32 s63, 59392
    buffer_load_dwordx4 v[140:143], v19, s[56:59], s63 offen sc1
    v_mfma_f32_16x16x32_bf16 a[56:59], a[236:239], v[56:59], a[56:59]
    ds_read_b64_tr_b16 a[206:207], v239 offset:17408
    v_mfma_f32_16x16x32_bf16 a[60:63], a[236:239], v[60:63], a[60:63]
    s_waitcnt lgkmcnt(14)
    v_mfma_f32_16x16x32_bf16 a[64:67], a[240:243], v[48:51], a[64:67]
    ds_read_b64_tr_b16 a[208:209], v240 offset:16384
    v_mfma_f32_16x16x32_bf16 a[68:71], a[240:243], v[52:55], a[68:71]
    s_mov_b32 s63, 11264
    buffer_load_dwordx4 v[144:147], v19, s[56:59], s63 offen sc1
    v_mfma_f32_16x16x32_bf16 a[72:75], a[240:243], v[56:59], a[72:75]
    ds_read_b64_tr_b16 a[210:211], v240 offset:17408
    v_mfma_f32_16x16x32_bf16 a[76:79], a[240:243], v[60:63], a[76:79]
    s_waitcnt lgkmcnt(14)
    v_mfma_f32_16x16x32_bf16 a[80:83], a[244:247], v[48:51], a[80:83]
    ds_read_b64_tr_b16 a[212:213], v241 offset:16384
    v_mfma_f32_16x16x32_bf16 a[84:87], a[244:247], v[52:55], a[84:87]
    s_mov_b32 s63, 27648
    buffer_load_dwordx4 v[148:151], v19, s[56:59], s63 offen sc1
    v_mfma_f32_16x16x32_bf16 a[88:91], a[244:247], v[56:59], a[88:91]
    ds_read_b64_tr_b16 a[214:215], v241 offset:17408
    v_mfma_f32_16x16x32_bf16 a[92:95], a[244:247], v[60:63], a[92:95]
    s_waitcnt lgkmcnt(14)
    v_mfma_f32_16x16x32_bf16 a[96:99], a[248:251], v[48:51], a[96:99]
    ds_read_b64_tr_b16 a[216:217], v242 offset:16384
    v_mfma_f32_16x16x32_bf16 a[100:103], a[248:251], v[52:55], a[100:103]
    s_mov_b32 s63, 44032
    buffer_load_dwordx4 v[152:155], v19, s[56:59], s63 offen sc1
    v_mfma_f32_16x16x32_bf16 a[104:107], a[248:251], v[56:59], a[104:107]
    ds_read_b64_tr_b16 a[218:219], v242 offset:17408
    v_mfma_f32_16x16x32_bf16 a[108:111], a[248:251], v[60:63], a[108:111]
    s_waitcnt lgkmcnt(14)
    v_mfma_f32_16x16x32_bf16 a[112:115], a[252:255], v[48:51], a[112:115]
    ds_read_b64_tr_b16 a[220:221], v243 offset:16384
    v_mfma_f32_16x16x32_bf16 a[116:119], a[252:255], v[52:55], a[116:119]
    s_mov_b32 s63, 60416
    buffer_load_dwordx4 v[156:159], v19, s[56:59], s63 offen sc1
    v_mfma_f32_16x16x32_bf16 a[120:123], a[252:255], v[56:59], a[120:123]
    ds_read_b64_tr_b16 a[222:223], v243 offset:17408
    v_mfma_f32_16x16x32_bf16 a[124:127], a[252:255], v[60:63], a[124:127]
    s_waitcnt vmcnt(16)
    s_barrier
    s_lshl_b32 s40, s38, 3
    s_add_u32 s40, s40, s39
    s_cmp_lg_u32 s3, 0
    s_cbranch_scc1 L_pub_f1
    s_lshl_b32 s60, s40, 7
    s_add_u32 s60, s60, 32768
    v_mov_b32 v30, s60
    v_mov_b32 v31, s36
    s_mov_b64 exec, 1
    buffer_store_dword v31, v30, s[44:47], 0 offen sc1
    s_mov_b64 exec, -1
L_pub_f1:
    s_waitcnt lgkmcnt(14)
    v_mfma_f32_16x16x32_bf16 a[0:3], a[192:195], v[64:67], a[0:3]
    ds_read_b64_tr_b16 a[224:225], v236 offset:24576
    v_mfma_f32_16x16x32_bf16 a[4:7], a[192:195], v[68:71], a[4:7]
    s_mov_b32 s63, 12288
    buffer_load_dwordx4 v[160:163], v19, s[56:59], s63 offen sc1
    v_mfma_f32_16x16x32_bf16 a[8:11], a[192:195], v[72:75], a[8:11]
    ds_read_b64_tr_b16 a[226:227], v236 offset:25600
    v_mfma_f32_16x16x32_bf16 a[12:15], a[192:195], v[76:79], a[12:15]
    s_waitcnt lgkmcnt(14)
    v_mfma_f32_16x16x32_bf16 a[16:19], a[196:199], v[64:67], a[16:19]
    ds_read_b64_tr_b16 a[228:229], v237 offset:24576
    v_mfma_f32_16x16x32_bf16 a[20:23], a[196:199], v[68:71], a[20:23]
    s_mov_b32 s63, 28672
    buffer_load_dwordx4 v[164:167], v19, s[56:59], s63 offen sc1
    v_mfma_f32_16x16x32_bf16 a[24:27], a[196:199], v[72:75], a[24:27]
    ds_read_b64_tr_b16 a[230:231], v237 offset:25600
    v_mfma_f32_16x16x32_bf16 a[28:31], a[196:199], v[76:79], a[28:31]
    s_waitcnt lgkmcnt(14)
    v_mfma_f32_16x16x32_bf16 a[32:35], a[200:203], v[64:67], a[32:35]
    ds_read_b64_tr_b16 a[232:233], v238 offset:24576
    v_mfma_f32_16x16x32_bf16 a[36:39], a[200:203], v[68:71], a[36:39]
    s_mov_b32 s63, 45056
    buffer_load_dwordx4 v[168:171], v19, s[56:59], s63 offen sc1
    v_mfma_f32_16x16x32_bf16 a[40:43], a[200:203], v[72:75], a[40:43]
    ds_read_b64_tr_b16 a[234:235], v238 offset:25600
    v_mfma_f32_16x16x32_bf16 a[44:47], a[200:203], v[76:79], a[44:47]
    s_waitcnt lgkmcnt(14)
    v_mfma_f32_16x16x32_bf16 a[48:51], a[204:207], v[64:67], a[48:51]
    ds_read_b64_tr_b16 a[236:237], v239 offset:24576
    v_mfma_f32_16x16x32_bf16 a[52:55], a[204:207], v[68:71], a[52:55]
    s_mov_b32 s63, 61440
    buffer_load_dwordx4 v[172:175], v19, s[56:59], s63 offen sc1
    v_mfma_f32_16x16x32_bf16 a[56:59], a[204:207], v[72:75], a[56:59]
    ds_read_b64_tr_b16 a[238:239], v239 offset:25600
    v_mfma_f32_16x16x32_bf16 a[60:63], a[204:207], v[76:79], a[60:63]
    s_waitcnt lgkmcnt(14)
    v_mfma_f32_16x16x32_bf16 a[64:67], a[208:211], v[64:67], a[64:67]
    ds_read_b64_tr_b16 a[240:241], v240 offset:24576
    v_mfma_f32_16x16x32_bf16 a[68:71], a[208:211], v[68:71], a[68:71]
    s_mov_b32 s63, 13312
    buffer_load_dwordx4 v[176:179], v19, s[56:59], s63 offen sc1
    v_mfma_f32_16x16x32_bf16 a[72:75], a[208:211], v[72:75], a[72:75]
    ds_read_b64_tr_b16 a[242:243], v240 offset:25600
    v_mfma_f32_16x16x32_bf16 a[76:79], a[208:211], v[76:79], a[76:79]
    s_waitcnt lgkmcnt(14)
    v_mfma_f32_16x16x32_bf16 a[80:83], a[212:215], v[64:67], a[80:83]
    ds_read_b64_tr_b16 a[244:245], v241 offset:24576
    v_mfma_f32_16x16x32_bf16 a[84:87], a[212:215], v[68:71], a[84:87]
    s_mov_b32 s63, 29696
    buffer_load_dwordx4 v[180:183], v19, s[56:59], s63 offen sc1
    v_mfma_f32_16x16x32_bf16 a[88:91], a[212:215], v[72:75], a[88:91]
    ds_read_b64_tr_b16 a[246:247], v241 offset:25600
    v_mfma_f32_16x16x32_bf16 a[92:95], a[212:215], v[76:79], a[92:95]
    s_waitcnt lgkmcnt(14)
    v_mfma_f32_16x16x32_bf16 a[96:99], a[216:219], v[64:67], a[96:99]
    ds_read_b64_tr_b16 a[248:249], v242 offset:24576
    v_mfma_f32_16x16x32_bf16 a[100:103], a[216:219], v[68:71], a[100:103]
    s_mov_b32 s63, 46080
    buffer_load_dwordx4 v[184:187], v19, s[56:59], s63 offen sc1
    v_mfma_f32_16x16x32_bf16 a[104:107], a[216:219], v[72:75], a[104:107]
    ds_read_b64_tr_b16 a[250:251], v242 offset:25600
    v_mfma_f32_16x16x32_bf16 a[108:111], a[216:219], v[76:79], a[108:111]
    s_waitcnt lgkmcnt(14)
    v_mfma_f32_16x16x32_bf16 a[112:115], a[220:223], v[64:67], a[112:115]
    ds_read_b64_tr_b16 a[252:253], v243 offset:24576
    v_mfma_f32_16x16x32_bf16 a[116:119], a[220:223], v[68:71], a[116:119]
    s_mov_b32 s63, 62464
    buffer_load_dwordx4 v[188:191], v19, s[56:59], s63 offen sc1
    v_mfma_f32_16x16x32_bf16 a[120:123], a[220:223], v[72:75], a[120:123]
    ds_read_b64_tr_b16 a[254:255], v243 offset:25600
    v_mfma_f32_16x16x32_bf16 a[124:127], a[220:223], v[76:79], a[124:127]
    s_waitcnt lgkmcnt(14)
    v_mfma_f32_16x16x32_bf16 a[0:3], a[224:227], v[80:83], a[0:3]
    ds_read_b64_tr_b16 a[192:193], v8 offset:0
    v_mfma_f32_16x16x32_bf16 a[4:7], a[224:227], v[84:87], a[4:7]
    s_mov_b32 s63, 14336
    buffer_load_dwordx4 v[192:195], v19, s[56:59], s63 offen sc1
    v_mfma_f32_16x16x32_bf16 a[8:11], a[224:227], v[88:91], a[8:11]
    ds_read_b64_tr_b16 a[194:195], v8 offset:1024
    v_mfma_f32_16x16x32_bf16 a[12:15], a[224:227], v[92:95], a[12:15]
    s_waitcnt lgkmcnt(14)
    v_mfma_f32_16x16x32_bf16 a[16:19], a[228:231], v[80:83], a[16:19]
    ds_read_b64_tr_b16 a[196:197], v9 offset:0
    v_mfma_f32_16x16x32_bf16 a[20:23], a[228:231], v[84:87], a[20:23]
    s_mov_b32 s63, 30720
    buffer_load_dwordx4 v[196:199], v19, s[56:59], s63 offen sc1
    v_mfma_f32_16x16x32_bf16 a[24:27], a[228:231], v[88:91], a[24:27]
    ds_read_b64_tr_b16 a[198:199], v9 offset:1024
    v_mfma_f32_16x16x32_bf16 a[28:31], a[228:231], v[92:95], a[28:31]
    s_waitcnt lgkmcnt(14)
    v_mfma_f32_16x16x32_bf16 a[32:35], a[232:235], v[80:83], a[32:35]
    ds_read_b64_tr_b16 a[200:201], v10 offset:0
    v_mfma_f32_16x16x32_bf16 a[36:39], a[232:235], v[84:87], a[36:39]
    s_mov_b32 s63, 47104
    buffer_load_dwordx4 v[200:203], v19, s[56:59], s63 offen sc1
    v_mfma_f32_16x16x32_bf16 a[40:43], a[232:235], v[88:91], a[40:43]
    ds_read_b64_tr_b16 a[202:203], v10 offset:1024
    v_mfma_f32_16x16x32_bf16 a[44:47], a[232:235], v[92:95], a[44:47]
    s_waitcnt lgkmcnt(14)
    v_mfma_f32_16x16x32_bf16 a[48:51], a[236:239], v[80:83], a[48:51]
    ds_read_b64_tr_b16 a[204:205], v11 offset:0
    v_mfma_f32_16x16x32_bf16 a[52:55], a[236:239], v[84:87], a[52:55]
    s_mov_b32 s63, 63488
    buffer_load_dwordx4 v[204:207], v19, s[56:59], s63 offen sc1
    v_mfma_f32_16x16x32_bf16 a[56:59], a[236:239], v[88:91], a[56:59]
    ds_read_b64_tr_b16 a[206:207], v11 offset:1024
    v_mfma_f32_16x16x32_bf16 a[60:63], a[236:239], v[92:95], a[60:63]
    s_waitcnt lgkmcnt(14)
    v_mfma_f32_16x16x32_bf16 a[64:67], a[240:243], v[80:83], a[64:67]
    ds_read_b64_tr_b16 a[208:209], v12 offset:0
    v_mfma_f32_16x16x32_bf16 a[68:71], a[240:243], v[84:87], a[68:71]
    s_mov_b32 s63, 15360
    buffer_load_dwordx4 v[208:211], v19, s[56:59], s63 offen sc1
    v_mfma_f32_16x16x32_bf16 a[72:75], a[240:243], v[88:91], a[72:75]
    ds_read_b64_tr_b16 a[210:211], v12 offset:1024
    v_mfma_f32_16x16x32_bf16 a[76:79], a[240:243], v[92:95], a[76:79]
    s_waitcnt lgkmcnt(14)
    v_mfma_f32_16x16x32_bf16 a[80:83], a[244:247], v[80:83], a[80:83]
    ds_read_b64_tr_b16 a[212:213], v13 offset:0
    v_mfma_f32_16x16x32_bf16 a[84:87], a[244:247], v[84:87], a[84:87]
    s_mov_b32 s63, 31744
    buffer_load_dwordx4 v[212:215], v19, s[56:59], s63 offen sc1
    v_mfma_f32_16x16x32_bf16 a[88:91], a[244:247], v[88:91], a[88:91]
    ds_read_b64_tr_b16 a[214:215], v13 offset:1024
    v_mfma_f32_16x16x32_bf16 a[92:95], a[244:247], v[92:95], a[92:95]
    s_waitcnt lgkmcnt(14)
    v_mfma_f32_16x16x32_bf16 a[96:99], a[248:251], v[80:83], a[96:99]
    ds_read_b64_tr_b16 a[216:217], v14 offset:0
    v_mfma_f32_16x16x32_bf16 a[100:103], a[248:251], v[84:87], a[100:103]
    s_mov_b32 s63, 48128
    buffer_load_dwordx4 v[216:219], v19, s[56:59], s63 offen sc1
    v_mfma_f32_16x16x32_bf16 a[104:107], a[248:251], v[88:91], a[104:107]
    ds_read_b64_tr_b16 a[218:219], v14 offset:1024
    v_mfma_f32_16x16x32_bf16 a[108:111], a[248:251], v[92:95], a[108:111]
    s_waitcnt lgkmcnt(14)
    v_mfma_f32_16x16x32_bf16 a[112:115], a[252:255], v[80:83], a[112:115]
    ds_read_b64_tr_b16 a[220:221], v15 offset:0
    v_mfma_f32_16x16x32_bf16 a[116:119], a[252:255], v[84:87], a[116:119]
    s_mov_b32 s63, 64512
    buffer_load_dwordx4 v[220:223], v19, s[56:59], s63 offen sc1
    v_mfma_f32_16x16x32_bf16 a[120:123], a[252:255], v[88:91], a[120:123]
    ds_read_b64_tr_b16 a[222:223], v15 offset:1024
    v_mfma_f32_16x16x32_bf16 a[124:127], a[252:255], v[92:95], a[124:127]
    s_barrier
    s_waitcnt lgkmcnt(14)
    v_mfma_f32_16x16x32_bf16 a[0:3], a[192:195], v[96:99], a[0:3]
    ds_read_b64_tr_b16 a[224:225], v8 offset:8192
    v_mfma_f32_16x16x32_bf16 a[4:7], a[192:195], v[100:103], a[4:7]
    s_add_u32 m0, s30, 0
    s_mov_b32 s63, 0
    buffer_load_dwordx4 v16, s[8:11], s63 offen offset:0 lds
    v_mfma_f32_16x16x32_bf16 a[8:11], a[192:195], v[104:107], a[8:11]
    ds_read_b64_tr_b16 a[226:227], v8 offset:9216
    v_mfma_f32_16x16x32_bf16 a[12:15], a[192:195], v[108:111], a[12:15]
    s_waitcnt lgkmcnt(14)
    v_mfma_f32_16x16x32_bf16 a[16:19], a[196:199], v[96:99], a[16:19]
    ds_read_b64_tr_b16 a[228:229], v9 offset:8192
    v_mfma_f32_16x16x32_bf16 a[20:23], a[196:199], v[100:103], a[20:23]
    s_add_u32 m0, s30, 0
    s_mov_b32 s63, 0
    buffer_load_dwordx4 v16, s[8:11], s63 offen offset:1024 lds
    v_mfma_f32_16x16x32_bf16 a[24:27], a[196:199], v[104:107], a[24:27]
    ds_read_b64_tr_b16 a[230:231], v9 offset:9216
    v_mfma_f32_16x16x32_bf16 a[28:31], a[196:199], v[108:111], a[28:31]
    s_waitcnt lgkmcnt(14)
    v_mfma_f32_16x16x32_bf16 a[32:35], a[200:203], v[96:99], a[32:35]
    ds_read_b64_tr_b16 a[232:233], v10 offset:8192
    v_mfma_f32_16x16x32_bf16 a[36:39], a[200:203], v[100:103], a[36:39]
    s_add_u32 m0, s30, 8192
    s_mov_b32 s63, 8192
    buffer_load_dwordx4 v16, s[8:11], s63 offen offset:0 lds
    v_mfma_f32_16x16x32_bf16 a[40:43], a[200:203], v[104:107], a[40:43]
    ds_read_b64_tr_b16 a[234:235], v10 offset:9216
    v_mfma_f32_16x16x32_bf16 a[44:47], a[200:203], v[108:111], a[44:47]
    s_waitcnt lgkmcnt(14)
    v_mfma_f32_16x16x32_bf16 a[48:51], a[204:207], v[96:99], a[48:51]
    ds_read_b64_tr_b16 a[236:237], v11 offset:8192
    v_mfma_f32_16x16x32_bf16 a[52:55], a[204:207], v[100:103], a[52:55]
    s_add_u32 m0, s30, 8192
    s_mov_b32 s63, 8192
    buffer_load_dwordx4 v16, s[8:11], s63 offen offset:1024 lds
    v_mfma_f32_16x16x32_bf16 a[56:59], a[204:207], v[104:107], a[56:59]
    ds_read_b64_tr_b16 a[238:239], v11 offset:9216
    v_mfma_f32_16x16x32_bf16 a[60:63], a[204:207], v[108:111], a[60:63]
    s_waitcnt lgkmcnt(14)
    v_mfma_f32_16x16x32_bf16 a[64:67], a[208:211], v[96:99], a[64:67]
    ds_read_b64_tr_b16 a[240:241], v12 offset:8192
    v_mfma_f32_16x16x32_bf16 a[68:71], a[208:211], v[100:103], a[68:71]
    s_add_u32 m0, s30, 16384
    s_mov_b32 s63, 16384
    buffer_load_dwordx4 v16, s[8:11], s63 offen offset:0 lds
    v_mfma_f32_16x16x32_bf16 a[72:75], a[208:211], v[104:107], a[72:75]
    ds_read_b64_tr_b16 a[242:243], v12 offset:9216
    v_mfma_f32_16x16x32_bf16 a[76:79], a[208:211], v[108:111], a[76:79]
    s_waitcnt lgkmcnt(14)
    v_mfma_f32_16x16x32_bf16 a[80:83], a[212:215], v[96:99], a[80:83]
    ds_read_b64_tr_b16 a[244:245], v13 offset:8192
    v_mfma_f32_16x16x32_bf16 a[84:87], a[212:215], v[100:103], a[84:87]
    s_add_u32 m0, s30, 16384
    s_mov_b32 s63, 16384
    buffer_load_dwordx4 v16, s[8:11], s63 offen offset:1024 lds
    v_mfma_f32_16x16x32_bf16 a[88:91], a[212:215], v[104:107], a[88:91]
    ds_read_b64_tr_b16 a[246:247], v13 offset:9216
    v_mfma_f32_16x16x32_bf16 a[92:95], a[212:215], v[108:111], a[92:95]
    s_waitcnt lgkmcnt(14)
    v_mfma_f32_16x16x32_bf16 a[96:99], a[216:219], v[96:99], a[96:99]
    ds_read_b64_tr_b16 a[248:249], v14 offset:8192
    v_mfma_f32_16x16x32_bf16 a[100:103], a[216:219], v[100:103], a[100:103]
    s_add_u32 m0, s30, 24576
    s_mov_b32 s63, 24576
    buffer_load_dwordx4 v16, s[8:11], s63 offen offset:0 lds
    v_mfma_f32_16x16x32_bf16 a[104:107], a[216:219], v[104:107], a[104:107]
    ds_read_b64_tr_b16 a[250:251], v14 offset:9216
    v_mfma_f32_16x16x32_bf16 a[108:111], a[216:219], v[108:111], a[108:111]
    s_waitcnt lgkmcnt(14)
    v_mfma_f32_16x16x32_bf16 a[112:115], a[220:223], v[96:99], a[112:115]
    ds_read_b64_tr_b16 a[252:253], v15 offset:8192
    v_mfma_f32_16x16x32_bf16 a[116:119], a[220:223], v[100:103], a[116:119]
    s_add_u32 m0, s30, 24576
    s_mov_b32 s63, 24576
    buffer_load_dwordx4 v16, s[8:11], s63 offen offset:1024 lds
    v_mfma_f32_16x16x32_bf16 a[120:123], a[220:223], v[104:107], a[120:123]
    ds_read_b64_tr_b16 a[254:255], v15 offset:9216
    v_mfma_f32_16x16x32_bf16 a[124:127], a[220:223], v[108:111], a[124:127]
    s_waitcnt lgkmcnt(14)
    v_mfma_f32_16x16x32_bf16 a[0:3], a[224:227], v[112:115], a[0:3]
    ds_read_b64_tr_b16 a[192:193], v8 offset:16384
    v_mfma_f32_16x16x32_bf16 a[4:7], a[224:227], v[116:119], a[4:7]
    v_mfma_f32_16x16x32_bf16 a[8:11], a[224:227], v[120:123], a[8:11]
    ds_read_b64_tr_b16 a[194:195], v8 offset:17408
    v_mfma_f32_16x16x32_bf16 a[12:15], a[224:227], v[124:127], a[12:15]
    s_waitcnt lgkmcnt(14)
    v_mfma_f32_16x16x32_bf16 a[16:19], a[228:231], v[112:115], a[16:19]
    ds_read_b64_tr_b16 a[196:197], v9 offset:16384
    v_mfma_f32_16x16x32_bf16 a[20:23], a[228:231], v[116:119], a[20:23]
    v_mfma_f32_16x16x32_bf16 a[24:27], a[228:231], v[120:123], a[24:27]
    ds_read_b64_tr_b16 a[198:199], v9 offset:17408
    v_mfma_f32_16x16x32_bf16 a[28:31], a[228:231], v[124:127], a[28:31]
    s_waitcnt lgkmcnt(14)
    v_mfma_f32_16x16x32_bf16 a[32:35], a[232:235], v[112:115], a[32:35]
    ds_read_b64_tr_b16 a[200:201], v10 offset:16384
    v_mfma_f32_16x16x32_bf16 a[36:39], a[232:235], v[116:119], a[36:39]
    v_mfma_f32_16x16x32_bf16 a[40:43], a[232:235], v[120:123], a[40:43]
    ds_read_b64_tr_b16 a[202:203], v10 offset:17408
    v_mfma_f32_16x16x32_bf16 a[44:47], a[232:235], v[124:127], a[44:47]
    s_waitcnt lgkmcnt(14)
    v_mfma_f32_16x16x32_bf16 a[48:51], a[236:239], v[112:115], a[48:51]
    ds_read_b64_tr_b16 a[204:205], v11 offset:16384
    v_mfma_f32_16x16x32_bf16 a[52:55], a[236:239], v[116:119], a[52:55]
    v_mfma_f32_16x16x32_bf16 a[56:59], a[236:239], v[120:123], a[56:59]
    ds_read_b64_tr_b16 a[206:207], v11 offset:17408
    v_mfma_f32_16x16x32_bf16 a[60:63], a[236:239], v[124:127], a[60:63]
    s_waitcnt lgkmcnt(14)
    v_mfma_f32_16x16x32_bf16 a[64:67], a[240:243], v[112:115], a[64:67]
    ds_read_b64_tr_b16 a[208:209], v12 offset:16384
    v_mfma_f32_16x16x32_bf16 a[68:71], a[240:243], v[116:119], a[68:71]
    v_mfma_f32_16x16x32_bf16 a[72:75], a[240:243], v[120:123], a[72:75]
    ds_read_b64_tr_b16 a[210:211], v12 offset:17408
    v_mfma_f32_16x16x32_bf16 a[76:79], a[240:243], v[124:127], a[76:79]
    s_waitcnt lgkmcnt(14)
    v_mfma_f32_16x16x32_bf16 a[80:83], a[244:247], v[112:115], a[80:83]
    ds_read_b64_tr_b16 a[212:213], v13 offset:16384
    v_mfma_f32_16x16x32_bf16 a[84:87], a[244:247], v[116:119], a[84:87]
    v_mfma_f32_16x16x32_bf16 a[88:91], a[244:247], v[120:123], a[88:91]
    ds_read_b64_tr_b16 a[214:215], v13 offset:17408
    v_mfma_f32_16x16x32_bf16 a[92:95], a[244:247], v[124:127], a[92:95]
    s_waitcnt lgkmcnt(14)
    v_mfma_f32_16x16x32_bf16 a[96:99], a[248:251], v[112:115], a[96:99]
    ds_read_b64_tr_b16 a[216:217], v14 offset:16384
    v_mfma_f32_16x16x32_bf16 a[100:103], a[248:251], v[116:119], a[100:103]
    v_mfma_f32_16x16x32_bf16 a[104:107], a[248:251], v[120:123], a[104:107]
    ds_read_b64_tr_b16 a[218:219], v14 offset:17408
    v_mfma_f32_16x16x32_bf16 a[108:111], a[248:251], v[124:127], a[108:111]
    s_waitcnt lgkmcnt(14)
    v_mfma_f32_16x16x32_bf16 a[112:115], a[252:255], v[112:115], a[112:115]
    ds_read_b64_tr_b16 a[220:221], v15 offset:16384
    v_mfma_f32_16x16x32_bf16 a[116:119], a[252:255], v[116:119], a[116:119]
    v_mfma_f32_16x16x32_bf16 a[120:123], a[252:255], v[120:123], a[120:123]
    ds_read_b64_tr_b16 a[222:223], v15 offset:17408
    v_mfma_f32_16x16x32_bf16 a[124:127], a[252:255], v[124:127], a[124:127]
    s_waitcnt lgkmcnt(14)
    v_mfma_f32_16x16x32_bf16 a[0:3], a[192:195], a[128:131], a[0:3]
    ds_read_b64_tr_b16 a[224:225], v8 offset:24576
    v_mfma_f32_16x16x32_bf16 a[4:7], a[192:195], a[132:135], a[4:7]
    v_mfma_f32_16x16x32_bf16 a[8:11], a[192:195], a[136:139], a[8:11]
    ds_read_b64_tr_b16 a[226:227], v8 offset:25600
    v_mfma_f32_16x16x32_bf16 a[12:15], a[192:195], a[140:143], a[12:15]
    s_waitcnt lgkmcnt(14)
    v_mfma_f32_16x16x32_bf16 a[16:19], a[196:199], a[128:131], a[16:19]
    ds_read_b64_tr_b16 a[228:229], v9 offset:24576
    v_mfma_f32_16x16x32_bf16 a[20:23], a[196:199], a[132:135], a[20:23]
    v_mfma_f32_16x16x32_bf16 a[24:27], a[196:199], a[136:139], a[24:27]
    ds_read_b64_tr_b16 a[230:231], v9 offset:25600
    v_mfma_f32_16x16x32_bf16 a[28:31], a[196:199], a[140:143], a[28:31]
    s_waitcnt lgkmcnt(14)
    v_mfma_f32_16x16x32_bf16 a[32:35], a[200:203], a[128:131], a[32:35]
    ds_read_b64_tr_b16 a[232:233], v10 offset:24576
    v_mfma_f32_16x16x32_bf16 a[36:39], a[200:203], a[132:135], a[36:39]
    v_mfma_f32_16x16x32_bf16 a[40:43], a[200:203], a[136:139], a[40:43]
    ds_read_b64_tr_b16 a[234:235], v10 offset:25600
    v_mfma_f32_16x16x32_bf16 a[44:47], a[200:203], a[140:143], a[44:47]
    s_waitcnt lgkmcnt(14)
    v_mfma_f32_16x16x32_bf16 a[48:51], a[204:207], a[128:131], a[48:51]
    ds_read_b64_tr_b16 a[236:237], v11 offset:24576
    v_mfma_f32_16x16x32_bf16 a[52:55], a[204:207], a[132:135], a[52:55]
    v_mfma_f32_16x16x32_bf16 a[56:59], a[204:207], a[136:139], a[56:59]
    ds_read_b64_tr_b16 a[238:239], v11 offset:25600
    v_mfma_f32_16x16x32_bf16 a[60:63], a[204:207], a[140:143], a[60:63]
    s_waitcnt lgkmcnt(14)
    v_mfma_f32_16x16x32_bf16 a[64:67], a[208:211], a[128:131], a[64:67]
    ds_read_b64_tr_b16 a[240:241], v12 offset:24576
    v_mfma_f32_16x16x32_bf16 a[68:71], a[208:211], a[132:135], a[68:71]
    v_mfma_f32_16x16x32_bf16 a[72:75], a[208:211], a[136:139], a[72:75]
    ds_read_b64_tr_b16 a[242:243], v12 offset:25600
    v_mfma_f32_16x16x32_bf16 a[76:79], a[208:211], a[140:143], a[76:79]
    s_waitcnt lgkmcnt(14)
    v_mfma_f32_16x16x32_bf16 a[80:83], a[212:215], a[128:131], a[80:83]
    ds_read_b64_tr_b16 a[244:245], v13 offset:24576
    v_mfma_f32_16x16x32_bf16 a[84:87], a[212:215], a[132:135], a[84:87]
    v_mfma_f32_16x16x32_bf16 a[88:91], a[212:215], a[136:139], a[88:91]
    ds_read_b64_tr_b16 a[246:247], v13 offset:25600
    v_mfma_f32_16x16x32_bf16 a[92:95], a[212:215], a[140:143], a[92:95]
    s_waitcnt lgkmcnt(14)
    v_mfma_f32_16x16x32_bf16 a[96:99], a[216:219], a[128:131], a[96:99]
    ds_read_b64_tr_b16 a[248:249], v14 offset:24576
    v_mfma_f32_16x16x32_bf16 a[100:103], a[216:219], a[132:135], a[100:103]
    v_mfma_f32_16x16x32_bf16 a[104:107], a[216:219], a[136:139], a[104:107]
    ds_read_b64_tr_b16 a[250:251], v14 offset:25600
    v_mfma_f32_16x16x32_bf16 a[108:111], a[216:219], a[140:143], a[108:111]
    s_waitcnt lgkmcnt(14)
    v_mfma_f32_16x16x32_bf16 a[112:115], a[220:223], a[128:131], a[112:115]
    ds_read_b64_tr_b16 a[252:253], v15 offset:24576
    v_mfma_f32_16x16x32_bf16 a[116:119], a[220:223], a[132:135], a[116:119]
    v_mfma_f32_16x16x32_bf16 a[120:123], a[220:223], a[136:139], a[120:123]
    ds_read_b64_tr_b16 a[254:255], v15 offset:25600
    v_mfma_f32_16x16x32_bf16 a[124:127], a[220:223], a[140:143], a[124:127]
    s_waitcnt lgkmcnt(14)
    v_mfma_f32_16x16x32_bf16 a[0:3], a[224:227], a[144:147], a[0:3]
    ds_read_b64_tr_b16 a[192:193], v236 offset:32768
    v_mfma_f32_16x16x32_bf16 a[4:7], a[224:227], a[148:151], a[4:7]
    v_mfma_f32_16x16x32_bf16 a[8:11], a[224:227], a[152:155], a[8:11]
    ds_read_b64_tr_b16 a[194:195], v236 offset:33792
    v_mfma_f32_16x16x32_bf16 a[12:15], a[224:227], a[156:159], a[12:15]
    s_waitcnt lgkmcnt(14)
    v_mfma_f32_16x16x32_bf16 a[16:19], a[228:231], a[144:147], a[16:19]
    ds_read_b64_tr_b16 a[196:197], v237 offset:32768
    v_mfma_f32_16x16x32_bf16 a[20:23], a[228:231], a[148:151], a[20:23]
    v_mfma_f32_16x16x32_bf16 a[24:27], a[228:231], a[152:155], a[24:27]
    ds_read_b64_tr_b16 a[198:199], v237 offset:33792
    v_mfma_f32_16x16x32_bf16 a[28:31], a[228:231], a[156:159], a[28:31]
    s_waitcnt lgkmcnt(14)
    v_mfma_f32_16x16x32_bf16 a[32:35], a[232:235], a[144:147], a[32:35]
    ds_read_b64_tr_b16 a[200:201], v238 offset:32768
    v_mfma_f32_16x16x32_bf16 a[36:39], a[232:235], a[148:151], a[36:39]
    v_mfma_f32_16x16x32_bf16 a[40:43], a[232:235], a[152:155], a[40:43]
    ds_read_b64_tr_b16 a[202:203], v238 offset:33792
    v_mfma_f32_16x16x32_bf16 a[44:47], a[232:235], a[156:159], a[44:47]
    s_waitcnt lgkmcnt(14)
    v_mfma_f32_16x16x32_bf16 a[48:51], a[236:239], a[144:147], a[48:51]
    ds_read_b64_tr_b16 a[204:205], v239 offset:32768
    v_mfma_f32_16x16x32_bf16 a[52:55], a[236:239], a[148:151], a[52:55]
    v_mfma_f32_16x16x32_bf16 a[56:59], a[236:239], a[152:155], a[56:59]
    ds_read_b64_tr_b16 a[206:207], v239 offset:33792
    v_mfma_f32_16x16x32_bf16 a[60:63], a[236:239], a[156:159], a[60:63]
    s_waitcnt lgkmcnt(14)
    v_mfma_f32_16x16x32_bf16 a[64:67], a[240:243], a[144:147], a[64:67]
    ds_read_b64_tr_b16 a[208:209], v240 offset:32768
    v_mfma_f32_16x16x32_bf16 a[68:71], a[240:243], a[148:151], a[68:71]
    v_mfma_f32_16x16x32_bf16 a[72:75], a[240:243], a[152:155], a[72:75]
    ds_read_b64_tr_b16 a[210:211], v240 offset:33792
    v_mfma_f32_16x16x32_bf16 a[76:79], a[240:243], a[156:159], a[76:79]
    s_waitcnt lgkmcnt(14)
    v_mfma_f32_16x16x32_bf16 a[80:83], a[244:247], a[144:147], a[80:83]
    ds_read_b64_tr_b16 a[212:213], v241 offset:32768
    v_mfma_f32_16x16x32_bf16 a[84:87], a[244:247], a[148:151], a[84:87]
    v_mfma_f32_16x16x32_bf16 a[88:91], a[244:247], a[152:155], a[88:91]
    ds_read_b64_tr_b16 a[214:215], v241 offset:33792
    v_mfma_f32_16x16x32_bf16 a[92:95], a[244:247], a[156:159], a[92:95]
    s_waitcnt lgkmcnt(14)
    v_mfma_f32_16x16x32_bf16 a[96:99], a[248:251], a[144:147], a[96:99]
    ds_read_b64_tr_b16 a[216:217], v242 offset:32768
    v_mfma_f32_16x16x32_bf16 a[100:103], a[248:251], a[148:151], a[100:103]
    v_mfma_f32_16x16x32_bf16 a[104:107], a[248:251], a[152:155], a[104:107]
    ds_read_b64_tr_b16 a[218:219], v242 offset:33792
    v_mfma_f32_16x16x32_bf16 a[108:111], a[248:251], a[156:159], a[108:111]
    s_waitcnt lgkmcnt(14)
    v_mfma_f32_16x16x32_bf16 a[112:115], a[252:255], a[144:147], a[112:115]
    ds_read_b64_tr_b16 a[220:221], v243 offset:32768
    v_mfma_f32_16x16x32_bf16 a[116:119], a[252:255], a[148:151], a[116:119]
    v_mfma_f32_16x16x32_bf16 a[120:123], a[252:255], a[152:155], a[120:123]
    ds_read_b64_tr_b16 a[222:223], v243 offset:33792
    v_mfma_f32_16x16x32_bf16 a[124:127], a[252:255], a[156:159], a[124:127]
    s_waitcnt lgkmcnt(14)
    v_mfma_f32_16x16x32_bf16 a[0:3], a[192:195], a[160:163], a[0:3]
    ds_read_b64_tr_b16 a[224:225], v236 offset:40960
    v_mfma_f32_16x16x32_bf16 a[4:7], a[192:195], a[164:167], a[4:7]
    v_mfma_f32_16x16x32_bf16 a[8:11], a[192:195], a[168:171], a[8:11]
    ds_read_b64_tr_b16 a[226:227], v236 offset:41984
    v_mfma_f32_16x16x32_bf16 a[12:15], a[192:195], a[172:175], a[12:15]
    s_waitcnt lgkmcnt(14)
    v_mfma_f32_16x16x32_bf16 a[16:19], a[196:199], a[160:163], a[16:19]
    ds_read_b64_tr_b16 a[228:229], v237 offset:40960
    v_mfma_f32_16x16x32_bf16 a[20:23], a[196:199], a[164:167], a[20:23]
    v_mfma_f32_16x16x32_bf16 a[24:27], a[196:199], a[168:171], a[24:27]
    ds_read_b64_tr_b16 a[230:231], v237 offset:41984
    v_mfma_f32_16x16x32_bf16 a[28:31], a[196:199], a[172:175], a[28:31]
    s_waitcnt lgkmcnt(14)
    v_mfma_f32_16x16x32_bf16 a[32:35], a[200:203], a[160:163], a[32:35]
    ds_read_b64_tr_b16 a[232:233], v238 offset:40960
    v_mfma_f32_16x16x32_bf16 a[36:39], a[200:203], a[164:167], a[36:39]
    v_mfma_f32_16x16x32_bf16 a[40:43], a[200:203], a[168:171], a[40:43]
    ds_read_b64_tr_b16 a[234:235], v238 offset:41984
    v_mfma_f32_16x16x32_bf16 a[44:47], a[200:203], a[172:175], a[44:47]
    s_waitcnt lgkmcnt(14)
    v_mfma_f32_16x16x32_bf16 a[48:51], a[204:207], a[160:163], a[48:51]
    ds_read_b64_tr_b16 a[236:237], v239 offset:40960
    v_mfma_f32_16x16x32_bf16 a[52:55], a[204:207], a[164:167], a[52:55]
    v_mfma_f32_16x16x32_bf16 a[56:59], a[204:207], a[168:171], a[56:59]
    ds_read_b64_tr_b16 a[238:239], v239 offset:41984
    v_mfma_f32_16x16x32_bf16 a[60:63], a[204:207], a[172:175], a[60:63]
    s_waitcnt lgkmcnt(14)
    v_mfma_f32_16x16x32_bf16 a[64:67], a[208:211], a[160:163], a[64:67]
    ds_read_b64_tr_b16 a[240:241], v240 offset:40960
    v_mfma_f32_16x16x32_bf16 a[68:71], a[208:211], a[164:167], a[68:71]
    v_mfma_f32_16x16x32_bf16 a[72:75], a[208:211], a[168:171], a[72:75]
    ds_read_b64_tr_b16 a[242:243], v240 offset:41984
    v_mfma_f32_16x16x32_bf16 a[76:79], a[208:211], a[172:175], a[76:79]
    s_waitcnt lgkmcnt(14)
    v_mfma_f32_16x16x32_bf16 a[80:83], a[212:215], a[160:163], a[80:83]
    ds_read_b64_tr_b16 a[244:245], v241 offset:40960
    v_mfma_f32_16x16x32_bf16 a[84:87], a[212:215], a[164:167], a[84:87]
    v_mfma_f32_16x16x32_bf16 a[88:91], a[212:215], a[168:171], a[88:91]
    ds_read_b64_tr_b16 a[246:247], v241 offset:41984
    v_mfma_f32_16x16x32_bf16 a[92:95], a[212:215], a[172:175], a[92:95]
    s_waitcnt lgkmcnt(14)
    v_mfma_f32_16x16x32_bf16 a[96:99], a[216:219], a[160:163], a[96:99]
    ds_read_b64_tr_b16 a[248:249], v242 offset:40960
    v_mfma_f32_16x16x32_bf16 a[100:103], a[216:219], a[164:167], a[100:103]
    v_mfma_f32_16x16x32_bf16 a[104:107], a[216:219], a[168:171], a[104:107]
    ds_read_b64_tr_b16 a[250:251], v242 offset:41984
    v_mfma_f32_16x16x32_bf16 a[108:111], a[216:219], a[172:175], a[108:111]
    s_waitcnt lgkmcnt(14)
    v_mfma_f32_16x16x32_bf16 a[112:115], a[220:223], a[160:163], a[112:115]
    ds_read_b64_tr_b16 a[252:253], v243 offset:40960
    v_mfma_f32_16x16x32_bf16 a[116:119], a[220:223], a[164:167], a[116:119]
    v_mfma_f32_16x16x32_bf16 a[120:123], a[220:223], a[168:171], a[120:123]
    ds_read_b64_tr_b16 a[254:255], v243 offset:41984
    v_mfma_f32_16x16x32_bf16 a[124:127], a[220:223], a[172:175], a[124:127]
    s_waitcnt lgkmcnt(14)
    v_mfma_f32_16x16x32_bf16 a[0:3], a[224:227], a[176:179], a[0:3]
    ds_read_b64_tr_b16 a[192:193], v236 offset:49152
    v_mfma_f32_16x16x32_bf16 a[4:7], a[224:227], a[180:183], a[4:7]
    v_mfma_f32_16x16x32_bf16 a[8:11], a[224:227], a[184:187], a[8:11]
    ds_read_b64_tr_b16 a[194:195], v236 offset:50176
    v_mfma_f32_16x16x32_bf16 a[12:15], a[224:227], a[188:191], a[12:15]
    s_waitcnt lgkmcnt(14)
    v_mfma_f32_16x16x32_bf16 a[16:19], a[228:231], a[176:179], a[16:19]
    ds_read_b64_tr_b16 a[196:197], v237 offset:49152
    v_mfma_f32_16x16x32_bf16 a[20:23], a[228:231], a[180:183], a[20:23]
    v_mfma_f32_16x16x32_bf16 a[24:27], a[228:231], a[184:187], a[24:27]
    ds_read_b64_tr_b16 a[198:199], v237 offset:50176
    v_mfma_f32_16x16x32_bf16 a[28:31], a[228:231], a[188:191], a[28:31]
    s_waitcnt lgkmcnt(14)
    v_mfma_f32_16x16x32_bf16 a[32:35], a[232:235], a[176:179], a[32:35]
    ds_read_b64_tr_b16 a[200:201], v238 offset:49152
    v_mfma_f32_16x16x32_bf16 a[36:39], a[232:235], a[180:183], a[36:39]
    v_mfma_f32_16x16x32_bf16 a[40:43], a[232:235], a[184:187], a[40:43]
    ds_read_b64_tr_b16 a[202:203], v238 offset:50176
    v_mfma_f32_16x16x32_bf16 a[44:47], a[232:235], a[188:191], a[44:47]
    s_waitcnt lgkmcnt(14)
    v_mfma_f32_16x16x32_bf16 a[48:51], a[236:239], a[176:179], a[48:51]
    ds_read_b64_tr_b16 a[204:205], v239 offset:49152
    v_mfma_f32_16x16x32_bf16 a[52:55], a[236:239], a[180:183], a[52:55]
    v_mfma_f32_16x16x32_bf16 a[56:59], a[236:239], a[184:187], a[56:59]
    ds_read_b64_tr_b16 a[206:207], v239 offset:50176
    v_mfma_f32_16x16x32_bf16 a[60:63], a[236:239], a[188:191], a[60:63]
    s_waitcnt lgkmcnt(14)
    v_mfma_f32_16x16x32_bf16 a[64:67], a[240:243], a[176:179], a[64:67]
    ds_read_b64_tr_b16 a[208:209], v240 offset:49152
    v_mfma_f32_16x16x32_bf16 a[68:71], a[240:243], a[180:183], a[68:71]
    v_mfma_f32_16x16x32_bf16 a[72:75], a[240:243], a[184:187], a[72:75]
    ds_read_b64_tr_b16 a[210:211], v240 offset:50176
    v_mfma_f32_16x16x32_bf16 a[76:79], a[240:243], a[188:191], a[76:79]
    s_waitcnt lgkmcnt(14)
    v_mfma_f32_16x16x32_bf16 a[80:83], a[244:247], a[176:179], a[80:83]
    ds_read_b64_tr_b16 a[212:213], v241 offset:49152
    v_mfma_f32_16x16x32_bf16 a[84:87], a[244:247], a[180:183], a[84:87]
    v_mfma_f32_16x16x32_bf16 a[88:91], a[244:247], a[184:187], a[88:91]
    ds_read_b64_tr_b16 a[214:215], v241 offset:50176
    v_mfma_f32_16x16x32_bf16 a[92:95], a[244:247], a[188:191], a[92:95]
    s_waitcnt lgkmcnt(14)
    v_mfma_f32_16x16x32_bf16 a[96:99], a[248:251], a[176:179], a[96:99]
    ds_read_b64_tr_b16 a[216:217], v242 offset:49152
    v_mfma_f32_16x16x32_bf16 a[100:103], a[248:251], a[180:183], a[100:103]
    v_mfma_f32_16x16x32_bf16 a[104:107], a[248:251], a[184:187], a[104:107]
    ds_read_b64_tr_b16 a[218:219], v242 offset:50176
    v_mfma_f32_16x16x32_bf16 a[108:111], a[248:251], a[188:191], a[108:111]
    s_waitcnt lgkmcnt(14)
    v_mfma_f32_16x16x32_bf16 a[112:115], a[252:255], a[176:179], a[112:115]
    ds_read_b64_tr_b16 a[220:221], v243 offset:49152
    v_mfma_f32_16x16x32_bf16 a[116:119], a[252:255], a[180:183], a[116:119]
    v_mfma_f32_16x16x32_bf16 a[120:123], a[252:255], a[184:187], a[120:123]
    ds_read_b64_tr_b16 a[222:223], v243 offset:50176
    v_mfma_f32_16x16x32_bf16 a[124:127], a[252:255], a[188:191], a[124:127]
    s_waitcnt vmcnt(24)
    s_barrier
    s_lshl_b32 s40, s38, 3
    s_sub_u32 s40, s40, 8
    v_min_u32 v29, 23, v1
    v_add_u32 v29, s40, v29
    v_max_i32 v29, 0, v29
    v_min_i32 v29, 255, v29
    v_lshlrev_b32 v29, 7, v29
    v_add_u32 v29, 32768, v29
    buffer_load_dword v28, v29, s[44:47], 0 offen sc1
    s_waitcnt lgkmcnt(14)
    v_mfma_f32_16x16x32_bf16 a[0:3], a[192:195], v[128:131], a[0:3]
    ds_read_b64_tr_b16 a[224:225], v236 offset:57344
    v_mfma_f32_16x16x32_bf16 a[4:7], a[192:195], v[132:135], a[4:7]
    s_add_u32 m0, s31, 0
    s_mov_b32 s63, 0
    buffer_load_dwordx4 v17, s[12:15], s63 offen offset:0 lds
    v_mfma_f32_16x16x32_bf16 a[8:11], a[192:195], v[136:139], a[8:11]
    ds_read_b64_tr_b16 a[226:227], v236 offset:58368
    v_mfma_f32_16x16x32_bf16 a[12:15], a[192:195], v[140:143], a[12:15]
    s_waitcnt lgkmcnt(14)
    v_mfma_f32_16x16x32_bf16 a[16:19], a[196:199], v[128:131], a[16:19]
    ds_read_b64_tr_b16 a[228:229], v237 offset:57344
    v_mfma_f32_16x16x32_bf16 a[20:23], a[196:199], v[132:135], a[20:23]
    s_add_u32 m0, s31, 0
    s_mov_b32 s63, 0
    buffer_load_dwordx4 v17, s[12:15], s63 offen offset:1024 lds
    v_mfma_f32_16x16x32_bf16 a[24:27], a[196:199], v[136:139], a[24:27]
    ds_read_b64_tr_b16 a[230:231], v237 offset:58368
    v_mfma_f32_16x16x32_bf16 a[28:31], a[196:199], v[140:143], a[28:31]
    s_waitcnt lgkmcnt(14)
    v_mfma_f32_16x16x32_bf16 a[32:35], a[200:203], v[128:131], a[32:35]
    ds_read_b64_tr_b16 a[232:233], v238 offset:57344
    v_mfma_f32_16x16x32_bf16 a[36:39], a[200:203], v[132:135], a[36:39]
    s_add_u32 m0, s31, 8192
    s_mov_b32 s63, 8192
    buffer_load_dwordx4 v17, s[12:15], s63 offen offset:0 lds
    v_mfma_f32_16x16x32_bf16 a[40:43], a[200:203], v[136:139], a[40:43]
    ds_read_b64_tr_b16 a[234:235], v238 offset:58368
    v_mfma_f32_16x16x32_bf16 a[44:47], a[200:203], v[140:143], a[44:47]
    s_waitcnt lgkmcnt(14)
    v_mfma_f32_16x16x32_bf16 a[48:51], a[204:207], v[128:131], a[48:51]
    ds_read_b64_tr_b16 a[236:237], v239 offset:57344
    v_mfma_f32_16x16x32_bf16 a[52:55], a[204:207], v[132:135], a[52:55]
    s_add_u32 m0, s31, 8192
    s_mov_b32 s63, 8192
    buffer_load_dwordx4 v17, s[12:15], s63 offen offset:1024 lds
    v_mfma_f32_16x16x32_bf16 a[56:59], a[204:207], v[136:139], a[56:59]
    ds_read_b64_tr_b16 a[238:239], v239 offset:58368
    v_mfma_f32_16x16x32_bf16 a[60:63], a[204:207], v[140:143], a[60:63]
    s_waitcnt lgkmcnt(14)
    v_mfma_f32_16x16x32_bf16 a[64:67], a[208:211], v[128:131], a[64:67]
    ds_read_b64_tr_b16 a[240:241], v240 offset:57344
    v_mfma_f32_16x16x32_bf16 a[68:71], a[208:211], v[132:135], a[68:71]
    s_add_u32 m0, s31, 16384
    s_mov_b32 s63, 16384
    buffer_load_dwordx4 v17, s[12:15], s63 offen offset:0 lds
    v_mfma_f32_16x16x32_bf16 a[72:75], a[208:211], v[136:139], a[72:75]
    ds_read_b64_tr_b16 a[242:243], v240 offset:58368
    v_mfma_f32_16x16x32_bf16 a[76:79], a[208:211], v[140:143], a[76:79]
    s_waitcnt lgkmcnt(14)
    v_mfma_f32_16x16x32_bf16 a[80:83], a[212:215], v[128:131], a[80:83]
    ds_read_b64_tr_b16 a[244:245], v241 offset:57344
    v_mfma_f32_16x16x32_bf16 a[84:87], a[212:215], v[132:135], a[84:87]
    s_add_u32 m0, s31, 16384
    s_mov_b32 s63, 16384
    buffer_load_dwordx4 v17, s[12:15], s63 offen offset:1024 lds
    v_mfma_f32_16x16x32_bf16 a[88:91], a[212:215], v[136:139], a[88:91]
    ds_read_b64_tr_b16 a[246:247], v241 offset:58368
    v_mfma_f32_16x16x32_bf16 a[92:95], a[212:215], v[140:143], a[92:95]
    s_waitcnt lgkmcnt(14)
    v_mfma_f32_16x16x32_bf16 a[96:99], a[216:219], v[128:131], a[96:99]
    ds_read_b64_tr_b16 a[248:249], v242 offset:57344
    v_mfma_f32_16x16x32_bf16 a[100:103], a[216:219], v[132:135], a[100:103]
    s_add_u32 m0, s31, 24576
    s_mov_b32 s63, 24576
    buffer_load_dwordx4 v17, s[12:15], s63 offen offset:0 lds
    v_mfma_f32_16x16x32_bf16 a[104:107], a[216:219], v[136:139], a[104:107]
    ds_read_b64_tr_b16 a[250:251], v242 offset:58368
    v_mfma_f32_16x16x32_bf16 a[108:111], a[216:219], v[140:143], a[108:111]
    s_waitcnt lgkmcnt(14)
    v_mfma_f32_16x16x32_bf16 a[112:115], a[220:223], v[128:131], a[112:115]
    ds_read_b64_tr_b16 a[252:253], v243 offset:57344
    v_mfma_f32_16x16x32_bf16 a[116:119], a[220:223], v[132:135], a[116:119]
    s_add_u32 m0, s31, 24576
    s_mov_b32 s63, 24576
    buffer_load_dwordx4 v17, s[12:15], s63 offen offset:1024 lds
    v_mfma_f32_16x16x32_bf16 a[120:123], a[220:223], v[136:139], a[120:123]
    ds_read_b64_tr_b16 a[254:255], v243 offset:58368
    v_mfma_f32_16x16x32_bf16 a[124:127], a[220:223], v[140:143], a[124:127]
    s_waitcnt lgkmcnt(14)
    v_mfma_f32_16x16x32_bf16 a[0:3], a[224:227], v[144:147], a[0:3]
    ds_read_b64_tr_b16 a[192:193], v8 offset:32768
    v_mfma_f32_16x16x32_bf16 a[4:7], a[224:227], v[148:151], a[4:7]
    v_mfma_f32_16x16x32_bf16 a[8:11], a[224:227], v[152:155], a[8:11]
    ds_read_b64_tr_b16 a[194:195], v8 offset:33792
    v_mfma_f32_16x16x32_bf16 a[12:15], a[224:227], v[156:159], a[12:15]
    s_waitcnt lgkmcnt(14)
    v_mfma_f32_16x16x32_bf16 a[16:19], a[228:231], v[144:147], a[16:19]
    ds_read_b64_tr_b16 a[196:197], v9 offset:32768
    v_mfma_f32_16x16x32_bf16 a[20:23], a[228:231], v[148:151], a[20:23]
    v_mfma_f32_16x16x32_bf16 a[24:27], a[228:231], v[152:155], a[24:27]
    ds_read_b64_tr_b16 a[198:199], v9 offset:33792
    v_mfma_f32_16x16x32_bf16 a[28:31], a[228:231], v[156:159], a[28:31]
    s_waitcnt lgkmcnt(14)
    v_mfma_f32_16x16x32_bf16 a[32:35], a[232:235], v[144:147], a[32:35]
    ds_read_b64_tr_b16 a[200:201], v10 offset:32768
    v_mfma_f32_16x16x32_bf16 a[36:39], a[232:235], v[148:151], a[36:39]
    v_mfma_f32_16x16x32_bf16 a[40:43], a[232:235], v[152:155], a[40:43]
    ds_read_b64_tr_b16 a[202:203], v10 offset:33792
    v_mfma_f32_16x16x32_bf16 a[44:47], a[232:235], v[156:159], a[44:47]
    s_waitcnt lgkmcnt(14)
    v_mfma_f32_16x16x32_bf16 a[48:51], a[236:239], v[144:147], a[48:51]
    ds_read_b64_tr_b16 a[204:205], v11 offset:32768
    v_mfma_f32_16x16x32_bf16 a[52:55], a[236:239], v[148:151], a[52:55]
    v_mfma_f32_16x16x32_bf16 a[56:59], a[236:239], v[152:155], a[56:59]
    ds_read_b64_tr_b16 a[206:207], v11 offset:33792
    v_mfma_f32_16x16x32_bf16 a[60:63], a[236:239], v[156:159], a[60:63]
    s_waitcnt lgkmcnt(14)
    v_mfma_f32_16x16x32_bf16 a[64:67], a[240:243], v[144:147], a[64:67]
    ds_read_b64_tr_b16 a[208:209], v12 offset:32768
    v_mfma_f32_16x16x32_bf16 a[68:71], a[240:243], v[148:151], a[68:71]
    v_mfma_f32_16x16x32_bf16 a[72:75], a[240:243], v[152:155], a[72:75]
    ds_read_b64_tr_b16 a[210:211], v12 offset:33792
    v_mfma_f32_16x16x32_bf16 a[76:79], a[240:243], v[156:159], a[76:79]
    s_waitcnt lgkmcnt(14)
    v_mfma_f32_16x16x32_bf16 a[80:83], a[244:247], v[144:147], a[80:83]
    ds_read_b64_tr_b16 a[212:213], v13 offset:32768
    v_mfma_f32_16x16x32_bf16 a[84:87], a[244:247], v[148:151], a[84:87]
    v_mfma_f32_16x16x32_bf16 a[88:91], a[244:247], v[152:155], a[88:91]
    ds_read_b64_tr_b16 a[214:215], v13 offset:33792
    v_mfma_f32_16x16x32_bf16 a[92:95], a[244:247], v[156:159], a[92:95]
    s_waitcnt lgkmcnt(14)
    v_mfma_f32_16x16x32_bf16 a[96:99], a[248:251], v[144:147], a[96:99]
    ds_read_b64_tr_b16 a[216:217], v14 offset:32768
    v_mfma_f32_16x16x32_bf16 a[100:103], a[248:251], v[148:151], a[100:103]
    v_mfma_f32_16x16x32_bf16 a[104:107], a[248:251], v[152:155], a[104:107]
    ds_read_b64_tr_b16 a[218:219], v14 offset:33792
    v_mfma_f32_16x16x32_bf16 a[108:111], a[248:251], v[156:159], a[108:111]
    s_waitcnt lgkmcnt(14)
    v_mfma_f32_16x16x32_bf16 a[112:115], a[252:255], v[144:147], a[112:115]
    ds_read_b64_tr_b16 a[220:221], v15 offset:32768
    v_mfma_f32_16x16x32_bf16 a[116:119], a[252:255], v[148:151], a[116:119]
    v_mfma_f32_16x16x32_bf16 a[120:123], a[252:255], v[152:155], a[120:123]
    ds_read_b64_tr_b16 a[222:223], v15 offset:33792
    v_mfma_f32_16x16x32_bf16 a[124:127], a[252:255], v[156:159], a[124:127]
    s_waitcnt vmcnt(25)
    s_barrier
    s_waitcnt lgkmcnt(14)
    v_mfma_f32_16x16x32_bf16 a[0:3], a[192:195], v[160:163], a[0:3]
    ds_read_b64_tr_b16 a[224:225], v8 offset:40960
    v_mfma_f32_16x16x32_bf16 a[4:7], a[192:195], v[164:167], a[4:7]
    s_add_u32 m0, s30, 32768
    s_mov_b32 s63, 32768
    buffer_load_dwordx4 v16, s[8:11], s63 offen offset:0 lds
    v_mfma_f32_16x16x32_bf16 a[8:11], a[192:195], v[168:171], a[8:11]
    ds_read_b64_tr_b16 a[226:227], v8 offset:41984
    v_mfma_f32_16x16x32_bf16 a[12:15], a[192:195], v[172:175], a[12:15]
    s_waitcnt lgkmcnt(14)
    v_mfma_f32_16x16x32_bf16 a[16:19], a[196:199], v[160:163], a[16:19]
    ds_read_b64_tr_b16 a[228:229], v9 offset:40960
    v_mfma_f32_16x16x32_bf16 a[20:23], a[196:199], v[164:167], a[20:23]
    s_add_u32 m0, s30, 32768
    s_mov_b32 s63, 32768
    buffer_load_dwordx4 v16, s[8:11], s63 offen offset:1024 lds
    v_mfma_f32_16x16x32_bf16 a[24:27], a[196:199], v[168:171], a[24:27]
    ds_read_b64_tr_b16 a[230:231], v9 offset:41984
    v_mfma_f32_16x16x32_bf16 a[28:31], a[196:199], v[172:175], a[28:31]
    s_waitcnt lgkmcnt(14)
    v_mfma_f32_16x16x32_bf16 a[32:35], a[200:203], v[160:163], a[32:35]
    ds_read_b64_tr_b16 a[232:233], v10 offset:40960
    v_mfma_f32_16x16x32_bf16 a[36:39], a[200:203], v[164:167], a[36:39]
    s_add_u32 m0, s30, 40960
    s_mov_b32 s63, 40960
    buffer_load_dwordx4 v16, s[8:11], s63 offen offset:0 lds
    v_mfma_f32_16x16x32_bf16 a[40:43], a[200:203], v[168:171], a[40:43]
    ds_read_b64_tr_b16 a[234:235], v10 offset:41984
    v_mfma_f32_16x16x32_bf16 a[44:47], a[200:203], v[172:175], a[44:47]
    s_waitcnt lgkmcnt(14)
    v_mfma_f32_16x16x32_bf16 a[48:51], a[204:207], v[160:163], a[48:51]
    ds_read_b64_tr_b16 a[236:237], v11 offset:40960
    v_mfma_f32_16x16x32_bf16 a[52:55], a[204:207], v[164:167], a[52:55]
    s_add_u32 m0, s30, 40960
    s_mov_b32 s63, 40960
    buffer_load_dwordx4 v16, s[8:11], s63 offen offset:1024 lds
    v_mfma_f32_16x16x32_bf16 a[56:59], a[204:207], v[168:171], a[56:59]
    ds_read_b64_tr_b16 a[238:239], v11 offset:41984
    v_mfma_f32_16x16x32_bf16 a[60:63], a[204:207], v[172:175], a[60:63]
    s_waitcnt lgkmcnt(14)
    v_mfma_f32_16x16x32_bf16 a[64:67], a[208:211], v[160:163], a[64:67]
    ds_read_b64_tr_b16 a[240:241], v12 offset:40960
    v_mfma_f32_16x16x32_bf16 a[68:71], a[208:211], v[164:167], a[68:71]
    s_add_u32 m0, s30, 49152
    s_mov_b32 s63, 49152
    buffer_load_dwordx4 v16, s[8:11], s63 offen offset:0 lds
    v_mfma_f32_16x16x32_bf16 a[72:75], a[208:211], v[168:171], a[72:75]
    ds_read_b64_tr_b16 a[242:243], v12 offset:41984
    v_mfma_f32_16x16x32_bf16 a[76:79], a[208:211], v[172:175], a[76:79]
    s_waitcnt lgkmcnt(14)
    v_mfma_f32_16x16x32_bf16 a[80:83], a[212:215], v[160:163], a[80:83]
    ds_read_b64_tr_b16 a[244:245], v13 offset:40960
    v_mfma_f32_16x16x32_bf16 a[84:87], a[212:215], v[164:167], a[84:87]
    s_add_u32 m0, s30, 49152
    s_mov_b32 s63, 49152
    buffer_load_dwordx4 v16, s[8:11], s63 offen offset:1024 lds
    v_mfma_f32_16x16x32_bf16 a[88:91], a[212:215], v[168:171], a[88:91]
    ds_read_b64_tr_b16 a[246:247], v13 offset:41984
    v_mfma_f32_16x16x32_bf16 a[92:95], a[212:215], v[172:175], a[92:95]
    s_waitcnt lgkmcnt(14)
    v_mfma_f32_16x16x32_bf16 a[96:99], a[216:219], v[160:163], a[96:99]
    ds_read_b64_tr_b16 a[248:249], v14 offset:40960
    v_mfma_f32_16x16x32_bf16 a[100:103], a[216:219], v[164:167], a[100:103]
    v_mfma_f32_16x16x32_bf16 a[104:107], a[216:219], v[168:171], a[104:107]
    ds_read_b64_tr_b16 a[250:251], v14 offset:41984
    v_mfma_f32_16x16x32_bf16 a[108:111], a[216:219], v[172:175], a[108:111]
    s_waitcnt lgkmcnt(14)
    v_mfma_f32_16x16x32_bf16 a[112:115], a[220:223], v[160:163], a[112:115]
    ds_read_b64_tr_b16 a[252:253], v15 offset:40960
    v_mfma_f32_16x16x32_bf16 a[116:119], a[220:223], v[164:167], a[116:119]
    v_mfma_f32_16x16x32_bf16 a[120:123], a[220:223], v[168:171], a[120:123]
    ds_read_b64_tr_b16 a[254:255], v15 offset:41984
    v_mfma_f32_16x16x32_bf16 a[124:127], a[220:223], v[172:175], a[124:127]
    s_waitcnt lgkmcnt(14)
    v_mfma_f32_16x16x32_bf16 a[0:3], a[224:227], v[176:179], a[0:3]
    ds_read_b64_tr_b16 a[192:193], v8 offset:49152
    v_mfma_f32_16x16x32_bf16 a[4:7], a[224:227], v[180:183], a[4:7]
    v_mfma_f32_16x16x32_bf16 a[8:11], a[224:227], v[184:187], a[8:11]
    ds_read_b64_tr_b16 a[194:195], v8 offset:50176
    v_mfma_f32_16x16x32_bf16 a[12:15], a[224:227], v[188:191], a[12:15]
    s_waitcnt lgkmcnt(14)
    v_mfma_f32_16x16x32_bf16 a[16:19], a[228:231], v[176:179], a[16:19]
    ds_read_b64_tr_b16 a[196:197], v9 offset:49152
    v_mfma_f32_16x16x32_bf16 a[20:23], a[228:231], v[180:183], a[20:23]
    v_mfma_f32_16x16x32_bf16 a[24:27], a[228:231], v[184:187], a[24:27]
    ds_read_b64_tr_b16 a[198:199], v9 offset:50176
    v_mfma_f32_16x16x32_bf16 a[28:31], a[228:231], v[188:191], a[28:31]
    s_waitcnt lgkmcnt(14)
    v_mfma_f32_16x16x32_bf16 a[32:35], a[232:235], v[176:179], a[32:35]
    ds_read_b64_tr_b16 a[200:201], v10 offset:49152
    v_mfma_f32_16x16x32_bf16 a[36:39], a[232:235], v[180:183], a[36:39]
    v_mfma_f32_16x16x32_bf16 a[40:43], a[232:235], v[184:187], a[40:43]
    ds_read_b64_tr_b16 a[202:203], v10 offset:50176
    v_mfma_f32_16x16x32_bf16 a[44:47], a[232:235], v[188:191], a[44:47]
    s_waitcnt lgkmcnt(14)
    v_mfma_f32_16x16x32_bf16 a[48:51], a[236:239], v[176:179], a[48:51]
    ds_read_b64_tr_b16 a[204:205], v11 offset:49152
    v_mfma_f32_16x16x32_bf16 a[52:55], a[236:239], v[180:183], a[52:55]
    v_mfma_f32_16x16x32_bf16 a[56:59], a[236:239], v[184:187], a[56:59]
    ds_read_b64_tr_b16 a[206:207], v11 offset:50176
    v_mfma_f32_16x16x32_bf16 a[60:63], a[236:239], v[188:191], a[60:63]
    s_waitcnt lgkmcnt(14)
    v_mfma_f32_16x16x32_bf16 a[64:67], a[240:243], v[176:179], a[64:67]
    ds_read_b64_tr_b16 a[208:209], v12 offset:49152
    v_mfma_f32_16x16x32_bf16 a[68:71], a[240:243], v[180:183], a[68:71]
    v_mfma_f32_16x16x32_bf16 a[72:75], a[240:243], v[184:187], a[72:75]
    ds_read_b64_tr_b16 a[210:211], v12 offset:50176
    v_mfma_f32_16x16x32_bf16 a[76:79], a[240:243], v[188:191], a[76:79]
    s_waitcnt lgkmcnt(14)
    v_mfma_f32_16x16x32_bf16 a[80:83], a[244:247], v[176:179], a[80:83]
    ds_read_b64_tr_b16 a[212:213], v13 offset:49152
    v_mfma_f32_16x16x32_bf16 a[84:87], a[244:247], v[180:183], a[84:87]
    v_mfma_f32_16x16x32_bf16 a[88:91], a[244:247], v[184:187], a[88:91]
    ds_read_b64_tr_b16 a[214:215], v13 offset:50176
    v_mfma_f32_16x16x32_bf16 a[92:95], a[244:247], v[188:191], a[92:95]
    s_waitcnt lgkmcnt(14)
    v_mfma_f32_16x16x32_bf16 a[96:99], a[248:251], v[176:179], a[96:99]
    ds_read_b64_tr_b16 a[216:217], v14 offset:49152
    v_mfma_f32_16x16x32_bf16 a[100:103], a[248:251], v[180:183], a[100:103]
    v_mfma_f32_16x16x32_bf16 a[104:107], a[248:251], v[184:187], a[104:107]
    ds_read_b64_tr_b16 a[218:219], v14 offset:50176
    v_mfma_f32_16x16x32_bf16 a[108:111], a[248:251], v[188:191], a[108:111]
    s_waitcnt lgkmcnt(14)
    v_mfma_f32_16x16x32_bf16 a[112:115], a[252:255], v[176:179], a[112:115]
    ds_read_b64_tr_b16 a[220:221], v15 offset:49152
    v_mfma_f32_16x16x32_bf16 a[116:119], a[252:255], v[180:183], a[116:119]
    v_mfma_f32_16x16x32_bf16 a[120:123], a[252:255], v[184:187], a[120:123]
    ds_read_b64_tr_b16 a[222:223], v15 offset:50176
    v_mfma_f32_16x16x32_bf16 a[124:127], a[252:255], v[188:191], a[124:127]
    s_waitcnt vmcnt(23)
    s_waitcnt lgkmcnt(14)
    v_mfma_f32_16x16x32_bf16 a[0:3], a[192:195], v[192:195], a[0:3]
    ds_read_b64_tr_b16 a[224:225], v8 offset:57344
    v_mfma_f32_16x16x32_bf16 a[4:7], a[192:195], v[196:199], a[4:7]
    v_mfma_f32_16x16x32_bf16 a[8:11], a[192:195], v[200:203], a[8:11]
    ds_read_b64_tr_b16 a[226:227], v8 offset:58368
    v_mfma_f32_16x16x32_bf16 a[12:15], a[192:195], v[204:207], a[12:15]
    s_waitcnt lgkmcnt(14)
    v_mfma_f32_16x16x32_bf16 a[16:19], a[196:199], v[192:195], a[16:19]
    ds_read_b64_tr_b16 a[228:229], v9 offset:57344
    v_mfma_f32_16x16x32_bf16 a[20:23], a[196:199], v[196:199], a[20:23]
    v_mfma_f32_16x16x32_bf16 a[24:27], a[196:199], v[200:203], a[24:27]
    ds_read_b64_tr_b16 a[230:231], v9 offset:58368
    v_mfma_f32_16x16x32_bf16 a[28:31], a[196:199], v[204:207], a[28:31]
    s_waitcnt lgkmcnt(14)
    v_mfma_f32_16x16x32_bf16 a[32:35], a[200:203], v[192:195], a[32:35]
    ds_read_b64_tr_b16 a[232:233], v10 offset:57344
    v_mfma_f32_16x16x32_bf16 a[36:39], a[200:203], v[196:199], a[36:39]
    v_mfma_f32_16x16x32_bf16 a[40:43], a[200:203], v[200:203], a[40:43]
    ds_read_b64_tr_b16 a[234:235], v10 offset:58368
    v_mfma_f32_16x16x32_bf16 a[44:47], a[200:203], v[204:207], a[44:47]
    s_waitcnt lgkmcnt(14)
    v_mfma_f32_16x16x32_bf16 a[48:51], a[204:207], v[192:195], a[48:51]
    ds_read_b64_tr_b16 a[236:237], v11 offset:57344
    v_mfma_f32_16x16x32_bf16 a[52:55], a[204:207], v[196:199], a[52:55]
    v_mfma_f32_16x16x32_bf16 a[56:59], a[204:207], v[200:203], a[56:59]
    ds_read_b64_tr_b16 a[238:239], v11 offset:58368
    v_mfma_f32_16x16x32_bf16 a[60:63], a[204:207], v[204:207], a[60:63]
    s_waitcnt lgkmcnt(14)
    v_mfma_f32_16x16x32_bf16 a[64:67], a[208:211], v[192:195], a[64:67]
    ds_read_b64_tr_b16 a[240:241], v12 offset:57344
    v_mfma_f32_16x16x32_bf16 a[68:71], a[208:211], v[196:199], a[68:71]
    v_mfma_f32_16x16x32_bf16 a[72:75], a[208:211], v[200:203], a[72:75]
    ds_read_b64_tr_b16 a[242:243], v12 offset:58368
    v_mfma_f32_16x16x32_bf16 a[76:79], a[208:211], v[204:207], a[76:79]
    s_waitcnt lgkmcnt(14)
    v_mfma_f32_16x16x32_bf16 a[80:83], a[212:215], v[192:195], a[80:83]
    ds_read_b64_tr_b16 a[244:245], v13 offset:57344
    v_mfma_f32_16x16x32_bf16 a[84:87], a[212:215], v[196:199], a[84:87]
    v_mfma_f32_16x16x32_bf16 a[88:91], a[212:215], v[200:203], a[88:91]
    ds_read_b64_tr_b16 a[246:247], v13 offset:58368
    v_mfma_f32_16x16x32_bf16 a[92:95], a[212:215], v[204:207], a[92:95]
    s_waitcnt lgkmcnt(14)
    v_mfma_f32_16x16x32_bf16 a[96:99], a[216:219], v[192:195], a[96:99]
    ds_read_b64_tr_b16 a[248:249], v14 offset:57344
    v_mfma_f32_16x16x32_bf16 a[100:103], a[216:219], v[196:199], a[100:103]
    v_mfma_f32_16x16x32_bf16 a[104:107], a[216:219], v[200:203], a[104:107]
    ds_read_b64_tr_b16 a[250:251], v14 offset:58368
    v_mfma_f32_16x16x32_bf16 a[108:111], a[216:219], v[204:207], a[108:111]
    s_waitcnt lgkmcnt(14)
    v_mfma_f32_16x16x32_bf16 a[112:115], a[220:223], v[192:195], a[112:115]
    ds_read_b64_tr_b16 a[252:253], v15 offset:57344
    v_mfma_f32_16x16x32_bf16 a[116:119], a[220:223], v[196:199], a[116:119]
    v_mfma_f32_16x16x32_bf16 a[120:123], a[220:223], v[200:203], a[120:123]
    ds_read_b64_tr_b16 a[254:255], v15 offset:58368
    v_mfma_f32_16x16x32_bf16 a[124:127], a[220:223], v[204:207], a[124:127]
    s_waitcnt lgkmcnt(14)
    v_mfma_f32_16x16x32_bf16 a[0:3], a[224:227], v[208:211], a[0:3]
    v_mfma_f32_16x16x32_bf16 a[4:7], a[224:227], v[212:215], a[4:7]
    v_mfma_f32_16x16x32_bf16 a[8:11], a[224:227], v[216:219], a[8:11]
    v_mfma_f32_16x16x32_bf16 a[12:15], a[224:227], v[220:223], a[12:15]
    s_waitcnt lgkmcnt(12)
    v_mfma_f32_16x16x32_bf16 a[16:19], a[228:231], v[208:211], a[16:19]
    v_mfma_f32_16x16x32_bf16 a[20:23], a[228:231], v[212:215], a[20:23]
    v_mfma_f32_16x16x32_bf16 a[24:27], a[228:231], v[216:219], a[24:27]
    v_mfma_f32_16x16x32_bf16 a[28:31], a[228:231], v[220:223], a[28:31]
    s_waitcnt lgkmcnt(10)
    v_mfma_f32_16x16x32_bf16 a[32:35], a[232:235], v[208:211], a[32:35]
    v_mfma_f32_16x16x32_bf16 a[36:39], a[232:235], v[212:215], a[36:39]
    v_mfma_f32_16x16x32_bf16 a[40:43], a[232:235], v[216:219], a[40:43]
    v_mfma_f32_16x16x32_bf16 a[44:47], a[232:235], v[220:223], a[44:47]
    s_waitcnt lgkmcnt(8)
    v_mfma_f32_16x16x32_bf16 a[48:51], a[236:239], v[208:211], a[48:51]
    v_mfma_f32_16x16x32_bf16 a[52:55], a[236:239], v[212:215], a[52:55]
    v_mfma_f32_16x16x32_bf16 a[56:59], a[236:239], v[216:219], a[56:59]
    v_mfma_f32_16x16x32_bf16 a[60:63], a[236:239], v[220:223], a[60:63]
    s_waitcnt lgkmcnt(6)
    v_mfma_f32_16x16x32_bf16 a[64:67], a[240:243], v[208:211], a[64:67]
    v_mfma_f32_16x16x32_bf16 a[68:71], a[240:243], v[212:215], a[68:71]
    v_mfma_f32_16x16x32_bf16 a[72:75], a[240:243], v[216:219], a[72:75]
    v_mfma_f32_16x16x32_bf16 a[76:79], a[240:243], v[220:223], a[76:79]
    s_waitcnt lgkmcnt(4)
    v_mfma_f32_16x16x32_bf16 a[80:83], a[244:247], v[208:211], a[80:83]
    v_mfma_f32_16x16x32_bf16 a[84:87], a[244:247], v[212:215], a[84:87]
    v_mfma_f32_16x16x32_bf16 a[88:91], a[244:247], v[216:219], a[88:91]
    v_mfma_f32_16x16x32_bf16 a[92:95], a[244:247], v[220:223], a[92:95]
    s_waitcnt lgkmcnt(2)
    v_mfma_f32_16x16x32_bf16 a[96:99], a[248:251], v[208:211], a[96:99]
    v_mfma_f32_16x16x32_bf16 a[100:103], a[248:251], v[212:215], a[100:103]
    v_mfma_f32_16x16x32_bf16 a[104:107], a[248:251], v[216:219], a[104:107]
    v_mfma_f32_16x16x32_bf16 a[108:111], a[248:251], v[220:223], a[108:111]
    s_waitcnt lgkmcnt(0)
    v_mfma_f32_16x16x32_bf16 a[112:115], a[252:255], v[208:211], a[112:115]
    v_mfma_f32_16x16x32_bf16 a[116:119], a[252:255], v[212:215], a[116:119]
    v_mfma_f32_16x16x32_bf16 a[120:123], a[252:255], v[216:219], a[120:123]
    v_mfma_f32_16x16x32_bf16 a[124:127], a[252:255], v[220:223], a[124:127]
    s_barrier
    s_mov_b32 s16, s66
    s_mov_b32 s17, s67
    s_mov_b32 s18, 0x80000
    s_mov_b32 s19, 0x20000
    s_add_u32 s20, s34, 0x400000
    s_addc_u32 s21, s35, 0
    s_mov_b32 s22, 0x200000
    s_mov_b32 s23, 0x20000
    s_lshl_b32 s41, s38, 16
    s_add_u32 s24, s34, 0x600000
    s_addc_u32 s25, s35, 0
    s_add_u32 s24, s24, s41
    s_addc_u32 s25, s25, 0
    s_mov_b32 s26, 0x10000
    s_mov_b32 s27, 0x20000
    s_add_u32 s48, s34, s41
    s_addc_u32 s49, s35, 0
    s_mov_b32 s50, 0x10000
    s_mov_b32 s51, 0x20000
    s_add_u32 s52, s34, 0x2000000
    s_addc_u32 s53, s35, 0
    s_mov_b32 s54, 0x20000
    s_mov_b32 s55, 0x20000
    s_lshr_b32 s43, s3, 1
    s_add_u32 s43, s43, 1
    s_and_b32 s42, s3, 1
    s_sub_u32 s41, 0, s43
    s_cmp_eq_u32 s42, 0
    s_cselect_b32 s43, s41, s43
    s_lshl_b32 s42, s38, 6
    s_add_u32 s43, s43, s42
    s_lshl_b32 s42, s3, 12
    v_add_u32 v24, s43, v20
    v_lshrrev_b32 v25, 4, v24
    v_lshlrev_b32 v25, 14, v25
    v_and_b32 v26, 15, v24
    v_lshl_add_u32 v25, v26, 4, v25
    v_lshl_add_u32 v25, v21, 8, v25
    v_add_u32 v25, s42, v25
    v_cmp_gt_u32 vcc, 0x800, v24
    v_mov_b32 v26, 0x80000000
    s_nop 0
    v_cndmask_b32 v233, v26, v25, vcc
    v_add_u32 v24, s43, v20
    v_add_u32 v24, 16, v24
    v_lshrrev_b32 v25, 4, v24
    v_lshlrev_b32 v25, 14, v25
    v_and_b32 v26, 15, v24
    v_lshl_add_u32 v25, v26, 4, v25
    v_lshl_add_u32 v25, v21, 8, v25
    v_add_u32 v25, s42, v25
    v_cmp_gt_u32 vcc, 0x800, v24
    v_mov_b32 v26, 0x80000000
    s_nop 0
    v_cndmask_b32 v234, v26, v25, vcc
    v_add_u32 v24, s43, v20
    v_add_u32 v24, 32, v24
    v_lshrrev_b32 v25, 4, v24
    v_lshlrev_b32 v25, 14, v25
    v_and_b32 v26, 15, v24
    v_lshl_add_u32 v25, v26, 4, v25
    v_lshl_add_u32 v25, v21, 8, v25
    v_add_u32 v25, s42, v25
    v_cmp_gt_u32 vcc, 0x800, v24
    v_mov_b32 v26, 0x80000000
    s_nop 0
    v_cndmask_b32 v235, v26, v25, vcc
    v_add_u32 v24, s43, v20
    v_add_u32 v24, 48, v24
    v_lshrrev_b32 v25, 4, v24
    v_lshlrev_b32 v25, 14, v25
    v_and_b32 v26, 15, v24
    v_lshl_add_u32 v25, v26, 4, v25
    v_lshl_add_u32 v25, v21, 8, v25
    v_add_u32 v25, s42, v25
    v_cmp_gt_u32 vcc, 0x800, v24
    v_mov_b32 v26, 0x80000000
    s_nop 0
    v_cndmask_b32 v236, v26, v25, vcc
    v_lshrrev_b32 v24, 1, v21
    v_lshlrev_b32 v24, 8, v24
    v_lshl_add_u32 v24, v20, 4, v24
    v_and_b32 v25, 1, v21
    v_lshl_add_u32 v24, v25, 3, v24
    s_lshl_b32 s42, s3, 14
    s_lshl_b32 s43, s39, 11
    s_add_u32 s42, s42, s43
    v_add_u32 v24, s42, v24
    s_waitcnt vmcnt(14)
    v_cmp_ne_u32 vcc, s36, v28
    s_nop 4
    s_cmp_eq_u64 vcc, 0
    s_cbranch_scc1 L_pok_f1
    s_mov_b32 s37, 0
L_spin_f1:
    buffer_load_dword v28, v29, s[44:47], 0 offen sc1
    s_add_u32 s37, s37, 1
    s_cmp_gt_u32 s37, 0x20000
    s_cbranch_scc1 recurrent_scan__mha_block_cached__mixer_s_mlp__prompt_kernel_end
    s_waitcnt vmcnt(0)
    v_cmp_ne_u32 vcc, s36, v28
    s_nop 4
    s_cmp_lg_u64 vcc, 0
    s_cbranch_scc1 L_spin_f1
L_pok_f1:
    s_mov_b32 s33, 0x3e0293ee
    v_accvgpr_read_b32 v136, a0
    s_add_u32 m0, s61, 0
    s_add_u32 s63, s62, 0
    buffer_load_dwordx4 v232, s[16:19], s63 offen lds
    v_accvgpr_read_b32 v137, a1
    v_accvgpr_read_b32 v138, a2
    v_accvgpr_read_b32 v139, a3
    v_accvgpr_read_b32 v140, a16
    v_accvgpr_read_b32 v141, a17
    v_accvgpr_read_b32 v142, a18
    v_accvgpr_read_b32 v143, a19
    v_pk_mul_f32 v[136:137], s[32:33], v[136:137] op_sel:[1,0] op_sel_hi:[1,1]
    v_pk_mul_f32 v[138:139], s[32:33], v[138:139] op_sel:[1,0] op_sel_hi:[1,1]
    s_add_u32 m0, s61, 1024
    s_add_u32 s63, s62, 8192
    buffer_load_dwordx4 v232, s[16:19], s63 offen lds
    v_pk_mul_f32 v[140:141], s[32:33], v[140:141] op_sel:[1,0] op_sel_hi:[1,1]
    v_pk_mul_f32 v[142:143], s[32:33], v[142:143] op_sel:[1,0] op_sel_hi:[1,1]
    v_cvt_pk_bf16_f32 v164, v136, v137
    v_cvt_pk_bf16_f32 v165, v138, v139
    v_cvt_pk_bf16_f32 v166, v140, v141
    v_cvt_pk_bf16_f32 v167, v142, v143
    s_nop 0
    v_permlane32_swap_b32 v164, v166
    s_nop 0
    v_permlane32_swap_b32 v165, v167
    s_nop 0
    v_permlane16_swap_b32 v164, v166
    s_add_u32 m0, s61, 2048
    s_add_u32 s63, s62, 16384
    buffer_load_dwordx4 v232, s[16:19], s63 offen lds
    v_permlane16_swap_b32 v165, v167
    v_accvgpr_read_b32 v136, a32
    v_accvgpr_read_b32 v137, a33
    v_accvgpr_read_b32 v138, a34
    v_accvgpr_read_b32 v139, a35
    v_accvgpr_read_b32 v140, a48
    v_accvgpr_read_b32 v141, a49
    v_accvgpr_read_b32 v142, a50
    v_accvgpr_read_b32 v143, a51
    s_add_u32 m0, s61, 3072
    s_add_u32 s63, s62, 24576
    buffer_load_dwordx4 v232, s[16:19], s63 offen lds
    v_pk_mul_f32 v[136:137], s[32:33], v[136:137] op_sel:[1,0] op_sel_hi:[1,1]
    v_pk_mul_f32 v[138:139], s[32:33], v[138:139] op_sel:[1,0] op_sel_hi:[1,1]
    v_pk_mul_f32 v[140:141], s[32:33], v[140:141] op_sel:[1,0] op_sel_hi:[1,1]
    v_pk_mul_f32 v[142:143], s[32:33], v[142:143] op_sel:[1,0] op_sel_hi:[1,1]
    v_cvt_pk_bf16_f32 v168, v136, v137
    v_cvt_pk_bf16_f32 v169, v138, v139
    v_cvt_pk_bf16_f32 v170, v140, v141
    v_cvt_pk_bf16_f32 v171, v142, v143
    s_nop 0
    v_permlane32_swap_b32 v168, v170
    s_mov_b32 s63, 0
    buffer_load_dwordx4 a[128:131], v233, s[20:23], s63 offen sc1
    v_permlane32_swap_b32 v169, v171
    v_permlane16_swap_b32 v168, v170
    s_nop 0
    v_permlane16_swap_b32 v169, v171
    v_accvgpr_read_b32 v136, a64
    v_accvgpr_read_b32 v137, a65
    v_accvgpr_read_b32 v138, a66
    v_accvgpr_read_b32 v139, a67
    v_accvgpr_read_b32 v140, a80
    v_accvgpr_read_b32 v141, a81
    s_mov_b32 s63, 0
    buffer_load_dwordx4 a[132:135], v234, s[20:23], s63 offen sc1
    v_accvgpr_read_b32 v142, a82
    v_accvgpr_read_b32 v143, a83
    v_pk_mul_f32 v[136:137], s[32:33], v[136:137] op_sel:[1,0] op_sel_hi:[1,1]
    v_pk_mul_f32 v[138:139], s[32:33], v[138:139] op_sel:[1,0] op_sel_hi:[1,1]
    v_pk_mul_f32 v[140:141], s[32:33], v[140:141] op_sel:[1,0] op_sel_hi:[1,1]
    v_pk_mul_f32 v[142:143], s[32:33], v[142:143] op_sel:[1,0] op_sel_hi:[1,1]
    v_cvt_pk_bf16_f32 v172, v136, v137
    v_cvt_pk_bf16_f32 v173, v138, v139
    v_cvt_pk_bf16_f32 v174, v140, v141
    s_mov_b32 s63, 0
    buffer_load_dwordx4 a[136:139], v235, s[20:23], s63 offen sc1
    v_cvt_pk_bf16_f32 v175, v142, v143
    v_permlane32_swap_b32 v172, v174
    s_nop 0
    v_permlane32_swap_b32 v173, v175
    s_nop 0
    v_permlane16_swap_b32 v172, v174
    s_nop 0
    v_permlane16_swap_b32 v173, v175
    v_accvgpr_read_b32 v136, a96
    v_accvgpr_read_b32 v137, a97
    v_accvgpr_read_b32 v138, a98
    v_accvgpr_read_b32 v139, a99
    s_mov_b32 s63, 0
    buffer_load_dwordx4 a[140:143], v236, s[20:23], s63 offen sc1
    v_accvgpr_read_b32 v140, a112
    v_accvgpr_read_b32 v141, a113
    v_accvgpr_read_b32 v142, a114
    v_accvgpr_read_b32 v143, a115
    v_pk_mul_f32 v[136:137], s[32:33], v[136:137] op_sel:[1,0] op_sel_hi:[1,1]
    v_pk_mul_f32 v[138:139], s[32:33], v[138:139] op_sel:[1,0] op_sel_hi:[1,1]
    v_pk_mul_f32 v[140:141], s[32:33], v[140:141] op_sel:[1,0] op_sel_hi:[1,1]
    v_pk_mul_f32 v[142:143], s[32:33], v[142:143] op_sel:[1,0] op_sel_hi:[1,1]
    v_cvt_pk_bf16_f32 v176, v136, v137
    s_add_u32 m0, s61, 4096
    s_add_u32 s63, s62, 32768
    buffer_load_dwordx4 v232, s[16:19], s63 offen lds
    v_cvt_pk_bf16_f32 v177, v138, v139
    v_cvt_pk_bf16_f32 v178, v140, v141
    v_cvt_pk_bf16_f32 v179, v142, v143
    s_nop 0
    v_permlane32_swap_b32 v176, v178
    s_nop 0
    v_permlane32_swap_b32 v177, v179
    s_nop 0
    v_permlane16_swap_b32 v176, v178
    s_nop 0
    v_permlane16_swap_b32 v177, v179
    v_accvgpr_read_b32 v136, a4
    v_accvgpr_read_b32 v137, a5
    s_add_u32 m0, s61, 5120
    s_add_u32 s63, s62, 40960
    buffer_load_dwordx4 v232, s[16:19], s63 offen lds
    v_accvgpr_read_b32 v138, a6
    v_accvgpr_read_b32 v139, a7
    v_accvgpr_read_b32 v140, a20
    v_accvgpr_read_b32 v141, a21
    v_accvgpr_read_b32 v142, a22
    v_accvgpr_read_b32 v143, a23
    v_pk_mul_f32 v[136:137], s[32:33], v[136:137] op_sel:[1,0] op_sel_hi:[1,1]
    v_pk_mul_f32 v[138:139], s[32:33], v[138:139] op_sel:[1,0] op_sel_hi:[1,1]
    v_pk_mul_f32 v[140:141], s[32:33], v[140:141] op_sel:[1,0] op_sel_hi:[1,1]
    s_add_u32 m0, s61, 6144
    s_add_u32 s63, s62, 49152
    buffer_load_dwordx4 v232, s[16:19], s63 offen lds
    v_pk_mul_f32 v[142:143], s[32:33], v[142:143] op_sel:[1,0] op_sel_hi:[1,1]
    v_cvt_pk_bf16_f32 v180, v136, v137
    v_cvt_pk_bf16_f32 v181, v138, v139
    v_cvt_pk_bf16_f32 v182, v140, v141
    v_cvt_pk_bf16_f32 v183, v142, v143
    s_nop 0
    v_permlane32_swap_b32 v180, v182
    s_nop 0
    v_permlane32_swap_b32 v181, v183
    s_nop 0
    v_permlane16_swap_b32 v180, v182
    s_nop 0
    v_permlane16_swap_b32 v181, v183
    s_add_u32 m0, s61, 7168
    s_add_u32 s63, s62, 57344
    buffer_load_dwordx4 v232, s[16:19], s63 offen lds
    v_accvgpr_read_b32 v136, a36
    v_accvgpr_read_b32 v137, a37
    v_accvgpr_read_b32 v138, a38
    v_accvgpr_read_b32 v139, a39
    v_accvgpr_read_b32 v140, a52
    v_accvgpr_read_b32 v141, a53
    v_accvgpr_read_b32 v142, a54
    v_accvgpr_read_b32 v143, a55
    v_pk_mul_f32 v[136:137], s[32:33], v[136:137] op_sel:[1,0] op_sel_hi:[1,1]
    s_mov_b32 s63, 1024
    buffer_load_dwordx4 a[144:147], v233, s[20:23], s63 offen sc1
    v_pk_mul_f32 v[138:139], s[32:33], v[138:139] op_sel:[1,0] op_sel_hi:[1,1]
    v_pk_mul_f32 v[140:141], s[32:33], v[140:141] op_sel:[1,0] op_sel_hi:[1,1]
    v_pk_mul_f32 v[142:143], s[32:33], v[142:143] op_sel:[1,0] op_sel_hi:[1,1]
    v_cvt_pk_bf16_f32 v184, v136, v137
    v_cvt_pk_bf16_f32 v185, v138, v139
    v_cvt_pk_bf16_f32 v186, v140, v141
    v_cvt_pk_bf16_f32 v187, v142, v143
    s_nop 0
    v_permlane32_swap_b32 v184, v186
    s_nop 0
    v_permlane32_swap_b32 v185, v187
    s_mov_b32 s63, 1024
    buffer_load_dwordx4 a[148:151], v234, s[20:23], s63 offen sc1
    v_permlane16_swap_b32 v184, v186
    v_permlane16_swap_b32 v185, v187
    v_accvgpr_read_b32 v136, a68
    v_accvgpr_read_b32 v137, a69
    v_accvgpr_read_b32 v138, a70
    v_accvgpr_read_b32 v139, a71
    v_accvgpr_read_b32 v140, a84
    v_accvgpr_read_b32 v141, a85
    v_accvgpr_read_b32 v142, a86
    s_mov_b32 s63, 1024
    buffer_load_dwordx4 a[152:155], v235, s[20:23], s63 offen sc1
    v_accvgpr_read_b32 v143, a87
    v_pk_mul_f32 v[136:137], s[32:33], v[136:137] op_sel:[1,0] op_sel_hi:[1,1]
    v_pk_mul_f32 v[138:139], s[32:33], v[138:139] op_sel:[1,0] op_sel_hi:[1,1]
    v_pk_mul_f32 v[140:141], s[32:33], v[140:141] op_sel:[1,0] op_sel_hi:[1,1]
    v_pk_mul_f32 v[142:143], s[32:33], v[142:143] op_sel:[1,0] op_sel_hi:[1,1]
    v_cvt_pk_bf16_f32 v188, v136, v137
    v_cvt_pk_bf16_f32 v189, v138, v139
    v_cvt_pk_bf16_f32 v190, v140, v141
    v_cvt_pk_bf16_f32 v191, v142, v143
    s_mov_b32 s63, 1024
    buffer_load_dwordx4 a[156:159], v236, s[20:23], s63 offen sc1
    v_permlane32_swap_b32 v188, v190
    v_permlane32_swap_b32 v189, v191
    s_nop 0
    v_permlane16_swap_b32 v188, v190
    s_nop 0
    v_permlane16_swap_b32 v189, v191
    v_accvgpr_read_b32 v136, a100
    v_accvgpr_read_b32 v137, a101
    v_accvgpr_read_b32 v138, a102
    v_accvgpr_read_b32 v139, a103
    v_accvgpr_read_b32 v140, a116
    s_add_u32 m0, s61, 8192
    s_add_u32 s63, s62, 65536
    buffer_load_dwordx4 v232, s[16:19], s63 offen lds
    v_accvgpr_read_b32 v141, a117
    v_accvgpr_read_b32 v142, a118
    v_accvgpr_read_b32 v143, a119
    v_pk_mul_f32 v[136:137], s[32:33], v[136:137] op_sel:[1,0] op_sel_hi:[1,1]
    v_pk_mul_f32 v[138:139], s[32:33], v[138:139] op_sel:[1,0] op_sel_hi:[1,1]
    v_pk_mul_f32 v[140:141], s[32:33], v[140:141] op_sel:[1,0] op_sel_hi:[1,1]
    v_pk_mul_f32 v[142:143], s[32:33], v[142:143] op_sel:[1,0] op_sel_hi:[1,1]
    v_cvt_pk_bf16_f32 v192, v136, v137
    v_cvt_pk_bf16_f32 v193, v138, v139
    s_add_u32 m0, s61, 9216
    s_add_u32 s63, s62, 73728
    buffer_load_dwordx4 v232, s[16:19], s63 offen lds
    v_cvt_pk_bf16_f32 v194, v140, v141
    v_cvt_pk_bf16_f32 v195, v142, v143
    s_nop 0
    v_permlane32_swap_b32 v192, v194
    s_nop 0
    v_permlane32_swap_b32 v193, v195
    s_nop 0
    v_permlane16_swap_b32 v192, v194
    s_nop 0
    v_permlane16_swap_b32 v193, v195
    v_accvgpr_read_b32 v136, a8
    v_accvgpr_read_b32 v137, a9
    v_accvgpr_read_b32 v138, a10
    s_add_u32 m0, s61, 10240
    s_add_u32 s63, s62, 81920
    buffer_load_dwordx4 v232, s[16:19], s63 offen lds
    v_accvgpr_read_b32 v139, a11
    v_accvgpr_read_b32 v140, a24
    v_accvgpr_read_b32 v141, a25
    v_accvgpr_read_b32 v142, a26
    v_accvgpr_read_b32 v143, a27
    v_pk_mul_f32 v[136:137], s[32:33], v[136:137] op_sel:[1,0] op_sel_hi:[1,1]
    v_pk_mul_f32 v[138:139], s[32:33], v[138:139] op_sel:[1,0] op_sel_hi:[1,1]
    v_pk_mul_f32 v[140:141], s[32:33], v[140:141] op_sel:[1,0] op_sel_hi:[1,1]
    v_pk_mul_f32 v[142:143], s[32:33], v[142:143] op_sel:[1,0] op_sel_hi:[1,1]
    s_add_u32 m0, s61, 11264
    s_add_u32 s63, s62, 90112
    buffer_load_dwordx4 v232, s[16:19], s63 offen lds
    v_cvt_pk_bf16_f32 v196, v136, v137
    v_cvt_pk_bf16_f32 v197, v138, v139
    v_cvt_pk_bf16_f32 v198, v140, v141
    v_cvt_pk_bf16_f32 v199, v142, v143
    s_nop 0
    v_permlane32_swap_b32 v196, v198
    s_nop 0
    v_permlane32_swap_b32 v197, v199
    s_nop 0
    v_permlane16_swap_b32 v196, v198
    s_nop 0
    v_permlane16_swap_b32 v197, v199
    v_accvgpr_read_b32 v136, a40
    s_mov_b32 s63, 2048
    buffer_load_dwordx4 a[160:163], v233, s[20:23], s63 offen sc1
    v_accvgpr_read_b32 v137, a41
    v_accvgpr_read_b32 v138, a42
    v_accvgpr_read_b32 v139, a43
    v_accvgpr_read_b32 v140, a56
    v_accvgpr_read_b32 v141, a57
    v_accvgpr_read_b32 v142, a58
    v_accvgpr_read_b32 v143, a59
    v_pk_mul_f32 v[136:137], s[32:33], v[136:137] op_sel:[1,0] op_sel_hi:[1,1]
    v_pk_mul_f32 v[138:139], s[32:33], v[138:139] op_sel:[1,0] op_sel_hi:[1,1]
    s_mov_b32 s63, 2048
    buffer_load_dwordx4 a[164:167], v234, s[20:23], s63 offen sc1
    v_pk_mul_f32 v[140:141], s[32:33], v[140:141] op_sel:[1,0] op_sel_hi:[1,1]
    v_pk_mul_f32 v[142:143], s[32:33], v[142:143] op_sel:[1,0] op_sel_hi:[1,1]
    v_cvt_pk_bf16_f32 v200, v136, v137
    v_cvt_pk_bf16_f32 v201, v138, v139
    v_cvt_pk_bf16_f32 v202, v140, v141
    v_cvt_pk_bf16_f32 v203, v142, v143
    s_nop 0
    v_permlane32_swap_b32 v200, v202
    s_nop 0
    v_permlane32_swap_b32 v201, v203
    s_nop 0
    v_permlane16_swap_b32 v200, v202
    s_mov_b32 s63, 2048
    buffer_load_dwordx4 a[168:171], v235, s[20:23], s63 offen sc1
    v_permlane16_swap_b32 v201, v203
    v_accvgpr_read_b32 v136, a72
    v_accvgpr_read_b32 v137, a73
    v_accvgpr_read_b32 v138, a74
    v_accvgpr_read_b32 v139, a75
    v_accvgpr_read_b32 v140, a88
    v_accvgpr_read_b32 v141, a89
    v_accvgpr_read_b32 v142, a90
    v_accvgpr_read_b32 v143, a91
    s_mov_b32 s63, 2048
    buffer_load_dwordx4 a[172:175], v236, s[20:23], s63 offen sc1
    v_pk_mul_f32 v[136:137], s[32:33], v[136:137] op_sel:[1,0] op_sel_hi:[1,1]
    v_pk_mul_f32 v[138:139], s[32:33], v[138:139] op_sel:[1,0] op_sel_hi:[1,1]
    v_pk_mul_f32 v[140:141], s[32:33], v[140:141] op_sel:[1,0] op_sel_hi:[1,1]
    v_pk_mul_f32 v[142:143], s[32:33], v[142:143] op_sel:[1,0] op_sel_hi:[1,1]
    v_cvt_pk_bf16_f32 v204, v136, v137
    v_cvt_pk_bf16_f32 v205, v138, v139
    v_cvt_pk_bf16_f32 v206, v140, v141
    v_cvt_pk_bf16_f32 v207, v142, v143
    s_nop 0
    v_permlane32_swap_b32 v204, v206
    s_add_u32 m0, s61, 12288
    s_add_u32 s63, s62, 98304
    buffer_load_dwordx4 v232, s[16:19], s63 offen lds
    v_permlane32_swap_b32 v205, v207
    v_permlane16_swap_b32 v204, v206
    s_nop 0
    v_permlane16_swap_b32 v205, v207
    v_accvgpr_read_b32 v136, a104
    v_accvgpr_read_b32 v137, a105
    v_accvgpr_read_b32 v138, a106
    v_accvgpr_read_b32 v139, a107
    v_accvgpr_read_b32 v140, a120
    v_accvgpr_read_b32 v141, a121
    s_add_u32 m0, s61, 13312
    s_add_u32 s63, s62, 106496
    buffer_load_dwordx4 v232, s[16:19], s63 offen lds
    v_accvgpr_read_b32 v142, a122
    v_accvgpr_read_b32 v143, a123
    v_pk_mul_f32 v[136:137], s[32:33], v[136:137] op_sel:[1,0] op_sel_hi:[1,1]
    v_pk_mul_f32 v[138:139], s[32:33], v[138:139] op_sel:[1,0] op_sel_hi:[1,1]
    v_pk_mul_f32 v[140:141], s[32:33], v[140:141] op_sel:[1,0] op_sel_hi:[1,1]
    v_pk_mul_f32 v[142:143], s[32:33], v[142:143] op_sel:[1,0] op_sel_hi:[1,1]
    v_cvt_pk_bf16_f32 v208, v136, v137
    v_cvt_pk_bf16_f32 v209, v138, v139
    v_cvt_pk_bf16_f32 v210, v140, v141
    s_add_u32 m0, s61, 14336
    s_add_u32 s63, s62, 114688
    buffer_load_dwordx4 v232, s[16:19], s63 offen lds
    v_cvt_pk_bf16_f32 v211, v142, v143
    v_permlane32_swap_b32 v208, v210
    s_nop 0
    v_permlane32_swap_b32 v209, v211
    s_nop 0
    v_permlane16_swap_b32 v208, v210
    s_nop 0
    v_permlane16_swap_b32 v209, v211
    v_accvgpr_read_b32 v136, a12
    v_accvgpr_read_b32 v137, a13
    v_accvgpr_read_b32 v138, a14
    v_accvgpr_read_b32 v139, a15
    s_add_u32 m0, s61, 15360
    s_add_u32 s63, s62, 122880
    buffer_load_dwordx4 v232, s[16:19], s63 offen lds
    v_accvgpr_read_b32 v140, a28
    v_accvgpr_read_b32 v141, a29
    v_accvgpr_read_b32 v142, a30
    v_accvgpr_read_b32 v143, a31
    v_pk_mul_f32 v[136:137], s[32:33], v[136:137] op_sel:[1,0] op_sel_hi:[1,1]
    v_pk_mul_f32 v[138:139], s[32:33], v[138:139] op_sel:[1,0] op_sel_hi:[1,1]
    v_pk_mul_f32 v[140:141], s[32:33], v[140:141] op_sel:[1,0] op_sel_hi:[1,1]
    v_pk_mul_f32 v[142:143], s[32:33], v[142:143] op_sel:[1,0] op_sel_hi:[1,1]
    v_cvt_pk_bf16_f32 v212, v136, v137
    s_mov_b32 s63, 3072
    buffer_load_dwordx4 a[176:179], v233, s[20:23], s63 offen sc1
    v_cvt_pk_bf16_f32 v213, v138, v139
    v_cvt_pk_bf16_f32 v214, v140, v141
    v_cvt_pk_bf16_f32 v215, v142, v143
    s_nop 0
    v_permlane32_swap_b32 v212, v214
    s_nop 0
    v_permlane32_swap_b32 v213, v215
    s_nop 0
    v_permlane16_swap_b32 v212, v214
    s_nop 0
    v_permlane16_swap_b32 v213, v215
    v_accvgpr_read_b32 v136, a44
    v_accvgpr_read_b32 v137, a45
    s_mov_b32 s63, 3072
    buffer_load_dwordx4 a[180:183], v234, s[20:23], s63 offen sc1
    v_accvgpr_read_b32 v138, a46
    v_accvgpr_read_b32 v139, a47
    v_accvgpr_read_b32 v140, a60
    v_accvgpr_read_b32 v141, a61
    v_accvgpr_read_b32 v142, a62
    v_accvgpr_read_b32 v143, a63
    v_pk_mul_f32 v[136:137], s[32:33], v[136:137] op_sel:[1,0] op_sel_hi:[1,1]
    v_pk_mul_f32 v[138:139], s[32:33], v[138:139] op_sel:[1,0] op_sel_hi:[1,1]
    v_pk_mul_f32 v[140:141], s[32:33], v[140:141] op_sel:[1,0] op_sel_hi:[1,1]
    s_mov_b32 s63, 3072
    buffer_load_dwordx4 a[184:187], v235, s[20:23], s63 offen sc1
    v_pk_mul_f32 v[142:143], s[32:33], v[142:143] op_sel:[1,0] op_sel_hi:[1,1]
    v_cvt_pk_bf16_f32 v216, v136, v137
    v_cvt_pk_bf16_f32 v217, v138, v139
    v_cvt_pk_bf16_f32 v218, v140, v141
    v_cvt_pk_bf16_f32 v219, v142, v143
    s_nop 0
    v_permlane32_swap_b32 v216, v218
    s_nop 0
    v_permlane32_swap_b32 v217, v219
    s_nop 0
    v_permlane16_swap_b32 v216, v218
    s_nop 0
    v_permlane16_swap_b32 v217, v219
    s_mov_b32 s63, 3072
    buffer_load_dwordx4 a[188:191], v236, s[20:23], s63 offen sc1
    v_accvgpr_read_b32 v136, a76
    v_accvgpr_read_b32 v137, a77
    v_accvgpr_read_b32 v138, a78
    v_accvgpr_read_b32 v139, a79
    v_accvgpr_read_b32 v140, a92
    v_accvgpr_read_b32 v141, a93
    v_accvgpr_read_b32 v142, a94
    v_accvgpr_read_b32 v143, a95
    v_pk_mul_f32 v[136:137], s[32:33], v[136:137] op_sel:[1,0] op_sel_hi:[1,1]
    buffer_load_dwordx2 v[128:129], v24, s[48:51], 0 offen offset:0 sc1
    v_pk_mul_f32 v[138:139], s[32:33], v[138:139] op_sel:[1,0] op_sel_hi:[1,1]
    v_pk_mul_f32 v[140:141], s[32:33], v[140:141] op_sel:[1,0] op_sel_hi:[1,1]
    v_pk_mul_f32 v[142:143], s[32:33], v[142:143] op_sel:[1,0] op_sel_hi:[1,1]
    v_cvt_pk_bf16_f32 v220, v136, v137
    v_cvt_pk_bf16_f32 v221, v138, v139
    v_cvt_pk_bf16_f32 v222, v140, v141
    v_cvt_pk_bf16_f32 v223, v142, v143
    s_nop 0
    v_permlane32_swap_b32 v220, v222
    s_nop 0
    v_permlane32_swap_b32 v221, v223
    buffer_load_dwordx2 v[130:131], v24, s[48:51], 0 offen offset:512 sc1
    v_permlane16_swap_b32 v220, v222
    v_permlane16_swap_b32 v221, v223
    v_accvgpr_read_b32 v136, a108
    v_accvgpr_read_b32 v137, a109
    v_accvgpr_read_b32 v138, a110
    v_accvgpr_read_b32 v139, a111
    v_accvgpr_read_b32 v140, a124
    v_accvgpr_read_b32 v141, a125
    v_accvgpr_read_b32 v142, a126
    buffer_load_dwordx2 v[132:133], v24, s[48:51], 0 offen offset:1024 sc1
    v_accvgpr_read_b32 v143, a127
    v_pk_mul_f32 v[136:137], s[32:33], v[136:137] op_sel:[1,0] op_sel_hi:[1,1]
    v_pk_mul_f32 v[138:139], s[32:33], v[138:139] op_sel:[1,0] op_sel_hi:[1,1]
    v_pk_mul_f32 v[140:141], s[32:33], v[140:141] op_sel:[1,0] op_sel_hi:[1,1]
    v_pk_mul_f32 v[142:143], s[32:33], v[142:143] op_sel:[1,0] op_sel_hi:[1,1]
    v_cvt_pk_bf16_f32 v224, v136, v137
    v_cvt_pk_bf16_f32 v225, v138, v139
    v_cvt_pk_bf16_f32 v226, v140, v141
    v_cvt_pk_bf16_f32 v227, v142, v143
    buffer_load_dwordx2 v[134:135], v24, s[48:51], 0 offen offset:1536 sc1
    v_permlane32_swap_b32 v224, v226
    v_permlane32_swap_b32 v225, v227
    s_nop 0
    v_permlane16_swap_b32 v224, v226
    s_nop 0
    v_permlane16_swap_b32 v225, v227
    v_mov_b32 v32, 0
    v_mov_b32 v33, 0
    v_mov_b32 v34, 0
    v_mov_b32 v35, 0
    v_mov_b32 v36, 0
    v_mov_b32 v37, 0
    v_mov_b32 v38, 0
    v_mov_b32 v39, 0
    v_mov_b32 v40, 0
    v_mov_b32 v41, 0
    v_mov_b32 v42, 0
    v_mov_b32 v43, 0
    v_mov_b32 v44, 0
    v_mov_b32 v45, 0
    v_mov_b32 v46, 0
    v_mov_b32 v47, 0
    v_mov_b32 v48, 0
    v_mov_b32 v49, 0
    v_mov_b32 v50, 0
    v_mov_b32 v51, 0
    v_mov_b32 v52, 0
    v_mov_b32 v53, 0
    v_mov_b32 v54, 0
    v_mov_b32 v55, 0
    v_mov_b32 v56, 0
    v_mov_b32 v57, 0
    v_mov_b32 v58, 0
    v_mov_b32 v59, 0
    v_mov_b32 v60, 0
    v_mov_b32 v61, 0
    v_mov_b32 v62, 0
    v_mov_b32 v63, 0
    v_mov_b32 v64, 0
    v_mov_b32 v65, 0
    v_mov_b32 v66, 0
    v_mov_b32 v67, 0
    v_mov_b32 v68, 0
    v_mov_b32 v69, 0
    v_mov_b32 v70, 0
    v_mov_b32 v71, 0
    v_mov_b32 v72, 0
    v_mov_b32 v73, 0
    v_mov_b32 v74, 0
    v_mov_b32 v75, 0
    v_mov_b32 v76, 0
    v_mov_b32 v77, 0
    v_mov_b32 v78, 0
    v_mov_b32 v79, 0
    v_mov_b32 v80, 0
    v_mov_b32 v81, 0
    v_mov_b32 v82, 0
    v_mov_b32 v83, 0
    v_mov_b32 v84, 0
    v_mov_b32 v85, 0
    v_mov_b32 v86, 0
    v_mov_b32 v87, 0
    v_mov_b32 v88, 0
    v_mov_b32 v89, 0
    v_mov_b32 v90, 0
    v_mov_b32 v91, 0
    v_mov_b32 v92, 0
    v_mov_b32 v93, 0
    v_mov_b32 v94, 0
    v_mov_b32 v95, 0
    s_waitcnt vmcnt(32)
    ds_read_b64_tr_b16 v[96:97], v228 offset:0
    ds_read_b64_tr_b16 v[98:99], v228 offset:2048
    ds_read_b64_tr_b16 v[100:101], v229 offset:0
    ds_read_b64_tr_b16 v[102:103], v229 offset:2048
    ds_read_b64_tr_b16 v[104:105], v230 offset:0
    ds_read_b64_tr_b16 v[106:107], v230 offset:2048
    ds_read_b64_tr_b16 v[108:109], v231 offset:0
    ds_read_b64_tr_b16 v[110:111], v231 offset:2048
    s_waitcnt vmcnt(24)
    s_waitcnt lgkmcnt(0)
    v_mfma_f32_16x16x32_bf16 v[32:35], v[96:99], a[128:131], v[32:35]
    ds_read_b64_tr_b16 v[112:113], v228 offset:4096
    v_mfma_f32_16x16x32_bf16 v[48:51], v[96:99], a[132:135], v[48:51]
    v_mfma_f32_16x16x32_bf16 v[64:67], v[96:99], a[136:139], v[64:67]
    ds_read_b64_tr_b16 v[114:115], v228 offset:6144
    v_mfma_f32_16x16x32_bf16 v[80:83], v[96:99], a[140:143], v[80:83]
    v_mfma_f32_16x16x32_bf16 v[36:39], v[100:103], a[128:131], v[36:39]
    ds_read_b64_tr_b16 v[116:117], v229 offset:4096
    v_mfma_f32_16x16x32_bf16 v[52:55], v[100:103], a[132:135], v[52:55]
    v_mfma_f32_16x16x32_bf16 v[68:71], v[100:103], a[136:139], v[68:71]
    ds_read_b64_tr_b16 v[118:119], v229 offset:6144
    v_mfma_f32_16x16x32_bf16 v[84:87], v[100:103], a[140:143], v[84:87]
    v_mfma_f32_16x16x32_bf16 v[40:43], v[104:107], a[128:131], v[40:43]
    ds_read_b64_tr_b16 v[120:121], v230 offset:4096
    v_mfma_f32_16x16x32_bf16 v[56:59], v[104:107], a[132:135], v[56:59]
    v_mfma_f32_16x16x32_bf16 v[72:75], v[104:107], a[136:139], v[72:75]
    ds_read_b64_tr_b16 v[122:123], v230 offset:6144
    v_mfma_f32_16x16x32_bf16 v[88:91], v[104:107], a[140:143], v[88:91]
    v_mfma_f32_16x16x32_bf16 v[44:47], v[108:111], a[128:131], v[44:47]
    ds_read_b64_tr_b16 v[124:125], v231 offset:4096
    v_mfma_f32_16x16x32_bf16 v[60:63], v[108:111], a[132:135], v[60:63]
    v_mfma_f32_16x16x32_bf16 v[76:79], v[108:111], a[136:139], v[76:79]
    ds_read_b64_tr_b16 v[126:127], v231 offset:6144
    v_mfma_f32_16x16x32_bf16 v[92:95], v[108:111], a[140:143], v[92:95]
    s_waitcnt vmcnt(16)
    s_waitcnt lgkmcnt(0)
    v_mfma_f32_16x16x32_bf16 v[32:35], v[112:115], a[144:147], v[32:35]
    ds_read_b64_tr_b16 v[96:97], v228 offset:8192
    v_mfma_f32_16x16x32_bf16 v[48:51], v[112:115], a[148:151], v[48:51]
    v_mfma_f32_16x16x32_bf16 v[64:67], v[112:115], a[152:155], v[64:67]
    ds_read_b64_tr_b16 v[98:99], v228 offset:10240
    v_mfma_f32_16x16x32_bf16 v[80:83], v[112:115], a[156:159], v[80:83]
    v_mfma_f32_16x16x32_bf16 v[36:39], v[116:119], a[144:147], v[36:39]
    ds_read_b64_tr_b16 v[100:101], v229 offset:8192
    v_mfma_f32_16x16x32_bf16 v[52:55], v[116:119], a[148:151], v[52:55]
    v_mfma_f32_16x16x32_bf16 v[68:71], v[116:119], a[152:155], v[68:71]
    ds_read_b64_tr_b16 v[102:103], v229 offset:10240
    v_mfma_f32_16x16x32_bf16 v[84:87], v[116:119], a[156:159], v[84:87]
    v_mfma_f32_16x16x32_bf16 v[40:43], v[120:123], a[144:147], v[40:43]
    ds_read_b64_tr_b16 v[104:105], v230 offset:8192
    v_mfma_f32_16x16x32_bf16 v[56:59], v[120:123], a[148:151], v[56:59]
    v_mfma_f32_16x16x32_bf16 v[72:75], v[120:123], a[152:155], v[72:75]
    ds_read_b64_tr_b16 v[106:107], v230 offset:10240
    v_mfma_f32_16x16x32_bf16 v[88:91], v[120:123], a[156:159], v[88:91]
    v_mfma_f32_16x16x32_bf16 v[44:47], v[124:127], a[144:147], v[44:47]
    ds_read_b64_tr_b16 v[108:109], v231 offset:8192
    v_mfma_f32_16x16x32_bf16 v[60:63], v[124:127], a[148:151], v[60:63]
    v_mfma_f32_16x16x32_bf16 v[76:79], v[124:127], a[152:155], v[76:79]
    ds_read_b64_tr_b16 v[110:111], v231 offset:10240
    v_mfma_f32_16x16x32_bf16 v[92:95], v[124:127], a[156:159], v[92:95]
    s_waitcnt vmcnt(8)
    s_waitcnt lgkmcnt(0)
    v_mfma_f32_16x16x32_bf16 v[32:35], v[96:99], a[160:163], v[32:35]
    ds_read_b64_tr_b16 v[112:113], v228 offset:12288
    v_mfma_f32_16x16x32_bf16 v[48:51], v[96:99], a[164:167], v[48:51]
    v_mfma_f32_16x16x32_bf16 v[64:67], v[96:99], a[168:171], v[64:67]
    ds_read_b64_tr_b16 v[114:115], v228 offset:14336
    v_mfma_f32_16x16x32_bf16 v[80:83], v[96:99], a[172:175], v[80:83]
    v_mfma_f32_16x16x32_bf16 v[36:39], v[100:103], a[160:163], v[36:39]
    ds_read_b64_tr_b16 v[116:117], v229 offset:12288
    v_mfma_f32_16x16x32_bf16 v[52:55], v[100:103], a[164:167], v[52:55]
    v_mfma_f32_16x16x32_bf16 v[68:71], v[100:103], a[168:171], v[68:71]
    ds_read_b64_tr_b16 v[118:119], v229 offset:14336
    v_mfma_f32_16x16x32_bf16 v[84:87], v[100:103], a[172:175], v[84:87]
    v_mfma_f32_16x16x32_bf16 v[40:43], v[104:107], a[160:163], v[40:43]
    ds_read_b64_tr_b16 v[120:121], v230 offset:12288
    v_mfma_f32_16x16x32_bf16 v[56:59], v[104:107], a[164:167], v[56:59]
    v_mfma_f32_16x16x32_bf16 v[72:75], v[104:107], a[168:171], v[72:75]
    ds_read_b64_tr_b16 v[122:123], v230 offset:14336
    v_mfma_f32_16x16x32_bf16 v[88:91], v[104:107], a[172:175], v[88:91]
    v_mfma_f32_16x16x32_bf16 v[44:47], v[108:111], a[160:163], v[44:47]
    ds_read_b64_tr_b16 v[124:125], v231 offset:12288
    v_mfma_f32_16x16x32_bf16 v[60:63], v[108:111], a[164:167], v[60:63]
    v_mfma_f32_16x16x32_bf16 v[76:79], v[108:111], a[168:171], v[76:79]
    ds_read_b64_tr_b16 v[126:127], v231 offset:14336
    v_mfma_f32_16x16x32_bf16 v[92:95], v[108:111], a[172:175], v[92:95]
    s_waitcnt vmcnt(4)
    s_waitcnt lgkmcnt(0)
    v_mfma_f32_16x16x32_bf16 v[32:35], v[112:115], a[176:179], v[32:35]
    v_mfma_f32_16x16x32_bf16 v[48:51], v[112:115], a[180:183], v[48:51]
    v_mfma_f32_16x16x32_bf16 v[64:67], v[112:115], a[184:187], v[64:67]
    v_mfma_f32_16x16x32_bf16 v[80:83], v[112:115], a[188:191], v[80:83]
    v_mfma_f32_16x16x32_bf16 v[36:39], v[116:119], a[176:179], v[36:39]
    v_mfma_f32_16x16x32_bf16 v[52:55], v[116:119], a[180:183], v[52:55]
    v_mfma_f32_16x16x32_bf16 v[68:71], v[116:119], a[184:187], v[68:71]
    v_mfma_f32_16x16x32_bf16 v[84:87], v[116:119], a[188:191], v[84:87]
    v_mfma_f32_16x16x32_bf16 v[40:43], v[120:123], a[176:179], v[40:43]
    v_mfma_f32_16x16x32_bf16 v[56:59], v[120:123], a[180:183], v[56:59]
    v_mfma_f32_16x16x32_bf16 v[72:75], v[120:123], a[184:187], v[72:75]
    v_mfma_f32_16x16x32_bf16 v[88:91], v[120:123], a[188:191], v[88:91]
    v_mfma_f32_16x16x32_bf16 v[44:47], v[124:127], a[176:179], v[44:47]
    v_mfma_f32_16x16x32_bf16 v[60:63], v[124:127], a[180:183], v[60:63]
    v_mfma_f32_16x16x32_bf16 v[76:79], v[124:127], a[184:187], v[76:79]
    v_mfma_f32_16x16x32_bf16 v[92:95], v[124:127], a[188:191], v[92:95]
    s_nop 7
    s_barrier
    v_add_u32 v24, s61, v19
    ds_write_b128 v24, v[32:35] offset:0
    ds_write_b128 v24, v[36:39] offset:1024
    ds_write_b128 v24, v[40:43] offset:2048
    ds_write_b128 v24, v[44:47] offset:3072
    ds_write_b128 v24, v[48:51] offset:4096
    ds_write_b128 v24, v[52:55] offset:5120
    ds_write_b128 v24, v[56:59] offset:6144
    ds_write_b128 v24, v[60:63] offset:7168
    ds_write_b128 v24, v[64:67] offset:8192
    ds_write_b128 v24, v[68:71] offset:9216
    ds_write_b128 v24, v[72:75] offset:10240
    ds_write_b128 v24, v[76:79] offset:11264
    ds_write_b128 v24, v[80:83] offset:12288
    ds_write_b128 v24, v[84:87] offset:13312
    ds_write_b128 v24, v[88:91] offset:14336
    ds_write_b128 v24, v[92:95] offset:15360
    s_waitcnt lgkmcnt(0)
    s_barrier
    s_lshl_b32 s60, s3, 12
    v_add_u32 v24, s60, v19
    v_add_u32 v25, 98304, v24
    v_add_u32 v26, 131072, v24
    ds_read_b128 v[32:35], v25 offset:0
    ds_read_b128 v[36:39], v25 offset:1024
    ds_read_b128 v[40:43], v25 offset:2048
    ds_read_b128 v[44:47], v25 offset:3072
    ds_read_b128 v[48:51], v25 offset:16384
    ds_read_b128 v[52:55], v25 offset:17408
    ds_read_b128 v[56:59], v25 offset:18432
    ds_read_b128 v[60:63], v25 offset:19456
    ds_read_b128 v[64:67], v26 offset:0
    ds_read_b128 v[68:71], v26 offset:1024
    ds_read_b128 v[72:75], v26 offset:2048
    ds_read_b128 v[76:79], v26 offset:3072
    ds_read_b128 v[80:83], v26 offset:16384
    ds_read_b128 v[84:87], v26 offset:17408
    ds_read_b128 v[88:91], v26 offset:18432
    ds_read_b128 v[92:95], v26 offset:19456
    s_waitcnt lgkmcnt(0)
    v_pk_add_f32 v[32:33], v[32:33], v[48:49]
    v_pk_add_f32 v[64:65], v[64:65], v[80:81]
    v_pk_add_f32 v[34:35], v[34:35], v[50:51]
    v_pk_add_f32 v[66:67], v[66:67], v[82:83]
    v_pk_add_f32 v[36:37], v[36:37], v[52:53]
    v_pk_add_f32 v[68:69], v[68:69], v[84:85]
    v_pk_add_f32 v[38:39], v[38:39], v[54:55]
    v_pk_add_f32 v[70:71], v[70:71], v[86:87]
    v_pk_add_f32 v[40:41], v[40:41], v[56:57]
    v_pk_add_f32 v[72:73], v[72:73], v[88:89]
    v_pk_add_f32 v[42:43], v[42:43], v[58:59]
    v_pk_add_f32 v[74:75], v[74:75], v[90:91]
    v_pk_add_f32 v[44:45], v[44:45], v[60:61]
    v_pk_add_f32 v[76:77], v[76:77], v[92:93]
    v_pk_add_f32 v[46:47], v[46:47], v[62:63]
    v_pk_add_f32 v[78:79], v[78:79], v[94:95]
    v_pk_add_f32 v[32:33], v[32:33], v[64:65]
    v_pk_add_f32 v[34:35], v[34:35], v[66:67]
    v_pk_add_f32 v[36:37], v[36:37], v[68:69]
    v_pk_add_f32 v[38:39], v[38:39], v[70:71]
    v_pk_add_f32 v[40:41], v[40:41], v[72:73]
    v_pk_add_f32 v[42:43], v[42:43], v[74:75]
    v_pk_add_f32 v[44:45], v[44:45], v[76:77]
    v_pk_add_f32 v[46:47], v[46:47], v[78:79]
    s_barrier
    v_cvt_pk_bf16_f32 v48, v32, v33
    v_cvt_pk_bf16_f32 v49, v34, v35
    v_cvt_pk_bf16_f32 v50, v36, v37
    v_cvt_pk_bf16_f32 v51, v38, v39
    v_cvt_pk_bf16_f32 v52, v40, v41
    v_cvt_pk_bf16_f32 v53, v42, v43
    v_cvt_pk_bf16_f32 v54, v44, v45
    v_cvt_pk_bf16_f32 v55, v46, v47
    v_lshlrev_b32 v32, 16, v48
    v_and_b32 v33, 0xffff0000, v48
    v_lshlrev_b32 v34, 16, v49
    v_and_b32 v35, 0xffff0000, v49
    v_lshlrev_b32 v36, 16, v50
    v_and_b32 v37, 0xffff0000, v50
    v_lshlrev_b32 v38, 16, v51
    v_and_b32 v39, 0xffff0000, v51
    v_lshlrev_b32 v40, 16, v52
    v_and_b32 v41, 0xffff0000, v52
    v_lshlrev_b32 v42, 16, v53
    v_and_b32 v43, 0xffff0000, v53
    v_lshlrev_b32 v44, 16, v54
    v_and_b32 v45, 0xffff0000, v54
    v_lshlrev_b32 v46, 16, v55
    v_and_b32 v47, 0xffff0000, v55
    s_waitcnt vmcnt(0)
    v_lshlrev_b32 v48, 16, v128
    v_and_b32 v49, 0xffff0000, v128
    v_lshlrev_b32 v50, 16, v129
    v_and_b32 v51, 0xffff0000, v129
    v_lshlrev_b32 v52, 16, v130
    v_and_b32 v53, 0xffff0000, v130
    v_lshlrev_b32 v54, 16, v131
    v_and_b32 v55, 0xffff0000, v131
    v_lshlrev_b32 v56, 16, v132
    v_and_b32 v57, 0xffff0000, v132
    v_lshlrev_b32 v58, 16, v133
    v_and_b32 v59, 0xffff0000, v133
    v_lshlrev_b32 v60, 16, v134
    v_and_b32 v61, 0xffff0000, v134
    v_lshlrev_b32 v62, 16, v135
    v_and_b32 v63, 0xffff0000, v135
    v_add_f32 v32, v32, v48
    v_add_f32 v33, v33, v49
    v_add_f32 v34, v34, v50
    v_add_f32 v35, v35, v51
    v_add_f32 v36, v36, v52
    v_add_f32 v37, v37, v53
    v_add_f32 v38, v38, v54
    v_add_f32 v39, v39, v55
    v_add_f32 v40, v40, v56
    v_add_f32 v41, v41, v57
    v_add_f32 v42, v42, v58
    v_add_f32 v43, v43, v59
    v_add_f32 v44, v44, v60
    v_add_f32 v45, v45, v61
    v_add_f32 v46, v46, v62
    v_add_f32 v47, v47, v63
    v_cvt_pk_bf16_f32 v64, v32, v33
    v_cvt_pk_bf16_f32 v65, v34, v35
    v_cvt_pk_bf16_f32 v66, v36, v37
    v_cvt_pk_bf16_f32 v67, v38, v39
    v_cvt_pk_bf16_f32 v68, v40, v41
    v_cvt_pk_bf16_f32 v69, v42, v43
    v_cvt_pk_bf16_f32 v70, v44, v45
    v_cvt_pk_bf16_f32 v71, v46, v47
    s_lshl_b32 s41, s3, 14
    s_lshl_b32 s43, s39, 11
    s_add_u32 s41, s41, s43
    s_add_u32 s43, s41, 1024
    buffer_store_dwordx4 v[64:67], v19, s[24:27], s41 offen sc1
    buffer_store_dwordx4 v[68:71], v19, s[24:27], s43 offen sc1
    v_lshlrev_b32 v32, 16, v64
    v_and_b32 v33, 0xffff0000, v64
    v_lshlrev_b32 v34, 16, v65
    v_and_b32 v35, 0xffff0000, v65
    v_lshlrev_b32 v36, 16, v66
    v_and_b32 v37, 0xffff0000, v66
    v_lshlrev_b32 v38, 16, v67
    v_and_b32 v39, 0xffff0000, v67
    v_lshlrev_b32 v40, 16, v68
    v_and_b32 v41, 0xffff0000, v68
    v_lshlrev_b32 v42, 16, v69
    v_and_b32 v43, 0xffff0000, v69
    v_lshlrev_b32 v44, 16, v70
    v_and_b32 v45, 0xffff0000, v70
    v_lshlrev_b32 v46, 16, v71
    v_and_b32 v47, 0xffff0000, v71
    v_add_f32 v26, v32, v33
    v_mul_f32 v27, v32, v32
    v_fmac_f32 v27, v33, v33
    v_add_f32 v26, v26, v34
    v_fmac_f32 v27, v34, v34
    v_add_f32 v26, v26, v35
    v_fmac_f32 v27, v35, v35
    v_add_f32 v26, v26, v36
    v_fmac_f32 v27, v36, v36
    v_add_f32 v26, v26, v37
    v_fmac_f32 v27, v37, v37
    v_add_f32 v26, v26, v38
    v_fmac_f32 v27, v38, v38
    v_add_f32 v26, v26, v39
    v_fmac_f32 v27, v39, v39
    v_add_f32 v26, v26, v40
    v_fmac_f32 v27, v40, v40
    v_add_f32 v26, v26, v41
    v_fmac_f32 v27, v41, v41
    v_add_f32 v26, v26, v42
    v_fmac_f32 v27, v42, v42
    v_add_f32 v26, v26, v43
    v_fmac_f32 v27, v43, v43
    v_add_f32 v26, v26, v44
    v_fmac_f32 v27, v44, v44
    v_add_f32 v26, v26, v45
    v_fmac_f32 v27, v45, v45
    v_add_f32 v26, v26, v46
    v_fmac_f32 v27, v46, v46
    v_add_f32 v26, v26, v47
    v_fmac_f32 v27, v47, v47
    v_mov_b32 v28, v26
    v_mov_b32 v29, v27
    s_nop 0
    v_permlane16_swap_b32 v26, v28
    s_nop 0
    v_permlane16_swap_b32 v27, v29
    v_add_f32 v26, v26, v28
    v_add_f32 v27, v27, v29
    v_mov_b32 v28, v26
    v_mov_b32 v29, v27
    s_nop 0
    v_permlane32_swap_b32 v26, v28
    s_nop 0
    v_permlane32_swap_b32 v27, v29
    v_add_f32 v26, v26, v28
    v_add_f32 v27, v27, v29
    s_lshl_b32 s41, s38, 6
    s_lshl_b32 s43, s3, 4
    s_add_u32 s41, s41, s43
    v_add_u32 v24, s41, v20
    v_lshlrev_b32 v24, 6, v24
    s_lshl_b32 s43, s39, 3
    v_add_u32 v24, s43, v24
    v_mov_b32 v25, 0x80000000
    v_cmp_gt_u32 vcc, 16, v1
    s_nop 1
    v_cndmask_b32 v24, v25, v24, vcc
    buffer_store_dwordx2 v[26:27], v24, s[52:55], 0 offen sc1
    s_add_u32 m0, s31, 32768
    s_mov_b32 s63, 32768
    buffer_load_dwordx4 v17, s[12:15], s63 offen offset:0 lds
    s_add_u32 m0, s31, 32768
    s_mov_b32 s63, 32768
    buffer_load_dwordx4 v17, s[12:15], s63 offen offset:1024 lds
    v_mov_b32 v160, 0x3f803f80
    v_mov_b32 v161, 0x3f803f80
    v_mov_b32 v162, 0x3f803f80
    v_mov_b32 v163, 0x3f803f80
    ds_read_b128 a[192:195], v4 offset:0
    ds_read_b128 a[196:199], v5 offset:0
    ds_read_b128 a[200:203], v6 offset:0
    ds_read_b128 a[204:207], v7 offset:0
    ds_read_b128 a[208:211], v4 offset:1024
    ds_read_b128 a[212:215], v5 offset:1024
    ds_read_b128 a[216:219], v6 offset:1024
    ds_read_b128 a[220:223], v7 offset:1024
    s_waitcnt lgkmcnt(7)
    v_mfma_f32_16x16x32_bf16 v[32:35], a[192:195], v[164:167], 0
    v_accvgpr_write_b32 a0, 0
    v_accvgpr_write_b32 a1, 0
    v_accvgpr_write_b32 a2, 0
    v_accvgpr_write_b32 a3, 0
    v_mfma_f32_16x16x32_bf16 v[36:39], a[192:195], v[180:183], 0
    v_accvgpr_write_b32 a4, 0
    v_accvgpr_write_b32 a5, 0
    v_accvgpr_write_b32 a6, 0
    v_accvgpr_write_b32 a7, 0
    v_mfma_f32_16x16x32_bf16 v[40:43], a[192:195], v[196:199], 0
    v_accvgpr_write_b32 a8, 0
    v_accvgpr_write_b32 a9, 0
    v_accvgpr_write_b32 a10, 0
    v_accvgpr_write_b32 a11, 0
    v_mfma_f32_16x16x32_bf16 v[44:47], a[192:195], v[212:215], 0
    v_accvgpr_write_b32 a12, 0
    v_accvgpr_write_b32 a13, 0
    v_accvgpr_write_b32 a14, 0
    v_accvgpr_write_b32 a15, 0
    s_waitcnt lgkmcnt(6)
    v_mfma_f32_16x16x32_bf16 v[32:35], a[196:199], v[168:171], v[32:35]
    v_accvgpr_write_b32 a16, 0
    v_accvgpr_write_b32 a17, 0
    v_accvgpr_write_b32 a18, 0
    v_accvgpr_write_b32 a19, 0
    v_mfma_f32_16x16x32_bf16 v[36:39], a[196:199], v[184:187], v[36:39]
    v_accvgpr_write_b32 a20, 0
    v_accvgpr_write_b32 a21, 0
    v_accvgpr_write_b32 a22, 0
    v_accvgpr_write_b32 a23, 0
    v_mfma_f32_16x16x32_bf16 v[40:43], a[196:199], v[200:203], v[40:43]
    v_accvgpr_write_b32 a24, 0
    v_accvgpr_write_b32 a25, 0
    v_accvgpr_write_b32 a26, 0
    v_accvgpr_write_b32 a27, 0
    v_mfma_f32_16x16x32_bf16 v[44:47], a[196:199], v[216:219], v[44:47]
    v_accvgpr_write_b32 a28, 0
    v_accvgpr_write_b32 a29, 0
    v_accvgpr_write_b32 a30, 0
    v_accvgpr_write_b32 a31, 0
    s_waitcnt lgkmcnt(5)
    v_mfma_f32_16x16x32_bf16 v[32:35], a[200:203], v[172:175], v[32:35]
    v_accvgpr_write_b32 a32, 0
    v_accvgpr_write_b32 a33, 0
    v_accvgpr_write_b32 a34, 0
    v_accvgpr_write_b32 a35, 0
    v_mfma_f32_16x16x32_bf16 v[36:39], a[200:203], v[188:191], v[36:39]
    v_accvgpr_write_b32 a36, 0
    v_accvgpr_write_b32 a37, 0
    v_accvgpr_write_b32 a38, 0
    v_accvgpr_write_b32 a39, 0
    v_mfma_f32_16x16x32_bf16 v[40:43], a[200:203], v[204:207], v[40:43]
    v_accvgpr_write_b32 a40, 0
    v_accvgpr_write_b32 a41, 0
    v_accvgpr_write_b32 a42, 0
    v_accvgpr_write_b32 a43, 0
    v_mfma_f32_16x16x32_bf16 v[44:47], a[200:203], v[220:223], v[44:47]
    v_accvgpr_write_b32 a44, 0
    v_accvgpr_write_b32 a45, 0
    v_accvgpr_write_b32 a46, 0
    v_accvgpr_write_b32 a47, 0
    s_waitcnt lgkmcnt(4)
    v_mfma_f32_16x16x32_bf16 v[32:35], a[204:207], v[176:179], v[32:35]
    v_accvgpr_write_b32 a48, 0
    v_accvgpr_write_b32 a49, 0
    v_accvgpr_write_b32 a50, 0
    v_accvgpr_write_b32 a51, 0
    v_mfma_f32_16x16x32_bf16 v[36:39], a[204:207], v[192:195], v[36:39]
    v_accvgpr_write_b32 a52, 0
    v_accvgpr_write_b32 a53, 0
    v_accvgpr_write_b32 a54, 0
    v_accvgpr_write_b32 a55, 0
    v_mfma_f32_16x16x32_bf16 v[40:43], a[204:207], v[208:211], v[40:43]
    v_accvgpr_write_b32 a56, 0
    v_accvgpr_write_b32 a57, 0
    v_accvgpr_write_b32 a58, 0
    v_accvgpr_write_b32 a59, 0
    v_mfma_f32_16x16x32_bf16 v[44:47], a[204:207], v[224:227], v[44:47]
    v_accvgpr_write_b32 a60, 0
    v_accvgpr_write_b32 a61, 0
    v_accvgpr_write_b32 a62, 0
    v_accvgpr_write_b32 a63, 0
    s_waitcnt lgkmcnt(3)
    v_mfma_f32_16x16x32_bf16 v[48:51], a[208:211], v[164:167], 0
    v_accvgpr_write_b32 a64, 0
    v_accvgpr_write_b32 a65, 0
    v_accvgpr_write_b32 a66, 0
    v_accvgpr_write_b32 a67, 0
    v_mfma_f32_16x16x32_bf16 v[52:55], a[208:211], v[180:183], 0
    v_accvgpr_write_b32 a68, 0
    v_accvgpr_write_b32 a69, 0
    v_accvgpr_write_b32 a70, 0
    v_accvgpr_write_b32 a71, 0
    v_mfma_f32_16x16x32_bf16 v[56:59], a[208:211], v[196:199], 0
    v_accvgpr_write_b32 a72, 0
    v_accvgpr_write_b32 a73, 0
    v_accvgpr_write_b32 a74, 0
    v_accvgpr_write_b32 a75, 0
    v_mfma_f32_16x16x32_bf16 v[60:63], a[208:211], v[212:215], 0
    v_accvgpr_write_b32 a76, 0
    v_accvgpr_write_b32 a77, 0
    v_accvgpr_write_b32 a78, 0
    v_accvgpr_write_b32 a79, 0
    s_waitcnt lgkmcnt(2)
    v_mfma_f32_16x16x32_bf16 v[48:51], a[212:215], v[168:171], v[48:51]
    v_accvgpr_write_b32 a80, 0
    v_accvgpr_write_b32 a81, 0
    v_accvgpr_write_b32 a82, 0
    v_accvgpr_write_b32 a83, 0
    v_mfma_f32_16x16x32_bf16 v[52:55], a[212:215], v[184:187], v[52:55]
    v_accvgpr_write_b32 a84, 0
    v_accvgpr_write_b32 a85, 0
    v_accvgpr_write_b32 a86, 0
    v_accvgpr_write_b32 a87, 0
    v_mfma_f32_16x16x32_bf16 v[56:59], a[212:215], v[200:203], v[56:59]
    v_accvgpr_write_b32 a88, 0
    v_accvgpr_write_b32 a89, 0
    v_accvgpr_write_b32 a90, 0
    v_accvgpr_write_b32 a91, 0
    v_mfma_f32_16x16x32_bf16 v[60:63], a[212:215], v[216:219], v[60:63]
    v_accvgpr_write_b32 a92, 0
    v_accvgpr_write_b32 a93, 0
    v_accvgpr_write_b32 a94, 0
    v_accvgpr_write_b32 a95, 0
    s_waitcnt lgkmcnt(1)
    v_mfma_f32_16x16x32_bf16 v[48:51], a[216:219], v[172:175], v[48:51]
    v_accvgpr_write_b32 a96, 0
    v_accvgpr_write_b32 a97, 0
    v_accvgpr_write_b32 a98, 0
    v_accvgpr_write_b32 a99, 0
    v_mfma_f32_16x16x32_bf16 v[52:55], a[216:219], v[188:191], v[52:55]
    v_accvgpr_write_b32 a100, 0
    v_accvgpr_write_b32 a101, 0
    v_accvgpr_write_b32 a102, 0
    v_accvgpr_write_b32 a103, 0
    v_mfma_f32_16x16x32_bf16 v[56:59], a[216:219], v[204:207], v[56:59]
    v_accvgpr_write_b32 a104, 0
    v_accvgpr_write_b32 a105, 0
    v_accvgpr_write_b32 a106, 0
    v_accvgpr_write_b32 a107, 0
    v_mfma_f32_16x16x32_bf16 v[60:63], a[216:219], v[220:223], v[60:63]
    v_accvgpr_write_b32 a108, 0
    v_accvgpr_write_b32 a109, 0
    v_accvgpr_write_b32 a110, 0
    v_accvgpr_write_b32 a111, 0
    s_waitcnt lgkmcnt(0)
    v_mfma_f32_16x16x32_bf16 v[48:51], a[220:223], v[176:179], v[48:51]
    v_accvgpr_write_b32 a112, 0
    v_accvgpr_write_b32 a113, 0
    v_accvgpr_write_b32 a114, 0
    v_accvgpr_write_b32 a115, 0
    v_mfma_f32_16x16x32_bf16 v[52:55], a[220:223], v[192:195], v[52:55]
    v_accvgpr_write_b32 a116, 0
    v_accvgpr_write_b32 a117, 0
    v_accvgpr_write_b32 a118, 0
    v_accvgpr_write_b32 a119, 0
    v_mfma_f32_16x16x32_bf16 v[56:59], a[220:223], v[208:211], v[56:59]
    v_accvgpr_write_b32 a120, 0
    v_accvgpr_write_b32 a121, 0
    v_accvgpr_write_b32 a122, 0
    v_accvgpr_write_b32 a123, 0
    v_mfma_f32_16x16x32_bf16 v[60:63], a[220:223], v[224:227], v[60:63]
    v_accvgpr_write_b32 a124, 0
    v_accvgpr_write_b32 a125, 0
    v_accvgpr_write_b32 a126, 0
    v_accvgpr_write_b32 a127, 0
    ds_read_b128 a[192:195], v4 offset:8192
    ds_read_b128 a[196:199], v5 offset:8192
    ds_read_b128 a[200:203], v6 offset:8192
    ds_read_b128 a[204:207], v7 offset:8192
    v_mov_b32 v144, 0
    v_mov_b32 v145, 0
    v_mov_b32 v146, 0
    v_mov_b32 v147, 0
    v_mov_b32 v148, 0
    v_mov_b32 v149, 0
    v_mov_b32 v150, 0
    v_mov_b32 v151, 0
    v_mov_b32 v152, 0
    v_mov_b32 v153, 0
    v_mov_b32 v154, 0
    v_mov_b32 v155, 0
    v_mov_b32 v156, 0
    v_mov_b32 v157, 0
    v_mov_b32 v158, 0
    v_mov_b32 v159, 0
    v_max3_f32 v228, v32, v33, v34
    v_max3_f32 v228, v228, v35, v48
    v_max3_f32 v228, v228, v49, v50
    v_max_f32 v228, v228, v51
    v_mov_b32 v232, v228
    s_nop 1
    v_permlane16_swap_b32 v228, v232
    v_max_f32 v228, v228, v232
    v_mov_b32 v232, v228
    s_nop 1
    v_permlane32_swap_b32 v228, v232
    v_max_f32 v228, v228, v232
    v_sub_f32 v128, 0, v228
    v_sub_f32 v129, 0, v228
    v_sub_f32 v130, 0, v228
    v_sub_f32 v131, 0, v228
    v_sub_f32 v32, v32, v228
    v_sub_f32 v33, v33, v228
    v_sub_f32 v34, v34, v228
    v_sub_f32 v35, v35, v228
    v_sub_f32 v48, v48, v228
    v_sub_f32 v49, v49, v228
    v_sub_f32 v50, v50, v228
    v_sub_f32 v51, v51, v228
    v_max3_f32 v229, v36, v37, v38
    v_max3_f32 v229, v229, v39, v52
    v_max3_f32 v229, v229, v53, v54
    v_max_f32 v229, v229, v55
    v_mov_b32 v232, v229
    s_nop 1
    v_permlane16_swap_b32 v229, v232
    v_max_f32 v229, v229, v232
    v_mov_b32 v232, v229
    s_nop 1
    v_permlane32_swap_b32 v229, v232
    v_max_f32 v229, v229, v232
    v_sub_f32 v132, 0, v229
    v_sub_f32 v133, 0, v229
    v_sub_f32 v134, 0, v229
    v_sub_f32 v135, 0, v229
    v_sub_f32 v36, v36, v229
    v_sub_f32 v37, v37, v229
    v_sub_f32 v38, v38, v229
    v_sub_f32 v39, v39, v229
    v_sub_f32 v52, v52, v229
    v_sub_f32 v53, v53, v229
    v_sub_f32 v54, v54, v229
    v_sub_f32 v55, v55, v229
    v_max3_f32 v230, v40, v41, v42
    v_max3_f32 v230, v230, v43, v56
    v_max3_f32 v230, v230, v57, v58
    v_max_f32 v230, v230, v59
    v_mov_b32 v232, v230
    s_nop 1
    v_permlane16_swap_b32 v230, v232
    v_max_f32 v230, v230, v232
    v_mov_b32 v232, v230
    s_nop 1
    v_permlane32_swap_b32 v230, v232
    v_max_f32 v230, v230, v232
    v_sub_f32 v136, 0, v230
    v_sub_f32 v137, 0, v230
    v_sub_f32 v138, 0, v230
    v_sub_f32 v139, 0, v230
    v_sub_f32 v40, v40, v230
    v_sub_f32 v41, v41, v230
    v_sub_f32 v42, v42, v230
    v_sub_f32 v43, v43, v230
    v_sub_f32 v56, v56, v230
    v_sub_f32 v57, v57, v230
    v_sub_f32 v58, v58, v230
    v_sub_f32 v59, v59, v230
    v_max3_f32 v231, v44, v45, v46
    v_max3_f32 v231, v231, v47, v60
    v_max3_f32 v231, v231, v61, v62
    v_max_f32 v231, v231, v63
    v_mov_b32 v232, v231
    s_nop 1
    v_permlane16_swap_b32 v231, v232
    v_max_f32 v231, v231, v232
    v_mov_b32 v232, v231
    s_nop 1
    v_permlane32_swap_b32 v231, v232
    v_max_f32 v231, v231, v232
    v_sub_f32 v140, 0, v231
    v_sub_f32 v141, 0, v231
    v_sub_f32 v142, 0, v231
    v_sub_f32 v143, 0, v231
    v_sub_f32 v44, v44, v231
    v_sub_f32 v45, v45, v231
    v_sub_f32 v46, v46, v231
    v_sub_f32 v47, v47, v231
    v_sub_f32 v60, v60, v231
    v_sub_f32 v61, v61, v231
    v_sub_f32 v62, v62, v231
    v_sub_f32 v63, v63, v231
    s_mov_b32 s28, 57344
    s_mov_b32 s29, 40960
    s_waitcnt lgkmcnt(3)
    v_mfma_f32_16x16x32_bf16 v[64:67], a[192:195], v[164:167], v[128:131]
    v_exp_f32 v32, v32
    v_mfma_f32_16x16x32_bf16 v[68:71], a[192:195], v[180:183], v[132:135]
    ds_read_b128 a[208:211], v4 offset:9216
    v_mfma_f32_16x16x32_bf16 v[72:75], a[192:195], v[196:199], v[136:139]
    s_waitcnt lgkmcnt(3)
    v_exp_f32 v33, v33
    v_mfma_f32_16x16x32_bf16 v[76:79], a[192:195], v[212:215], v[140:143]
    ds_read_b128 a[212:215], v5 offset:9216
    v_cvt_pk_bf16_f32 v96, v32, v33
    v_mfma_f32_16x16x32_bf16 v[64:67], a[196:199], v[168:171], v[64:67]
    s_add_u32 m0, s30, 57344
    v_exp_f32 v34, v34
    v_mfma_f32_16x16x32_bf16 v[68:71], a[196:199], v[184:187], v[68:71]
    ds_read_b128 a[216:219], v6 offset:9216
    v_mfma_f32_16x16x32_bf16 v[72:75], a[196:199], v[200:203], v[72:75]
    s_waitcnt lgkmcnt(4)
    v_exp_f32 v35, v35
    v_mfma_f32_16x16x32_bf16 v[76:79], a[196:199], v[216:219], v[76:79]
    buffer_load_dwordx4 v16, s[8:11], s28 offen offset:0 lds
    v_mfma_f32_16x16x32_bf16 v[64:67], a[200:203], v[172:175], v[64:67]
    v_exp_f32 v48, v48
    v_mfma_f32_16x16x32_bf16 v[68:71], a[200:203], v[188:191], v[68:71]
    ds_read_b128 a[220:223], v7 offset:9216
    v_cvt_pk_bf16_f32 v97, v34, v35
    v_mfma_f32_16x16x32_bf16 v[72:75], a[200:203], v[204:207], v[72:75]
    s_waitcnt lgkmcnt(4)
    v_exp_f32 v49, v49
    v_mfma_f32_16x16x32_bf16 v[76:79], a[200:203], v[220:223], v[76:79]
    v_cvt_pk_bf16_f32 v98, v48, v49
    v_mfma_f32_16x16x32_bf16 v[64:67], a[204:207], v[176:179], v[64:67]
    v_exp_f32 v50, v50
    v_mfma_f32_16x16x32_bf16 v[68:71], a[204:207], v[192:195], v[68:71]
    v_mfma_f32_16x16x32_bf16 v[72:75], a[204:207], v[208:211], v[72:75]
    s_waitcnt lgkmcnt(3)
    v_exp_f32 v51, v51
    v_mfma_f32_16x16x32_bf16 v[76:79], a[204:207], v[224:227], v[76:79]
    buffer_load_dwordx4 v16, s[8:11], s28 offen offset:1024 lds
    v_mfma_f32_16x16x32_bf16 v[80:83], a[208:211], v[164:167], v[128:131]
    v_exp_f32 v36, v36
    v_mfma_f32_16x16x32_bf16 v[84:87], a[208:211], v[180:183], v[132:135]
    v_cvt_pk_bf16_f32 v99, v50, v51
    v_mfma_f32_16x16x32_bf16 v[88:91], a[208:211], v[196:199], v[136:139]
    s_waitcnt lgkmcnt(2)
    v_exp_f32 v37, v37
    v_mfma_f32_16x16x32_bf16 v[92:95], a[208:211], v[212:215], v[140:143]
    v_cvt_pk_bf16_f32 v100, v36, v37
    v_mfma_f32_16x16x32_bf16 v[80:83], a[212:215], v[168:171], v[80:83]
    s_add_u32 m0, s31, 40960
    v_exp_f32 v38, v38
    v_mfma_f32_16x16x32_bf16 v[84:87], a[212:215], v[184:187], v[84:87]
    v_mfma_f32_16x16x32_bf16 v[88:91], a[212:215], v[200:203], v[88:91]
    s_waitcnt lgkmcnt(1)
    v_exp_f32 v39, v39
    v_mfma_f32_16x16x32_bf16 v[92:95], a[212:215], v[216:219], v[92:95]
    buffer_load_dwordx4 v17, s[12:15], s29 offen offset:0 lds
    v_mfma_f32_16x16x32_bf16 v[80:83], a[216:219], v[172:175], v[80:83]
    v_exp_f32 v52, v52
    v_mfma_f32_16x16x32_bf16 v[84:87], a[216:219], v[188:191], v[84:87]
    v_cvt_pk_bf16_f32 v101, v38, v39
    v_mfma_f32_16x16x32_bf16 v[88:91], a[216:219], v[204:207], v[88:91]
    s_waitcnt lgkmcnt(0)
    v_exp_f32 v53, v53
    v_mfma_f32_16x16x32_bf16 v[92:95], a[216:219], v[220:223], v[92:95]
    v_cvt_pk_bf16_f32 v102, v52, v53
    v_mfma_f32_16x16x32_bf16 v[80:83], a[220:223], v[176:179], v[80:83]
    v_exp_f32 v54, v54
    v_mfma_f32_16x16x32_bf16 v[84:87], a[220:223], v[192:195], v[84:87]
    v_mfma_f32_16x16x32_bf16 v[88:91], a[220:223], v[208:211], v[88:91]
    v_exp_f32 v55, v55
    v_mfma_f32_16x16x32_bf16 v[92:95], a[220:223], v[224:227], v[92:95]
    buffer_load_dwordx4 v17, s[12:15], s29 offen offset:1024 lds
    v_exp_f32 v40, v40
    v_cvt_pk_bf16_f32 v103, v54, v55
    v_exp_f32 v41, v41
    s_nop 0
    v_cvt_pk_bf16_f32 v104, v40, v41
    s_add_u32 s28, s28, 8192
    v_exp_f32 v42, v42
    v_exp_f32 v43, v43
    s_add_u32 s29, s29, 8192
    v_exp_f32 v56, v56
    v_cvt_pk_bf16_f32 v105, v42, v43
    v_exp_f32 v57, v57
    s_nop 0
    v_cvt_pk_bf16_f32 v106, v56, v57
    v_exp_f32 v58, v58
    v_exp_f32 v59, v59
    s_waitcnt vmcnt(6)
    v_exp_f32 v44, v44
    v_cvt_pk_bf16_f32 v107, v58, v59
    v_exp_f32 v45, v45
    s_nop 0
    v_cvt_pk_bf16_f32 v108, v44, v45
    s_barrier
    v_exp_f32 v46, v46
    ds_read_b128 a[192:195], v4 offset:16384
    v_exp_f32 v47, v47
    v_exp_f32 v60, v60
    ds_read_b128 a[196:199], v5 offset:16384
    v_cvt_pk_bf16_f32 v109, v46, v47
    v_exp_f32 v61, v61
    ds_read_b128 a[200:203], v6 offset:16384
    v_cvt_pk_bf16_f32 v110, v60, v61
    v_exp_f32 v62, v62
    ds_read_b128 a[204:207], v7 offset:16384
    v_exp_f32 v63, v63
    s_waitcnt lgkmcnt(3)
    s_lshl_b32 s40, s38, 3
    s_add_u32 s40, s40, s39
    s_cmp_lg_u32 s3, 0
    s_cbranch_scc1 L_pub_f2
    s_lshl_b32 s60, s40, 7
    s_add_u32 s60, s60, 98304
    v_mov_b32 v30, s60
    v_mov_b32 v31, s36
    s_mov_b64 exec, 1
    buffer_store_dword v31, v30, s[44:47], 0 offen sc1
    s_mov_b64 exec, -1
L_pub_f2:
    v_lshlrev_b32 v26, 6, v1
    s_lshl_b32 s40, s2, 2
    s_add_u32 s40, s40, s3
    s_mul_i32 s41, s40, 1792
    s_mov_b32 s48, s6
    s_mov_b32 s49, s7
    s_mov_b32 s50, 0x1c0000
    s_mov_b32 s51, 0x20000
    buffer_load_dword v3, v26, s[48:51], s41 offen
    v_lshrrev_b32 v24, 3, v1
    v_and_b32 v25, 7, v1
    v_lshlrev_b32 v26, 1, v21
    v_xor_b32 v25, v25, v26
    v_lshlrev_b32 v25, 4, v25
    v_lshl_add_u32 v24, v24, 10, v25
    s_lshl_b32 s58, s39, 7
    s_add_u32 s48, s4, s58
    s_addc_u32 s49, s5, 0
    s_sub_u32 s50, 4194304, s58
    s_mov_b32 s51, 0x20000
    s_mul_i32 s41, s39, 753664
    s_add_u32 s52, s34, 0x3000000
    s_addc_u32 s53, s35, 0
    s_add_u32 s52, s52, s41
    s_addc_u32 s53, s53, 0
    s_mov_b32 s54, 0xb8000
    s_mov_b32 s55, 0x20000
    s_and_b32 s59, s2, 31
    s_lshl_b32 s59, s59, 2
    s_add_u32 s59, s59, s3
    s_lshl_b32 s56, s59, 13
    s_lshl_b32 s57, s59, 10
    s_and_b32 s42, s2, 7
    s_lshl_b32 s42, s42, 1
    s_lshr_b32 s40, s2, 3
    s_and_b32 s40, s40, 1
    s_add_u32 s42, s42, s40
    s_lshr_b32 s43, s2, 4
    s_movk_i32 s40, 3584
    s_lshl_b32 s41, s3, 3
    v_add_u32 v30, 0, v21
    v_lshlrev_b32 v31, 1, v30
    v_xor_b32 v31, v31, v20
    v_lshlrev_b32 v31, 4, v31
    v_add_u32 v30, s41, v30
    v_mul_lo_u32 v30, v30, s40
    v_add_u32 v236, v30, v31
    v_add_u32 v30, 4, v21
    v_lshlrev_b32 v31, 1, v30
    v_xor_b32 v31, v31, v20
    v_lshlrev_b32 v31, 4, v31
    v_add_u32 v30, s41, v30
    v_mul_lo_u32 v30, v30, s40
    v_add_u32 v237, v30, v31
    s_lshl_b32 s40, s43, 8
    s_add_u32 s16, s6, s40
    s_addc_u32 s17, s7, 0
    s_sub_u32 s18, 0x1c0000, s40
    s_mov_b32 s19, 0x20000
    s_cmp_lt_u32 s43, 14
    s_cselect_b32 s18, s18, 0
    s_lshl_b32 s63, s3, 11
    s_mov_b32 s32, 0
.p2align 6
recurrent_scan__mha_block_cached__mixer_s_mlp__prompt_kernel_loop:
    v_mfma_f32_16x16x32_bf16 v[32:35], a[192:195], v[164:167], v[128:131]
    v_exp_f32 v64, v64
    v_mfma_f32_16x16x32_bf16 v[36:39], a[192:195], v[180:183], v[132:135]
    ds_read_b128 a[208:211], v4 offset:17408
    v_cvt_pk_bf16_f32 v111, v62, v63
    v_mfma_f32_16x16x32_bf16 v[40:43], a[192:195], v[196:199], v[136:139]
    s_waitcnt lgkmcnt(3)
    v_exp_f32 v65, v65
    v_mfma_f32_16x16x32_bf16 v[44:47], a[192:195], v[212:215], v[140:143]
    ds_read_b128 a[212:215], v5 offset:17408
    v_cvt_pk_bf16_f32 v112, v64, v65
    v_mfma_f32_16x16x32_bf16 v[32:35], a[196:199], v[168:171], v[32:35]
    s_add_u32 m0, s30, 0
    v_exp_f32 v66, v66
    v_mfma_f32_16x16x32_bf16 v[36:39], a[196:199], v[184:187], v[36:39]
    ds_read_b128 a[216:219], v6 offset:17408
    v_mfma_f32_16x16x32_bf16 v[40:43], a[196:199], v[200:203], v[40:43]
    s_waitcnt lgkmcnt(4)
    v_exp_f32 v67, v67
    v_mfma_f32_16x16x32_bf16 v[44:47], a[196:199], v[216:219], v[44:47]
    buffer_load_dwordx4 v16, s[8:11], s28 offen offset:0 lds
    v_mfma_f32_16x16x32_bf16 v[32:35], a[200:203], v[172:175], v[32:35]
    v_exp_f32 v80, v80
    v_mfma_f32_16x16x32_bf16 v[36:39], a[200:203], v[188:191], v[36:39]
    ds_read_b128 a[220:223], v7 offset:17408
    v_cvt_pk_bf16_f32 v113, v66, v67
    v_mfma_f32_16x16x32_bf16 v[40:43], a[200:203], v[204:207], v[40:43]
    s_waitcnt lgkmcnt(4)
    v_exp_f32 v81, v81
    v_mfma_f32_16x16x32_bf16 v[44:47], a[200:203], v[220:223], v[44:47]
    ds_read_b64_tr_b16 a[224:225], v8 offset:0
    v_cvt_pk_bf16_f32 v114, v80, v81
    v_mfma_f32_16x16x32_bf16 v[32:35], a[204:207], v[176:179], v[32:35]
    v_exp_f32 v82, v82
    v_mfma_f32_16x16x32_bf16 v[36:39], a[204:207], v[192:195], v[36:39]
    ds_read_b64_tr_b16 a[226:227], v8 offset:1024
    v_mfma_f32_16x16x32_bf16 v[40:43], a[204:207], v[208:211], v[40:43]
    s_waitcnt lgkmcnt(5)
    v_exp_f32 v83, v83
    v_mfma_f32_16x16x32_bf16 v[44:47], a[204:207], v[224:227], v[44:47]
    buffer_load_dwordx4 v16, s[8:11], s28 offen offset:1024 lds
    v_mfma_f32_16x16x32_bf16 v[48:51], a[208:211], v[164:167], v[128:131]
    v_exp_f32 v68, v68
    v_mfma_f32_16x16x32_bf16 v[52:55], a[208:211], v[180:183], v[132:135]
    ds_read_b64_tr_b16 a[228:229], v9 offset:0
    v_cvt_pk_bf16_f32 v115, v82, v83
    v_mfma_f32_16x16x32_bf16 v[56:59], a[208:211], v[196:199], v[136:139]
    s_waitcnt lgkmcnt(5)
    v_exp_f32 v69, v69
    v_mfma_f32_16x16x32_bf16 v[60:63], a[208:211], v[212:215], v[140:143]
    ds_read_b64_tr_b16 a[230:231], v9 offset:1024
    v_cvt_pk_bf16_f32 v116, v68, v69
    v_mfma_f32_16x16x32_bf16 v[48:51], a[212:215], v[168:171], v[48:51]
    s_add_u32 m0, s31, 49152
    v_exp_f32 v70, v70
    v_mfma_f32_16x16x32_bf16 v[52:55], a[212:215], v[184:187], v[52:55]
    ds_read_b64_tr_b16 a[232:233], v10 offset:0
    v_mfma_f32_16x16x32_bf16 v[56:59], a[212:215], v[200:203], v[56:59]
    s_waitcnt lgkmcnt(6)
    v_exp_f32 v71, v71
    v_mfma_f32_16x16x32_bf16 v[60:63], a[212:215], v[216:219], v[60:63]
    buffer_load_dwordx4 v17, s[12:15], s29 offen offset:0 lds
    v_mfma_f32_16x16x32_bf16 v[48:51], a[216:219], v[172:175], v[48:51]
    v_exp_f32 v84, v84
    v_mfma_f32_16x16x32_bf16 v[52:55], a[216:219], v[188:191], v[52:55]
    ds_read_b64_tr_b16 a[234:235], v10 offset:1024
    v_cvt_pk_bf16_f32 v117, v70, v71
    v_mfma_f32_16x16x32_bf16 v[56:59], a[216:219], v[204:207], v[56:59]
    s_waitcnt lgkmcnt(6)
    v_exp_f32 v85, v85
    v_mfma_f32_16x16x32_bf16 v[60:63], a[216:219], v[220:223], v[60:63]
    ds_read_b64_tr_b16 a[236:237], v11 offset:0
    v_cvt_pk_bf16_f32 v118, v84, v85
    v_mfma_f32_16x16x32_bf16 v[48:51], a[220:223], v[176:179], v[48:51]
    v_exp_f32 v86, v86
    v_mfma_f32_16x16x32_bf16 v[52:55], a[220:223], v[192:195], v[52:55]
    ds_read_b64_tr_b16 a[238:239], v11 offset:1024
    v_mfma_f32_16x16x32_bf16 v[56:59], a[220:223], v[208:211], v[56:59]
    s_waitcnt lgkmcnt(6)
    v_exp_f32 v87, v87
    v_mfma_f32_16x16x32_bf16 v[60:63], a[220:223], v[224:227], v[60:63]
    buffer_load_dwordx4 v17, s[12:15], s29 offen offset:1024 lds
    v_mfma_f32_16x16x32_bf16 a[0:3], a[224:227], v[96:99], a[0:3]
    v_exp_f32 v72, v72
    v_mfma_f32_16x16x32_bf16 a[4:7], a[224:227], v[100:103], a[4:7]
    ds_read_b64_tr_b16 a[240:241], v12 offset:0
    v_cvt_pk_bf16_f32 v119, v86, v87
    v_mfma_f32_16x16x32_bf16 a[8:11], a[224:227], v[104:107], a[8:11]
    s_waitcnt lgkmcnt(5)
    v_exp_f32 v73, v73
    v_mfma_f32_16x16x32_bf16 a[12:15], a[224:227], v[108:111], a[12:15]
    ds_read_b64_tr_b16 a[242:243], v12 offset:1024
    v_cvt_pk_bf16_f32 v120, v72, v73
    v_mfma_f32_16x16x32_bf16 a[16:19], a[228:231], v[96:99], a[16:19]
    s_add_u32 s28, s28, 8192
    v_exp_f32 v74, v74
    v_mfma_f32_16x16x32_bf16 a[20:23], a[228:231], v[100:103], a[20:23]
    ds_read_b64_tr_b16 a[244:245], v13 offset:0
    v_mfma_f32_16x16x32_bf16 a[24:27], a[228:231], v[104:107], a[24:27]
    s_waitcnt lgkmcnt(5)
    v_exp_f32 v75, v75
    v_mfma_f32_16x16x32_bf16 a[28:31], a[228:231], v[108:111], a[28:31]
    v_mfma_f32_16x16x32_bf16 a[32:35], a[232:235], v[96:99], a[32:35]
    s_add_u32 s29, s29, 8192
    v_exp_f32 v88, v88
    v_mfma_f32_16x16x32_bf16 a[36:39], a[232:235], v[100:103], a[36:39]
    ds_read_b64_tr_b16 a[246:247], v13 offset:1024
    v_cvt_pk_bf16_f32 v121, v74, v75
    v_mfma_f32_16x16x32_bf16 a[40:43], a[232:235], v[104:107], a[40:43]
    s_waitcnt lgkmcnt(4)
    v_exp_f32 v89, v89
    v_mfma_f32_16x16x32_bf16 a[44:47], a[232:235], v[108:111], a[44:47]
    ds_read_b64_tr_b16 a[248:249], v14 offset:0
    v_cvt_pk_bf16_f32 v122, v88, v89
    v_mfma_f32_16x16x32_bf16 a[48:51], a[236:239], v[96:99], a[48:51]
    v_exp_f32 v90, v90
    v_mfma_f32_16x16x32_bf16 a[52:55], a[236:239], v[100:103], a[52:55]
    ds_read_b64_tr_b16 a[250:251], v14 offset:1024
    v_mfma_f32_16x16x32_bf16 a[56:59], a[236:239], v[104:107], a[56:59]
    s_waitcnt lgkmcnt(4)
    v_exp_f32 v91, v91
    v_mfma_f32_16x16x32_bf16 a[60:63], a[236:239], v[108:111], a[60:63]
    v_mfma_f32_16x16x32_bf16 a[64:67], a[240:243], v[96:99], a[64:67]
    v_exp_f32 v76, v76
    v_mfma_f32_16x16x32_bf16 a[68:71], a[240:243], v[100:103], a[68:71]
    ds_read_b64_tr_b16 a[252:253], v15 offset:0
    v_cvt_pk_bf16_f32 v123, v90, v91
    v_mfma_f32_16x16x32_bf16 a[72:75], a[240:243], v[104:107], a[72:75]
    s_waitcnt lgkmcnt(3)
    v_exp_f32 v77, v77
    v_mfma_f32_16x16x32_bf16 a[76:79], a[240:243], v[108:111], a[76:79]
    ds_read_b64_tr_b16 a[254:255], v15 offset:1024
    v_cvt_pk_bf16_f32 v124, v76, v77
    v_mfma_f32_16x16x32_bf16 a[80:83], a[244:247], v[96:99], a[80:83]
    v_exp_f32 v78, v78
    v_mfma_f32_16x16x32_bf16 a[84:87], a[244:247], v[100:103], a[84:87]
    ds_read_b128 a[192:195], v4 offset:24576
    v_mfma_f32_16x16x32_bf16 a[88:91], a[244:247], v[104:107], a[88:91]
    s_waitcnt lgkmcnt(3)
    v_exp_f32 v79, v79
    v_mfma_f32_16x16x32_bf16 a[92:95], a[244:247], v[108:111], a[92:95]
    v_mfma_f32_16x16x32_bf16 a[96:99], a[248:251], v[96:99], a[96:99]
    v_exp_f32 v92, v92
    v_mfma_f32_16x16x32_bf16 a[100:103], a[248:251], v[100:103], a[100:103]
    ds_read_b128 a[196:199], v5 offset:24576
    v_cvt_pk_bf16_f32 v125, v78, v79
    v_mfma_f32_16x16x32_bf16 a[104:107], a[248:251], v[104:107], a[104:107]
    s_waitcnt lgkmcnt(2)
    v_exp_f32 v93, v93
    v_mfma_f32_16x16x32_bf16 a[108:111], a[248:251], v[108:111], a[108:111]
    ds_read_b128 a[200:203], v6 offset:24576
    v_cvt_pk_bf16_f32 v126, v92, v93
    v_mfma_f32_16x16x32_bf16 a[112:115], a[252:255], v[96:99], a[112:115]
    v_exp_f32 v94, v94
    v_mfma_f32_16x16x32_bf16 a[116:119], a[252:255], v[100:103], a[116:119]
    ds_read_b128 a[204:207], v7 offset:24576
    v_mfma_f32_16x16x32_bf16 a[120:123], a[252:255], v[104:107], a[120:123]
    v_exp_f32 v95, v95
    v_mfma_f32_16x16x32_bf16 a[124:127], a[252:255], v[108:111], a[124:127]
    v_mfma_f32_16x16x32_bf16 v[144:147], v[160:163], v[96:99], v[144:147]
    v_mfma_f32_16x16x32_bf16 v[148:151], v[160:163], v[100:103], v[148:151]
    v_mfma_f32_16x16x32_bf16 v[152:155], v[160:163], v[104:107], v[152:155]
    s_cmp_lg_u32 s32, 4
    s_cbranch_scc1 L_nosw
    s_add_u32 s48, s64, s58
    s_addc_u32 s49, s65, 0
    s_sub_u32 s50, 1835008, s58
    s_lshl_b32 s56, s59, 13
    s_nop 3
L_nosw:
    buffer_load_dwordx4 a[128:131], v24, s[48:51], s56 offen
    s_add_u32 s56, s56, 1048576
    s_waitcnt lgkmcnt(3)
    v_mfma_f32_16x16x32_bf16 v[156:159], v[160:163], v[108:111], v[156:159]
    v_mfma_f32_16x16x32_bf16 v[64:67], a[192:195], v[164:167], v[128:131]
    v_exp_f32 v32, v32
    v_mfma_f32_16x16x32_bf16 v[68:71], a[192:195], v[180:183], v[132:135]
    ds_read_b128 a[208:211], v4 offset:25600
    v_cvt_pk_bf16_f32 v127, v94, v95
    v_mfma_f32_16x16x32_bf16 v[72:75], a[192:195], v[196:199], v[136:139]
    s_waitcnt lgkmcnt(3)
    v_exp_f32 v33, v33
    v_mfma_f32_16x16x32_bf16 v[76:79], a[192:195], v[212:215], v[140:143]
    ds_read_b128 a[212:215], v5 offset:25600
    v_cvt_pk_bf16_f32 v96, v32, v33
    v_mfma_f32_16x16x32_bf16 v[64:67], a[196:199], v[168:171], v[64:67]
    s_add_u32 m0, s30, 8192
    v_exp_f32 v34, v34
    v_mfma_f32_16x16x32_bf16 v[68:71], a[196:199], v[184:187], v[68:71]
    ds_read_b128 a[216:219], v6 offset:25600
    v_mfma_f32_16x16x32_bf16 v[72:75], a[196:199], v[200:203], v[72:75]
    s_waitcnt lgkmcnt(4)
    v_exp_f32 v35, v35
    v_mfma_f32_16x16x32_bf16 v[76:79], a[196:199], v[216:219], v[76:79]
    buffer_load_dwordx4 v16, s[8:11], s28 offen offset:0 lds
    v_mfma_f32_16x16x32_bf16 v[64:67], a[200:203], v[172:175], v[64:67]
    v_exp_f32 v48, v48
    v_mfma_f32_16x16x32_bf16 v[68:71], a[200:203], v[188:191], v[68:71]
    ds_read_b128 a[220:223], v7 offset:25600
    v_cvt_pk_bf16_f32 v97, v34, v35
    v_mfma_f32_16x16x32_bf16 v[72:75], a[200:203], v[204:207], v[72:75]
    s_waitcnt lgkmcnt(4)
    v_exp_f32 v49, v49
    v_mfma_f32_16x16x32_bf16 v[76:79], a[200:203], v[220:223], v[76:79]
    ds_read_b64_tr_b16 a[224:225], v8 offset:8192
    v_cvt_pk_bf16_f32 v98, v48, v49
    v_mfma_f32_16x16x32_bf16 v[64:67], a[204:207], v[176:179], v[64:67]
    v_exp_f32 v50, v50
    v_mfma_f32_16x16x32_bf16 v[68:71], a[204:207], v[192:195], v[68:71]
    ds_read_b64_tr_b16 a[226:227], v8 offset:9216
    v_mfma_f32_16x16x32_bf16 v[72:75], a[204:207], v[208:211], v[72:75]
    s_waitcnt lgkmcnt(5)
    v_exp_f32 v51, v51
    v_mfma_f32_16x16x32_bf16 v[76:79], a[204:207], v[224:227], v[76:79]
    buffer_load_dwordx4 v16, s[8:11], s28 offen offset:1024 lds
    v_mfma_f32_16x16x32_bf16 v[80:83], a[208:211], v[164:167], v[128:131]
    v_exp_f32 v36, v36
    v_mfma_f32_16x16x32_bf16 v[84:87], a[208:211], v[180:183], v[132:135]
    ds_read_b64_tr_b16 a[228:229], v9 offset:8192
    v_cvt_pk_bf16_f32 v99, v50, v51
    v_mfma_f32_16x16x32_bf16 v[88:91], a[208:211], v[196:199], v[136:139]
    s_waitcnt lgkmcnt(5)
    v_exp_f32 v37, v37
    v_mfma_f32_16x16x32_bf16 v[92:95], a[208:211], v[212:215], v[140:143]
    ds_read_b64_tr_b16 a[230:231], v9 offset:9216
    v_cvt_pk_bf16_f32 v100, v36, v37
    v_mfma_f32_16x16x32_bf16 v[80:83], a[212:215], v[168:171], v[80:83]
    s_add_u32 m0, s31, 57344
    v_exp_f32 v38, v38
    v_mfma_f32_16x16x32_bf16 v[84:87], a[212:215], v[184:187], v[84:87]
    ds_read_b64_tr_b16 a[232:233], v10 offset:8192
    v_mfma_f32_16x16x32_bf16 v[88:91], a[212:215], v[200:203], v[88:91]
    s_waitcnt lgkmcnt(6)
    v_exp_f32 v39, v39
    v_mfma_f32_16x16x32_bf16 v[92:95], a[212:215], v[216:219], v[92:95]
    buffer_load_dwordx4 v17, s[12:15], s29 offen offset:0 lds
    v_mfma_f32_16x16x32_bf16 v[80:83], a[216:219], v[172:175], v[80:83]
    v_exp_f32 v52, v52
    v_mfma_f32_16x16x32_bf16 v[84:87], a[216:219], v[188:191], v[84:87]
    ds_read_b64_tr_b16 a[234:235], v10 offset:9216
    v_cvt_pk_bf16_f32 v101, v38, v39
    v_mfma_f32_16x16x32_bf16 v[88:91], a[216:219], v[204:207], v[88:91]
    s_waitcnt lgkmcnt(6)
    v_exp_f32 v53, v53
    v_mfma_f32_16x16x32_bf16 v[92:95], a[216:219], v[220:223], v[92:95]
    ds_read_b64_tr_b16 a[236:237], v11 offset:8192
    v_cvt_pk_bf16_f32 v102, v52, v53
    v_mfma_f32_16x16x32_bf16 v[80:83], a[220:223], v[176:179], v[80:83]
    v_exp_f32 v54, v54
    v_mfma_f32_16x16x32_bf16 v[84:87], a[220:223], v[192:195], v[84:87]
    ds_read_b64_tr_b16 a[238:239], v11 offset:9216
    v_mfma_f32_16x16x32_bf16 v[88:91], a[220:223], v[208:211], v[88:91]
    s_waitcnt lgkmcnt(6)
    v_exp_f32 v55, v55
    v_mfma_f32_16x16x32_bf16 v[92:95], a[220:223], v[224:227], v[92:95]
    buffer_load_dwordx4 v17, s[12:15], s29 offen offset:1024 lds
    v_mfma_f32_16x16x32_bf16 a[0:3], a[224:227], v[112:115], a[0:3]
    v_exp_f32 v40, v40
    v_mfma_f32_16x16x32_bf16 a[4:7], a[224:227], v[116:119], a[4:7]
    ds_read_b64_tr_b16 a[240:241], v12 offset:8192
    v_cvt_pk_bf16_f32 v103, v54, v55
    v_mfma_f32_16x16x32_bf16 a[8:11], a[224:227], v[120:123], a[8:11]
    s_waitcnt lgkmcnt(5)
    v_exp_f32 v41, v41
    v_mfma_f32_16x16x32_bf16 a[12:15], a[224:227], v[124:127], a[12:15]
    ds_read_b64_tr_b16 a[242:243], v12 offset:9216
    v_cvt_pk_bf16_f32 v104, v40, v41
    v_mfma_f32_16x16x32_bf16 a[16:19], a[228:231], v[112:115], a[16:19]
    s_add_u32 s28, s28, 8192
    v_exp_f32 v42, v42
    v_mfma_f32_16x16x32_bf16 a[20:23], a[228:231], v[116:119], a[20:23]
    ds_read_b64_tr_b16 a[244:245], v13 offset:8192
    v_mfma_f32_16x16x32_bf16 a[24:27], a[228:231], v[120:123], a[24:27]
    s_waitcnt lgkmcnt(5)
    v_exp_f32 v43, v43
    v_mfma_f32_16x16x32_bf16 a[28:31], a[228:231], v[124:127], a[28:31]
    v_mfma_f32_16x16x32_bf16 a[32:35], a[232:235], v[112:115], a[32:35]
    s_add_u32 s29, s29, 8192
    v_exp_f32 v56, v56
    v_mfma_f32_16x16x32_bf16 a[36:39], a[232:235], v[116:119], a[36:39]
    ds_read_b64_tr_b16 a[246:247], v13 offset:9216
    v_cvt_pk_bf16_f32 v105, v42, v43
    v_mfma_f32_16x16x32_bf16 a[40:43], a[232:235], v[120:123], a[40:43]
    s_waitcnt lgkmcnt(4)
    v_exp_f32 v57, v57
    v_mfma_f32_16x16x32_bf16 a[44:47], a[232:235], v[124:127], a[44:47]
    ds_read_b64_tr_b16 a[248:249], v14 offset:8192
    v_cvt_pk_bf16_f32 v106, v56, v57
    v_mfma_f32_16x16x32_bf16 a[48:51], a[236:239], v[112:115], a[48:51]
    v_exp_f32 v58, v58
    v_mfma_f32_16x16x32_bf16 a[52:55], a[236:239], v[116:119], a[52:55]
    ds_read_b64_tr_b16 a[250:251], v14 offset:9216
    v_mfma_f32_16x16x32_bf16 a[56:59], a[236:239], v[120:123], a[56:59]
    s_waitcnt lgkmcnt(4)
    v_exp_f32 v59, v59
    v_mfma_f32_16x16x32_bf16 a[60:63], a[236:239], v[124:127], a[60:63]
    v_mfma_f32_16x16x32_bf16 a[64:67], a[240:243], v[112:115], a[64:67]
    s_waitcnt vmcnt(16)
    v_exp_f32 v44, v44
    v_mfma_f32_16x16x32_bf16 a[68:71], a[240:243], v[116:119], a[68:71]
    ds_read_b64_tr_b16 a[252:253], v15 offset:8192
    v_cvt_pk_bf16_f32 v107, v58, v59
    v_mfma_f32_16x16x32_bf16 a[72:75], a[240:243], v[120:123], a[72:75]
    s_waitcnt lgkmcnt(3)
    v_exp_f32 v45, v45
    v_mfma_f32_16x16x32_bf16 a[76:79], a[240:243], v[124:127], a[76:79]
    ds_read_b64_tr_b16 a[254:255], v15 offset:9216
    v_cvt_pk_bf16_f32 v108, v44, v45
    v_mfma_f32_16x16x32_bf16 a[80:83], a[244:247], v[112:115], a[80:83]
    s_barrier
    v_exp_f32 v46, v46
    v_mfma_f32_16x16x32_bf16 a[84:87], a[244:247], v[116:119], a[84:87]
    ds_read_b128 a[192:195], v4 offset:32768
    v_mfma_f32_16x16x32_bf16 a[88:91], a[244:247], v[120:123], a[88:91]
    s_waitcnt lgkmcnt(3)
    v_exp_f32 v47, v47
    v_mfma_f32_16x16x32_bf16 a[92:95], a[244:247], v[124:127], a[92:95]
    v_mfma_f32_16x16x32_bf16 a[96:99], a[248:251], v[112:115], a[96:99]
    v_exp_f32 v60, v60
    v_mfma_f32_16x16x32_bf16 a[100:103], a[248:251], v[116:119], a[100:103]
    ds_read_b128 a[196:199], v5 offset:32768
    v_cvt_pk_bf16_f32 v109, v46, v47
    v_mfma_f32_16x16x32_bf16 a[104:107], a[248:251], v[120:123], a[104:107]
    s_waitcnt lgkmcnt(2)
    v_exp_f32 v61, v61
    v_mfma_f32_16x16x32_bf16 a[108:111], a[248:251], v[124:127], a[108:111]
    ds_read_b128 a[200:203], v6 offset:32768
    v_cvt_pk_bf16_f32 v110, v60, v61
    v_mfma_f32_16x16x32_bf16 a[112:115], a[252:255], v[112:115], a[112:115]
    v_exp_f32 v62, v62
    v_mfma_f32_16x16x32_bf16 a[116:119], a[252:255], v[116:119], a[116:119]
    ds_read_b128 a[204:207], v7 offset:32768
    v_mfma_f32_16x16x32_bf16 a[120:123], a[252:255], v[120:123], a[120:123]
    v_exp_f32 v63, v63
    v_mfma_f32_16x16x32_bf16 a[124:127], a[252:255], v[124:127], a[124:127]
    v_mfma_f32_16x16x32_bf16 v[144:147], v[160:163], v[112:115], v[144:147]
    v_mfma_f32_16x16x32_bf16 v[148:151], v[160:163], v[116:119], v[148:151]
    v_mfma_f32_16x16x32_bf16 v[152:155], v[160:163], v[120:123], v[152:155]
    s_waitcnt lgkmcnt(3)
    v_mfma_f32_16x16x32_bf16 v[156:159], v[160:163], v[124:127], v[156:159]
    v_mfma_f32_16x16x32_bf16 v[32:35], a[192:195], v[164:167], v[128:131]
    v_exp_f32 v64, v64
    v_mfma_f32_16x16x32_bf16 v[36:39], a[192:195], v[180:183], v[132:135]
    ds_read_b128 a[208:211], v4 offset:33792
    v_cvt_pk_bf16_f32 v111, v62, v63
    v_mfma_f32_16x16x32_bf16 v[40:43], a[192:195], v[196:199], v[136:139]
    s_waitcnt lgkmcnt(3)
    v_exp_f32 v65, v65
    v_mfma_f32_16x16x32_bf16 v[44:47], a[192:195], v[212:215], v[140:143]
    ds_read_b128 a[212:215], v5 offset:33792
    v_cvt_pk_bf16_f32 v112, v64, v65
    v_mfma_f32_16x16x32_bf16 v[32:35], a[196:199], v[168:171], v[32:35]
    s_add_u32 m0, s30, 16384
    v_exp_f32 v66, v66
    v_mfma_f32_16x16x32_bf16 v[36:39], a[196:199], v[184:187], v[36:39]
    ds_read_b128 a[216:219], v6 offset:33792
    v_mfma_f32_16x16x32_bf16 v[40:43], a[196:199], v[200:203], v[40:43]
    s_waitcnt lgkmcnt(4)
    v_exp_f32 v67, v67
    v_mfma_f32_16x16x32_bf16 v[44:47], a[196:199], v[216:219], v[44:47]
    buffer_load_dwordx4 v16, s[8:11], s28 offen offset:0 lds
    v_mfma_f32_16x16x32_bf16 v[32:35], a[200:203], v[172:175], v[32:35]
    v_exp_f32 v80, v80
    v_mfma_f32_16x16x32_bf16 v[36:39], a[200:203], v[188:191], v[36:39]
    ds_read_b128 a[220:223], v7 offset:33792
    v_cvt_pk_bf16_f32 v113, v66, v67
    v_mfma_f32_16x16x32_bf16 v[40:43], a[200:203], v[204:207], v[40:43]
    s_waitcnt lgkmcnt(4)
    v_exp_f32 v81, v81
    v_mfma_f32_16x16x32_bf16 v[44:47], a[200:203], v[220:223], v[44:47]
    ds_read_b64_tr_b16 a[224:225], v8 offset:16384
    v_cvt_pk_bf16_f32 v114, v80, v81
    v_mfma_f32_16x16x32_bf16 v[32:35], a[204:207], v[176:179], v[32:35]
    v_exp_f32 v82, v82
    v_mfma_f32_16x16x32_bf16 v[36:39], a[204:207], v[192:195], v[36:39]
    ds_read_b64_tr_b16 a[226:227], v8 offset:17408
    v_mfma_f32_16x16x32_bf16 v[40:43], a[204:207], v[208:211], v[40:43]
    s_waitcnt lgkmcnt(5)
    v_exp_f32 v83, v83
    v_mfma_f32_16x16x32_bf16 v[44:47], a[204:207], v[224:227], v[44:47]
    buffer_load_dwordx4 v16, s[8:11], s28 offen offset:1024 lds
    v_mfma_f32_16x16x32_bf16 v[48:51], a[208:211], v[164:167], v[128:131]
    v_exp_f32 v68, v68
    v_mfma_f32_16x16x32_bf16 v[52:55], a[208:211], v[180:183], v[132:135]
    ds_read_b64_tr_b16 a[228:229], v9 offset:16384
    v_cvt_pk_bf16_f32 v115, v82, v83
    v_mfma_f32_16x16x32_bf16 v[56:59], a[208:211], v[196:199], v[136:139]
    s_waitcnt lgkmcnt(5)
    v_exp_f32 v69, v69
    v_mfma_f32_16x16x32_bf16 v[60:63], a[208:211], v[212:215], v[140:143]
    ds_read_b64_tr_b16 a[230:231], v9 offset:17408
    v_cvt_pk_bf16_f32 v116, v68, v69
    v_mfma_f32_16x16x32_bf16 v[48:51], a[212:215], v[168:171], v[48:51]
    s_add_u32 m0, s31, 0
    v_exp_f32 v70, v70
    v_mfma_f32_16x16x32_bf16 v[52:55], a[212:215], v[184:187], v[52:55]
    ds_read_b64_tr_b16 a[232:233], v10 offset:16384
    v_mfma_f32_16x16x32_bf16 v[56:59], a[212:215], v[200:203], v[56:59]
    s_waitcnt lgkmcnt(6)
    v_exp_f32 v71, v71
    v_mfma_f32_16x16x32_bf16 v[60:63], a[212:215], v[216:219], v[60:63]
    buffer_load_dwordx4 v17, s[12:15], s29 offen offset:0 lds
    v_mfma_f32_16x16x32_bf16 v[48:51], a[216:219], v[172:175], v[48:51]
    v_exp_f32 v84, v84
    v_mfma_f32_16x16x32_bf16 v[52:55], a[216:219], v[188:191], v[52:55]
    ds_read_b64_tr_b16 a[234:235], v10 offset:17408
    v_cvt_pk_bf16_f32 v117, v70, v71
    v_mfma_f32_16x16x32_bf16 v[56:59], a[216:219], v[204:207], v[56:59]
    s_waitcnt lgkmcnt(6)
    v_exp_f32 v85, v85
    v_mfma_f32_16x16x32_bf16 v[60:63], a[216:219], v[220:223], v[60:63]
    ds_read_b64_tr_b16 a[236:237], v11 offset:16384
    v_cvt_pk_bf16_f32 v118, v84, v85
    v_mfma_f32_16x16x32_bf16 v[48:51], a[220:223], v[176:179], v[48:51]
    v_exp_f32 v86, v86
    v_mfma_f32_16x16x32_bf16 v[52:55], a[220:223], v[192:195], v[52:55]
    ds_read_b64_tr_b16 a[238:239], v11 offset:17408
    v_mfma_f32_16x16x32_bf16 v[56:59], a[220:223], v[208:211], v[56:59]
    s_waitcnt lgkmcnt(6)
    v_exp_f32 v87, v87
    v_mfma_f32_16x16x32_bf16 v[60:63], a[220:223], v[224:227], v[60:63]
    buffer_load_dwordx4 v17, s[12:15], s29 offen offset:1024 lds
    v_mfma_f32_16x16x32_bf16 a[0:3], a[224:227], v[96:99], a[0:3]
    v_exp_f32 v72, v72
    v_mfma_f32_16x16x32_bf16 a[4:7], a[224:227], v[100:103], a[4:7]
    ds_read_b64_tr_b16 a[240:241], v12 offset:16384
    v_cvt_pk_bf16_f32 v119, v86, v87
    v_mfma_f32_16x16x32_bf16 a[8:11], a[224:227], v[104:107], a[8:11]
    s_waitcnt lgkmcnt(5)
    v_exp_f32 v73, v73
    v_mfma_f32_16x16x32_bf16 a[12:15], a[224:227], v[108:111], a[12:15]
    ds_read_b64_tr_b16 a[242:243], v12 offset:17408
    v_cvt_pk_bf16_f32 v120, v72, v73
    v_mfma_f32_16x16x32_bf16 a[16:19], a[228:231], v[96:99], a[16:19]
    s_add_u32 s28, s28, 8192
    v_exp_f32 v74, v74
    v_mfma_f32_16x16x32_bf16 a[20:23], a[228:231], v[100:103], a[20:23]
    ds_read_b64_tr_b16 a[244:245], v13 offset:16384
    v_mfma_f32_16x16x32_bf16 a[24:27], a[228:231], v[104:107], a[24:27]
    s_waitcnt lgkmcnt(5)
    v_exp_f32 v75, v75
    v_mfma_f32_16x16x32_bf16 a[28:31], a[228:231], v[108:111], a[28:31]
    v_mfma_f32_16x16x32_bf16 a[32:35], a[232:235], v[96:99], a[32:35]
    s_add_u32 s29, s29, 8192
    v_exp_f32 v88, v88
    v_mfma_f32_16x16x32_bf16 a[36:39], a[232:235], v[100:103], a[36:39]
    ds_read_b64_tr_b16 a[246:247], v13 offset:17408
    v_cvt_pk_bf16_f32 v121, v74, v75
    v_mfma_f32_16x16x32_bf16 a[40:43], a[232:235], v[104:107], a[40:43]
    s_waitcnt lgkmcnt(4)
    v_exp_f32 v89, v89
    v_mfma_f32_16x16x32_bf16 a[44:47], a[232:235], v[108:111], a[44:47]
    ds_read_b64_tr_b16 a[248:249], v14 offset:16384
    v_cvt_pk_bf16_f32 v122, v88, v89
    v_mfma_f32_16x16x32_bf16 a[48:51], a[236:239], v[96:99], a[48:51]
    v_exp_f32 v90, v90
    v_mfma_f32_16x16x32_bf16 a[52:55], a[236:239], v[100:103], a[52:55]
    ds_read_b64_tr_b16 a[250:251], v14 offset:17408
    v_mfma_f32_16x16x32_bf16 a[56:59], a[236:239], v[104:107], a[56:59]
    s_waitcnt lgkmcnt(4)
    v_exp_f32 v91, v91
    v_mfma_f32_16x16x32_bf16 a[60:63], a[236:239], v[108:111], a[60:63]
    v_mfma_f32_16x16x32_bf16 a[64:67], a[240:243], v[96:99], a[64:67]
    v_exp_f32 v76, v76
    v_mfma_f32_16x16x32_bf16 a[68:71], a[240:243], v[100:103], a[68:71]
    ds_read_b64_tr_b16 a[252:253], v15 offset:16384
    v_cvt_pk_bf16_f32 v123, v90, v91
    v_mfma_f32_16x16x32_bf16 a[72:75], a[240:243], v[104:107], a[72:75]
    s_waitcnt lgkmcnt(3)
    v_exp_f32 v77, v77
    v_mfma_f32_16x16x32_bf16 a[76:79], a[240:243], v[108:111], a[76:79]
    ds_read_b64_tr_b16 a[254:255], v15 offset:17408
    v_cvt_pk_bf16_f32 v124, v76, v77
    v_mfma_f32_16x16x32_bf16 a[80:83], a[244:247], v[96:99], a[80:83]
    v_exp_f32 v78, v78
    v_mfma_f32_16x16x32_bf16 a[84:87], a[244:247], v[100:103], a[84:87]
    ds_read_b128 a[192:195], v4 offset:40960
    v_mfma_f32_16x16x32_bf16 a[88:91], a[244:247], v[104:107], a[88:91]
    s_waitcnt lgkmcnt(3)
    v_exp_f32 v79, v79
    v_mfma_f32_16x16x32_bf16 a[92:95], a[244:247], v[108:111], a[92:95]
    v_mfma_f32_16x16x32_bf16 a[96:99], a[248:251], v[96:99], a[96:99]
    v_exp_f32 v92, v92
    v_mfma_f32_16x16x32_bf16 a[100:103], a[248:251], v[100:103], a[100:103]
    ds_read_b128 a[196:199], v5 offset:40960
    v_cvt_pk_bf16_f32 v125, v78, v79
    v_mfma_f32_16x16x32_bf16 a[104:107], a[248:251], v[104:107], a[104:107]
    s_waitcnt lgkmcnt(2)
    v_exp_f32 v93, v93
    v_mfma_f32_16x16x32_bf16 a[108:111], a[248:251], v[108:111], a[108:111]
    ds_read_b128 a[200:203], v6 offset:40960
    v_cvt_pk_bf16_f32 v126, v92, v93
    v_mfma_f32_16x16x32_bf16 a[112:115], a[252:255], v[96:99], a[112:115]
    v_exp_f32 v94, v94
    v_mfma_f32_16x16x32_bf16 a[116:119], a[252:255], v[100:103], a[116:119]
    ds_read_b128 a[204:207], v7 offset:40960
    v_mfma_f32_16x16x32_bf16 a[120:123], a[252:255], v[104:107], a[120:123]
    v_exp_f32 v95, v95
    v_mfma_f32_16x16x32_bf16 a[124:127], a[252:255], v[108:111], a[124:127]
    v_mfma_f32_16x16x32_bf16 v[144:147], v[160:163], v[96:99], v[144:147]
    v_mfma_f32_16x16x32_bf16 v[148:151], v[160:163], v[100:103], v[148:151]
    v_mfma_f32_16x16x32_bf16 v[152:155], v[160:163], v[104:107], v[152:155]
    s_waitcnt lgkmcnt(3)
    v_mfma_f32_16x16x32_bf16 v[156:159], v[160:163], v[108:111], v[156:159]
    v_mfma_f32_16x16x32_bf16 v[64:67], a[192:195], v[164:167], v[128:131]
    v_exp_f32 v32, v32
    v_mfma_f32_16x16x32_bf16 v[68:71], a[192:195], v[180:183], v[132:135]
    ds_read_b128 a[208:211], v4 offset:41984
    v_cvt_pk_bf16_f32 v127, v94, v95
    v_mfma_f32_16x16x32_bf16 v[72:75], a[192:195], v[196:199], v[136:139]
    s_waitcnt lgkmcnt(3)
    v_exp_f32 v33, v33
    v_mfma_f32_16x16x32_bf16 v[76:79], a[192:195], v[212:215], v[140:143]
    ds_read_b128 a[212:215], v5 offset:41984
    v_cvt_pk_bf16_f32 v96, v32, v33
    v_mfma_f32_16x16x32_bf16 v[64:67], a[196:199], v[168:171], v[64:67]
    s_add_u32 m0, s30, 24576
    v_exp_f32 v34, v34
    v_mfma_f32_16x16x32_bf16 v[68:71], a[196:199], v[184:187], v[68:71]
    ds_read_b128 a[216:219], v6 offset:41984
    v_mfma_f32_16x16x32_bf16 v[72:75], a[196:199], v[200:203], v[72:75]
    s_waitcnt lgkmcnt(4)
    v_exp_f32 v35, v35
    v_mfma_f32_16x16x32_bf16 v[76:79], a[196:199], v[216:219], v[76:79]
    buffer_load_dwordx4 v16, s[8:11], s28 offen offset:0 lds
    v_mfma_f32_16x16x32_bf16 v[64:67], a[200:203], v[172:175], v[64:67]
    v_exp_f32 v48, v48
    v_mfma_f32_16x16x32_bf16 v[68:71], a[200:203], v[188:191], v[68:71]
    ds_read_b128 a[220:223], v7 offset:41984
    v_cvt_pk_bf16_f32 v97, v34, v35
    v_mfma_f32_16x16x32_bf16 v[72:75], a[200:203], v[204:207], v[72:75]
    s_waitcnt lgkmcnt(4)
    v_exp_f32 v49, v49
    v_mfma_f32_16x16x32_bf16 v[76:79], a[200:203], v[220:223], v[76:79]
    ds_read_b64_tr_b16 a[224:225], v8 offset:24576
    v_cvt_pk_bf16_f32 v98, v48, v49
    v_mfma_f32_16x16x32_bf16 v[64:67], a[204:207], v[176:179], v[64:67]
    v_exp_f32 v50, v50
    v_mfma_f32_16x16x32_bf16 v[68:71], a[204:207], v[192:195], v[68:71]
    ds_read_b64_tr_b16 a[226:227], v8 offset:25600
    v_mfma_f32_16x16x32_bf16 v[72:75], a[204:207], v[208:211], v[72:75]
    s_waitcnt lgkmcnt(5)
    v_exp_f32 v51, v51
    v_mfma_f32_16x16x32_bf16 v[76:79], a[204:207], v[224:227], v[76:79]
    buffer_load_dwordx4 v16, s[8:11], s28 offen offset:1024 lds
    v_mfma_f32_16x16x32_bf16 v[80:83], a[208:211], v[164:167], v[128:131]
    v_exp_f32 v36, v36
    v_mfma_f32_16x16x32_bf16 v[84:87], a[208:211], v[180:183], v[132:135]
    ds_read_b64_tr_b16 a[228:229], v9 offset:24576
    v_cvt_pk_bf16_f32 v99, v50, v51
    v_mfma_f32_16x16x32_bf16 v[88:91], a[208:211], v[196:199], v[136:139]
    s_waitcnt lgkmcnt(5)
    v_exp_f32 v37, v37
    v_mfma_f32_16x16x32_bf16 v[92:95], a[208:211], v[212:215], v[140:143]
    ds_read_b64_tr_b16 a[230:231], v9 offset:25600
    v_cvt_pk_bf16_f32 v100, v36, v37
    v_mfma_f32_16x16x32_bf16 v[80:83], a[212:215], v[168:171], v[80:83]
    s_add_u32 m0, s31, 8192
    v_exp_f32 v38, v38
    v_mfma_f32_16x16x32_bf16 v[84:87], a[212:215], v[184:187], v[84:87]
    ds_read_b64_tr_b16 a[232:233], v10 offset:24576
    v_mfma_f32_16x16x32_bf16 v[88:91], a[212:215], v[200:203], v[88:91]
    s_waitcnt lgkmcnt(6)
    v_exp_f32 v39, v39
    v_mfma_f32_16x16x32_bf16 v[92:95], a[212:215], v[216:219], v[92:95]
    buffer_load_dwordx4 v17, s[12:15], s29 offen offset:0 lds
    v_mfma_f32_16x16x32_bf16 v[80:83], a[216:219], v[172:175], v[80:83]
    v_exp_f32 v52, v52
    v_mfma_f32_16x16x32_bf16 v[84:87], a[216:219], v[188:191], v[84:87]
    ds_read_b64_tr_b16 a[234:235], v10 offset:25600
    v_cvt_pk_bf16_f32 v101, v38, v39
    v_mfma_f32_16x16x32_bf16 v[88:91], a[216:219], v[204:207], v[88:91]
    s_waitcnt lgkmcnt(6)
    v_exp_f32 v53, v53
    v_mfma_f32_16x16x32_bf16 v[92:95], a[216:219], v[220:223], v[92:95]
    ds_read_b64_tr_b16 a[236:237], v11 offset:24576
    v_cvt_pk_bf16_f32 v102, v52, v53
    v_mfma_f32_16x16x32_bf16 v[80:83], a[220:223], v[176:179], v[80:83]
    v_exp_f32 v54, v54
    v_mfma_f32_16x16x32_bf16 v[84:87], a[220:223], v[192:195], v[84:87]
    ds_read_b64_tr_b16 a[238:239], v11 offset:25600
    v_mfma_f32_16x16x32_bf16 v[88:91], a[220:223], v[208:211], v[88:91]
    s_waitcnt lgkmcnt(6)
    v_exp_f32 v55, v55
    v_mfma_f32_16x16x32_bf16 v[92:95], a[220:223], v[224:227], v[92:95]
    buffer_load_dwordx4 v17, s[12:15], s29 offen offset:1024 lds
    v_mfma_f32_16x16x32_bf16 a[0:3], a[224:227], v[112:115], a[0:3]
    v_exp_f32 v40, v40
    v_mfma_f32_16x16x32_bf16 a[4:7], a[224:227], v[116:119], a[4:7]
    ds_read_b64_tr_b16 a[240:241], v12 offset:24576
    v_cvt_pk_bf16_f32 v103, v54, v55
    v_mfma_f32_16x16x32_bf16 a[8:11], a[224:227], v[120:123], a[8:11]
    s_waitcnt lgkmcnt(5)
    v_exp_f32 v41, v41
    v_mfma_f32_16x16x32_bf16 a[12:15], a[224:227], v[124:127], a[12:15]
    ds_read_b64_tr_b16 a[242:243], v12 offset:25600
    v_cvt_pk_bf16_f32 v104, v40, v41
    v_mfma_f32_16x16x32_bf16 a[16:19], a[228:231], v[112:115], a[16:19]
    s_add_u32 s28, s28, 8192
    v_exp_f32 v42, v42
    v_mfma_f32_16x16x32_bf16 a[20:23], a[228:231], v[116:119], a[20:23]
    ds_read_b64_tr_b16 a[244:245], v13 offset:24576
    v_mfma_f32_16x16x32_bf16 a[24:27], a[228:231], v[120:123], a[24:27]
    s_waitcnt lgkmcnt(5)
    v_exp_f32 v43, v43
    v_mfma_f32_16x16x32_bf16 a[28:31], a[228:231], v[124:127], a[28:31]
    v_mfma_f32_16x16x32_bf16 a[32:35], a[232:235], v[112:115], a[32:35]
    s_add_u32 s29, s29, 8192
    v_exp_f32 v56, v56
    v_mfma_f32_16x16x32_bf16 a[36:39], a[232:235], v[116:119], a[36:39]
    ds_read_b64_tr_b16 a[246:247], v13 offset:25600
    v_cvt_pk_bf16_f32 v105, v42, v43
    v_mfma_f32_16x16x32_bf16 a[40:43], a[232:235], v[120:123], a[40:43]
    s_waitcnt lgkmcnt(4)
    v_exp_f32 v57, v57
    v_mfma_f32_16x16x32_bf16 a[44:47], a[232:235], v[124:127], a[44:47]
    ds_read_b64_tr_b16 a[248:249], v14 offset:24576
    v_cvt_pk_bf16_f32 v106, v56, v57
    v_mfma_f32_16x16x32_bf16 a[48:51], a[236:239], v[112:115], a[48:51]
    v_exp_f32 v58, v58
    v_mfma_f32_16x16x32_bf16 a[52:55], a[236:239], v[116:119], a[52:55]
    ds_read_b64_tr_b16 a[250:251], v14 offset:25600
    v_mfma_f32_16x16x32_bf16 a[56:59], a[236:239], v[120:123], a[56:59]
    s_waitcnt lgkmcnt(4)
    v_exp_f32 v59, v59
    v_mfma_f32_16x16x32_bf16 a[60:63], a[236:239], v[124:127], a[60:63]
    v_mfma_f32_16x16x32_bf16 a[64:67], a[240:243], v[112:115], a[64:67]
    s_waitcnt vmcnt(16)
    v_exp_f32 v44, v44
    v_mfma_f32_16x16x32_bf16 a[68:71], a[240:243], v[116:119], a[68:71]
    ds_read_b64_tr_b16 a[252:253], v15 offset:24576
    v_cvt_pk_bf16_f32 v107, v58, v59
    v_mfma_f32_16x16x32_bf16 a[72:75], a[240:243], v[120:123], a[72:75]
    s_waitcnt lgkmcnt(3)
    v_exp_f32 v45, v45
    v_mfma_f32_16x16x32_bf16 a[76:79], a[240:243], v[124:127], a[76:79]
    ds_read_b64_tr_b16 a[254:255], v15 offset:25600
    v_cvt_pk_bf16_f32 v108, v44, v45
    v_mfma_f32_16x16x32_bf16 a[80:83], a[244:247], v[112:115], a[80:83]
    s_barrier
    v_exp_f32 v46, v46
    v_mfma_f32_16x16x32_bf16 a[84:87], a[244:247], v[116:119], a[84:87]
    ds_read_b128 a[192:195], v4 offset:49152
    v_mfma_f32_16x16x32_bf16 a[88:91], a[244:247], v[120:123], a[88:91]
    s_waitcnt lgkmcnt(3)
    v_exp_f32 v47, v47
    v_mfma_f32_16x16x32_bf16 a[92:95], a[244:247], v[124:127], a[92:95]
    v_mfma_f32_16x16x32_bf16 a[96:99], a[248:251], v[112:115], a[96:99]
    v_exp_f32 v60, v60
    v_mfma_f32_16x16x32_bf16 a[100:103], a[248:251], v[116:119], a[100:103]
    ds_read_b128 a[196:199], v5 offset:49152
    v_cvt_pk_bf16_f32 v109, v46, v47
    v_mfma_f32_16x16x32_bf16 a[104:107], a[248:251], v[120:123], a[104:107]
    s_waitcnt lgkmcnt(2)
    v_exp_f32 v61, v61
    v_mfma_f32_16x16x32_bf16 a[108:111], a[248:251], v[124:127], a[108:111]
    ds_read_b128 a[200:203], v6 offset:49152
    v_cvt_pk_bf16_f32 v110, v60, v61
    v_mfma_f32_16x16x32_bf16 a[112:115], a[252:255], v[112:115], a[112:115]
    v_exp_f32 v62, v62
    v_mfma_f32_16x16x32_bf16 a[116:119], a[252:255], v[116:119], a[116:119]
    ds_read_b128 a[204:207], v7 offset:49152
    v_mfma_f32_16x16x32_bf16 a[120:123], a[252:255], v[120:123], a[120:123]
    v_exp_f32 v63, v63
    v_mfma_f32_16x16x32_bf16 a[124:127], a[252:255], v[124:127], a[124:127]
    v_mfma_f32_16x16x32_bf16 v[144:147], v[160:163], v[112:115], v[144:147]
    v_mfma_f32_16x16x32_bf16 v[148:151], v[160:163], v[116:119], v[148:151]
    v_mfma_f32_16x16x32_bf16 v[152:155], v[160:163], v[120:123], v[152:155]
    s_waitcnt lgkmcnt(3)
    v_mfma_f32_16x16x32_bf16 v[156:159], v[160:163], v[124:127], v[156:159]
    v_mfma_f32_16x16x32_bf16 v[32:35], a[192:195], v[164:167], v[128:131]
    v_exp_f32 v64, v64
    v_mfma_f32_16x16x32_bf16 v[36:39], a[192:195], v[180:183], v[132:135]
    ds_read_b128 a[208:211], v4 offset:50176
    v_cvt_pk_bf16_f32 v111, v62, v63
    v_mfma_f32_16x16x32_bf16 v[40:43], a[192:195], v[196:199], v[136:139]
    s_waitcnt lgkmcnt(3)
    v_exp_f32 v65, v65
    v_mfma_f32_16x16x32_bf16 v[44:47], a[192:195], v[212:215], v[140:143]
    ds_read_b128 a[212:215], v5 offset:50176
    v_cvt_pk_bf16_f32 v112, v64, v65
    v_mfma_f32_16x16x32_bf16 v[32:35], a[196:199], v[168:171], v[32:35]
    s_add_u32 m0, s30, 32768
    v_exp_f32 v66, v66
    v_mfma_f32_16x16x32_bf16 v[36:39], a[196:199], v[184:187], v[36:39]
    ds_read_b128 a[216:219], v6 offset:50176
    v_mfma_f32_16x16x32_bf16 v[40:43], a[196:199], v[200:203], v[40:43]
    s_waitcnt lgkmcnt(4)
    v_exp_f32 v67, v67
    v_mfma_f32_16x16x32_bf16 v[44:47], a[196:199], v[216:219], v[44:47]
    buffer_load_dwordx4 v16, s[8:11], s28 offen offset:0 lds
    v_mfma_f32_16x16x32_bf16 v[32:35], a[200:203], v[172:175], v[32:35]
    v_exp_f32 v80, v80
    v_mfma_f32_16x16x32_bf16 v[36:39], a[200:203], v[188:191], v[36:39]
    ds_read_b128 a[220:223], v7 offset:50176
    v_cvt_pk_bf16_f32 v113, v66, v67
    v_mfma_f32_16x16x32_bf16 v[40:43], a[200:203], v[204:207], v[40:43]
    s_waitcnt lgkmcnt(4)
    v_exp_f32 v81, v81
    v_mfma_f32_16x16x32_bf16 v[44:47], a[200:203], v[220:223], v[44:47]
    ds_read_b64_tr_b16 a[224:225], v8 offset:32768
    v_cvt_pk_bf16_f32 v114, v80, v81
    v_mfma_f32_16x16x32_bf16 v[32:35], a[204:207], v[176:179], v[32:35]
    v_exp_f32 v82, v82
    v_mfma_f32_16x16x32_bf16 v[36:39], a[204:207], v[192:195], v[36:39]
    ds_read_b64_tr_b16 a[226:227], v8 offset:33792
    v_mfma_f32_16x16x32_bf16 v[40:43], a[204:207], v[208:211], v[40:43]
    s_waitcnt lgkmcnt(5)
    v_exp_f32 v83, v83
    v_mfma_f32_16x16x32_bf16 v[44:47], a[204:207], v[224:227], v[44:47]
    buffer_load_dwordx4 v16, s[8:11], s28 offen offset:1024 lds
    v_mfma_f32_16x16x32_bf16 v[48:51], a[208:211], v[164:167], v[128:131]
    v_exp_f32 v68, v68
    v_mfma_f32_16x16x32_bf16 v[52:55], a[208:211], v[180:183], v[132:135]
    ds_read_b64_tr_b16 a[228:229], v9 offset:32768
    v_cvt_pk_bf16_f32 v115, v82, v83
    v_mfma_f32_16x16x32_bf16 v[56:59], a[208:211], v[196:199], v[136:139]
    s_waitcnt lgkmcnt(5)
    v_exp_f32 v69, v69
    v_mfma_f32_16x16x32_bf16 v[60:63], a[208:211], v[212:215], v[140:143]
    ds_read_b64_tr_b16 a[230:231], v9 offset:33792
    v_cvt_pk_bf16_f32 v116, v68, v69
    v_mfma_f32_16x16x32_bf16 v[48:51], a[212:215], v[168:171], v[48:51]
    s_add_u32 m0, s31, 16384
    v_exp_f32 v70, v70
    v_mfma_f32_16x16x32_bf16 v[52:55], a[212:215], v[184:187], v[52:55]
    ds_read_b64_tr_b16 a[232:233], v10 offset:32768
    v_mfma_f32_16x16x32_bf16 v[56:59], a[212:215], v[200:203], v[56:59]
    s_waitcnt lgkmcnt(6)
    v_exp_f32 v71, v71
    v_mfma_f32_16x16x32_bf16 v[60:63], a[212:215], v[216:219], v[60:63]
    buffer_load_dwordx4 v17, s[12:15], s29 offen offset:0 lds
    v_mfma_f32_16x16x32_bf16 v[48:51], a[216:219], v[172:175], v[48:51]
    v_exp_f32 v84, v84
    v_mfma_f32_16x16x32_bf16 v[52:55], a[216:219], v[188:191], v[52:55]
    ds_read_b64_tr_b16 a[234:235], v10 offset:33792
    v_cvt_pk_bf16_f32 v117, v70, v71
    v_mfma_f32_16x16x32_bf16 v[56:59], a[216:219], v[204:207], v[56:59]
    s_waitcnt lgkmcnt(6)
    v_exp_f32 v85, v85
    v_mfma_f32_16x16x32_bf16 v[60:63], a[216:219], v[220:223], v[60:63]
    ds_read_b64_tr_b16 a[236:237], v11 offset:32768
    v_cvt_pk_bf16_f32 v118, v84, v85
    v_mfma_f32_16x16x32_bf16 v[48:51], a[220:223], v[176:179], v[48:51]
    v_exp_f32 v86, v86
    v_mfma_f32_16x16x32_bf16 v[52:55], a[220:223], v[192:195], v[52:55]
    ds_read_b64_tr_b16 a[238:239], v11 offset:33792
    v_mfma_f32_16x16x32_bf16 v[56:59], a[220:223], v[208:211], v[56:59]
    s_waitcnt lgkmcnt(6)
    v_exp_f32 v87, v87
    v_mfma_f32_16x16x32_bf16 v[60:63], a[220:223], v[224:227], v[60:63]
    buffer_load_dwordx4 v17, s[12:15], s29 offen offset:1024 lds
    v_mfma_f32_16x16x32_bf16 a[0:3], a[224:227], v[96:99], a[0:3]
    v_exp_f32 v72, v72
    v_mfma_f32_16x16x32_bf16 a[4:7], a[224:227], v[100:103], a[4:7]
    ds_read_b64_tr_b16 a[240:241], v12 offset:32768
    v_cvt_pk_bf16_f32 v119, v86, v87
    v_mfma_f32_16x16x32_bf16 a[8:11], a[224:227], v[104:107], a[8:11]
    s_waitcnt lgkmcnt(5)
    v_exp_f32 v73, v73
    v_mfma_f32_16x16x32_bf16 a[12:15], a[224:227], v[108:111], a[12:15]
    ds_read_b64_tr_b16 a[242:243], v12 offset:33792
    v_cvt_pk_bf16_f32 v120, v72, v73
    v_mfma_f32_16x16x32_bf16 a[16:19], a[228:231], v[96:99], a[16:19]
    s_add_u32 s28, s28, 8192
    v_exp_f32 v74, v74
    v_mfma_f32_16x16x32_bf16 a[20:23], a[228:231], v[100:103], a[20:23]
    ds_read_b64_tr_b16 a[244:245], v13 offset:32768
    v_mfma_f32_16x16x32_bf16 a[24:27], a[228:231], v[104:107], a[24:27]
    s_waitcnt lgkmcnt(5)
    v_exp_f32 v75, v75
    v_mfma_f32_16x16x32_bf16 a[28:31], a[228:231], v[108:111], a[28:31]
    v_mfma_f32_16x16x32_bf16 a[32:35], a[232:235], v[96:99], a[32:35]
    s_add_u32 s29, s29, 8192
    v_exp_f32 v88, v88
    v_mfma_f32_16x16x32_bf16 a[36:39], a[232:235], v[100:103], a[36:39]
    ds_read_b64_tr_b16 a[246:247], v13 offset:33792
    v_cvt_pk_bf16_f32 v121, v74, v75
    v_mfma_f32_16x16x32_bf16 a[40:43], a[232:235], v[104:107], a[40:43]
    s_waitcnt lgkmcnt(4)
    v_exp_f32 v89, v89
    v_mfma_f32_16x16x32_bf16 a[44:47], a[232:235], v[108:111], a[44:47]
    ds_read_b64_tr_b16 a[248:249], v14 offset:32768
    v_cvt_pk_bf16_f32 v122, v88, v89
    v_mfma_f32_16x16x32_bf16 a[48:51], a[236:239], v[96:99], a[48:51]
    v_exp_f32 v90, v90
    v_mfma_f32_16x16x32_bf16 a[52:55], a[236:239], v[100:103], a[52:55]
    ds_read_b64_tr_b16 a[250:251], v14 offset:33792
    v_mfma_f32_16x16x32_bf16 a[56:59], a[236:239], v[104:107], a[56:59]
    s_waitcnt lgkmcnt(4)
    v_exp_f32 v91, v91
    v_mfma_f32_16x16x32_bf16 a[60:63], a[236:239], v[108:111], a[60:63]
    v_mfma_f32_16x16x32_bf16 a[64:67], a[240:243], v[96:99], a[64:67]
    v_exp_f32 v76, v76
    v_mfma_f32_16x16x32_bf16 a[68:71], a[240:243], v[100:103], a[68:71]
    ds_read_b64_tr_b16 a[252:253], v15 offset:32768
    v_cvt_pk_bf16_f32 v123, v90, v91
    v_mfma_f32_16x16x32_bf16 a[72:75], a[240:243], v[104:107], a[72:75]
    s_waitcnt lgkmcnt(3)
    v_exp_f32 v77, v77
    v_mfma_f32_16x16x32_bf16 a[76:79], a[240:243], v[108:111], a[76:79]
    ds_read_b64_tr_b16 a[254:255], v15 offset:33792
    v_cvt_pk_bf16_f32 v124, v76, v77
    v_mfma_f32_16x16x32_bf16 a[80:83], a[244:247], v[96:99], a[80:83]
    v_exp_f32 v78, v78
    v_mfma_f32_16x16x32_bf16 a[84:87], a[244:247], v[100:103], a[84:87]
    ds_read_b128 a[192:195], v4 offset:57344
    v_mfma_f32_16x16x32_bf16 a[88:91], a[244:247], v[104:107], a[88:91]
    s_waitcnt lgkmcnt(3)
    v_exp_f32 v79, v79
    v_mfma_f32_16x16x32_bf16 a[92:95], a[244:247], v[108:111], a[92:95]
    v_mfma_f32_16x16x32_bf16 a[96:99], a[248:251], v[96:99], a[96:99]
    v_exp_f32 v92, v92
    v_mfma_f32_16x16x32_bf16 a[100:103], a[248:251], v[100:103], a[100:103]
    ds_read_b128 a[196:199], v5 offset:57344
    v_cvt_pk_bf16_f32 v125, v78, v79
    v_mfma_f32_16x16x32_bf16 a[104:107], a[248:251], v[104:107], a[104:107]
    s_waitcnt lgkmcnt(2)
    v_exp_f32 v93, v93
    v_mfma_f32_16x16x32_bf16 a[108:111], a[248:251], v[108:111], a[108:111]
    ds_read_b128 a[200:203], v6 offset:57344
    v_cvt_pk_bf16_f32 v126, v92, v93
    v_mfma_f32_16x16x32_bf16 a[112:115], a[252:255], v[96:99], a[112:115]
    v_exp_f32 v94, v94
    v_mfma_f32_16x16x32_bf16 a[116:119], a[252:255], v[100:103], a[116:119]
    ds_read_b128 a[204:207], v7 offset:57344
    v_mfma_f32_16x16x32_bf16 a[120:123], a[252:255], v[104:107], a[120:123]
    v_exp_f32 v95, v95
    v_mfma_f32_16x16x32_bf16 a[124:127], a[252:255], v[108:111], a[124:127]
    v_mfma_f32_16x16x32_bf16 v[144:147], v[160:163], v[96:99], v[144:147]
    v_mfma_f32_16x16x32_bf16 v[148:151], v[160:163], v[100:103], v[148:151]
    v_mfma_f32_16x16x32_bf16 v[152:155], v[160:163], v[104:107], v[152:155]
    s_waitcnt lgkmcnt(3)
    v_mfma_f32_16x16x32_bf16 v[156:159], v[160:163], v[108:111], v[156:159]
    v_mfma_f32_16x16x32_bf16 v[64:67], a[192:195], v[164:167], v[128:131]
    v_exp_f32 v32, v32
    v_mfma_f32_16x16x32_bf16 v[68:71], a[192:195], v[180:183], v[132:135]
    ds_read_b128 a[208:211], v4 offset:58368
    v_cvt_pk_bf16_f32 v127, v94, v95
    v_mfma_f32_16x16x32_bf16 v[72:75], a[192:195], v[196:199], v[136:139]
    s_waitcnt lgkmcnt(3)
    v_exp_f32 v33, v33
    v_mfma_f32_16x16x32_bf16 v[76:79], a[192:195], v[212:215], v[140:143]
    ds_read_b128 a[212:215], v5 offset:58368
    v_cvt_pk_bf16_f32 v96, v32, v33
    v_mfma_f32_16x16x32_bf16 v[64:67], a[196:199], v[168:171], v[64:67]
    s_add_u32 m0, s30, 40960
    v_exp_f32 v34, v34
    v_mfma_f32_16x16x32_bf16 v[68:71], a[196:199], v[184:187], v[68:71]
    ds_read_b128 a[216:219], v6 offset:58368
    v_mfma_f32_16x16x32_bf16 v[72:75], a[196:199], v[200:203], v[72:75]
    s_waitcnt lgkmcnt(4)
    v_exp_f32 v35, v35
    v_mfma_f32_16x16x32_bf16 v[76:79], a[196:199], v[216:219], v[76:79]
    buffer_load_dwordx4 v16, s[8:11], s28 offen offset:0 lds
    v_mfma_f32_16x16x32_bf16 v[64:67], a[200:203], v[172:175], v[64:67]
    v_exp_f32 v48, v48
    v_mfma_f32_16x16x32_bf16 v[68:71], a[200:203], v[188:191], v[68:71]
    ds_read_b128 a[220:223], v7 offset:58368
    v_cvt_pk_bf16_f32 v97, v34, v35
    v_mfma_f32_16x16x32_bf16 v[72:75], a[200:203], v[204:207], v[72:75]
    s_waitcnt lgkmcnt(4)
    v_exp_f32 v49, v49
    v_mfma_f32_16x16x32_bf16 v[76:79], a[200:203], v[220:223], v[76:79]
    ds_read_b64_tr_b16 a[224:225], v8 offset:40960
    v_cvt_pk_bf16_f32 v98, v48, v49
    v_mfma_f32_16x16x32_bf16 v[64:67], a[204:207], v[176:179], v[64:67]
    v_exp_f32 v50, v50
    v_mfma_f32_16x16x32_bf16 v[68:71], a[204:207], v[192:195], v[68:71]
    ds_read_b64_tr_b16 a[226:227], v8 offset:41984
    v_mfma_f32_16x16x32_bf16 v[72:75], a[204:207], v[208:211], v[72:75]
    s_waitcnt lgkmcnt(5)
    v_exp_f32 v51, v51
    v_mfma_f32_16x16x32_bf16 v[76:79], a[204:207], v[224:227], v[76:79]
    buffer_load_dwordx4 v16, s[8:11], s28 offen offset:1024 lds
    v_mfma_f32_16x16x32_bf16 v[80:83], a[208:211], v[164:167], v[128:131]
    v_exp_f32 v36, v36
    v_mfma_f32_16x16x32_bf16 v[84:87], a[208:211], v[180:183], v[132:135]
    ds_read_b64_tr_b16 a[228:229], v9 offset:40960
    v_cvt_pk_bf16_f32 v99, v50, v51
    v_mfma_f32_16x16x32_bf16 v[88:91], a[208:211], v[196:199], v[136:139]
    s_waitcnt lgkmcnt(5)
    v_exp_f32 v37, v37
    v_mfma_f32_16x16x32_bf16 v[92:95], a[208:211], v[212:215], v[140:143]
    ds_read_b64_tr_b16 a[230:231], v9 offset:41984
    v_cvt_pk_bf16_f32 v100, v36, v37
    v_mfma_f32_16x16x32_bf16 v[80:83], a[212:215], v[168:171], v[80:83]
    s_add_u32 m0, s31, 24576
    v_exp_f32 v38, v38
    v_mfma_f32_16x16x32_bf16 v[84:87], a[212:215], v[184:187], v[84:87]
    ds_read_b64_tr_b16 a[232:233], v10 offset:40960
    v_mfma_f32_16x16x32_bf16 v[88:91], a[212:215], v[200:203], v[88:91]
    s_waitcnt lgkmcnt(6)
    v_exp_f32 v39, v39
    v_mfma_f32_16x16x32_bf16 v[92:95], a[212:215], v[216:219], v[92:95]
    buffer_load_dwordx4 v17, s[12:15], s29 offen offset:0 lds
    v_mfma_f32_16x16x32_bf16 v[80:83], a[216:219], v[172:175], v[80:83]
    v_exp_f32 v52, v52
    v_mfma_f32_16x16x32_bf16 v[84:87], a[216:219], v[188:191], v[84:87]
    ds_read_b64_tr_b16 a[234:235], v10 offset:41984
    v_cvt_pk_bf16_f32 v101, v38, v39
    v_mfma_f32_16x16x32_bf16 v[88:91], a[216:219], v[204:207], v[88:91]
    s_waitcnt lgkmcnt(6)
    v_exp_f32 v53, v53
    v_mfma_f32_16x16x32_bf16 v[92:95], a[216:219], v[220:223], v[92:95]
    ds_read_b64_tr_b16 a[236:237], v11 offset:40960
    v_cvt_pk_bf16_f32 v102, v52, v53
    v_mfma_f32_16x16x32_bf16 v[80:83], a[220:223], v[176:179], v[80:83]
    v_exp_f32 v54, v54
    v_mfma_f32_16x16x32_bf16 v[84:87], a[220:223], v[192:195], v[84:87]
    ds_read_b64_tr_b16 a[238:239], v11 offset:41984
    v_mfma_f32_16x16x32_bf16 v[88:91], a[220:223], v[208:211], v[88:91]
    s_waitcnt lgkmcnt(6)
    v_exp_f32 v55, v55
    v_mfma_f32_16x16x32_bf16 v[92:95], a[220:223], v[224:227], v[92:95]
    buffer_load_dwordx4 v17, s[12:15], s29 offen offset:1024 lds
    v_mfma_f32_16x16x32_bf16 a[0:3], a[224:227], v[112:115], a[0:3]
    v_exp_f32 v40, v40
    v_mfma_f32_16x16x32_bf16 a[4:7], a[224:227], v[116:119], a[4:7]
    ds_read_b64_tr_b16 a[240:241], v12 offset:40960
    v_cvt_pk_bf16_f32 v103, v54, v55
    v_mfma_f32_16x16x32_bf16 a[8:11], a[224:227], v[120:123], a[8:11]
    s_waitcnt lgkmcnt(5)
    v_exp_f32 v41, v41
    v_mfma_f32_16x16x32_bf16 a[12:15], a[224:227], v[124:127], a[12:15]
    ds_read_b64_tr_b16 a[242:243], v12 offset:41984
    v_cvt_pk_bf16_f32 v104, v40, v41
    v_mfma_f32_16x16x32_bf16 a[16:19], a[228:231], v[112:115], a[16:19]
    s_add_u32 s28, s28, 8192
    v_exp_f32 v42, v42
    v_mfma_f32_16x16x32_bf16 a[20:23], a[228:231], v[116:119], a[20:23]
    ds_read_b64_tr_b16 a[244:245], v13 offset:40960
    v_mfma_f32_16x16x32_bf16 a[24:27], a[228:231], v[120:123], a[24:27]
    s_waitcnt lgkmcnt(5)
    v_exp_f32 v43, v43
    v_mfma_f32_16x16x32_bf16 a[28:31], a[228:231], v[124:127], a[28:31]
    v_mfma_f32_16x16x32_bf16 a[32:35], a[232:235], v[112:115], a[32:35]
    s_add_u32 s29, s29, 8192
    v_exp_f32 v56, v56
    v_mfma_f32_16x16x32_bf16 a[36:39], a[232:235], v[116:119], a[36:39]
    ds_read_b64_tr_b16 a[246:247], v13 offset:41984
    v_cvt_pk_bf16_f32 v105, v42, v43
    v_mfma_f32_16x16x32_bf16 a[40:43], a[232:235], v[120:123], a[40:43]
    s_waitcnt lgkmcnt(4)
    v_exp_f32 v57, v57
    v_mfma_f32_16x16x32_bf16 a[44:47], a[232:235], v[124:127], a[44:47]
    ds_read_b64_tr_b16 a[248:249], v14 offset:40960
    v_cvt_pk_bf16_f32 v106, v56, v57
    v_mfma_f32_16x16x32_bf16 a[48:51], a[236:239], v[112:115], a[48:51]
    v_exp_f32 v58, v58
    v_mfma_f32_16x16x32_bf16 a[52:55], a[236:239], v[116:119], a[52:55]
    ds_read_b64_tr_b16 a[250:251], v14 offset:41984
    v_mfma_f32_16x16x32_bf16 a[56:59], a[236:239], v[120:123], a[56:59]
    s_waitcnt lgkmcnt(4)
    v_exp_f32 v59, v59
    v_mfma_f32_16x16x32_bf16 a[60:63], a[236:239], v[124:127], a[60:63]
    v_mfma_f32_16x16x32_bf16 a[64:67], a[240:243], v[112:115], a[64:67]
    s_waitcnt vmcnt(16)
    v_exp_f32 v44, v44
    v_mfma_f32_16x16x32_bf16 a[68:71], a[240:243], v[116:119], a[68:71]
    ds_read_b64_tr_b16 a[252:253], v15 offset:40960
    v_cvt_pk_bf16_f32 v107, v58, v59
    v_mfma_f32_16x16x32_bf16 a[72:75], a[240:243], v[120:123], a[72:75]
    s_waitcnt lgkmcnt(3)
    v_exp_f32 v45, v45
    v_mfma_f32_16x16x32_bf16 a[76:79], a[240:243], v[124:127], a[76:79]
    ds_read_b64_tr_b16 a[254:255], v15 offset:41984
    v_cvt_pk_bf16_f32 v108, v44, v45
    v_mfma_f32_16x16x32_bf16 a[80:83], a[244:247], v[112:115], a[80:83]
    s_barrier
    v_exp_f32 v46, v46
    v_mfma_f32_16x16x32_bf16 a[84:87], a[244:247], v[116:119], a[84:87]
    ds_read_b128 a[192:195], v4 offset:0
    v_mfma_f32_16x16x32_bf16 a[88:91], a[244:247], v[120:123], a[88:91]
    s_waitcnt lgkmcnt(3)
    v_exp_f32 v47, v47
    v_mfma_f32_16x16x32_bf16 a[92:95], a[244:247], v[124:127], a[92:95]
    v_mfma_f32_16x16x32_bf16 a[96:99], a[248:251], v[112:115], a[96:99]
    v_exp_f32 v60, v60
    v_mfma_f32_16x16x32_bf16 a[100:103], a[248:251], v[116:119], a[100:103]
    ds_read_b128 a[196:199], v5 offset:0
    v_cvt_pk_bf16_f32 v109, v46, v47
    v_mfma_f32_16x16x32_bf16 a[104:107], a[248:251], v[120:123], a[104:107]
    s_waitcnt lgkmcnt(2)
    v_exp_f32 v61, v61
    v_mfma_f32_16x16x32_bf16 a[108:111], a[248:251], v[124:127], a[108:111]
    ds_read_b128 a[200:203], v6 offset:0
    v_cvt_pk_bf16_f32 v110, v60, v61
    v_mfma_f32_16x16x32_bf16 a[112:115], a[252:255], v[112:115], a[112:115]
    v_exp_f32 v62, v62
    v_mfma_f32_16x16x32_bf16 a[116:119], a[252:255], v[116:119], a[116:119]
    ds_read_b128 a[204:207], v7 offset:0
    v_mfma_f32_16x16x32_bf16 a[120:123], a[252:255], v[120:123], a[120:123]
    v_exp_f32 v63, v63
    v_mfma_f32_16x16x32_bf16 a[124:127], a[252:255], v[124:127], a[124:127]
    v_mfma_f32_16x16x32_bf16 v[144:147], v[160:163], v[112:115], v[144:147]
    v_mfma_f32_16x16x32_bf16 v[148:151], v[160:163], v[116:119], v[148:151]
    v_mfma_f32_16x16x32_bf16 v[152:155], v[160:163], v[120:123], v[152:155]
    s_waitcnt lgkmcnt(3)
    v_mfma_f32_16x16x32_bf16 v[156:159], v[160:163], v[124:127], v[156:159]
    v_mfma_f32_16x16x32_bf16 v[32:35], a[192:195], v[164:167], v[128:131]
    v_exp_f32 v64, v64
    v_mfma_f32_16x16x32_bf16 v[36:39], a[192:195], v[180:183], v[132:135]
    ds_read_b128 a[208:211], v4 offset:1024
    v_cvt_pk_bf16_f32 v111, v62, v63
    v_mfma_f32_16x16x32_bf16 v[40:43], a[192:195], v[196:199], v[136:139]
    s_waitcnt lgkmcnt(3)
    v_exp_f32 v65, v65
    v_mfma_f32_16x16x32_bf16 v[44:47], a[192:195], v[212:215], v[140:143]
    ds_read_b128 a[212:215], v5 offset:1024
    v_cvt_pk_bf16_f32 v112, v64, v65
    v_mfma_f32_16x16x32_bf16 v[32:35], a[196:199], v[168:171], v[32:35]
    s_add_u32 m0, s30, 49152
    v_exp_f32 v66, v66
    v_mfma_f32_16x16x32_bf16 v[36:39], a[196:199], v[184:187], v[36:39]
    ds_read_b128 a[216:219], v6 offset:1024
    v_mfma_f32_16x16x32_bf16 v[40:43], a[196:199], v[200:203], v[40:43]
    s_waitcnt lgkmcnt(4)
    v_exp_f32 v67, v67
    v_mfma_f32_16x16x32_bf16 v[44:47], a[196:199], v[216:219], v[44:47]
    buffer_load_dwordx4 v16, s[8:11], s28 offen offset:0 lds
    v_mfma_f32_16x16x32_bf16 v[32:35], a[200:203], v[172:175], v[32:35]
    v_exp_f32 v80, v80
    v_mfma_f32_16x16x32_bf16 v[36:39], a[200:203], v[188:191], v[36:39]
    ds_read_b128 a[220:223], v7 offset:1024
    v_cvt_pk_bf16_f32 v113, v66, v67
    v_mfma_f32_16x16x32_bf16 v[40:43], a[200:203], v[204:207], v[40:43]
    s_waitcnt lgkmcnt(4)
    v_exp_f32 v81, v81
    v_mfma_f32_16x16x32_bf16 v[44:47], a[200:203], v[220:223], v[44:47]
    ds_read_b64_tr_b16 a[224:225], v8 offset:49152
    v_cvt_pk_bf16_f32 v114, v80, v81
    v_mfma_f32_16x16x32_bf16 v[32:35], a[204:207], v[176:179], v[32:35]
    v_exp_f32 v82, v82
    v_mfma_f32_16x16x32_bf16 v[36:39], a[204:207], v[192:195], v[36:39]
    ds_read_b64_tr_b16 a[226:227], v8 offset:50176
    v_mfma_f32_16x16x32_bf16 v[40:43], a[204:207], v[208:211], v[40:43]
    s_waitcnt lgkmcnt(5)
    v_exp_f32 v83, v83
    v_mfma_f32_16x16x32_bf16 v[44:47], a[204:207], v[224:227], v[44:47]
    buffer_load_dwordx4 v16, s[8:11], s28 offen offset:1024 lds
    v_mfma_f32_16x16x32_bf16 v[48:51], a[208:211], v[164:167], v[128:131]
    v_exp_f32 v68, v68
    v_mfma_f32_16x16x32_bf16 v[52:55], a[208:211], v[180:183], v[132:135]
    ds_read_b64_tr_b16 a[228:229], v9 offset:49152
    v_cvt_pk_bf16_f32 v115, v82, v83
    v_mfma_f32_16x16x32_bf16 v[56:59], a[208:211], v[196:199], v[136:139]
    s_waitcnt lgkmcnt(5)
    v_exp_f32 v69, v69
    v_mfma_f32_16x16x32_bf16 v[60:63], a[208:211], v[212:215], v[140:143]
    ds_read_b64_tr_b16 a[230:231], v9 offset:50176
    v_cvt_pk_bf16_f32 v116, v68, v69
    v_mfma_f32_16x16x32_bf16 v[48:51], a[212:215], v[168:171], v[48:51]
    s_add_u32 m0, s31, 32768
    v_exp_f32 v70, v70
    v_mfma_f32_16x16x32_bf16 v[52:55], a[212:215], v[184:187], v[52:55]
    ds_read_b64_tr_b16 a[232:233], v10 offset:49152
    v_mfma_f32_16x16x32_bf16 v[56:59], a[212:215], v[200:203], v[56:59]
    s_waitcnt lgkmcnt(6)
    v_exp_f32 v71, v71
    v_mfma_f32_16x16x32_bf16 v[60:63], a[212:215], v[216:219], v[60:63]
    buffer_load_dwordx4 v17, s[12:15], s29 offen offset:0 lds
    v_mfma_f32_16x16x32_bf16 v[48:51], a[216:219], v[172:175], v[48:51]
    v_exp_f32 v84, v84
    v_mfma_f32_16x16x32_bf16 v[52:55], a[216:219], v[188:191], v[52:55]
    ds_read_b64_tr_b16 a[234:235], v10 offset:50176
    v_cvt_pk_bf16_f32 v117, v70, v71
    v_mfma_f32_16x16x32_bf16 v[56:59], a[216:219], v[204:207], v[56:59]
    s_waitcnt lgkmcnt(6)
    v_exp_f32 v85, v85
    v_mfma_f32_16x16x32_bf16 v[60:63], a[216:219], v[220:223], v[60:63]
    ds_read_b64_tr_b16 a[236:237], v11 offset:49152
    v_cvt_pk_bf16_f32 v118, v84, v85
    v_mfma_f32_16x16x32_bf16 v[48:51], a[220:223], v[176:179], v[48:51]
    v_exp_f32 v86, v86
    v_mfma_f32_16x16x32_bf16 v[52:55], a[220:223], v[192:195], v[52:55]
    ds_read_b64_tr_b16 a[238:239], v11 offset:50176
    v_mfma_f32_16x16x32_bf16 v[56:59], a[220:223], v[208:211], v[56:59]
    s_waitcnt lgkmcnt(6)
    v_exp_f32 v87, v87
    v_mfma_f32_16x16x32_bf16 v[60:63], a[220:223], v[224:227], v[60:63]
    buffer_load_dwordx4 v17, s[12:15], s29 offen offset:1024 lds
    v_mfma_f32_16x16x32_bf16 a[0:3], a[224:227], v[96:99], a[0:3]
    v_exp_f32 v72, v72
    v_mfma_f32_16x16x32_bf16 a[4:7], a[224:227], v[100:103], a[4:7]
    ds_read_b64_tr_b16 a[240:241], v12 offset:49152
    v_cvt_pk_bf16_f32 v119, v86, v87
    v_mfma_f32_16x16x32_bf16 a[8:11], a[224:227], v[104:107], a[8:11]
    s_waitcnt lgkmcnt(5)
    v_exp_f32 v73, v73
    v_mfma_f32_16x16x32_bf16 a[12:15], a[224:227], v[108:111], a[12:15]
    ds_read_b64_tr_b16 a[242:243], v12 offset:50176
    v_cvt_pk_bf16_f32 v120, v72, v73
    v_mfma_f32_16x16x32_bf16 a[16:19], a[228:231], v[96:99], a[16:19]
    s_add_u32 s28, s28, 8192
    v_exp_f32 v74, v74
    v_mfma_f32_16x16x32_bf16 a[20:23], a[228:231], v[100:103], a[20:23]
    ds_read_b64_tr_b16 a[244:245], v13 offset:49152
    v_mfma_f32_16x16x32_bf16 a[24:27], a[228:231], v[104:107], a[24:27]
    s_waitcnt lgkmcnt(5)
    v_exp_f32 v75, v75
    v_mfma_f32_16x16x32_bf16 a[28:31], a[228:231], v[108:111], a[28:31]
    v_mfma_f32_16x16x32_bf16 a[32:35], a[232:235], v[96:99], a[32:35]
    s_add_u32 s29, s29, 8192
    v_exp_f32 v88, v88
    v_mfma_f32_16x16x32_bf16 a[36:39], a[232:235], v[100:103], a[36:39]
    ds_read_b64_tr_b16 a[246:247], v13 offset:50176
    v_cvt_pk_bf16_f32 v121, v74, v75
    v_mfma_f32_16x16x32_bf16 a[40:43], a[232:235], v[104:107], a[40:43]
    s_waitcnt lgkmcnt(4)
    v_exp_f32 v89, v89
    v_mfma_f32_16x16x32_bf16 a[44:47], a[232:235], v[108:111], a[44:47]
    ds_read_b64_tr_b16 a[248:249], v14 offset:49152
    v_cvt_pk_bf16_f32 v122, v88, v89
    v_mfma_f32_16x16x32_bf16 a[48:51], a[236:239], v[96:99], a[48:51]
    v_exp_f32 v90, v90
    v_mfma_f32_16x16x32_bf16 a[52:55], a[236:239], v[100:103], a[52:55]
    ds_read_b64_tr_b16 a[250:251], v14 offset:50176
    v_mfma_f32_16x16x32_bf16 a[56:59], a[236:239], v[104:107], a[56:59]
    s_waitcnt lgkmcnt(4)
    v_exp_f32 v91, v91
    v_mfma_f32_16x16x32_bf16 a[60:63], a[236:239], v[108:111], a[60:63]
    v_mfma_f32_16x16x32_bf16 a[64:67], a[240:243], v[96:99], a[64:67]
    v_exp_f32 v76, v76
    v_mfma_f32_16x16x32_bf16 a[68:71], a[240:243], v[100:103], a[68:71]
    ds_read_b64_tr_b16 a[252:253], v15 offset:49152
    v_cvt_pk_bf16_f32 v123, v90, v91
    v_mfma_f32_16x16x32_bf16 a[72:75], a[240:243], v[104:107], a[72:75]
    s_waitcnt lgkmcnt(3)
    v_exp_f32 v77, v77
    v_mfma_f32_16x16x32_bf16 a[76:79], a[240:243], v[108:111], a[76:79]
    ds_read_b64_tr_b16 a[254:255], v15 offset:50176
    v_cvt_pk_bf16_f32 v124, v76, v77
    v_mfma_f32_16x16x32_bf16 a[80:83], a[244:247], v[96:99], a[80:83]
    v_exp_f32 v78, v78
    v_mfma_f32_16x16x32_bf16 a[84:87], a[244:247], v[100:103], a[84:87]
    ds_read_b128 a[192:195], v4 offset:8192
    v_mfma_f32_16x16x32_bf16 a[88:91], a[244:247], v[104:107], a[88:91]
    s_waitcnt lgkmcnt(3)
    v_exp_f32 v79, v79
    v_mfma_f32_16x16x32_bf16 a[92:95], a[244:247], v[108:111], a[92:95]
    v_mfma_f32_16x16x32_bf16 a[96:99], a[248:251], v[96:99], a[96:99]
    v_exp_f32 v92, v92
    v_mfma_f32_16x16x32_bf16 a[100:103], a[248:251], v[100:103], a[100:103]
    ds_read_b128 a[196:199], v5 offset:8192
    v_cvt_pk_bf16_f32 v125, v78, v79
    v_mfma_f32_16x16x32_bf16 a[104:107], a[248:251], v[104:107], a[104:107]
    s_waitcnt lgkmcnt(2)
    v_exp_f32 v93, v93
    v_mfma_f32_16x16x32_bf16 a[108:111], a[248:251], v[108:111], a[108:111]
    ds_read_b128 a[200:203], v6 offset:8192
    v_cvt_pk_bf16_f32 v126, v92, v93
    v_mfma_f32_16x16x32_bf16 a[112:115], a[252:255], v[96:99], a[112:115]
    v_exp_f32 v94, v94
    v_mfma_f32_16x16x32_bf16 a[116:119], a[252:255], v[100:103], a[116:119]
    ds_read_b128 a[204:207], v7 offset:8192
    v_mfma_f32_16x16x32_bf16 a[120:123], a[252:255], v[104:107], a[120:123]
    v_exp_f32 v95, v95
    v_mfma_f32_16x16x32_bf16 a[124:127], a[252:255], v[108:111], a[124:127]
    v_mfma_f32_16x16x32_bf16 v[144:147], v[160:163], v[96:99], v[144:147]
    v_mfma_f32_16x16x32_bf16 v[148:151], v[160:163], v[100:103], v[148:151]
    v_mfma_f32_16x16x32_bf16 v[152:155], v[160:163], v[104:107], v[152:155]
    buffer_store_dwordx4 a[128:131], v19, s[52:55], s57 offen sc1
    s_add_u32 s57, s57, 131072
    s_waitcnt lgkmcnt(3)
    v_mfma_f32_16x16x32_bf16 v[156:159], v[160:163], v[108:111], v[156:159]
    v_mfma_f32_16x16x32_bf16 v[64:67], a[192:195], v[164:167], v[128:131]
    v_exp_f32 v32, v32
    v_mfma_f32_16x16x32_bf16 v[68:71], a[192:195], v[180:183], v[132:135]
    ds_read_b128 a[208:211], v4 offset:9216
    v_cvt_pk_bf16_f32 v127, v94, v95
    v_mfma_f32_16x16x32_bf16 v[72:75], a[192:195], v[196:199], v[136:139]
    s_waitcnt lgkmcnt(3)
    v_exp_f32 v33, v33
    v_mfma_f32_16x16x32_bf16 v[76:79], a[192:195], v[212:215], v[140:143]
    ds_read_b128 a[212:215], v5 offset:9216
    v_cvt_pk_bf16_f32 v96, v32, v33
    v_mfma_f32_16x16x32_bf16 v[64:67], a[196:199], v[168:171], v[64:67]
    s_add_u32 m0, s30, 57344
    v_exp_f32 v34, v34
    v_mfma_f32_16x16x32_bf16 v[68:71], a[196:199], v[184:187], v[68:71]
    ds_read_b128 a[216:219], v6 offset:9216
    v_mfma_f32_16x16x32_bf16 v[72:75], a[196:199], v[200:203], v[72:75]
    s_waitcnt lgkmcnt(4)
    v_exp_f32 v35, v35
    v_mfma_f32_16x16x32_bf16 v[76:79], a[196:199], v[216:219], v[76:79]
    buffer_load_dwordx4 v16, s[8:11], s28 offen offset:0 lds
    v_mfma_f32_16x16x32_bf16 v[64:67], a[200:203], v[172:175], v[64:67]
    v_exp_f32 v48, v48
    v_mfma_f32_16x16x32_bf16 v[68:71], a[200:203], v[188:191], v[68:71]
    ds_read_b128 a[220:223], v7 offset:9216
    v_cvt_pk_bf16_f32 v97, v34, v35
    v_mfma_f32_16x16x32_bf16 v[72:75], a[200:203], v[204:207], v[72:75]
    s_waitcnt lgkmcnt(4)
    v_exp_f32 v49, v49
    v_mfma_f32_16x16x32_bf16 v[76:79], a[200:203], v[220:223], v[76:79]
    ds_read_b64_tr_b16 a[224:225], v8 offset:57344
    v_cvt_pk_bf16_f32 v98, v48, v49
    v_mfma_f32_16x16x32_bf16 v[64:67], a[204:207], v[176:179], v[64:67]
    v_exp_f32 v50, v50
    v_mfma_f32_16x16x32_bf16 v[68:71], a[204:207], v[192:195], v[68:71]
    ds_read_b64_tr_b16 a[226:227], v8 offset:58368
    v_mfma_f32_16x16x32_bf16 v[72:75], a[204:207], v[208:211], v[72:75]
    s_waitcnt lgkmcnt(5)
    v_exp_f32 v51, v51
    v_mfma_f32_16x16x32_bf16 v[76:79], a[204:207], v[224:227], v[76:79]
    buffer_load_dwordx4 v16, s[8:11], s28 offen offset:1024 lds
    v_mfma_f32_16x16x32_bf16 v[80:83], a[208:211], v[164:167], v[128:131]
    v_exp_f32 v36, v36
    v_mfma_f32_16x16x32_bf16 v[84:87], a[208:211], v[180:183], v[132:135]
    ds_read_b64_tr_b16 a[228:229], v9 offset:57344
    v_cvt_pk_bf16_f32 v99, v50, v51
    v_mfma_f32_16x16x32_bf16 v[88:91], a[208:211], v[196:199], v[136:139]
    s_waitcnt lgkmcnt(5)
    v_exp_f32 v37, v37
    v_mfma_f32_16x16x32_bf16 v[92:95], a[208:211], v[212:215], v[140:143]
    ds_read_b64_tr_b16 a[230:231], v9 offset:58368
    v_cvt_pk_bf16_f32 v100, v36, v37
    v_mfma_f32_16x16x32_bf16 v[80:83], a[212:215], v[168:171], v[80:83]
    s_add_u32 m0, s31, 40960
    v_exp_f32 v38, v38
    v_mfma_f32_16x16x32_bf16 v[84:87], a[212:215], v[184:187], v[84:87]
    ds_read_b64_tr_b16 a[232:233], v10 offset:57344
    v_mfma_f32_16x16x32_bf16 v[88:91], a[212:215], v[200:203], v[88:91]
    s_waitcnt lgkmcnt(6)
    v_exp_f32 v39, v39
    v_mfma_f32_16x16x32_bf16 v[92:95], a[212:215], v[216:219], v[92:95]
    buffer_load_dwordx4 v17, s[12:15], s29 offen offset:0 lds
    v_mfma_f32_16x16x32_bf16 v[80:83], a[216:219], v[172:175], v[80:83]
    v_exp_f32 v52, v52
    v_mfma_f32_16x16x32_bf16 v[84:87], a[216:219], v[188:191], v[84:87]
    ds_read_b64_tr_b16 a[234:235], v10 offset:58368
    v_cvt_pk_bf16_f32 v101, v38, v39
    v_mfma_f32_16x16x32_bf16 v[88:91], a[216:219], v[204:207], v[88:91]
    s_waitcnt lgkmcnt(6)
    v_exp_f32 v53, v53
    v_mfma_f32_16x16x32_bf16 v[92:95], a[216:219], v[220:223], v[92:95]
    ds_read_b64_tr_b16 a[236:237], v11 offset:57344
    v_cvt_pk_bf16_f32 v102, v52, v53
    v_mfma_f32_16x16x32_bf16 v[80:83], a[220:223], v[176:179], v[80:83]
    v_exp_f32 v54, v54
    v_mfma_f32_16x16x32_bf16 v[84:87], a[220:223], v[192:195], v[84:87]
    ds_read_b64_tr_b16 a[238:239], v11 offset:58368
    v_mfma_f32_16x16x32_bf16 v[88:91], a[220:223], v[208:211], v[88:91]
    s_waitcnt lgkmcnt(6)
    v_exp_f32 v55, v55
    v_mfma_f32_16x16x32_bf16 v[92:95], a[220:223], v[224:227], v[92:95]
    buffer_load_dwordx4 v17, s[12:15], s29 offen offset:1024 lds
    v_mfma_f32_16x16x32_bf16 a[0:3], a[224:227], v[112:115], a[0:3]
    v_exp_f32 v40, v40
    v_mfma_f32_16x16x32_bf16 a[4:7], a[224:227], v[116:119], a[4:7]
    ds_read_b64_tr_b16 a[240:241], v12 offset:57344
    v_cvt_pk_bf16_f32 v103, v54, v55
    v_mfma_f32_16x16x32_bf16 a[8:11], a[224:227], v[120:123], a[8:11]
    s_waitcnt lgkmcnt(5)
    v_exp_f32 v41, v41
    v_mfma_f32_16x16x32_bf16 a[12:15], a[224:227], v[124:127], a[12:15]
    ds_read_b64_tr_b16 a[242:243], v12 offset:58368
    v_cvt_pk_bf16_f32 v104, v40, v41
    v_mfma_f32_16x16x32_bf16 a[16:19], a[228:231], v[112:115], a[16:19]
    s_add_u32 s28, s28, 8192
    v_exp_f32 v42, v42
    v_mfma_f32_16x16x32_bf16 a[20:23], a[228:231], v[116:119], a[20:23]
    ds_read_b64_tr_b16 a[244:245], v13 offset:57344
    v_mfma_f32_16x16x32_bf16 a[24:27], a[228:231], v[120:123], a[24:27]
    s_waitcnt lgkmcnt(5)
    v_exp_f32 v43, v43
    v_mfma_f32_16x16x32_bf16 a[28:31], a[228:231], v[124:127], a[28:31]
    v_mfma_f32_16x16x32_bf16 a[32:35], a[232:235], v[112:115], a[32:35]
    s_add_u32 s29, s29, 8192
    v_exp_f32 v56, v56
    v_mfma_f32_16x16x32_bf16 a[36:39], a[232:235], v[116:119], a[36:39]
    ds_read_b64_tr_b16 a[246:247], v13 offset:58368
    v_cvt_pk_bf16_f32 v105, v42, v43
    v_mfma_f32_16x16x32_bf16 a[40:43], a[232:235], v[120:123], a[40:43]
    s_waitcnt lgkmcnt(4)
    v_exp_f32 v57, v57
    v_mfma_f32_16x16x32_bf16 a[44:47], a[232:235], v[124:127], a[44:47]
    ds_read_b64_tr_b16 a[248:249], v14 offset:57344
    v_cvt_pk_bf16_f32 v106, v56, v57
    v_mfma_f32_16x16x32_bf16 a[48:51], a[236:239], v[112:115], a[48:51]
    v_exp_f32 v58, v58
    v_mfma_f32_16x16x32_bf16 a[52:55], a[236:239], v[116:119], a[52:55]
    ds_read_b64_tr_b16 a[250:251], v14 offset:58368
    v_mfma_f32_16x16x32_bf16 a[56:59], a[236:239], v[120:123], a[56:59]
    s_waitcnt lgkmcnt(4)
    v_exp_f32 v59, v59
    v_mfma_f32_16x16x32_bf16 a[60:63], a[236:239], v[124:127], a[60:63]
    v_mfma_f32_16x16x32_bf16 a[64:67], a[240:243], v[112:115], a[64:67]
    s_waitcnt vmcnt(16)
    v_exp_f32 v44, v44
    v_mfma_f32_16x16x32_bf16 a[68:71], a[240:243], v[116:119], a[68:71]
    ds_read_b64_tr_b16 a[252:253], v15 offset:57344
    v_cvt_pk_bf16_f32 v107, v58, v59
    v_mfma_f32_16x16x32_bf16 a[72:75], a[240:243], v[120:123], a[72:75]
    s_waitcnt lgkmcnt(3)
    v_exp_f32 v45, v45
    v_mfma_f32_16x16x32_bf16 a[76:79], a[240:243], v[124:127], a[76:79]
    ds_read_b64_tr_b16 a[254:255], v15 offset:58368
    v_cvt_pk_bf16_f32 v108, v44, v45
    v_mfma_f32_16x16x32_bf16 a[80:83], a[244:247], v[112:115], a[80:83]
    s_barrier
    v_exp_f32 v46, v46
    v_mfma_f32_16x16x32_bf16 a[84:87], a[244:247], v[116:119], a[84:87]
    ds_read_b128 a[192:195], v4 offset:16384
    v_mfma_f32_16x16x32_bf16 a[88:91], a[244:247], v[120:123], a[88:91]
    s_waitcnt lgkmcnt(3)
    v_exp_f32 v47, v47
    v_mfma_f32_16x16x32_bf16 a[92:95], a[244:247], v[124:127], a[92:95]
    v_mfma_f32_16x16x32_bf16 a[96:99], a[248:251], v[112:115], a[96:99]
    v_exp_f32 v60, v60
    v_mfma_f32_16x16x32_bf16 a[100:103], a[248:251], v[116:119], a[100:103]
    ds_read_b128 a[196:199], v5 offset:16384
    v_cvt_pk_bf16_f32 v109, v46, v47
    v_mfma_f32_16x16x32_bf16 a[104:107], a[248:251], v[120:123], a[104:107]
    s_waitcnt lgkmcnt(2)
    v_exp_f32 v61, v61
    v_mfma_f32_16x16x32_bf16 a[108:111], a[248:251], v[124:127], a[108:111]
    ds_read_b128 a[200:203], v6 offset:16384
    v_cvt_pk_bf16_f32 v110, v60, v61
    v_mfma_f32_16x16x32_bf16 a[112:115], a[252:255], v[112:115], a[112:115]
    v_exp_f32 v62, v62
    v_mfma_f32_16x16x32_bf16 a[116:119], a[252:255], v[116:119], a[116:119]
    ds_read_b128 a[204:207], v7 offset:16384
    v_mfma_f32_16x16x32_bf16 a[120:123], a[252:255], v[120:123], a[120:123]
    v_exp_f32 v63, v63
    v_mfma_f32_16x16x32_bf16 a[124:127], a[252:255], v[124:127], a[124:127]
    v_mfma_f32_16x16x32_bf16 v[144:147], v[160:163], v[112:115], v[144:147]
    v_mfma_f32_16x16x32_bf16 v[148:151], v[160:163], v[116:119], v[148:151]
    v_mfma_f32_16x16x32_bf16 v[152:155], v[160:163], v[120:123], v[152:155]
    s_waitcnt lgkmcnt(3)
    v_mfma_f32_16x16x32_bf16 v[156:159], v[160:163], v[124:127], v[156:159]
    s_add_u32 s32, s32, 1
    s_cmp_lt_u32 s32, 7
    s_cbranch_scc1 recurrent_scan__mha_block_cached__mixer_s_mlp__prompt_kernel_loop
    v_mfma_f32_16x16x32_bf16 v[32:35], a[192:195], v[164:167], v[128:131]
    v_exp_f32 v64, v64
    v_mfma_f32_16x16x32_bf16 v[36:39], a[192:195], v[180:183], v[132:135]
    ds_read_b128 a[208:211], v4 offset:17408
    v_cvt_pk_bf16_f32 v111, v62, v63
    v_mfma_f32_16x16x32_bf16 v[40:43], a[192:195], v[196:199], v[136:139]
    s_mov_b32 s48, s6
    s_mov_b32 s49, s7
    s_mov_b32 s50, 0x1c0000
    s_mov_b32 s51, 0x20000
    s_lshr_b32 s40, s2, 3
    s_lshl_b32 s40, s40, 2
    s_add_u32 s40, s40, s3
    s_mul_i32 s56, s40, 14336
    v_lshlrev_b32 v25, 6, v1
    s_waitcnt lgkmcnt(3)
    v_exp_f32 v65, v65
    v_mfma_f32_16x16x32_bf16 v[44:47], a[192:195], v[212:215], v[140:143]
    ds_read_b128 a[212:215], v5 offset:17408
    v_cvt_pk_bf16_f32 v112, v64, v65
    v_mfma_f32_16x16x32_bf16 v[32:35], a[196:199], v[168:171], v[32:35]
    s_add_u32 m0, s30, 0
    v_exp_f32 v66, v66
    v_mfma_f32_16x16x32_bf16 v[36:39], a[196:199], v[184:187], v[36:39]
    ds_read_b128 a[216:219], v6 offset:17408
    v_mfma_f32_16x16x32_bf16 v[40:43], a[196:199], v[200:203], v[40:43]
    s_waitcnt lgkmcnt(4)
    v_exp_f32 v67, v67
    v_mfma_f32_16x16x32_bf16 v[44:47], a[196:199], v[216:219], v[44:47]
    buffer_load_dwordx4 v16, s[8:11], s28 offen offset:0 lds
    v_mfma_f32_16x16x32_bf16 v[32:35], a[200:203], v[172:175], v[32:35]
    v_exp_f32 v80, v80
    v_mfma_f32_16x16x32_bf16 v[36:39], a[200:203], v[188:191], v[36:39]
    ds_read_b128 a[220:223], v7 offset:17408
    v_cvt_pk_bf16_f32 v113, v66, v67
    v_mfma_f32_16x16x32_bf16 v[40:43], a[200:203], v[204:207], v[40:43]
    s_waitcnt lgkmcnt(4)
    v_exp_f32 v81, v81
    v_mfma_f32_16x16x32_bf16 v[44:47], a[200:203], v[220:223], v[44:47]
    ds_read_b64_tr_b16 a[224:225], v8 offset:0
    v_cvt_pk_bf16_f32 v114, v80, v81
    v_mfma_f32_16x16x32_bf16 v[32:35], a[204:207], v[176:179], v[32:35]
    v_exp_f32 v82, v82
    v_mfma_f32_16x16x32_bf16 v[36:39], a[204:207], v[192:195], v[36:39]
    ds_read_b64_tr_b16 a[226:227], v8 offset:1024
    v_mfma_f32_16x16x32_bf16 v[40:43], a[204:207], v[208:211], v[40:43]
    buffer_load_dword v3, v25, s[48:51], s56 offen
    s_add_u32 s56, s56, 4096
    s_waitcnt lgkmcnt(5)
    v_exp_f32 v83, v83
    v_mfma_f32_16x16x32_bf16 v[44:47], a[204:207], v[224:227], v[44:47]
    buffer_load_dwordx4 v16, s[8:11], s28 offen offset:1024 lds
    v_mfma_f32_16x16x32_bf16 v[48:51], a[208:211], v[164:167], v[128:131]
    v_exp_f32 v68, v68
    v_mfma_f32_16x16x32_bf16 v[52:55], a[208:211], v[180:183], v[132:135]
    ds_read_b64_tr_b16 a[228:229], v9 offset:0
    v_cvt_pk_bf16_f32 v115, v82, v83
    v_mfma_f32_16x16x32_bf16 v[56:59], a[208:211], v[196:199], v[136:139]
    s_waitcnt lgkmcnt(5)
    v_exp_f32 v69, v69
    v_mfma_f32_16x16x32_bf16 v[60:63], a[208:211], v[212:215], v[140:143]
    ds_read_b64_tr_b16 a[230:231], v9 offset:1024
    v_cvt_pk_bf16_f32 v116, v68, v69
    v_mfma_f32_16x16x32_bf16 v[48:51], a[212:215], v[168:171], v[48:51]
    s_add_u32 m0, s31, 49152
    v_exp_f32 v70, v70
    v_mfma_f32_16x16x32_bf16 v[52:55], a[212:215], v[184:187], v[52:55]
    ds_read_b64_tr_b16 a[232:233], v10 offset:0
    v_mfma_f32_16x16x32_bf16 v[56:59], a[212:215], v[200:203], v[56:59]
    s_waitcnt lgkmcnt(6)
    v_exp_f32 v71, v71
    v_mfma_f32_16x16x32_bf16 v[60:63], a[212:215], v[216:219], v[60:63]
    buffer_load_dwordx4 v17, s[12:15], s29 offen offset:0 lds
    v_mfma_f32_16x16x32_bf16 v[48:51], a[216:219], v[172:175], v[48:51]
    v_exp_f32 v84, v84
    v_mfma_f32_16x16x32_bf16 v[52:55], a[216:219], v[188:191], v[52:55]
    ds_read_b64_tr_b16 a[234:235], v10 offset:1024
    v_cvt_pk_bf16_f32 v117, v70, v71
    v_mfma_f32_16x16x32_bf16 v[56:59], a[216:219], v[204:207], v[56:59]
    buffer_load_dword v3, v25, s[48:51], s56 offen
    s_add_u32 s56, s56, 4096
    s_waitcnt lgkmcnt(6)
    v_exp_f32 v85, v85
    v_mfma_f32_16x16x32_bf16 v[60:63], a[216:219], v[220:223], v[60:63]
    ds_read_b64_tr_b16 a[236:237], v11 offset:0
    v_cvt_pk_bf16_f32 v118, v84, v85
    v_mfma_f32_16x16x32_bf16 v[48:51], a[220:223], v[176:179], v[48:51]
    v_exp_f32 v86, v86
    v_mfma_f32_16x16x32_bf16 v[52:55], a[220:223], v[192:195], v[52:55]
    ds_read_b64_tr_b16 a[238:239], v11 offset:1024
    v_mfma_f32_16x16x32_bf16 v[56:59], a[220:223], v[208:211], v[56:59]
    s_waitcnt lgkmcnt(6)
    v_exp_f32 v87, v87
    v_mfma_f32_16x16x32_bf16 v[60:63], a[220:223], v[224:227], v[60:63]
    buffer_load_dwordx4 v17, s[12:15], s29 offen offset:1024 lds
    v_mfma_f32_16x16x32_bf16 a[0:3], a[224:227], v[96:99], a[0:3]
    v_exp_f32 v72, v72
    v_mfma_f32_16x16x32_bf16 a[4:7], a[224:227], v[100:103], a[4:7]
    ds_read_b64_tr_b16 a[240:241], v12 offset:0
    v_cvt_pk_bf16_f32 v119, v86, v87
    v_mfma_f32_16x16x32_bf16 a[8:11], a[224:227], v[104:107], a[8:11]
    s_waitcnt lgkmcnt(5)
    v_exp_f32 v73, v73
    v_mfma_f32_16x16x32_bf16 a[12:15], a[224:227], v[108:111], a[12:15]
    ds_read_b64_tr_b16 a[242:243], v12 offset:1024
    v_cvt_pk_bf16_f32 v120, v72, v73
    v_mfma_f32_16x16x32_bf16 a[16:19], a[228:231], v[96:99], a[16:19]
    s_add_u32 s28, s28, 8192
    v_exp_f32 v74, v74
    v_mfma_f32_16x16x32_bf16 a[20:23], a[228:231], v[100:103], a[20:23]
    ds_read_b64_tr_b16 a[244:245], v13 offset:0
    v_mfma_f32_16x16x32_bf16 a[24:27], a[228:231], v[104:107], a[24:27]
    buffer_load_dword v3, v25, s[48:51], s56 offen
    s_add_u32 s56, s56, 4096
    s_waitcnt lgkmcnt(5)
    v_exp_f32 v75, v75
    v_mfma_f32_16x16x32_bf16 a[28:31], a[228:231], v[108:111], a[28:31]
    v_mfma_f32_16x16x32_bf16 a[32:35], a[232:235], v[96:99], a[32:35]
    s_add_u32 s29, s29, 8192
    v_exp_f32 v88, v88
    v_mfma_f32_16x16x32_bf16 a[36:39], a[232:235], v[100:103], a[36:39]
    ds_read_b64_tr_b16 a[246:247], v13 offset:1024
    v_cvt_pk_bf16_f32 v121, v74, v75
    v_mfma_f32_16x16x32_bf16 a[40:43], a[232:235], v[104:107], a[40:43]
    s_waitcnt lgkmcnt(4)
    v_exp_f32 v89, v89
    v_mfma_f32_16x16x32_bf16 a[44:47], a[232:235], v[108:111], a[44:47]
    ds_read_b64_tr_b16 a[248:249], v14 offset:0
    v_cvt_pk_bf16_f32 v122, v88, v89
    v_mfma_f32_16x16x32_bf16 a[48:51], a[236:239], v[96:99], a[48:51]
    v_exp_f32 v90, v90
    v_mfma_f32_16x16x32_bf16 a[52:55], a[236:239], v[100:103], a[52:55]
    ds_read_b64_tr_b16 a[250:251], v14 offset:1024
    v_mfma_f32_16x16x32_bf16 a[56:59], a[236:239], v[104:107], a[56:59]
    s_waitcnt lgkmcnt(4)
    v_exp_f32 v91, v91
    v_mfma_f32_16x16x32_bf16 a[60:63], a[236:239], v[108:111], a[60:63]
    v_mfma_f32_16x16x32_bf16 a[64:67], a[240:243], v[96:99], a[64:67]
    v_exp_f32 v76, v76
    v_mfma_f32_16x16x32_bf16 a[68:71], a[240:243], v[100:103], a[68:71]
    ds_read_b64_tr_b16 a[252:253], v15 offset:0
    v_cvt_pk_bf16_f32 v123, v90, v91
    v_mfma_f32_16x16x32_bf16 a[72:75], a[240:243], v[104:107], a[72:75]
    buffer_load_dword v3, v25, s[48:51], s56 offen
    s_add_u32 s56, s56, 4096
    s_waitcnt lgkmcnt(3)
    v_exp_f32 v77, v77
    v_mfma_f32_16x16x32_bf16 a[76:79], a[240:243], v[108:111], a[76:79]
    ds_read_b64_tr_b16 a[254:255], v15 offset:1024
    v_cvt_pk_bf16_f32 v124, v76, v77
    v_mfma_f32_16x16x32_bf16 a[80:83], a[244:247], v[96:99], a[80:83]
    v_exp_f32 v78, v78
    v_mfma_f32_16x16x32_bf16 a[84:87], a[244:247], v[100:103], a[84:87]
    ds_read_b128 a[192:195], v4 offset:24576
    v_mfma_f32_16x16x32_bf16 a[88:91], a[244:247], v[104:107], a[88:91]
    s_waitcnt lgkmcnt(3)
    v_exp_f32 v79, v79
    v_mfma_f32_16x16x32_bf16 a[92:95], a[244:247], v[108:111], a[92:95]
    v_mfma_f32_16x16x32_bf16 a[96:99], a[248:251], v[96:99], a[96:99]
    v_exp_f32 v92, v92
    v_mfma_f32_16x16x32_bf16 a[100:103], a[248:251], v[100:103], a[100:103]
    ds_read_b128 a[196:199], v5 offset:24576
    v_cvt_pk_bf16_f32 v125, v78, v79
    v_mfma_f32_16x16x32_bf16 a[104:107], a[248:251], v[104:107], a[104:107]
    s_waitcnt lgkmcnt(2)
    v_exp_f32 v93, v93
    v_mfma_f32_16x16x32_bf16 a[108:111], a[248:251], v[108:111], a[108:111]
    ds_read_b128 a[200:203], v6 offset:24576
    v_cvt_pk_bf16_f32 v126, v92, v93
    v_mfma_f32_16x16x32_bf16 a[112:115], a[252:255], v[96:99], a[112:115]
    v_exp_f32 v94, v94
    v_mfma_f32_16x16x32_bf16 a[116:119], a[252:255], v[100:103], a[116:119]
    ds_read_b128 a[204:207], v7 offset:24576
    v_mfma_f32_16x16x32_bf16 a[120:123], a[252:255], v[104:107], a[120:123]
    v_exp_f32 v95, v95
    v_mfma_f32_16x16x32_bf16 a[124:127], a[252:255], v[108:111], a[124:127]
    v_mfma_f32_16x16x32_bf16 v[144:147], v[160:163], v[96:99], v[144:147]
    v_mfma_f32_16x16x32_bf16 v[148:151], v[160:163], v[100:103], v[148:151]
    v_mfma_f32_16x16x32_bf16 v[152:155], v[160:163], v[104:107], v[152:155]
    s_waitcnt lgkmcnt(3)
    v_mfma_f32_16x16x32_bf16 v[156:159], v[160:163], v[108:111], v[156:159]
    v_mfma_f32_16x16x32_bf16 v[64:67], a[192:195], v[164:167], v[128:131]
    v_exp_f32 v32, v32
    v_mfma_f32_16x16x32_bf16 v[68:71], a[192:195], v[180:183], v[132:135]
    ds_read_b128 a[208:211], v4 offset:25600
    v_cvt_pk_bf16_f32 v127, v94, v95
    v_mfma_f32_16x16x32_bf16 v[72:75], a[192:195], v[196:199], v[136:139]
    s_waitcnt lgkmcnt(3)
    v_exp_f32 v33, v33
    v_mfma_f32_16x16x32_bf16 v[76:79], a[192:195], v[212:215], v[140:143]
    ds_read_b128 a[212:215], v5 offset:25600
    v_cvt_pk_bf16_f32 v96, v32, v33
    v_mfma_f32_16x16x32_bf16 v[64:67], a[196:199], v[168:171], v[64:67]
    s_add_u32 m0, s30, 8192
    v_exp_f32 v34, v34
    v_mfma_f32_16x16x32_bf16 v[68:71], a[196:199], v[184:187], v[68:71]
    ds_read_b128 a[216:219], v6 offset:25600
    v_mfma_f32_16x16x32_bf16 v[72:75], a[196:199], v[200:203], v[72:75]
    s_waitcnt lgkmcnt(4)
    v_exp_f32 v35, v35
    v_mfma_f32_16x16x32_bf16 v[76:79], a[196:199], v[216:219], v[76:79]
    buffer_load_dwordx4 v16, s[8:11], s28 offen offset:0 lds
    v_mfma_f32_16x16x32_bf16 v[64:67], a[200:203], v[172:175], v[64:67]
    v_exp_f32 v48, v48
    v_mfma_f32_16x16x32_bf16 v[68:71], a[200:203], v[188:191], v[68:71]
    ds_read_b128 a[220:223], v7 offset:25600
    v_cvt_pk_bf16_f32 v97, v34, v35
    v_mfma_f32_16x16x32_bf16 v[72:75], a[200:203], v[204:207], v[72:75]
    s_waitcnt lgkmcnt(4)
    v_exp_f32 v49, v49
    v_mfma_f32_16x16x32_bf16 v[76:79], a[200:203], v[220:223], v[76:79]
    ds_read_b64_tr_b16 a[224:225], v8 offset:8192
    v_cvt_pk_bf16_f32 v98, v48, v49
    v_mfma_f32_16x16x32_bf16 v[64:67], a[204:207], v[176:179], v[64:67]
    v_exp_f32 v50, v50
    v_mfma_f32_16x16x32_bf16 v[68:71], a[204:207], v[192:195], v[68:71]
    ds_read_b64_tr_b16 a[226:227], v8 offset:9216
    v_mfma_f32_16x16x32_bf16 v[72:75], a[204:207], v[208:211], v[72:75]
    s_waitcnt lgkmcnt(5)
    v_exp_f32 v51, v51
    v_mfma_f32_16x16x32_bf16 v[76:79], a[204:207], v[224:227], v[76:79]
    buffer_load_dwordx4 v16, s[8:11], s28 offen offset:1024 lds
    v_mfma_f32_16x16x32_bf16 v[80:83], a[208:211], v[164:167], v[128:131]
    v_exp_f32 v36, v36
    v_mfma_f32_16x16x32_bf16 v[84:87], a[208:211], v[180:183], v[132:135]
    ds_read_b64_tr_b16 a[228:229], v9 offset:8192
    v_cvt_pk_bf16_f32 v99, v50, v51
    v_mfma_f32_16x16x32_bf16 v[88:91], a[208:211], v[196:199], v[136:139]
    s_waitcnt lgkmcnt(5)
    v_exp_f32 v37, v37
    v_mfma_f32_16x16x32_bf16 v[92:95], a[208:211], v[212:215], v[140:143]
    ds_read_b64_tr_b16 a[230:231], v9 offset:9216
    v_cvt_pk_bf16_f32 v100, v36, v37
    v_mfma_f32_16x16x32_bf16 v[80:83], a[212:215], v[168:171], v[80:83]
    s_add_u32 m0, s31, 57344
    v_exp_f32 v38, v38
    v_mfma_f32_16x16x32_bf16 v[84:87], a[212:215], v[184:187], v[84:87]
    ds_read_b64_tr_b16 a[232:233], v10 offset:8192
    v_mfma_f32_16x16x32_bf16 v[88:91], a[212:215], v[200:203], v[88:91]
    s_waitcnt lgkmcnt(6)
    v_exp_f32 v39, v39
    v_mfma_f32_16x16x32_bf16 v[92:95], a[212:215], v[216:219], v[92:95]
    buffer_load_dwordx4 v17, s[12:15], s29 offen offset:0 lds
    v_mfma_f32_16x16x32_bf16 v[80:83], a[216:219], v[172:175], v[80:83]
    v_exp_f32 v52, v52
    v_mfma_f32_16x16x32_bf16 v[84:87], a[216:219], v[188:191], v[84:87]
    ds_read_b64_tr_b16 a[234:235], v10 offset:9216
    v_cvt_pk_bf16_f32 v101, v38, v39
    v_mfma_f32_16x16x32_bf16 v[88:91], a[216:219], v[204:207], v[88:91]
    s_waitcnt lgkmcnt(6)
    v_exp_f32 v53, v53
    v_mfma_f32_16x16x32_bf16 v[92:95], a[216:219], v[220:223], v[92:95]
    ds_read_b64_tr_b16 a[236:237], v11 offset:8192
    v_cvt_pk_bf16_f32 v102, v52, v53
    v_mfma_f32_16x16x32_bf16 v[80:83], a[220:223], v[176:179], v[80:83]
    v_exp_f32 v54, v54
    v_mfma_f32_16x16x32_bf16 v[84:87], a[220:223], v[192:195], v[84:87]
    ds_read_b64_tr_b16 a[238:239], v11 offset:9216
    v_mfma_f32_16x16x32_bf16 v[88:91], a[220:223], v[208:211], v[88:91]
    s_waitcnt lgkmcnt(6)
    v_exp_f32 v55, v55
    v_mfma_f32_16x16x32_bf16 v[92:95], a[220:223], v[224:227], v[92:95]
    buffer_load_dwordx4 v17, s[12:15], s29 offen offset:1024 lds
    v_mfma_f32_16x16x32_bf16 a[0:3], a[224:227], v[112:115], a[0:3]
    v_exp_f32 v40, v40
    v_mfma_f32_16x16x32_bf16 a[4:7], a[224:227], v[116:119], a[4:7]
    ds_read_b64_tr_b16 a[240:241], v12 offset:8192
    v_cvt_pk_bf16_f32 v103, v54, v55
    v_mfma_f32_16x16x32_bf16 a[8:11], a[224:227], v[120:123], a[8:11]
    s_waitcnt lgkmcnt(5)
    v_exp_f32 v41, v41
    v_mfma_f32_16x16x32_bf16 a[12:15], a[224:227], v[124:127], a[12:15]
    ds_read_b64_tr_b16 a[242:243], v12 offset:9216
    v_cvt_pk_bf16_f32 v104, v40, v41
    v_mfma_f32_16x16x32_bf16 a[16:19], a[228:231], v[112:115], a[16:19]
    s_add_u32 s28, s28, 8192
    v_exp_f32 v42, v42
    v_mfma_f32_16x16x32_bf16 a[20:23], a[228:231], v[116:119], a[20:23]
    ds_read_b64_tr_b16 a[244:245], v13 offset:8192
    v_mfma_f32_16x16x32_bf16 a[24:27], a[228:231], v[120:123], a[24:27]
    s_waitcnt lgkmcnt(5)
    v_exp_f32 v43, v43
    v_mfma_f32_16x16x32_bf16 a[28:31], a[228:231], v[124:127], a[28:31]
    v_mfma_f32_16x16x32_bf16 a[32:35], a[232:235], v[112:115], a[32:35]
    s_add_u32 s29, s29, 8192
    v_exp_f32 v56, v56
    v_mfma_f32_16x16x32_bf16 a[36:39], a[232:235], v[116:119], a[36:39]
    ds_read_b64_tr_b16 a[246:247], v13 offset:9216
    v_cvt_pk_bf16_f32 v105, v42, v43
    v_mfma_f32_16x16x32_bf16 a[40:43], a[232:235], v[120:123], a[40:43]
    s_waitcnt lgkmcnt(4)
    v_exp_f32 v57, v57
    v_mfma_f32_16x16x32_bf16 a[44:47], a[232:235], v[124:127], a[44:47]
    ds_read_b64_tr_b16 a[248:249], v14 offset:8192
    v_cvt_pk_bf16_f32 v106, v56, v57
    v_mfma_f32_16x16x32_bf16 a[48:51], a[236:239], v[112:115], a[48:51]
    v_exp_f32 v58, v58
    v_mfma_f32_16x16x32_bf16 a[52:55], a[236:239], v[116:119], a[52:55]
    ds_read_b64_tr_b16 a[250:251], v14 offset:9216
    v_mfma_f32_16x16x32_bf16 a[56:59], a[236:239], v[120:123], a[56:59]
    s_waitcnt lgkmcnt(4)
    v_exp_f32 v59, v59
    v_mfma_f32_16x16x32_bf16 a[60:63], a[236:239], v[124:127], a[60:63]
    v_mfma_f32_16x16x32_bf16 a[64:67], a[240:243], v[112:115], a[64:67]
    s_waitcnt vmcnt(16)
    v_exp_f32 v44, v44
    v_mfma_f32_16x16x32_bf16 a[68:71], a[240:243], v[116:119], a[68:71]
    ds_read_b64_tr_b16 a[252:253], v15 offset:8192
    v_cvt_pk_bf16_f32 v107, v58, v59
    v_mfma_f32_16x16x32_bf16 a[72:75], a[240:243], v[120:123], a[72:75]
    s_waitcnt lgkmcnt(3)
    v_exp_f32 v45, v45
    v_mfma_f32_16x16x32_bf16 a[76:79], a[240:243], v[124:127], a[76:79]
    ds_read_b64_tr_b16 a[254:255], v15 offset:9216
    v_cvt_pk_bf16_f32 v108, v44, v45
    v_mfma_f32_16x16x32_bf16 a[80:83], a[244:247], v[112:115], a[80:83]
    s_barrier
    v_exp_f32 v46, v46
    v_mfma_f32_16x16x32_bf16 a[84:87], a[244:247], v[116:119], a[84:87]
    ds_read_b128 a[192:195], v4 offset:32768
    v_mfma_f32_16x16x32_bf16 a[88:91], a[244:247], v[120:123], a[88:91]
    s_waitcnt lgkmcnt(3)
    v_exp_f32 v47, v47
    v_mfma_f32_16x16x32_bf16 a[92:95], a[244:247], v[124:127], a[92:95]
    v_mfma_f32_16x16x32_bf16 a[96:99], a[248:251], v[112:115], a[96:99]
    v_exp_f32 v60, v60
    v_mfma_f32_16x16x32_bf16 a[100:103], a[248:251], v[116:119], a[100:103]
    ds_read_b128 a[196:199], v5 offset:32768
    v_cvt_pk_bf16_f32 v109, v46, v47
    v_mfma_f32_16x16x32_bf16 a[104:107], a[248:251], v[120:123], a[104:107]
    s_waitcnt lgkmcnt(2)
    v_exp_f32 v61, v61
    v_mfma_f32_16x16x32_bf16 a[108:111], a[248:251], v[124:127], a[108:111]
    ds_read_b128 a[200:203], v6 offset:32768
    v_cvt_pk_bf16_f32 v110, v60, v61
    v_mfma_f32_16x16x32_bf16 a[112:115], a[252:255], v[112:115], a[112:115]
    v_exp_f32 v62, v62
    v_mfma_f32_16x16x32_bf16 a[116:119], a[252:255], v[116:119], a[116:119]
    ds_read_b128 a[204:207], v7 offset:32768
    v_mfma_f32_16x16x32_bf16 a[120:123], a[252:255], v[120:123], a[120:123]
    v_exp_f32 v63, v63
    v_mfma_f32_16x16x32_bf16 a[124:127], a[252:255], v[124:127], a[124:127]
    v_mfma_f32_16x16x32_bf16 v[144:147], v[160:163], v[112:115], v[144:147]
    v_mfma_f32_16x16x32_bf16 v[148:151], v[160:163], v[116:119], v[148:151]
    v_mfma_f32_16x16x32_bf16 v[152:155], v[160:163], v[120:123], v[152:155]
    s_waitcnt lgkmcnt(3)
    v_mfma_f32_16x16x32_bf16 v[156:159], v[160:163], v[124:127], v[156:159]
    v_mfma_f32_16x16x32_bf16 v[32:35], a[192:195], v[164:167], v[128:131]
    v_exp_f32 v64, v64
    v_mfma_f32_16x16x32_bf16 v[36:39], a[192:195], v[180:183], v[132:135]
    ds_read_b128 a[208:211], v4 offset:33792
    v_cvt_pk_bf16_f32 v111, v62, v63
    v_mfma_f32_16x16x32_bf16 v[40:43], a[192:195], v[196:199], v[136:139]
    s_waitcnt lgkmcnt(3)
    v_exp_f32 v65, v65
    v_mfma_f32_16x16x32_bf16 v[44:47], a[192:195], v[212:215], v[140:143]
    ds_read_b128 a[212:215], v5 offset:33792
    v_cvt_pk_bf16_f32 v112, v64, v65
    v_mfma_f32_16x16x32_bf16 v[32:35], a[196:199], v[168:171], v[32:35]
    v_exp_f32 v66, v66
    v_mfma_f32_16x16x32_bf16 v[36:39], a[196:199], v[184:187], v[36:39]
    ds_read_b128 a[216:219], v6 offset:33792
    v_mfma_f32_16x16x32_bf16 v[40:43], a[196:199], v[200:203], v[40:43]
    s_waitcnt lgkmcnt(4)
    v_exp_f32 v67, v67
    v_mfma_f32_16x16x32_bf16 v[44:47], a[196:199], v[216:219], v[44:47]
    v_mfma_f32_16x16x32_bf16 v[32:35], a[200:203], v[172:175], v[32:35]
    v_exp_f32 v80, v80
    v_mfma_f32_16x16x32_bf16 v[36:39], a[200:203], v[188:191], v[36:39]
    ds_read_b128 a[220:223], v7 offset:33792
    v_cvt_pk_bf16_f32 v113, v66, v67
    v_mfma_f32_16x16x32_bf16 v[40:43], a[200:203], v[204:207], v[40:43]
    s_waitcnt lgkmcnt(4)
    v_exp_f32 v81, v81
    v_mfma_f32_16x16x32_bf16 v[44:47], a[200:203], v[220:223], v[44:47]
    ds_read_b64_tr_b16 a[224:225], v8 offset:16384
    v_cvt_pk_bf16_f32 v114, v80, v81
    v_mfma_f32_16x16x32_bf16 v[32:35], a[204:207], v[176:179], v[32:35]
    v_exp_f32 v82, v82
    v_mfma_f32_16x16x32_bf16 v[36:39], a[204:207], v[192:195], v[36:39]
    ds_read_b64_tr_b16 a[226:227], v8 offset:17408
    v_mfma_f32_16x16x32_bf16 v[40:43], a[204:207], v[208:211], v[40:43]
    s_waitcnt lgkmcnt(5)
    v_exp_f32 v83, v83
    v_mfma_f32_16x16x32_bf16 v[44:47], a[204:207], v[224:227], v[44:47]
    v_mfma_f32_16x16x32_bf16 v[48:51], a[208:211], v[164:167], v[128:131]
    v_exp_f32 v68, v68
    v_mfma_f32_16x16x32_bf16 v[52:55], a[208:211], v[180:183], v[132:135]
    ds_read_b64_tr_b16 a[228:229], v9 offset:16384
    v_cvt_pk_bf16_f32 v115, v82, v83
    v_mfma_f32_16x16x32_bf16 v[56:59], a[208:211], v[196:199], v[136:139]
    s_waitcnt lgkmcnt(5)
    v_exp_f32 v69, v69
    v_mfma_f32_16x16x32_bf16 v[60:63], a[208:211], v[212:215], v[140:143]
    ds_read_b64_tr_b16 a[230:231], v9 offset:17408
    v_cvt_pk_bf16_f32 v116, v68, v69
    v_mfma_f32_16x16x32_bf16 v[48:51], a[212:215], v[168:171], v[48:51]
    v_exp_f32 v70, v70
    v_mfma_f32_16x16x32_bf16 v[52:55], a[212:215], v[184:187], v[52:55]
    ds_read_b64_tr_b16 a[232:233], v10 offset:16384
    v_mfma_f32_16x16x32_bf16 v[56:59], a[212:215], v[200:203], v[56:59]
    s_waitcnt lgkmcnt(6)
    v_exp_f32 v71, v71
    v_mfma_f32_16x16x32_bf16 v[60:63], a[212:215], v[216:219], v[60:63]
    v_mfma_f32_16x16x32_bf16 v[48:51], a[216:219], v[172:175], v[48:51]
    v_exp_f32 v84, v84
    v_mfma_f32_16x16x32_bf16 v[52:55], a[216:219], v[188:191], v[52:55]
    ds_read_b64_tr_b16 a[234:235], v10 offset:17408
    v_cvt_pk_bf16_f32 v117, v70, v71
    v_mfma_f32_16x16x32_bf16 v[56:59], a[216:219], v[204:207], v[56:59]
    s_waitcnt lgkmcnt(6)
    v_exp_f32 v85, v85
    v_mfma_f32_16x16x32_bf16 v[60:63], a[216:219], v[220:223], v[60:63]
    ds_read_b64_tr_b16 a[236:237], v11 offset:16384
    v_cvt_pk_bf16_f32 v118, v84, v85
    v_mfma_f32_16x16x32_bf16 v[48:51], a[220:223], v[176:179], v[48:51]
    v_exp_f32 v86, v86
    v_mfma_f32_16x16x32_bf16 v[52:55], a[220:223], v[192:195], v[52:55]
    ds_read_b64_tr_b16 a[238:239], v11 offset:17408
    v_mfma_f32_16x16x32_bf16 v[56:59], a[220:223], v[208:211], v[56:59]
    s_waitcnt lgkmcnt(6)
    v_exp_f32 v87, v87
    v_mfma_f32_16x16x32_bf16 v[60:63], a[220:223], v[224:227], v[60:63]
    v_mfma_f32_16x16x32_bf16 a[0:3], a[224:227], v[96:99], a[0:3]
    v_exp_f32 v72, v72
    v_mfma_f32_16x16x32_bf16 a[4:7], a[224:227], v[100:103], a[4:7]
    ds_read_b64_tr_b16 a[240:241], v12 offset:16384
    v_cvt_pk_bf16_f32 v119, v86, v87
    v_mfma_f32_16x16x32_bf16 a[8:11], a[224:227], v[104:107], a[8:11]
    s_waitcnt lgkmcnt(5)
    v_exp_f32 v73, v73
    v_mfma_f32_16x16x32_bf16 a[12:15], a[224:227], v[108:111], a[12:15]
    ds_read_b64_tr_b16 a[242:243], v12 offset:17408
    v_cvt_pk_bf16_f32 v120, v72, v73
    v_mfma_f32_16x16x32_bf16 a[16:19], a[228:231], v[96:99], a[16:19]
    v_exp_f32 v74, v74
    v_mfma_f32_16x16x32_bf16 a[20:23], a[228:231], v[100:103], a[20:23]
    ds_read_b64_tr_b16 a[244:245], v13 offset:16384
    v_mfma_f32_16x16x32_bf16 a[24:27], a[228:231], v[104:107], a[24:27]
    s_waitcnt lgkmcnt(5)
    v_exp_f32 v75, v75
    v_mfma_f32_16x16x32_bf16 a[28:31], a[228:231], v[108:111], a[28:31]
    v_mfma_f32_16x16x32_bf16 a[32:35], a[232:235], v[96:99], a[32:35]
    v_exp_f32 v88, v88
    v_mfma_f32_16x16x32_bf16 a[36:39], a[232:235], v[100:103], a[36:39]
    ds_read_b64_tr_b16 a[246:247], v13 offset:17408
    v_cvt_pk_bf16_f32 v121, v74, v75
    v_mfma_f32_16x16x32_bf16 a[40:43], a[232:235], v[104:107], a[40:43]
    s_waitcnt lgkmcnt(4)
    v_exp_f32 v89, v89
    v_mfma_f32_16x16x32_bf16 a[44:47], a[232:235], v[108:111], a[44:47]
    ds_read_b64_tr_b16 a[248:249], v14 offset:16384
    v_cvt_pk_bf16_f32 v122, v88, v89
    v_mfma_f32_16x16x32_bf16 a[48:51], a[236:239], v[96:99], a[48:51]
    v_exp_f32 v90, v90
    v_mfma_f32_16x16x32_bf16 a[52:55], a[236:239], v[100:103], a[52:55]
    ds_read_b64_tr_b16 a[250:251], v14 offset:17408
    v_mfma_f32_16x16x32_bf16 a[56:59], a[236:239], v[104:107], a[56:59]
    s_waitcnt lgkmcnt(4)
    v_exp_f32 v91, v91
    v_mfma_f32_16x16x32_bf16 a[60:63], a[236:239], v[108:111], a[60:63]
    v_mfma_f32_16x16x32_bf16 a[64:67], a[240:243], v[96:99], a[64:67]
    v_exp_f32 v76, v76
    v_mfma_f32_16x16x32_bf16 a[68:71], a[240:243], v[100:103], a[68:71]
    ds_read_b64_tr_b16 a[252:253], v15 offset:16384
    v_cvt_pk_bf16_f32 v123, v90, v91
    v_mfma_f32_16x16x32_bf16 a[72:75], a[240:243], v[104:107], a[72:75]
    s_waitcnt lgkmcnt(3)
    v_exp_f32 v77, v77
    v_mfma_f32_16x16x32_bf16 a[76:79], a[240:243], v[108:111], a[76:79]
    ds_read_b64_tr_b16 a[254:255], v15 offset:17408
    v_cvt_pk_bf16_f32 v124, v76, v77
    v_mfma_f32_16x16x32_bf16 a[80:83], a[244:247], v[96:99], a[80:83]
    v_exp_f32 v78, v78
    v_mfma_f32_16x16x32_bf16 a[84:87], a[244:247], v[100:103], a[84:87]
    ds_read_b128 a[192:195], v4 offset:40960
    v_mfma_f32_16x16x32_bf16 a[88:91], a[244:247], v[104:107], a[88:91]
    s_waitcnt lgkmcnt(3)
    v_exp_f32 v79, v79
    v_mfma_f32_16x16x32_bf16 a[92:95], a[244:247], v[108:111], a[92:95]
    v_mfma_f32_16x16x32_bf16 a[96:99], a[248:251], v[96:99], a[96:99]
    v_exp_f32 v92, v92
    v_mfma_f32_16x16x32_bf16 a[100:103], a[248:251], v[100:103], a[100:103]
    ds_read_b128 a[196:199], v5 offset:40960
    v_cvt_pk_bf16_f32 v125, v78, v79
    v_mfma_f32_16x16x32_bf16 a[104:107], a[248:251], v[104:107], a[104:107]
    s_waitcnt lgkmcnt(2)
    v_exp_f32 v93, v93
    v_mfma_f32_16x16x32_bf16 a[108:111], a[248:251], v[108:111], a[108:111]
    ds_read_b128 a[200:203], v6 offset:40960
    v_cvt_pk_bf16_f32 v126, v92, v93
    v_mfma_f32_16x16x32_bf16 a[112:115], a[252:255], v[96:99], a[112:115]
    v_exp_f32 v94, v94
    v_mfma_f32_16x16x32_bf16 a[116:119], a[252:255], v[100:103], a[116:119]
    ds_read_b128 a[204:207], v7 offset:40960
    v_mfma_f32_16x16x32_bf16 a[120:123], a[252:255], v[104:107], a[120:123]
    v_exp_f32 v95, v95
    v_mfma_f32_16x16x32_bf16 a[124:127], a[252:255], v[108:111], a[124:127]
    v_mfma_f32_16x16x32_bf16 v[144:147], v[160:163], v[96:99], v[144:147]
    v_mfma_f32_16x16x32_bf16 v[148:151], v[160:163], v[100:103], v[148:151]
    v_mfma_f32_16x16x32_bf16 v[152:155], v[160:163], v[104:107], v[152:155]
    s_waitcnt lgkmcnt(3)
    v_mfma_f32_16x16x32_bf16 v[156:159], v[160:163], v[108:111], v[156:159]
    v_mfma_f32_16x16x32_bf16 v[64:67], a[192:195], v[164:167], v[128:131]
    v_exp_f32 v32, v32
    v_mfma_f32_16x16x32_bf16 v[68:71], a[192:195], v[180:183], v[132:135]
    ds_read_b128 a[208:211], v4 offset:41984
    v_cvt_pk_bf16_f32 v127, v94, v95
    v_mfma_f32_16x16x32_bf16 v[72:75], a[192:195], v[196:199], v[136:139]
    s_waitcnt lgkmcnt(3)
    v_exp_f32 v33, v33
    v_mfma_f32_16x16x32_bf16 v[76:79], a[192:195], v[212:215], v[140:143]
    ds_read_b128 a[212:215], v5 offset:41984
    v_cvt_pk_bf16_f32 v96, v32, v33
    v_mfma_f32_16x16x32_bf16 v[64:67], a[196:199], v[168:171], v[64:67]
    v_exp_f32 v34, v34
    v_mfma_f32_16x16x32_bf16 v[68:71], a[196:199], v[184:187], v[68:71]
    ds_read_b128 a[216:219], v6 offset:41984
    v_mfma_f32_16x16x32_bf16 v[72:75], a[196:199], v[200:203], v[72:75]
    s_waitcnt lgkmcnt(4)
    v_exp_f32 v35, v35
    v_mfma_f32_16x16x32_bf16 v[76:79], a[196:199], v[216:219], v[76:79]
    v_mfma_f32_16x16x32_bf16 v[64:67], a[200:203], v[172:175], v[64:67]
    v_exp_f32 v48, v48
    v_mfma_f32_16x16x32_bf16 v[68:71], a[200:203], v[188:191], v[68:71]
    ds_read_b128 a[220:223], v7 offset:41984
    v_cvt_pk_bf16_f32 v97, v34, v35
    v_mfma_f32_16x16x32_bf16 v[72:75], a[200:203], v[204:207], v[72:75]
    s_waitcnt lgkmcnt(4)
    v_exp_f32 v49, v49
    v_mfma_f32_16x16x32_bf16 v[76:79], a[200:203], v[220:223], v[76:79]
    ds_read_b64_tr_b16 a[224:225], v8 offset:24576
    v_cvt_pk_bf16_f32 v98, v48, v49
    v_mfma_f32_16x16x32_bf16 v[64:67], a[204:207], v[176:179], v[64:67]
    v_exp_f32 v50, v50
    v_mfma_f32_16x16x32_bf16 v[68:71], a[204:207], v[192:195], v[68:71]
    ds_read_b64_tr_b16 a[226:227], v8 offset:25600
    v_mfma_f32_16x16x32_bf16 v[72:75], a[204:207], v[208:211], v[72:75]
    s_waitcnt lgkmcnt(5)
    v_exp_f32 v51, v51
    v_mfma_f32_16x16x32_bf16 v[76:79], a[204:207], v[224:227], v[76:79]
    v_mfma_f32_16x16x32_bf16 v[80:83], a[208:211], v[164:167], v[128:131]
    v_exp_f32 v36, v36
    v_mfma_f32_16x16x32_bf16 v[84:87], a[208:211], v[180:183], v[132:135]
    ds_read_b64_tr_b16 a[228:229], v9 offset:24576
    v_cvt_pk_bf16_f32 v99, v50, v51
    v_mfma_f32_16x16x32_bf16 v[88:91], a[208:211], v[196:199], v[136:139]
    s_waitcnt lgkmcnt(5)
    v_exp_f32 v37, v37
    v_mfma_f32_16x16x32_bf16 v[92:95], a[208:211], v[212:215], v[140:143]
    ds_read_b64_tr_b16 a[230:231], v9 offset:25600
    v_cvt_pk_bf16_f32 v100, v36, v37
    v_mfma_f32_16x16x32_bf16 v[80:83], a[212:215], v[168:171], v[80:83]
    v_exp_f32 v38, v38
    v_mfma_f32_16x16x32_bf16 v[84:87], a[212:215], v[184:187], v[84:87]
    ds_read_b64_tr_b16 a[232:233], v10 offset:24576
    v_mfma_f32_16x16x32_bf16 v[88:91], a[212:215], v[200:203], v[88:91]
    s_waitcnt lgkmcnt(6)
    v_exp_f32 v39, v39
    v_mfma_f32_16x16x32_bf16 v[92:95], a[212:215], v[216:219], v[92:95]
    v_mfma_f32_16x16x32_bf16 v[80:83], a[216:219], v[172:175], v[80:83]
    v_exp_f32 v52, v52
    v_mfma_f32_16x16x32_bf16 v[84:87], a[216:219], v[188:191], v[84:87]
    ds_read_b64_tr_b16 a[234:235], v10 offset:25600
    v_cvt_pk_bf16_f32 v101, v38, v39
    v_mfma_f32_16x16x32_bf16 v[88:91], a[216:219], v[204:207], v[88:91]
    s_waitcnt lgkmcnt(6)
    v_exp_f32 v53, v53
    v_mfma_f32_16x16x32_bf16 v[92:95], a[216:219], v[220:223], v[92:95]
    ds_read_b64_tr_b16 a[236:237], v11 offset:24576
    v_cvt_pk_bf16_f32 v102, v52, v53
    v_mfma_f32_16x16x32_bf16 v[80:83], a[220:223], v[176:179], v[80:83]
    v_exp_f32 v54, v54
    v_mfma_f32_16x16x32_bf16 v[84:87], a[220:223], v[192:195], v[84:87]
    ds_read_b64_tr_b16 a[238:239], v11 offset:25600
    v_mfma_f32_16x16x32_bf16 v[88:91], a[220:223], v[208:211], v[88:91]
    s_waitcnt lgkmcnt(6)
    v_exp_f32 v55, v55
    v_mfma_f32_16x16x32_bf16 v[92:95], a[220:223], v[224:227], v[92:95]
    v_mfma_f32_16x16x32_bf16 a[0:3], a[224:227], v[112:115], a[0:3]
    v_exp_f32 v40, v40
    v_mfma_f32_16x16x32_bf16 a[4:7], a[224:227], v[116:119], a[4:7]
    ds_read_b64_tr_b16 a[240:241], v12 offset:24576
    v_cvt_pk_bf16_f32 v103, v54, v55
    v_mfma_f32_16x16x32_bf16 a[8:11], a[224:227], v[120:123], a[8:11]
    s_waitcnt lgkmcnt(5)
    v_exp_f32 v41, v41
    v_mfma_f32_16x16x32_bf16 a[12:15], a[224:227], v[124:127], a[12:15]
    ds_read_b64_tr_b16 a[242:243], v12 offset:25600
    v_cvt_pk_bf16_f32 v104, v40, v41
    v_mfma_f32_16x16x32_bf16 a[16:19], a[228:231], v[112:115], a[16:19]
    v_exp_f32 v42, v42
    v_mfma_f32_16x16x32_bf16 a[20:23], a[228:231], v[116:119], a[20:23]
    ds_read_b64_tr_b16 a[244:245], v13 offset:24576
    v_mfma_f32_16x16x32_bf16 a[24:27], a[228:231], v[120:123], a[24:27]
    s_waitcnt lgkmcnt(5)
    v_exp_f32 v43, v43
    v_mfma_f32_16x16x32_bf16 a[28:31], a[228:231], v[124:127], a[28:31]
    v_mfma_f32_16x16x32_bf16 a[32:35], a[232:235], v[112:115], a[32:35]
    v_exp_f32 v56, v56
    v_mfma_f32_16x16x32_bf16 a[36:39], a[232:235], v[116:119], a[36:39]
    ds_read_b64_tr_b16 a[246:247], v13 offset:25600
    v_cvt_pk_bf16_f32 v105, v42, v43
    v_mfma_f32_16x16x32_bf16 a[40:43], a[232:235], v[120:123], a[40:43]
    s_waitcnt lgkmcnt(4)
    v_exp_f32 v57, v57
    v_mfma_f32_16x16x32_bf16 a[44:47], a[232:235], v[124:127], a[44:47]
    ds_read_b64_tr_b16 a[248:249], v14 offset:24576
    v_cvt_pk_bf16_f32 v106, v56, v57
    v_mfma_f32_16x16x32_bf16 a[48:51], a[236:239], v[112:115], a[48:51]
    v_exp_f32 v58, v58
    v_mfma_f32_16x16x32_bf16 a[52:55], a[236:239], v[116:119], a[52:55]
    ds_read_b64_tr_b16 a[250:251], v14 offset:25600
    v_mfma_f32_16x16x32_bf16 a[56:59], a[236:239], v[120:123], a[56:59]
    s_waitcnt lgkmcnt(4)
    v_exp_f32 v59, v59
    v_mfma_f32_16x16x32_bf16 a[60:63], a[236:239], v[124:127], a[60:63]
    v_mfma_f32_16x16x32_bf16 a[64:67], a[240:243], v[112:115], a[64:67]
    s_waitcnt vmcnt(8)
    v_exp_f32 v44, v44
    v_mfma_f32_16x16x32_bf16 a[68:71], a[240:243], v[116:119], a[68:71]
    ds_read_b64_tr_b16 a[252:253], v15 offset:24576
    v_cvt_pk_bf16_f32 v107, v58, v59
    v_mfma_f32_16x16x32_bf16 a[72:75], a[240:243], v[120:123], a[72:75]
    s_waitcnt lgkmcnt(3)
    v_exp_f32 v45, v45
    v_mfma_f32_16x16x32_bf16 a[76:79], a[240:243], v[124:127], a[76:79]
    ds_read_b64_tr_b16 a[254:255], v15 offset:25600
    v_cvt_pk_bf16_f32 v108, v44, v45
    v_mfma_f32_16x16x32_bf16 a[80:83], a[244:247], v[112:115], a[80:83]
    s_barrier
    v_exp_f32 v46, v46
    v_mfma_f32_16x16x32_bf16 a[84:87], a[244:247], v[116:119], a[84:87]
    ds_read_b128 a[192:195], v4 offset:49152
    v_mfma_f32_16x16x32_bf16 a[88:91], a[244:247], v[120:123], a[88:91]
    s_waitcnt lgkmcnt(3)
    v_exp_f32 v47, v47
    v_mfma_f32_16x16x32_bf16 a[92:95], a[244:247], v[124:127], a[92:95]
    v_mfma_f32_16x16x32_bf16 a[96:99], a[248:251], v[112:115], a[96:99]
    v_exp_f32 v60, v60
    v_mfma_f32_16x16x32_bf16 a[100:103], a[248:251], v[116:119], a[100:103]
    ds_read_b128 a[196:199], v5 offset:49152
    v_cvt_pk_bf16_f32 v109, v46, v47
    v_mfma_f32_16x16x32_bf16 a[104:107], a[248:251], v[120:123], a[104:107]
    s_waitcnt lgkmcnt(2)
    v_exp_f32 v61, v61
    v_mfma_f32_16x16x32_bf16 a[108:111], a[248:251], v[124:127], a[108:111]
    ds_read_b128 a[200:203], v6 offset:49152
    v_cvt_pk_bf16_f32 v110, v60, v61
    v_mfma_f32_16x16x32_bf16 a[112:115], a[252:255], v[112:115], a[112:115]
    v_exp_f32 v62, v62
    v_mfma_f32_16x16x32_bf16 a[116:119], a[252:255], v[116:119], a[116:119]
    ds_read_b128 a[204:207], v7 offset:49152
    v_mfma_f32_16x16x32_bf16 a[120:123], a[252:255], v[120:123], a[120:123]
    v_exp_f32 v63, v63
    v_mfma_f32_16x16x32_bf16 a[124:127], a[252:255], v[124:127], a[124:127]
    v_mfma_f32_16x16x32_bf16 v[144:147], v[160:163], v[112:115], v[144:147]
    v_mfma_f32_16x16x32_bf16 v[148:151], v[160:163], v[116:119], v[148:151]
    v_mfma_f32_16x16x32_bf16 v[152:155], v[160:163], v[120:123], v[152:155]
    s_waitcnt lgkmcnt(3)
    v_mfma_f32_16x16x32_bf16 v[156:159], v[160:163], v[124:127], v[156:159]
    v_mfma_f32_16x16x32_bf16 v[32:35], a[192:195], v[164:167], v[128:131]
    v_exp_f32 v64, v64
    v_mfma_f32_16x16x32_bf16 v[36:39], a[192:195], v[180:183], v[132:135]
    ds_read_b128 a[208:211], v4 offset:50176
    v_cvt_pk_bf16_f32 v111, v62, v63
    v_mfma_f32_16x16x32_bf16 v[40:43], a[192:195], v[196:199], v[136:139]
    s_lshl_b32 s40, s42, 4
    v_min_u32 v23, 15, v1
    v_add_u32 v23, s40, v23
    v_lshlrev_b32 v23, 7, v23
    v_add_u32 v23, 98304, v23
    buffer_load_dword v22, v23, s[44:47], 0 offen sc1
    s_waitcnt lgkmcnt(3)
    v_exp_f32 v65, v65
    v_mfma_f32_16x16x32_bf16 v[44:47], a[192:195], v[212:215], v[140:143]
    ds_read_b128 a[212:215], v5 offset:50176
    v_cvt_pk_bf16_f32 v112, v64, v65
    v_mfma_f32_16x16x32_bf16 v[32:35], a[196:199], v[168:171], v[32:35]
    v_exp_f32 v66, v66
    v_mfma_f32_16x16x32_bf16 v[36:39], a[196:199], v[184:187], v[36:39]
    ds_read_b128 a[216:219], v6 offset:50176
    v_mfma_f32_16x16x32_bf16 v[40:43], a[196:199], v[200:203], v[40:43]
    s_waitcnt lgkmcnt(4)
    v_exp_f32 v67, v67
    v_mfma_f32_16x16x32_bf16 v[44:47], a[196:199], v[216:219], v[44:47]
    v_mfma_f32_16x16x32_bf16 v[32:35], a[200:203], v[172:175], v[32:35]
    s_add_u32 m0, s63, 0
    s_mov_b32 s41, 0
    buffer_load_dwordx4 v236, s[16:19], s41 offen lds
    v_exp_f32 v80, v80
    v_mfma_f32_16x16x32_bf16 v[36:39], a[200:203], v[188:191], v[36:39]
    ds_read_b128 a[220:223], v7 offset:50176
    v_cvt_pk_bf16_f32 v113, v66, v67
    v_mfma_f32_16x16x32_bf16 v[40:43], a[200:203], v[204:207], v[40:43]
    s_waitcnt lgkmcnt(4)
    v_exp_f32 v81, v81
    v_mfma_f32_16x16x32_bf16 v[44:47], a[200:203], v[220:223], v[44:47]
    ds_read_b64_tr_b16 a[224:225], v8 offset:32768
    v_cvt_pk_bf16_f32 v114, v80, v81
    v_mfma_f32_16x16x32_bf16 v[32:35], a[204:207], v[176:179], v[32:35]
    v_exp_f32 v82, v82
    v_mfma_f32_16x16x32_bf16 v[36:39], a[204:207], v[192:195], v[36:39]
    ds_read_b64_tr_b16 a[226:227], v8 offset:33792
    v_mfma_f32_16x16x32_bf16 v[40:43], a[204:207], v[208:211], v[40:43]
    s_add_u32 m0, s63, 1024
    s_mov_b32 s41, 0
    buffer_load_dwordx4 v237, s[16:19], s41 offen lds
    s_waitcnt lgkmcnt(5)
    v_exp_f32 v83, v83
    v_mfma_f32_16x16x32_bf16 v[44:47], a[204:207], v[224:227], v[44:47]
    v_mfma_f32_16x16x32_bf16 v[48:51], a[208:211], v[164:167], v[128:131]
    v_exp_f32 v68, v68
    v_mfma_f32_16x16x32_bf16 v[52:55], a[208:211], v[180:183], v[132:135]
    ds_read_b64_tr_b16 a[228:229], v9 offset:32768
    v_cvt_pk_bf16_f32 v115, v82, v83
    v_mfma_f32_16x16x32_bf16 v[56:59], a[208:211], v[196:199], v[136:139]
    s_waitcnt lgkmcnt(5)
    v_exp_f32 v69, v69
    v_mfma_f32_16x16x32_bf16 v[60:63], a[208:211], v[212:215], v[140:143]
    ds_read_b64_tr_b16 a[230:231], v9 offset:33792
    v_cvt_pk_bf16_f32 v116, v68, v69
    v_mfma_f32_16x16x32_bf16 v[48:51], a[212:215], v[168:171], v[48:51]
    s_add_u32 m0, s63, 8192
    s_mov_b32 s41, 114688
    buffer_load_dwordx4 v236, s[16:19], s41 offen lds
    v_exp_f32 v70, v70
    v_mfma_f32_16x16x32_bf16 v[52:55], a[212:215], v[184:187], v[52:55]
    ds_read_b64_tr_b16 a[232:233], v10 offset:32768
    v_mfma_f32_16x16x32_bf16 v[56:59], a[212:215], v[200:203], v[56:59]
    s_waitcnt lgkmcnt(6)
    v_exp_f32 v71, v71
    v_mfma_f32_16x16x32_bf16 v[60:63], a[212:215], v[216:219], v[60:63]
    v_mfma_f32_16x16x32_bf16 v[48:51], a[216:219], v[172:175], v[48:51]
    v_exp_f32 v84, v84
    v_mfma_f32_16x16x32_bf16 v[52:55], a[216:219], v[188:191], v[52:55]
    ds_read_b64_tr_b16 a[234:235], v10 offset:33792
    v_cvt_pk_bf16_f32 v117, v70, v71
    v_mfma_f32_16x16x32_bf16 v[56:59], a[216:219], v[204:207], v[56:59]
    s_add_u32 m0, s63, 9216
    s_mov_b32 s41, 114688
    buffer_load_dwordx4 v237, s[16:19], s41 offen lds
    s_waitcnt lgkmcnt(6)
    v_exp_f32 v85, v85
    v_mfma_f32_16x16x32_bf16 v[60:63], a[216:219], v[220:223], v[60:63]
    ds_read_b64_tr_b16 a[236:237], v11 offset:32768
    v_cvt_pk_bf16_f32 v118, v84, v85
    v_mfma_f32_16x16x32_bf16 v[48:51], a[220:223], v[176:179], v[48:51]
    v_exp_f32 v86, v86
    v_mfma_f32_16x16x32_bf16 v[52:55], a[220:223], v[192:195], v[52:55]
    ds_read_b64_tr_b16 a[238:239], v11 offset:33792
    v_mfma_f32_16x16x32_bf16 v[56:59], a[220:223], v[208:211], v[56:59]
    s_waitcnt lgkmcnt(6)
    v_exp_f32 v87, v87
    v_mfma_f32_16x16x32_bf16 v[60:63], a[220:223], v[224:227], v[60:63]
    v_mfma_f32_16x16x32_bf16 a[0:3], a[224:227], v[96:99], a[0:3]
    s_add_u32 m0, s63, 16384
    s_mov_b32 s41, 229376
    buffer_load_dwordx4 v236, s[16:19], s41 offen lds
    v_exp_f32 v72, v72
    v_mfma_f32_16x16x32_bf16 a[4:7], a[224:227], v[100:103], a[4:7]
    ds_read_b64_tr_b16 a[240:241], v12 offset:32768
    v_cvt_pk_bf16_f32 v119, v86, v87
    v_mfma_f32_16x16x32_bf16 a[8:11], a[224:227], v[104:107], a[8:11]
    s_waitcnt lgkmcnt(5)
    v_exp_f32 v73, v73
    v_mfma_f32_16x16x32_bf16 a[12:15], a[224:227], v[108:111], a[12:15]
    ds_read_b64_tr_b16 a[242:243], v12 offset:33792
    v_cvt_pk_bf16_f32 v120, v72, v73
    v_mfma_f32_16x16x32_bf16 a[16:19], a[228:231], v[96:99], a[16:19]
    v_exp_f32 v74, v74
    v_mfma_f32_16x16x32_bf16 a[20:23], a[228:231], v[100:103], a[20:23]
    ds_read_b64_tr_b16 a[244:245], v13 offset:32768
    v_mfma_f32_16x16x32_bf16 a[24:27], a[228:231], v[104:107], a[24:27]
    s_add_u32 m0, s63, 17408
    s_mov_b32 s41, 229376
    buffer_load_dwordx4 v237, s[16:19], s41 offen lds
    s_waitcnt lgkmcnt(5)
    v_exp_f32 v75, v75
    v_mfma_f32_16x16x32_bf16 a[28:31], a[228:231], v[108:111], a[28:31]
    v_mfma_f32_16x16x32_bf16 a[32:35], a[232:235], v[96:99], a[32:35]
    v_exp_f32 v88, v88
    v_mfma_f32_16x16x32_bf16 a[36:39], a[232:235], v[100:103], a[36:39]
    ds_read_b64_tr_b16 a[246:247], v13 offset:33792
    v_cvt_pk_bf16_f32 v121, v74, v75
    v_mfma_f32_16x16x32_bf16 a[40:43], a[232:235], v[104:107], a[40:43]
    s_waitcnt lgkmcnt(4)
    v_exp_f32 v89, v89
    v_mfma_f32_16x16x32_bf16 a[44:47], a[232:235], v[108:111], a[44:47]
    ds_read_b64_tr_b16 a[248:249], v14 offset:32768
    v_cvt_pk_bf16_f32 v122, v88, v89
    v_mfma_f32_16x16x32_bf16 a[48:51], a[236:239], v[96:99], a[48:51]
    s_add_u32 m0, s63, 24576
    s_mov_b32 s41, 344064
    buffer_load_dwordx4 v236, s[16:19], s41 offen lds
    v_exp_f32 v90, v90
    v_mfma_f32_16x16x32_bf16 a[52:55], a[236:239], v[100:103], a[52:55]
    ds_read_b64_tr_b16 a[250:251], v14 offset:33792
    v_mfma_f32_16x16x32_bf16 a[56:59], a[236:239], v[104:107], a[56:59]
    s_waitcnt lgkmcnt(4)
    v_exp_f32 v91, v91
    v_mfma_f32_16x16x32_bf16 a[60:63], a[236:239], v[108:111], a[60:63]
    v_mfma_f32_16x16x32_bf16 a[64:67], a[240:243], v[96:99], a[64:67]
    v_exp_f32 v76, v76
    v_mfma_f32_16x16x32_bf16 a[68:71], a[240:243], v[100:103], a[68:71]
    ds_read_b64_tr_b16 a[252:253], v15 offset:32768
    v_cvt_pk_bf16_f32 v123, v90, v91
    v_mfma_f32_16x16x32_bf16 a[72:75], a[240:243], v[104:107], a[72:75]
    s_add_u32 m0, s63, 25600
    s_mov_b32 s41, 344064
    buffer_load_dwordx4 v237, s[16:19], s41 offen lds
    s_waitcnt lgkmcnt(3)
    v_exp_f32 v77, v77
    v_mfma_f32_16x16x32_bf16 a[76:79], a[240:243], v[108:111], a[76:79]
    ds_read_b64_tr_b16 a[254:255], v15 offset:33792
    v_cvt_pk_bf16_f32 v124, v76, v77
    v_mfma_f32_16x16x32_bf16 a[80:83], a[244:247], v[96:99], a[80:83]
    v_exp_f32 v78, v78
    v_mfma_f32_16x16x32_bf16 a[84:87], a[244:247], v[100:103], a[84:87]
    ds_read_b128 a[192:195], v4 offset:57344
    v_mfma_f32_16x16x32_bf16 a[88:91], a[244:247], v[104:107], a[88:91]
    s_waitcnt lgkmcnt(3)
    v_exp_f32 v79, v79
    v_mfma_f32_16x16x32_bf16 a[92:95], a[244:247], v[108:111], a[92:95]
    v_mfma_f32_16x16x32_bf16 a[96:99], a[248:251], v[96:99], a[96:99]
    v_exp_f32 v92, v92
    v_mfma_f32_16x16x32_bf16 a[100:103], a[248:251], v[100:103], a[100:103]
    ds_read_b128 a[196:199], v5 offset:57344
    v_cvt_pk_bf16_f32 v125, v78, v79
    v_mfma_f32_16x16x32_bf16 a[104:107], a[248:251], v[104:107], a[104:107]
    s_waitcnt lgkmcnt(2)
    v_exp_f32 v93, v93
    v_mfma_f32_16x16x32_bf16 a[108:111], a[248:251], v[108:111], a[108:111]
    ds_read_b128 a[200:203], v6 offset:57344
    v_cvt_pk_bf16_f32 v126, v92, v93
    v_mfma_f32_16x16x32_bf16 a[112:115], a[252:255], v[96:99], a[112:115]
    v_exp_f32 v94, v94
    v_mfma_f32_16x16x32_bf16 a[116:119], a[252:255], v[100:103], a[116:119]
    ds_read_b128 a[204:207], v7 offset:57344
    v_mfma_f32_16x16x32_bf16 a[120:123], a[252:255], v[104:107], a[120:123]
    v_exp_f32 v95, v95
    v_mfma_f32_16x16x32_bf16 a[124:127], a[252:255], v[108:111], a[124:127]
    v_mfma_f32_16x16x32_bf16 v[144:147], v[160:163], v[96:99], v[144:147]
    v_mfma_f32_16x16x32_bf16 v[148:151], v[160:163], v[100:103], v[148:151]
    v_mfma_f32_16x16x32_bf16 v[152:155], v[160:163], v[104:107], v[152:155]
    s_waitcnt lgkmcnt(3)
    v_mfma_f32_16x16x32_bf16 v[156:159], v[160:163], v[108:111], v[156:159]
    v_mfma_f32_16x16x32_bf16 v[64:67], a[192:195], v[164:167], v[128:131]
    v_exp_f32 v32, v32
    v_mfma_f32_16x16x32_bf16 v[68:71], a[192:195], v[180:183], v[132:135]
    ds_read_b128 a[208:211], v4 offset:58368
    v_cvt_pk_bf16_f32 v127, v94, v95
    v_mfma_f32_16x16x32_bf16 v[72:75], a[192:195], v[196:199], v[136:139]
    s_waitcnt lgkmcnt(3)
    v_exp_f32 v33, v33
    v_mfma_f32_16x16x32_bf16 v[76:79], a[192:195], v[212:215], v[140:143]
    ds_read_b128 a[212:215], v5 offset:58368
    v_cvt_pk_bf16_f32 v96, v32, v33
    v_mfma_f32_16x16x32_bf16 v[64:67], a[196:199], v[168:171], v[64:67]
    v_exp_f32 v34, v34
    v_mfma_f32_16x16x32_bf16 v[68:71], a[196:199], v[184:187], v[68:71]
    ds_read_b128 a[216:219], v6 offset:58368
    v_mfma_f32_16x16x32_bf16 v[72:75], a[196:199], v[200:203], v[72:75]
    s_waitcnt lgkmcnt(4)
    v_exp_f32 v35, v35
    v_mfma_f32_16x16x32_bf16 v[76:79], a[196:199], v[216:219], v[76:79]
    v_mfma_f32_16x16x32_bf16 v[64:67], a[200:203], v[172:175], v[64:67]
    v_exp_f32 v48, v48
    v_mfma_f32_16x16x32_bf16 v[68:71], a[200:203], v[188:191], v[68:71]
    ds_read_b128 a[220:223], v7 offset:58368
    v_cvt_pk_bf16_f32 v97, v34, v35
    v_mfma_f32_16x16x32_bf16 v[72:75], a[200:203], v[204:207], v[72:75]
    s_waitcnt lgkmcnt(4)
    v_exp_f32 v49, v49
    v_mfma_f32_16x16x32_bf16 v[76:79], a[200:203], v[220:223], v[76:79]
    ds_read_b64_tr_b16 a[224:225], v8 offset:40960
    v_cvt_pk_bf16_f32 v98, v48, v49
    v_mfma_f32_16x16x32_bf16 v[64:67], a[204:207], v[176:179], v[64:67]
    v_exp_f32 v50, v50
    v_mfma_f32_16x16x32_bf16 v[68:71], a[204:207], v[192:195], v[68:71]
    ds_read_b64_tr_b16 a[226:227], v8 offset:41984
    v_mfma_f32_16x16x32_bf16 v[72:75], a[204:207], v[208:211], v[72:75]
    s_waitcnt lgkmcnt(5)
    v_exp_f32 v51, v51
    v_mfma_f32_16x16x32_bf16 v[76:79], a[204:207], v[224:227], v[76:79]
    v_mfma_f32_16x16x32_bf16 v[80:83], a[208:211], v[164:167], v[128:131]
    v_exp_f32 v36, v36
    v_mfma_f32_16x16x32_bf16 v[84:87], a[208:211], v[180:183], v[132:135]
    ds_read_b64_tr_b16 a[228:229], v9 offset:40960
    v_cvt_pk_bf16_f32 v99, v50, v51
    v_mfma_f32_16x16x32_bf16 v[88:91], a[208:211], v[196:199], v[136:139]
    s_waitcnt lgkmcnt(5)
    v_exp_f32 v37, v37
    v_mfma_f32_16x16x32_bf16 v[92:95], a[208:211], v[212:215], v[140:143]
    ds_read_b64_tr_b16 a[230:231], v9 offset:41984
    v_cvt_pk_bf16_f32 v100, v36, v37
    v_mfma_f32_16x16x32_bf16 v[80:83], a[212:215], v[168:171], v[80:83]
    v_exp_f32 v38, v38
    v_mfma_f32_16x16x32_bf16 v[84:87], a[212:215], v[184:187], v[84:87]
    ds_read_b64_tr_b16 a[232:233], v10 offset:40960
    v_mfma_f32_16x16x32_bf16 v[88:91], a[212:215], v[200:203], v[88:91]
    s_waitcnt lgkmcnt(6)
    v_exp_f32 v39, v39
    v_mfma_f32_16x16x32_bf16 v[92:95], a[212:215], v[216:219], v[92:95]
    v_mfma_f32_16x16x32_bf16 v[80:83], a[216:219], v[172:175], v[80:83]
    v_exp_f32 v52, v52
    v_mfma_f32_16x16x32_bf16 v[84:87], a[216:219], v[188:191], v[84:87]
    ds_read_b64_tr_b16 a[234:235], v10 offset:41984
    v_cvt_pk_bf16_f32 v101, v38, v39
    v_mfma_f32_16x16x32_bf16 v[88:91], a[216:219], v[204:207], v[88:91]
    s_waitcnt lgkmcnt(6)
    v_exp_f32 v53, v53
    v_mfma_f32_16x16x32_bf16 v[92:95], a[216:219], v[220:223], v[92:95]
    ds_read_b64_tr_b16 a[236:237], v11 offset:40960
    v_cvt_pk_bf16_f32 v102, v52, v53
    v_mfma_f32_16x16x32_bf16 v[80:83], a[220:223], v[176:179], v[80:83]
    v_exp_f32 v54, v54
    v_mfma_f32_16x16x32_bf16 v[84:87], a[220:223], v[192:195], v[84:87]
    ds_read_b64_tr_b16 a[238:239], v11 offset:41984
    v_mfma_f32_16x16x32_bf16 v[88:91], a[220:223], v[208:211], v[88:91]
    s_waitcnt lgkmcnt(6)
    v_exp_f32 v55, v55
    v_mfma_f32_16x16x32_bf16 v[92:95], a[220:223], v[224:227], v[92:95]
    v_mfma_f32_16x16x32_bf16 a[0:3], a[224:227], v[112:115], a[0:3]
    v_exp_f32 v40, v40
    v_mfma_f32_16x16x32_bf16 a[4:7], a[224:227], v[116:119], a[4:7]
    ds_read_b64_tr_b16 a[240:241], v12 offset:40960
    v_cvt_pk_bf16_f32 v103, v54, v55
    v_mfma_f32_16x16x32_bf16 a[8:11], a[224:227], v[120:123], a[8:11]
    s_waitcnt lgkmcnt(5)
    v_exp_f32 v41, v41
    v_mfma_f32_16x16x32_bf16 a[12:15], a[224:227], v[124:127], a[12:15]
    ds_read_b64_tr_b16 a[242:243], v12 offset:41984
    v_cvt_pk_bf16_f32 v104, v40, v41
    v_mfma_f32_16x16x32_bf16 a[16:19], a[228:231], v[112:115], a[16:19]
    v_exp_f32 v42, v42
    v_mfma_f32_16x16x32_bf16 a[20:23], a[228:231], v[116:119], a[20:23]
    ds_read_b64_tr_b16 a[244:245], v13 offset:40960
    v_mfma_f32_16x16x32_bf16 a[24:27], a[228:231], v[120:123], a[24:27]
    s_waitcnt lgkmcnt(5)
    v_exp_f32 v43, v43
    v_mfma_f32_16x16x32_bf16 a[28:31], a[228:231], v[124:127], a[28:31]
    v_mfma_f32_16x16x32_bf16 a[32:35], a[232:235], v[112:115], a[32:35]
    v_exp_f32 v56, v56
    v_mfma_f32_16x16x32_bf16 a[36:39], a[232:235], v[116:119], a[36:39]
    ds_read_b64_tr_b16 a[246:247], v13 offset:41984
    v_cvt_pk_bf16_f32 v105, v42, v43
    v_mfma_f32_16x16x32_bf16 a[40:43], a[232:235], v[120:123], a[40:43]
    s_waitcnt lgkmcnt(4)
    v_exp_f32 v57, v57
    v_mfma_f32_16x16x32_bf16 a[44:47], a[232:235], v[124:127], a[44:47]
    ds_read_b64_tr_b16 a[248:249], v14 offset:40960
    v_cvt_pk_bf16_f32 v106, v56, v57
    v_mfma_f32_16x16x32_bf16 a[48:51], a[236:239], v[112:115], a[48:51]
    v_exp_f32 v58, v58
    v_mfma_f32_16x16x32_bf16 a[52:55], a[236:239], v[116:119], a[52:55]
    ds_read_b64_tr_b16 a[250:251], v14 offset:41984
    v_mfma_f32_16x16x32_bf16 a[56:59], a[236:239], v[120:123], a[56:59]
    s_waitcnt lgkmcnt(4)
    v_exp_f32 v59, v59
    v_mfma_f32_16x16x32_bf16 a[60:63], a[236:239], v[124:127], a[60:63]
    v_mfma_f32_16x16x32_bf16 a[64:67], a[240:243], v[112:115], a[64:67]
    s_waitcnt vmcnt(0)
    v_exp_f32 v44, v44
    v_mfma_f32_16x16x32_bf16 a[68:71], a[240:243], v[116:119], a[68:71]
    ds_read_b64_tr_b16 a[252:253], v15 offset:40960
    v_cvt_pk_bf16_f32 v107, v58, v59
    v_mfma_f32_16x16x32_bf16 a[72:75], a[240:243], v[120:123], a[72:75]
    s_waitcnt lgkmcnt(3)
    v_exp_f32 v45, v45
    v_mfma_f32_16x16x32_bf16 a[76:79], a[240:243], v[124:127], a[76:79]
    ds_read_b64_tr_b16 a[254:255], v15 offset:41984
    v_cvt_pk_bf16_f32 v108, v44, v45
    v_mfma_f32_16x16x32_bf16 a[80:83], a[244:247], v[112:115], a[80:83]
    s_barrier
    v_exp_f32 v46, v46
    v_mfma_f32_16x16x32_bf16 a[84:87], a[244:247], v[116:119], a[84:87]
    v_mfma_f32_16x16x32_bf16 a[88:91], a[244:247], v[120:123], a[88:91]
    s_waitcnt lgkmcnt(2)
    v_exp_f32 v47, v47
    v_mfma_f32_16x16x32_bf16 a[92:95], a[244:247], v[124:127], a[92:95]
    v_mfma_f32_16x16x32_bf16 a[96:99], a[248:251], v[112:115], a[96:99]
    v_exp_f32 v60, v60
    v_mfma_f32_16x16x32_bf16 a[100:103], a[248:251], v[116:119], a[100:103]
    v_cvt_pk_bf16_f32 v109, v46, v47
    v_mfma_f32_16x16x32_bf16 a[104:107], a[248:251], v[120:123], a[104:107]
    s_waitcnt lgkmcnt(0)
    v_exp_f32 v61, v61
    v_mfma_f32_16x16x32_bf16 a[108:111], a[248:251], v[124:127], a[108:111]
    v_cvt_pk_bf16_f32 v110, v60, v61
    v_mfma_f32_16x16x32_bf16 a[112:115], a[252:255], v[112:115], a[112:115]
    v_exp_f32 v62, v62
    v_mfma_f32_16x16x32_bf16 a[116:119], a[252:255], v[116:119], a[116:119]
    v_mfma_f32_16x16x32_bf16 a[120:123], a[252:255], v[120:123], a[120:123]
    v_exp_f32 v63, v63
    v_mfma_f32_16x16x32_bf16 a[124:127], a[252:255], v[124:127], a[124:127]
    v_mfma_f32_16x16x32_bf16 v[144:147], v[160:163], v[112:115], v[144:147]
    v_mfma_f32_16x16x32_bf16 v[148:151], v[160:163], v[116:119], v[148:151]
    v_mfma_f32_16x16x32_bf16 v[152:155], v[160:163], v[120:123], v[152:155]
    v_mfma_f32_16x16x32_bf16 v[156:159], v[160:163], v[124:127], v[156:159]
    s_cmp_lg_u32 s3, 0
    s_cbranch_scc1 L_pub_fw
    s_lshl_b32 s60, s2, 7
    s_add_u32 s60, s60, 65536
    v_mov_b32 v30, s60
    v_mov_b32 v31, s36
    s_mov_b64 exec, 1
    buffer_store_dword v31, v30, s[44:47], 0 offen sc1
    s_mov_b64 exec, -1
L_pub_fw:
    v_exp_f32 v64, v64
    v_cvt_pk_bf16_f32 v111, v62, v63
    v_exp_f32 v65, v65
    s_nop 0
    v_cvt_pk_bf16_f32 v112, v64, v65
    v_exp_f32 v66, v66
    v_exp_f32 v67, v67
    v_exp_f32 v80, v80
    v_cvt_pk_bf16_f32 v113, v66, v67
    v_exp_f32 v81, v81
    ds_read_b64_tr_b16 a[224:225], v8 offset:49152
    v_cvt_pk_bf16_f32 v114, v80, v81
    v_exp_f32 v82, v82
    ds_read_b64_tr_b16 a[226:227], v8 offset:50176
    v_exp_f32 v83, v83
    v_exp_f32 v68, v68
    ds_read_b64_tr_b16 a[228:229], v9 offset:49152
    v_cvt_pk_bf16_f32 v115, v82, v83
    v_exp_f32 v69, v69
    ds_read_b64_tr_b16 a[230:231], v9 offset:50176
    v_cvt_pk_bf16_f32 v116, v68, v69
    v_exp_f32 v70, v70
    ds_read_b64_tr_b16 a[232:233], v10 offset:49152
    v_exp_f32 v71, v71
    v_exp_f32 v84, v84
    ds_read_b64_tr_b16 a[234:235], v10 offset:50176
    v_cvt_pk_bf16_f32 v117, v70, v71
    v_exp_f32 v85, v85
    ds_read_b64_tr_b16 a[236:237], v11 offset:49152
    v_cvt_pk_bf16_f32 v118, v84, v85
    v_exp_f32 v86, v86
    ds_read_b64_tr_b16 a[238:239], v11 offset:50176
    s_waitcnt lgkmcnt(6)
    v_exp_f32 v87, v87
    v_mfma_f32_16x16x32_bf16 a[0:3], a[224:227], v[96:99], a[0:3]
    v_exp_f32 v72, v72
    v_mfma_f32_16x16x32_bf16 a[4:7], a[224:227], v[100:103], a[4:7]
    ds_read_b64_tr_b16 a[240:241], v12 offset:49152
    v_cvt_pk_bf16_f32 v119, v86, v87
    v_mfma_f32_16x16x32_bf16 a[8:11], a[224:227], v[104:107], a[8:11]
    s_waitcnt lgkmcnt(5)
    v_exp_f32 v73, v73
    v_mfma_f32_16x16x32_bf16 a[12:15], a[224:227], v[108:111], a[12:15]
    ds_read_b64_tr_b16 a[242:243], v12 offset:50176
    v_cvt_pk_bf16_f32 v120, v72, v73
    v_mfma_f32_16x16x32_bf16 a[16:19], a[228:231], v[96:99], a[16:19]
    v_exp_f32 v74, v74
    v_mfma_f32_16x16x32_bf16 a[20:23], a[228:231], v[100:103], a[20:23]
    ds_read_b64_tr_b16 a[244:245], v13 offset:49152
    v_mfma_f32_16x16x32_bf16 a[24:27], a[228:231], v[104:107], a[24:27]
    s_waitcnt lgkmcnt(5)
    v_exp_f32 v75, v75
    v_mfma_f32_16x16x32_bf16 a[28:31], a[228:231], v[108:111], a[28:31]
    v_mfma_f32_16x16x32_bf16 a[32:35], a[232:235], v[96:99], a[32:35]
    v_exp_f32 v88, v88
    v_mfma_f32_16x16x32_bf16 a[36:39], a[232:235], v[100:103], a[36:39]
    ds_read_b64_tr_b16 a[246:247], v13 offset:50176
    v_cvt_pk_bf16_f32 v121, v74, v75
    v_mfma_f32_16x16x32_bf16 a[40:43], a[232:235], v[104:107], a[40:43]
    s_waitcnt lgkmcnt(4)
    v_exp_f32 v89, v89
    v_mfma_f32_16x16x32_bf16 a[44:47], a[232:235], v[108:111], a[44:47]
    ds_read_b64_tr_b16 a[248:249], v14 offset:49152
    v_cvt_pk_bf16_f32 v122, v88, v89
    v_mfma_f32_16x16x32_bf16 a[48:51], a[236:239], v[96:99], a[48:51]
    v_exp_f32 v90, v90
    v_mfma_f32_16x16x32_bf16 a[52:55], a[236:239], v[100:103], a[52:55]
    ds_read_b64_tr_b16 a[250:251], v14 offset:50176
    v_mfma_f32_16x16x32_bf16 a[56:59], a[236:239], v[104:107], a[56:59]
    s_waitcnt lgkmcnt(4)
    v_exp_f32 v91, v91
    v_mfma_f32_16x16x32_bf16 a[60:63], a[236:239], v[108:111], a[60:63]
    v_mfma_f32_16x16x32_bf16 a[64:67], a[240:243], v[96:99], a[64:67]
    v_exp_f32 v76, v76
    v_mfma_f32_16x16x32_bf16 a[68:71], a[240:243], v[100:103], a[68:71]
    ds_read_b64_tr_b16 a[252:253], v15 offset:49152
    v_cvt_pk_bf16_f32 v123, v90, v91
    v_mfma_f32_16x16x32_bf16 a[72:75], a[240:243], v[104:107], a[72:75]
    s_waitcnt lgkmcnt(3)
    v_exp_f32 v77, v77
    v_mfma_f32_16x16x32_bf16 a[76:79], a[240:243], v[108:111], a[76:79]
    ds_read_b64_tr_b16 a[254:255], v15 offset:50176
    v_cvt_pk_bf16_f32 v124, v76, v77
    v_mfma_f32_16x16x32_bf16 a[80:83], a[244:247], v[96:99], a[80:83]
    v_exp_f32 v78, v78
    v_mfma_f32_16x16x32_bf16 a[84:87], a[244:247], v[100:103], a[84:87]
    v_mfma_f32_16x16x32_bf16 a[88:91], a[244:247], v[104:107], a[88:91]
    s_waitcnt lgkmcnt(2)
    v_exp_f32 v79, v79
    v_mfma_f32_16x16x32_bf16 a[92:95], a[244:247], v[108:111], a[92:95]
    v_mfma_f32_16x16x32_bf16 a[96:99], a[248:251], v[96:99], a[96:99]
    v_exp_f32 v92, v92
    v_mfma_f32_16x16x32_bf16 a[100:103], a[248:251], v[100:103], a[100:103]
    v_cvt_pk_bf16_f32 v125, v78, v79
    v_mfma_f32_16x16x32_bf16 a[104:107], a[248:251], v[104:107], a[104:107]
    s_waitcnt lgkmcnt(0)
    v_exp_f32 v93, v93
    v_mfma_f32_16x16x32_bf16 a[108:111], a[248:251], v[108:111], a[108:111]
    v_cvt_pk_bf16_f32 v126, v92, v93
    v_mfma_f32_16x16x32_bf16 a[112:115], a[252:255], v[96:99], a[112:115]
    v_exp_f32 v94, v94
    v_mfma_f32_16x16x32_bf16 a[116:119], a[252:255], v[100:103], a[116:119]
    v_mfma_f32_16x16x32_bf16 a[120:123], a[252:255], v[104:107], a[120:123]
    v_exp_f32 v95, v95
    v_mfma_f32_16x16x32_bf16 a[124:127], a[252:255], v[108:111], a[124:127]
    v_mfma_f32_16x16x32_bf16 v[144:147], v[160:163], v[96:99], v[144:147]
    v_mfma_f32_16x16x32_bf16 v[148:151], v[160:163], v[100:103], v[148:151]
    v_cvt_pk_bf16_f32 v127, v94, v95
    v_mfma_f32_16x16x32_bf16 v[152:155], v[160:163], v[104:107], v[152:155]
    v_mfma_f32_16x16x32_bf16 v[156:159], v[160:163], v[108:111], v[156:159]
    ds_read_b64_tr_b16 a[224:225], v8 offset:57344
    ds_read_b64_tr_b16 a[226:227], v8 offset:58368
    ds_read_b64_tr_b16 a[228:229], v9 offset:57344
    ds_read_b64_tr_b16 a[230:231], v9 offset:58368
    ds_read_b64_tr_b16 a[232:233], v10 offset:57344
    ds_read_b64_tr_b16 a[234:235], v10 offset:58368
    ds_read_b64_tr_b16 a[236:237], v11 offset:57344
    ds_read_b64_tr_b16 a[238:239], v11 offset:58368
    s_waitcnt lgkmcnt(6)
    v_mfma_f32_16x16x32_bf16 a[0:3], a[224:227], v[112:115], a[0:3]
    v_mfma_f32_16x16x32_bf16 a[4:7], a[224:227], v[116:119], a[4:7]
    ds_read_b64_tr_b16 a[240:241], v12 offset:57344
    v_mfma_f32_16x16x32_bf16 a[8:11], a[224:227], v[120:123], a[8:11]
    s_waitcnt lgkmcnt(5)
    v_mfma_f32_16x16x32_bf16 a[12:15], a[224:227], v[124:127], a[12:15]
    ds_read_b64_tr_b16 a[242:243], v12 offset:58368
    v_mfma_f32_16x16x32_bf16 a[16:19], a[228:231], v[112:115], a[16:19]
    v_mfma_f32_16x16x32_bf16 a[20:23], a[228:231], v[116:119], a[20:23]
    ds_read_b64_tr_b16 a[244:245], v13 offset:57344
    v_mfma_f32_16x16x32_bf16 a[24:27], a[228:231], v[120:123], a[24:27]
    s_waitcnt lgkmcnt(5)
    v_mfma_f32_16x16x32_bf16 a[28:31], a[228:231], v[124:127], a[28:31]
    v_mfma_f32_16x16x32_bf16 a[32:35], a[232:235], v[112:115], a[32:35]
    v_mfma_f32_16x16x32_bf16 a[36:39], a[232:235], v[116:119], a[36:39]
    ds_read_b64_tr_b16 a[246:247], v13 offset:58368
    v_mfma_f32_16x16x32_bf16 a[40:43], a[232:235], v[120:123], a[40:43]
    s_waitcnt lgkmcnt(4)
    v_mfma_f32_16x16x32_bf16 a[44:47], a[232:235], v[124:127], a[44:47]
    ds_read_b64_tr_b16 a[248:249], v14 offset:57344
    v_mfma_f32_16x16x32_bf16 a[48:51], a[236:239], v[112:115], a[48:51]
    v_mfma_f32_16x16x32_bf16 a[52:55], a[236:239], v[116:119], a[52:55]
    ds_read_b64_tr_b16 a[250:251], v14 offset:58368
    v_mfma_f32_16x16x32_bf16 a[56:59], a[236:239], v[120:123], a[56:59]
    s_waitcnt lgkmcnt(4)
    v_mfma_f32_16x16x32_bf16 a[60:63], a[236:239], v[124:127], a[60:63]
    v_mfma_f32_16x16x32_bf16 a[64:67], a[240:243], v[112:115], a[64:67]
    v_mfma_f32_16x16x32_bf16 a[68:71], a[240:243], v[116:119], a[68:71]
    ds_read_b64_tr_b16 a[252:253], v15 offset:57344
    v_mfma_f32_16x16x32_bf16 a[72:75], a[240:243], v[120:123], a[72:75]
    s_waitcnt lgkmcnt(3)
    v_mfma_f32_16x16x32_bf16 a[76:79], a[240:243], v[124:127], a[76:79]
    ds_read_b64_tr_b16 a[254:255], v15 offset:58368
    v_mfma_f32_16x16x32_bf16 a[80:83], a[244:247], v[112:115], a[80:83]
    v_mfma_f32_16x16x32_bf16 a[84:87], a[244:247], v[116:119], a[84:87]
    v_mfma_f32_16x16x32_bf16 a[88:91], a[244:247], v[120:123], a[88:91]
    s_waitcnt lgkmcnt(2)
    v_mfma_f32_16x16x32_bf16 a[92:95], a[244:247], v[124:127], a[92:95]
    v_mfma_f32_16x16x32_bf16 a[96:99], a[248:251], v[112:115], a[96:99]
    v_mfma_f32_16x16x32_bf16 a[100:103], a[248:251], v[116:119], a[100:103]
    v_mfma_f32_16x16x32_bf16 a[104:107], a[248:251], v[120:123], a[104:107]
    s_waitcnt lgkmcnt(0)
    v_mfma_f32_16x16x32_bf16 a[108:111], a[248:251], v[124:127], a[108:111]
    v_mfma_f32_16x16x32_bf16 a[112:115], a[252:255], v[112:115], a[112:115]
    v_mfma_f32_16x16x32_bf16 a[116:119], a[252:255], v[116:119], a[116:119]
    v_mfma_f32_16x16x32_bf16 a[120:123], a[252:255], v[120:123], a[120:123]
    v_mfma_f32_16x16x32_bf16 a[124:127], a[252:255], v[124:127], a[124:127]
    v_mfma_f32_16x16x32_bf16 v[144:147], v[160:163], v[112:115], v[144:147]
    v_mfma_f32_16x16x32_bf16 v[148:151], v[160:163], v[116:119], v[148:151]
    v_mfma_f32_16x16x32_bf16 v[152:155], v[160:163], v[120:123], v[152:155]
    v_mfma_f32_16x16x32_bf16 v[156:159], v[160:163], v[124:127], v[156:159]
    s_mov_b32 s32, 0
recurrent_scan__mha_block_cached__mixer_s_mlp__prompt_kernel_store:
    s_nop 7
    v_rcp_f32 v232, v144
    v_rcp_f32 v233, v148
    v_rcp_f32 v234, v152
    v_rcp_f32 v235, v156
    v_mov_b32 v238, v19
    s_lshl_b32 s40, s39, 4
    s_lshl_b32 s41, s3, 2
    s_add_u32 s40, s40, s41
    s_lshl_b32 s41, s40, 17
    s_lshl_b32 s40, s38, 12
    s_add_u32 s41, s41, s40
    s_add_u32 s24, s34, 0x1000000
    s_addc_u32 s25, s35, 0
    s_add_u32 s24, s24, s41
    s_addc_u32 s25, s25, 0
    s_mov_b32 s26, 0x80000
    s_mov_b32 s27, 0x20000
    v_accvgpr_read_b32 v240, a0
    v_accvgpr_read_b32 v241, a1
    v_accvgpr_read_b32 v242, a2
    v_accvgpr_read_b32 v243, a3
    v_accvgpr_read_b32 v244, a16
    v_accvgpr_read_b32 v245, a17
    v_accvgpr_read_b32 v246, a18
    v_accvgpr_read_b32 v247, a19
    v_pk_mul_f32 v[240:241], v[232:233], v[240:241] op_sel:[0,0] op_sel_hi:[0,1]
    v_pk_mul_f32 v[242:243], v[232:233], v[242:243] op_sel:[0,0] op_sel_hi:[0,1]
    v_pk_mul_f32 v[244:245], v[232:233], v[244:245] op_sel:[0,0] op_sel_hi:[0,1]
    v_pk_mul_f32 v[246:247], v[232:233], v[246:247] op_sel:[0,0] op_sel_hi:[0,1]
    v_cvt_pk_bf16_f32 v240, v240, v241
    v_cvt_pk_bf16_f32 v241, v242, v243
    v_cvt_pk_bf16_f32 v242, v244, v245
    v_cvt_pk_bf16_f32 v243, v246, v247
    s_mov_b32 s33, 0
    buffer_store_dwordx4 v[240:243], v238, s[24:27], s33 offen sc1
    v_accvgpr_read_b32 v248, a32
    v_accvgpr_read_b32 v249, a33
    v_accvgpr_read_b32 v250, a34
    v_accvgpr_read_b32 v251, a35
    v_accvgpr_read_b32 v252, a48
    v_accvgpr_read_b32 v253, a49
    v_accvgpr_read_b32 v254, a50
    v_accvgpr_read_b32 v255, a51
    v_pk_mul_f32 v[248:249], v[232:233], v[248:249] op_sel:[0,0] op_sel_hi:[0,1]
    v_pk_mul_f32 v[250:251], v[232:233], v[250:251] op_sel:[0,0] op_sel_hi:[0,1]
    v_pk_mul_f32 v[252:253], v[232:233], v[252:253] op_sel:[0,0] op_sel_hi:[0,1]
    v_pk_mul_f32 v[254:255], v[232:233], v[254:255] op_sel:[0,0] op_sel_hi:[0,1]
    v_cvt_pk_bf16_f32 v248, v248, v249
    v_cvt_pk_bf16_f32 v249, v250, v251
    v_cvt_pk_bf16_f32 v250, v252, v253
    v_cvt_pk_bf16_f32 v251, v254, v255
    s_mov_b32 s33, 1024
    buffer_store_dwordx4 v[248:251], v238, s[24:27], s33 offen sc1
    v_accvgpr_read_b32 v240, a64
    v_accvgpr_read_b32 v241, a65
    v_accvgpr_read_b32 v242, a66
    v_accvgpr_read_b32 v243, a67
    v_accvgpr_read_b32 v244, a80
    v_accvgpr_read_b32 v245, a81
    v_accvgpr_read_b32 v246, a82
    v_accvgpr_read_b32 v247, a83
    v_pk_mul_f32 v[240:241], v[232:233], v[240:241] op_sel:[0,0] op_sel_hi:[0,1]
    v_pk_mul_f32 v[242:243], v[232:233], v[242:243] op_sel:[0,0] op_sel_hi:[0,1]
    v_pk_mul_f32 v[244:245], v[232:233], v[244:245] op_sel:[0,0] op_sel_hi:[0,1]
    v_pk_mul_f32 v[246:247], v[232:233], v[246:247] op_sel:[0,0] op_sel_hi:[0,1]
    v_cvt_pk_bf16_f32 v240, v240, v241
    v_cvt_pk_bf16_f32 v241, v242, v243
    v_cvt_pk_bf16_f32 v242, v244, v245
    v_cvt_pk_bf16_f32 v243, v246, v247
    s_mov_b32 s33, 2048
    buffer_store_dwordx4 v[240:243], v238, s[24:27], s33 offen sc1
    v_accvgpr_read_b32 v248, a96
    v_accvgpr_read_b32 v249, a97
    v_accvgpr_read_b32 v250, a98
    v_accvgpr_read_b32 v251, a99
    v_accvgpr_read_b32 v252, a112
    v_accvgpr_read_b32 v253, a113
    v_accvgpr_read_b32 v254, a114
    v_accvgpr_read_b32 v255, a115
    v_pk_mul_f32 v[248:249], v[232:233], v[248:249] op_sel:[0,0] op_sel_hi:[0,1]
    v_pk_mul_f32 v[250:251], v[232:233], v[250:251] op_sel:[0,0] op_sel_hi:[0,1]
    v_pk_mul_f32 v[252:253], v[232:233], v[252:253] op_sel:[0,0] op_sel_hi:[0,1]
    v_pk_mul_f32 v[254:255], v[232:233], v[254:255] op_sel:[0,0] op_sel_hi:[0,1]
    v_cvt_pk_bf16_f32 v248, v248, v249
    v_cvt_pk_bf16_f32 v249, v250, v251
    v_cvt_pk_bf16_f32 v250, v252, v253
    v_cvt_pk_bf16_f32 v251, v254, v255
    s_mov_b32 s33, 3072
    buffer_store_dwordx4 v[248:251], v238, s[24:27], s33 offen sc1
    v_accvgpr_read_b32 v240, a4
    v_accvgpr_read_b32 v241, a5
    v_accvgpr_read_b32 v242, a6
    v_accvgpr_read_b32 v243, a7
    v_accvgpr_read_b32 v244, a20
    v_accvgpr_read_b32 v245, a21
    v_accvgpr_read_b32 v246, a22
    v_accvgpr_read_b32 v247, a23
    v_pk_mul_f32 v[240:241], v[232:233], v[240:241] op_sel:[1,0] op_sel_hi:[1,1]
    v_pk_mul_f32 v[242:243], v[232:233], v[242:243] op_sel:[1,0] op_sel_hi:[1,1]
    v_pk_mul_f32 v[244:245], v[232:233], v[244:245] op_sel:[1,0] op_sel_hi:[1,1]
    v_pk_mul_f32 v[246:247], v[232:233], v[246:247] op_sel:[1,0] op_sel_hi:[1,1]
    v_cvt_pk_bf16_f32 v240, v240, v241
    v_cvt_pk_bf16_f32 v241, v242, v243
    v_cvt_pk_bf16_f32 v242, v244, v245
    v_cvt_pk_bf16_f32 v243, v246, v247
    s_mov_b32 s33, 131072
    buffer_store_dwordx4 v[240:243], v238, s[24:27], s33 offen sc1
    v_accvgpr_read_b32 v248, a36
    v_accvgpr_read_b32 v249, a37
    v_accvgpr_read_b32 v250, a38
    v_accvgpr_read_b32 v251, a39
    v_accvgpr_read_b32 v252, a52
    v_accvgpr_read_b32 v253, a53
    v_accvgpr_read_b32 v254, a54
    v_accvgpr_read_b32 v255, a55
    v_pk_mul_f32 v[248:249], v[232:233], v[248:249] op_sel:[1,0] op_sel_hi:[1,1]
    v_pk_mul_f32 v[250:251], v[232:233], v[250:251] op_sel:[1,0] op_sel_hi:[1,1]
    v_pk_mul_f32 v[252:253], v[232:233], v[252:253] op_sel:[1,0] op_sel_hi:[1,1]
    v_pk_mul_f32 v[254:255], v[232:233], v[254:255] op_sel:[1,0] op_sel_hi:[1,1]
    v_cvt_pk_bf16_f32 v248, v248, v249
    v_cvt_pk_bf16_f32 v249, v250, v251
    v_cvt_pk_bf16_f32 v250, v252, v253
    v_cvt_pk_bf16_f32 v251, v254, v255
    s_mov_b32 s33, 132096
    buffer_store_dwordx4 v[248:251], v238, s[24:27], s33 offen sc1
    v_accvgpr_read_b32 v240, a68
    v_accvgpr_read_b32 v241, a69
    v_accvgpr_read_b32 v242, a70
    v_accvgpr_read_b32 v243, a71
    v_accvgpr_read_b32 v244, a84
    v_accvgpr_read_b32 v245, a85
    v_accvgpr_read_b32 v246, a86
    v_accvgpr_read_b32 v247, a87
    v_pk_mul_f32 v[240:241], v[232:233], v[240:241] op_sel:[1,0] op_sel_hi:[1,1]
    v_pk_mul_f32 v[242:243], v[232:233], v[242:243] op_sel:[1,0] op_sel_hi:[1,1]
    v_pk_mul_f32 v[244:245], v[232:233], v[244:245] op_sel:[1,0] op_sel_hi:[1,1]
    v_pk_mul_f32 v[246:247], v[232:233], v[246:247] op_sel:[1,0] op_sel_hi:[1,1]
    v_cvt_pk_bf16_f32 v240, v240, v241
    v_cvt_pk_bf16_f32 v241, v242, v243
    v_cvt_pk_bf16_f32 v242, v244, v245
    v_cvt_pk_bf16_f32 v243, v246, v247
    s_mov_b32 s33, 133120
    buffer_store_dwordx4 v[240:243], v238, s[24:27], s33 offen sc1
    v_accvgpr_read_b32 v248, a100
    v_accvgpr_read_b32 v249, a101
    v_accvgpr_read_b32 v250, a102
    v_accvgpr_read_b32 v251, a103
    v_accvgpr_read_b32 v252, a116
    v_accvgpr_read_b32 v253, a117
    v_accvgpr_read_b32 v254, a118
    v_accvgpr_read_b32 v255, a119
    v_pk_mul_f32 v[248:249], v[232:233], v[248:249] op_sel:[1,0] op_sel_hi:[1,1]
    v_pk_mul_f32 v[250:251], v[232:233], v[250:251] op_sel:[1,0] op_sel_hi:[1,1]
    v_pk_mul_f32 v[252:253], v[232:233], v[252:253] op_sel:[1,0] op_sel_hi:[1,1]
    v_pk_mul_f32 v[254:255], v[232:233], v[254:255] op_sel:[1,0] op_sel_hi:[1,1]
    v_cvt_pk_bf16_f32 v248, v248, v249
    v_cvt_pk_bf16_f32 v249, v250, v251
    v_cvt_pk_bf16_f32 v250, v252, v253
    v_cvt_pk_bf16_f32 v251, v254, v255
    s_mov_b32 s33, 134144
    buffer_store_dwordx4 v[248:251], v238, s[24:27], s33 offen sc1
    v_accvgpr_read_b32 v240, a8
    v_accvgpr_read_b32 v241, a9
    v_accvgpr_read_b32 v242, a10
    v_accvgpr_read_b32 v243, a11
    v_accvgpr_read_b32 v244, a24
    v_accvgpr_read_b32 v245, a25
    v_accvgpr_read_b32 v246, a26
    v_accvgpr_read_b32 v247, a27
    v_pk_mul_f32 v[240:241], v[234:235], v[240:241] op_sel:[0,0] op_sel_hi:[0,1]
    v_pk_mul_f32 v[242:243], v[234:235], v[242:243] op_sel:[0,0] op_sel_hi:[0,1]
    v_pk_mul_f32 v[244:245], v[234:235], v[244:245] op_sel:[0,0] op_sel_hi:[0,1]
    v_pk_mul_f32 v[246:247], v[234:235], v[246:247] op_sel:[0,0] op_sel_hi:[0,1]
    v_cvt_pk_bf16_f32 v240, v240, v241
    v_cvt_pk_bf16_f32 v241, v242, v243
    v_cvt_pk_bf16_f32 v242, v244, v245
    v_cvt_pk_bf16_f32 v243, v246, v247
    s_mov_b32 s33, 262144
    buffer_store_dwordx4 v[240:243], v238, s[24:27], s33 offen sc1
    v_accvgpr_read_b32 v248, a40
    v_accvgpr_read_b32 v249, a41
    v_accvgpr_read_b32 v250, a42
    v_accvgpr_read_b32 v251, a43
    v_accvgpr_read_b32 v252, a56
    v_accvgpr_read_b32 v253, a57
    v_accvgpr_read_b32 v254, a58
    v_accvgpr_read_b32 v255, a59
    v_pk_mul_f32 v[248:249], v[234:235], v[248:249] op_sel:[0,0] op_sel_hi:[0,1]
    v_pk_mul_f32 v[250:251], v[234:235], v[250:251] op_sel:[0,0] op_sel_hi:[0,1]
    v_pk_mul_f32 v[252:253], v[234:235], v[252:253] op_sel:[0,0] op_sel_hi:[0,1]
    v_pk_mul_f32 v[254:255], v[234:235], v[254:255] op_sel:[0,0] op_sel_hi:[0,1]
    v_cvt_pk_bf16_f32 v248, v248, v249
    v_cvt_pk_bf16_f32 v249, v250, v251
    v_cvt_pk_bf16_f32 v250, v252, v253
    v_cvt_pk_bf16_f32 v251, v254, v255
    s_mov_b32 s33, 263168
    buffer_store_dwordx4 v[248:251], v238, s[24:27], s33 offen sc1
    v_accvgpr_read_b32 v240, a72
    v_accvgpr_read_b32 v241, a73
    v_accvgpr_read_b32 v242, a74
    v_accvgpr_read_b32 v243, a75
    v_accvgpr_read_b32 v244, a88
    v_accvgpr_read_b32 v245, a89
    v_accvgpr_read_b32 v246, a90
    v_accvgpr_read_b32 v247, a91
    v_pk_mul_f32 v[240:241], v[234:235], v[240:241] op_sel:[0,0] op_sel_hi:[0,1]
    v_pk_mul_f32 v[242:243], v[234:235], v[242:243] op_sel:[0,0] op_sel_hi:[0,1]
    v_pk_mul_f32 v[244:245], v[234:235], v[244:245] op_sel:[0,0] op_sel_hi:[0,1]
    v_pk_mul_f32 v[246:247], v[234:235], v[246:247] op_sel:[0,0] op_sel_hi:[0,1]
    v_cvt_pk_bf16_f32 v240, v240, v241
    v_cvt_pk_bf16_f32 v241, v242, v243
    v_cvt_pk_bf16_f32 v242, v244, v245
    v_cvt_pk_bf16_f32 v243, v246, v247
    s_mov_b32 s33, 264192
    buffer_store_dwordx4 v[240:243], v238, s[24:27], s33 offen sc1
    v_accvgpr_read_b32 v248, a104
    v_accvgpr_read_b32 v249, a105
    v_accvgpr_read_b32 v250, a106
    v_accvgpr_read_b32 v251, a107
    v_accvgpr_read_b32 v252, a120
    v_accvgpr_read_b32 v253, a121
    v_accvgpr_read_b32 v254, a122
    v_accvgpr_read_b32 v255, a123
    v_pk_mul_f32 v[248:249], v[234:235], v[248:249] op_sel:[0,0] op_sel_hi:[0,1]
    v_pk_mul_f32 v[250:251], v[234:235], v[250:251] op_sel:[0,0] op_sel_hi:[0,1]
    v_pk_mul_f32 v[252:253], v[234:235], v[252:253] op_sel:[0,0] op_sel_hi:[0,1]
    v_pk_mul_f32 v[254:255], v[234:235], v[254:255] op_sel:[0,0] op_sel_hi:[0,1]
    v_cvt_pk_bf16_f32 v248, v248, v249
    v_cvt_pk_bf16_f32 v249, v250, v251
    v_cvt_pk_bf16_f32 v250, v252, v253
    v_cvt_pk_bf16_f32 v251, v254, v255
    s_mov_b32 s33, 265216
    buffer_store_dwordx4 v[248:251], v238, s[24:27], s33 offen sc1
    v_accvgpr_read_b32 v240, a12
    v_accvgpr_read_b32 v241, a13
    v_accvgpr_read_b32 v242, a14
    v_accvgpr_read_b32 v243, a15
    v_accvgpr_read_b32 v244, a28
    v_accvgpr_read_b32 v245, a29
    v_accvgpr_read_b32 v246, a30
    v_accvgpr_read_b32 v247, a31
    v_pk_mul_f32 v[240:241], v[234:235], v[240:241] op_sel:[1,0] op_sel_hi:[1,1]
    v_pk_mul_f32 v[242:243], v[234:235], v[242:243] op_sel:[1,0] op_sel_hi:[1,1]
    v_pk_mul_f32 v[244:245], v[234:235], v[244:245] op_sel:[1,0] op_sel_hi:[1,1]
    v_pk_mul_f32 v[246:247], v[234:235], v[246:247] op_sel:[1,0] op_sel_hi:[1,1]
    v_cvt_pk_bf16_f32 v240, v240, v241
    v_cvt_pk_bf16_f32 v241, v242, v243
    v_cvt_pk_bf16_f32 v242, v244, v245
    v_cvt_pk_bf16_f32 v243, v246, v247
    s_mov_b32 s33, 393216
    buffer_store_dwordx4 v[240:243], v238, s[24:27], s33 offen sc1
    v_accvgpr_read_b32 v248, a44
    v_accvgpr_read_b32 v249, a45
    v_accvgpr_read_b32 v250, a46
    v_accvgpr_read_b32 v251, a47
    v_accvgpr_read_b32 v252, a60
    v_accvgpr_read_b32 v253, a61
    v_accvgpr_read_b32 v254, a62
    v_accvgpr_read_b32 v255, a63
    v_pk_mul_f32 v[248:249], v[234:235], v[248:249] op_sel:[1,0] op_sel_hi:[1,1]
    v_pk_mul_f32 v[250:251], v[234:235], v[250:251] op_sel:[1,0] op_sel_hi:[1,1]
    v_pk_mul_f32 v[252:253], v[234:235], v[252:253] op_sel:[1,0] op_sel_hi:[1,1]
    v_pk_mul_f32 v[254:255], v[234:235], v[254:255] op_sel:[1,0] op_sel_hi:[1,1]
    v_cvt_pk_bf16_f32 v248, v248, v249
    v_cvt_pk_bf16_f32 v249, v250, v251
    v_cvt_pk_bf16_f32 v250, v252, v253
    v_cvt_pk_bf16_f32 v251, v254, v255
    s_mov_b32 s33, 394240
    buffer_store_dwordx4 v[248:251], v238, s[24:27], s33 offen sc1
    v_accvgpr_read_b32 v240, a76
    v_accvgpr_read_b32 v241, a77
    v_accvgpr_read_b32 v242, a78
    v_accvgpr_read_b32 v243, a79
    v_accvgpr_read_b32 v244, a92
    v_accvgpr_read_b32 v245, a93
    v_accvgpr_read_b32 v246, a94
    v_accvgpr_read_b32 v247, a95
    v_pk_mul_f32 v[240:241], v[234:235], v[240:241] op_sel:[1,0] op_sel_hi:[1,1]
    v_pk_mul_f32 v[242:243], v[234:235], v[242:243] op_sel:[1,0] op_sel_hi:[1,1]
    v_pk_mul_f32 v[244:245], v[234:235], v[244:245] op_sel:[1,0] op_sel_hi:[1,1]
    v_pk_mul_f32 v[246:247], v[234:235], v[246:247] op_sel:[1,0] op_sel_hi:[1,1]
    v_cvt_pk_bf16_f32 v240, v240, v241
    v_cvt_pk_bf16_f32 v241, v242, v243
    v_cvt_pk_bf16_f32 v242, v244, v245
    v_cvt_pk_bf16_f32 v243, v246, v247
    s_mov_b32 s33, 395264
    buffer_store_dwordx4 v[240:243], v238, s[24:27], s33 offen sc1
    v_accvgpr_read_b32 v248, a108
    v_accvgpr_read_b32 v249, a109
    v_accvgpr_read_b32 v250, a110
    v_accvgpr_read_b32 v251, a111
    v_accvgpr_read_b32 v252, a124
    v_accvgpr_read_b32 v253, a125
    v_accvgpr_read_b32 v254, a126
    v_accvgpr_read_b32 v255, a127
    v_pk_mul_f32 v[248:249], v[234:235], v[248:249] op_sel:[1,0] op_sel_hi:[1,1]
    v_pk_mul_f32 v[250:251], v[234:235], v[250:251] op_sel:[1,0] op_sel_hi:[1,1]
    v_pk_mul_f32 v[252:253], v[234:235], v[252:253] op_sel:[1,0] op_sel_hi:[1,1]
    v_pk_mul_f32 v[254:255], v[234:235], v[254:255] op_sel:[1,0] op_sel_hi:[1,1]
    v_cvt_pk_bf16_f32 v248, v248, v249
    v_cvt_pk_bf16_f32 v249, v250, v251
    v_cvt_pk_bf16_f32 v250, v252, v253
    v_cvt_pk_bf16_f32 v251, v254, v255
    s_mov_b32 s33, 396288
    buffer_store_dwordx4 v[248:251], v238, s[24:27], s33 offen sc1
    s_cmp_lg_u32 s32, 0
    s_cbranch_scc1 recurrent_scan__mha_block_cached__mixer_s_mlp__prompt_kernel_guarded
    s_nop 7
    s_mov_b32 s33, 0x4e800000
    v_cmp_nge_f32 vcc, s33, v144
    s_mov_b64 s[40:41], vcc
    v_cmp_nge_f32 vcc, s33, v148
    s_or_b64 s[40:41], s[40:41], vcc
    v_cmp_nge_f32 vcc, s33, v152
    s_or_b64 s[40:41], s[40:41], vcc
    v_cmp_nge_f32 vcc, s33, v156
    s_or_b64 s[40:41], s[40:41], vcc
    s_cmp_lg_u64 s[40:41], 0
    s_cselect_b32 s40, 1, 0
    v_mov_b32 v228, s40
    s_lshl_b32 s41, s3, 2
    s_add_u32 s41, s41, 163776
    v_mov_b32 v229, s41
    ds_write_b32 v229, v228
    s_waitcnt lgkmcnt(0)
    s_barrier
    v_mov_b32 v229, 163776
    ds_read_b128 v[232:235], v229
    s_waitcnt lgkmcnt(0)
    v_or3_b32 v228, v232, v233, v234
    v_or_b32 v228, v228, v235
    s_nop 0
    v_readfirstlane_b32 s40, v228
    s_cmp_lg_u32 s40, 0
    s_cbranch_scc1 recurrent_scan__mha_block_cached__mixer_s_mlp__prompt_kernel_slow
recurrent_scan__mha_block_cached__mixer_s_mlp__prompt_kernel_guarded:
    v_lshrrev_b32 v26, 2, v20
    v_and_b32 v27, 3, v20
    v_lshl_add_u32 v28, v21, 2, v26
    v_and_b32 v29, 7, v28
    v_lshlrev_b32 v28, 8, v28
    v_lshl_add_u32 v28, v27, 3, v28
    v_mov_b32 v239, v20
    v_mov_b32 v240, v21
    s_cmp_ge_u32 s43, 14
    s_cbranch_scc1 L_g3idle
    v_cmp_ne_u32 vcc, s36, v22
    s_nop 4
    s_cmp_eq_u64 vcc, 0
    s_cbranch_scc1 L_pok_f2
    s_mov_b32 s37, 0
L_spin_f2:
    buffer_load_dword v22, v23, s[44:47], 0 offen sc1
    s_add_u32 s37, s37, 1
    s_cmp_gt_u32 s37, 0x20000
    s_cbranch_scc1 recurrent_scan__mha_block_cached__mixer_s_mlp__prompt_kernel_end
    s_waitcnt vmcnt(0)
    v_cmp_ne_u32 vcc, s36, v22
    s_nop 4
    s_cmp_lg_u64 vcc, 0
    s_cbranch_scc1 L_spin_f2
L_pok_f2:
    s_lshl_b32 s40, s42, 3
    s_lshl_b32 s41, s3, 1
    s_add_u32 s40, s40, s41
    s_lshl_b32 s41, s40, 14
    s_add_u32 s20, s34, 0x600000
    s_addc_u32 s21, s35, 0
    s_add_u32 s20, s20, s41
    s_addc_u32 s21, s21, 0
    s_mov_b32 s22, 0x8000
    s_mov_b32 s23, 0x20000
    s_add_u32 s48, s34, 0x2000000
    s_addc_u32 s49, s35, 0
    s_mov_b32 s50, 0x20000
    s_mov_b32 s51, 0x20000
    s_mov_b32 s41, 0
    buffer_load_dwordx4 v[96:99], v238, s[20:23], s41 offen sc1
    s_mov_b32 s41, 16384
    buffer_load_dwordx4 v[100:103], v238, s[20:23], s41 offen sc1
    s_mov_b32 s41, 1024
    buffer_load_dwordx4 v[104:107], v238, s[20:23], s41 offen sc1
    s_mov_b32 s41, 17408
    buffer_load_dwordx4 v[108:111], v238, s[20:23], s41 offen sc1
    v_xor_b32 v30, 0, v29
    v_lshl_add_u32 v4, v30, 5, v28
    s_mov_b32 s41, 2048
    buffer_load_dwordx4 v[112:115], v238, s[20:23], s41 offen sc1
    v_xor_b32 v30, 1, v29
    v_lshl_add_u32 v5, v30, 5, v28
    v_xor_b32 v30, 2, v29
    v_lshl_add_u32 v6, v30, 5, v28
    v_xor_b32 v30, 3, v29
    s_mov_b32 s41, 18432
    buffer_load_dwordx4 v[116:119], v238, s[20:23], s41 offen sc1
    v_lshl_add_u32 v7, v30, 5, v28
    v_xor_b32 v30, 4, v29
    v_lshl_add_u32 v8, v30, 5, v28
    v_xor_b32 v30, 5, v29
    v_lshl_add_u32 v9, v30, 5, v28
    s_mov_b32 s41, 3072
    buffer_load_dwordx4 v[120:123], v238, s[20:23], s41 offen sc1
    v_xor_b32 v30, 6, v29
    v_lshl_add_u32 v10, v30, 5, v28
    v_xor_b32 v30, 7, v29
    v_lshl_add_u32 v11, v30, 5, v28
    v_add_u32 v12, 0x10000, v4
    s_mov_b32 s41, 19456
    buffer_load_dwordx4 v[124:127], v238, s[20:23], s41 offen sc1
    v_add_u32 v13, 0x10000, v5
    v_add_u32 v14, 0x10000, v6
    v_add_u32 v15, 0x10000, v7
    v_add_u32 v16, 0x10000, v8
    v_add_u32 v17, 0x10000, v9
    s_mov_b32 s41, 4096
    buffer_load_dwordx4 v[128:131], v238, s[20:23], s41 offen sc1
    v_add_u32 v18, 0x10000, v10
    v_add_u32 v19, 0x10000, v11
    v_mov_b32 v32, 0
    v_mov_b32 v33, 0
    v_mov_b32 v34, 0
    s_mov_b32 s41, 20480
    buffer_load_dwordx4 v[132:135], v238, s[20:23], s41 offen sc1
    v_mov_b32 v35, 0
    v_mov_b32 v36, 0
    v_mov_b32 v37, 0
    v_mov_b32 v38, 0
    v_mov_b32 v39, 0
    s_mov_b32 s41, 5120
    buffer_load_dwordx4 v[136:139], v238, s[20:23], s41 offen sc1
    v_mov_b32 v40, 0
    v_mov_b32 v41, 0
    v_mov_b32 v42, 0
    v_mov_b32 v43, 0
    v_mov_b32 v44, 0
    s_mov_b32 s41, 21504
    buffer_load_dwordx4 v[140:143], v238, s[20:23], s41 offen sc1
    v_mov_b32 v45, 0
    v_mov_b32 v46, 0
    v_mov_b32 v47, 0
    v_mov_b32 v48, 0
    v_mov_b32 v49, 0
    s_mov_b32 s41, 6144
    buffer_load_dwordx4 v[144:147], v238, s[20:23], s41 offen sc1
    v_mov_b32 v50, 0
    v_mov_b32 v51, 0
    v_mov_b32 v52, 0
    v_mov_b32 v53, 0
    v_mov_b32 v54, 0
    s_mov_b32 s41, 22528
    buffer_load_dwordx4 v[148:151], v238, s[20:23], s41 offen sc1
    v_mov_b32 v55, 0
    v_mov_b32 v56, 0
    v_mov_b32 v57, 0
    v_mov_b32 v58, 0
    v_mov_b32 v59, 0
    s_mov_b32 s41, 7168
    buffer_load_dwordx4 v[152:155], v238, s[20:23], s41 offen sc1
    v_mov_b32 v60, 0
    v_mov_b32 v61, 0
    v_mov_b32 v62, 0
    v_mov_b32 v63, 0
    v_mov_b32 v64, 0
    s_mov_b32 s41, 23552
    buffer_load_dwordx4 v[156:159], v238, s[20:23], s41 offen sc1
    v_mov_b32 v65, 0
    v_mov_b32 v66, 0
    v_mov_b32 v67, 0
    v_mov_b32 v68, 0
    v_mov_b32 v69, 0
    s_add_u32 m0, s63, 32768
    s_mov_b32 s41, 458752
    buffer_load_dwordx4 v236, s[16:19], s41 offen lds
    v_mov_b32 v70, 0
    v_mov_b32 v71, 0
    v_mov_b32 v72, 0
    v_mov_b32 v73, 0
    v_mov_b32 v74, 0
    s_add_u32 m0, s63, 33792
    s_mov_b32 s41, 458752
    buffer_load_dwordx4 v237, s[16:19], s41 offen lds
    v_mov_b32 v75, 0
    v_mov_b32 v76, 0
    v_mov_b32 v77, 0
    v_mov_b32 v78, 0
    v_mov_b32 v79, 0
    s_add_u32 m0, s63, 40960
    s_mov_b32 s41, 573440
    buffer_load_dwordx4 v236, s[16:19], s41 offen lds
    v_mov_b32 v80, 0
    v_mov_b32 v81, 0
    v_mov_b32 v82, 0
    v_mov_b32 v83, 0
    v_mov_b32 v84, 0
    s_add_u32 m0, s63, 41984
    s_mov_b32 s41, 573440
    buffer_load_dwordx4 v237, s[16:19], s41 offen lds
    v_mov_b32 v85, 0
    v_mov_b32 v86, 0
    v_mov_b32 v87, 0
    v_mov_b32 v88, 0
    v_mov_b32 v89, 0
    s_add_u32 m0, s63, 49152
    s_mov_b32 s41, 688128
    buffer_load_dwordx4 v236, s[16:19], s41 offen lds
    v_mov_b32 v90, 0
    v_mov_b32 v91, 0
    v_mov_b32 v92, 0
    v_mov_b32 v93, 0
    v_mov_b32 v94, 0
    s_add_u32 m0, s63, 50176
    s_mov_b32 s41, 688128
    buffer_load_dwordx4 v237, s[16:19], s41 offen lds
    v_mov_b32 v95, 0
    v_accvgpr_write_b32 a192, 0
    v_accvgpr_write_b32 a193, 0
    v_accvgpr_write_b32 a194, 0
    v_accvgpr_write_b32 a195, 0
    s_add_u32 m0, s63, 57344
    s_mov_b32 s41, 802816
    buffer_load_dwordx4 v236, s[16:19], s41 offen lds
    v_accvgpr_write_b32 a196, 0
    v_accvgpr_write_b32 a197, 0
    v_accvgpr_write_b32 a198, 0
    v_accvgpr_write_b32 a199, 0
    v_accvgpr_write_b32 a200, 0
    s_add_u32 m0, s63, 58368
    s_mov_b32 s41, 802816
    buffer_load_dwordx4 v237, s[16:19], s41 offen lds
    v_accvgpr_write_b32 a201, 0
    v_accvgpr_write_b32 a202, 0
    v_accvgpr_write_b32 a203, 0
    v_accvgpr_write_b32 a204, 0
    v_accvgpr_write_b32 a205, 0
    s_add_u32 m0, s63, 65536
    s_mov_b32 s41, 917504
    buffer_load_dwordx4 v236, s[16:19], s41 offen lds
    v_accvgpr_write_b32 a206, 0
    v_accvgpr_write_b32 a207, 0
    v_accvgpr_write_b32 a208, 0
    v_accvgpr_write_b32 a209, 0
    v_accvgpr_write_b32 a210, 0
    s_add_u32 m0, s63, 66560
    s_mov_b32 s41, 917504
    buffer_load_dwordx4 v237, s[16:19], s41 offen lds
    v_accvgpr_write_b32 a211, 0
    v_accvgpr_write_b32 a212, 0
    v_accvgpr_write_b32 a213, 0
    v_accvgpr_write_b32 a214, 0
    v_accvgpr_write_b32 a215, 0
    s_add_u32 m0, s63, 73728
    s_mov_b32 s41, 1032192
    buffer_load_dwordx4 v236, s[16:19], s41 offen lds
    v_accvgpr_write_b32 a216, 0
    v_accvgpr_write_b32 a217, 0
    v_accvgpr_write_b32 a218, 0
    v_accvgpr_write_b32 a219, 0
    v_accvgpr_write_b32 a220, 0
    s_add_u32 m0, s63, 74752
    s_mov_b32 s41, 1032192
    buffer_load_dwordx4 v237, s[16:19], s41 offen lds
    v_accvgpr_write_b32 a221, 0
    v_accvgpr_write_b32 a222, 0
    v_accvgpr_write_b32 a223, 0
    v_mov_b32 v228, 0x3f803f80
    v_mov_b32 v229, 0x3f803f80
    v_mov_b32 v230, 0x3f803f80
    v_mov_b32 v231, 0x3f803f80
    s_waitcnt vmcnt(24)
    s_barrier
    ds_read_b64_tr_b16 a[128:129], v4 offset:0
    ds_read_b64_tr_b16 a[130:131], v4 offset:4096
    ds_read_b64_tr_b16 a[132:133], v5 offset:0
    ds_read_b64_tr_b16 a[134:135], v5 offset:4096
    ds_read_b64_tr_b16 a[136:137], v6 offset:0
    ds_read_b64_tr_b16 a[138:139], v6 offset:4096
    ds_read_b64_tr_b16 a[140:141], v7 offset:0
    ds_read_b64_tr_b16 a[142:143], v7 offset:4096
    ds_read_b64_tr_b16 a[144:145], v8 offset:0
    ds_read_b64_tr_b16 a[146:147], v8 offset:4096
    ds_read_b64_tr_b16 a[148:149], v9 offset:0
    ds_read_b64_tr_b16 a[150:151], v9 offset:4096
    ds_read_b64_tr_b16 a[152:153], v10 offset:0
    ds_read_b64_tr_b16 a[154:155], v10 offset:4096
    ds_read_b64_tr_b16 a[156:157], v11 offset:0
    ds_read_b64_tr_b16 a[158:159], v11 offset:4096
    s_waitcnt lgkmcnt(14)
    v_mfma_f32_16x16x32_bf16 v[32:35], a[128:131], v[96:99], v[32:35]
    ds_read_b64_tr_b16 a[160:161], v4 offset:8192
    v_mfma_f32_16x16x32_bf16 v[64:67], a[128:131], v[100:103], v[64:67]
    ds_read_b64_tr_b16 a[162:163], v4 offset:12288
    v_mfma_f32_16x16x32_bf16 a[192:195], a[128:131], v[228:231], a[192:195]
    s_waitcnt lgkmcnt(14)
    v_mfma_f32_16x16x32_bf16 v[36:39], a[132:135], v[96:99], v[36:39]
    ds_read_b64_tr_b16 a[164:165], v5 offset:8192
    v_mfma_f32_16x16x32_bf16 v[68:71], a[132:135], v[100:103], v[68:71]
    ds_read_b64_tr_b16 a[166:167], v5 offset:12288
    s_mov_b32 s41, 8192
    buffer_load_dwordx4 v[160:163], v238, s[20:23], s41 offen sc1
    v_mfma_f32_16x16x32_bf16 a[196:199], a[132:135], v[228:231], a[196:199]
    s_waitcnt lgkmcnt(14)
    v_mfma_f32_16x16x32_bf16 v[40:43], a[136:139], v[96:99], v[40:43]
    ds_read_b64_tr_b16 a[168:169], v6 offset:8192
    v_mfma_f32_16x16x32_bf16 v[72:75], a[136:139], v[100:103], v[72:75]
    ds_read_b64_tr_b16 a[170:171], v6 offset:12288
    v_mfma_f32_16x16x32_bf16 a[200:203], a[136:139], v[228:231], a[200:203]
    s_waitcnt lgkmcnt(14)
    v_mfma_f32_16x16x32_bf16 v[44:47], a[140:143], v[96:99], v[44:47]
    ds_read_b64_tr_b16 a[172:173], v7 offset:8192
    v_mfma_f32_16x16x32_bf16 v[76:79], a[140:143], v[100:103], v[76:79]
    ds_read_b64_tr_b16 a[174:175], v7 offset:12288
    s_mov_b32 s41, 24576
    buffer_load_dwordx4 v[164:167], v238, s[20:23], s41 offen sc1
    v_mfma_f32_16x16x32_bf16 a[204:207], a[140:143], v[228:231], a[204:207]
    s_waitcnt lgkmcnt(14)
    v_mfma_f32_16x16x32_bf16 v[48:51], a[144:147], v[96:99], v[48:51]
    ds_read_b64_tr_b16 a[176:177], v8 offset:8192
    v_mfma_f32_16x16x32_bf16 v[80:83], a[144:147], v[100:103], v[80:83]
    ds_read_b64_tr_b16 a[178:179], v8 offset:12288
    v_mfma_f32_16x16x32_bf16 a[208:211], a[144:147], v[228:231], a[208:211]
    s_waitcnt lgkmcnt(14)
    v_mfma_f32_16x16x32_bf16 v[52:55], a[148:151], v[96:99], v[52:55]
    ds_read_b64_tr_b16 a[180:181], v9 offset:8192
    v_mfma_f32_16x16x32_bf16 v[84:87], a[148:151], v[100:103], v[84:87]
    ds_read_b64_tr_b16 a[182:183], v9 offset:12288
    s_add_u32 m0, s63, 81920
    s_mov_b32 s41, 1146880
    buffer_load_dwordx4 v236, s[16:19], s41 offen lds
    v_mfma_f32_16x16x32_bf16 a[212:215], a[148:151], v[228:231], a[212:215]
    s_waitcnt lgkmcnt(14)
    v_mfma_f32_16x16x32_bf16 v[56:59], a[152:155], v[96:99], v[56:59]
    ds_read_b64_tr_b16 a[184:185], v10 offset:8192
    v_mfma_f32_16x16x32_bf16 v[88:91], a[152:155], v[100:103], v[88:91]
    ds_read_b64_tr_b16 a[186:187], v10 offset:12288
    v_mfma_f32_16x16x32_bf16 a[216:219], a[152:155], v[228:231], a[216:219]
    s_waitcnt lgkmcnt(14)
    v_mfma_f32_16x16x32_bf16 v[60:63], a[156:159], v[96:99], v[60:63]
    ds_read_b64_tr_b16 a[188:189], v11 offset:8192
    v_mfma_f32_16x16x32_bf16 v[92:95], a[156:159], v[100:103], v[92:95]
    ds_read_b64_tr_b16 a[190:191], v11 offset:12288
    s_add_u32 m0, s63, 82944
    s_mov_b32 s41, 1146880
    buffer_load_dwordx4 v237, s[16:19], s41 offen lds
    v_mfma_f32_16x16x32_bf16 a[220:223], a[156:159], v[228:231], a[220:223]
    s_waitcnt lgkmcnt(14)
    v_mfma_f32_16x16x32_bf16 v[32:35], a[160:163], v[104:107], v[32:35]
    ds_read_b64_tr_b16 a[128:129], v4 offset:16384
    v_mfma_f32_16x16x32_bf16 v[64:67], a[160:163], v[108:111], v[64:67]
    ds_read_b64_tr_b16 a[130:131], v4 offset:20480
    v_mfma_f32_16x16x32_bf16 a[192:195], a[160:163], v[228:231], a[192:195]
    s_waitcnt lgkmcnt(14)
    v_mfma_f32_16x16x32_bf16 v[36:39], a[164:167], v[104:107], v[36:39]
    ds_read_b64_tr_b16 a[132:133], v5 offset:16384
    v_mfma_f32_16x16x32_bf16 v[68:71], a[164:167], v[108:111], v[68:71]
    ds_read_b64_tr_b16 a[134:135], v5 offset:20480
    s_mov_b32 s41, 9216
    buffer_load_dwordx4 v[168:171], v238, s[20:23], s41 offen sc1
    v_mfma_f32_16x16x32_bf16 a[196:199], a[164:167], v[228:231], a[196:199]
    s_waitcnt lgkmcnt(14)
    v_mfma_f32_16x16x32_bf16 v[40:43], a[168:171], v[104:107], v[40:43]
    ds_read_b64_tr_b16 a[136:137], v6 offset:16384
    v_mfma_f32_16x16x32_bf16 v[72:75], a[168:171], v[108:111], v[72:75]
    ds_read_b64_tr_b16 a[138:139], v6 offset:20480
    v_mfma_f32_16x16x32_bf16 a[200:203], a[168:171], v[228:231], a[200:203]
    s_waitcnt lgkmcnt(14)
    v_mfma_f32_16x16x32_bf16 v[44:47], a[172:175], v[104:107], v[44:47]
    ds_read_b64_tr_b16 a[140:141], v7 offset:16384
    v_mfma_f32_16x16x32_bf16 v[76:79], a[172:175], v[108:111], v[76:79]
    ds_read_b64_tr_b16 a[142:143], v7 offset:20480
    s_mov_b32 s41, 25600
    buffer_load_dwordx4 v[172:175], v238, s[20:23], s41 offen sc1
    v_mfma_f32_16x16x32_bf16 a[204:207], a[172:175], v[228:231], a[204:207]
    s_waitcnt lgkmcnt(14)
    v_mfma_f32_16x16x32_bf16 v[48:51], a[176:179], v[104:107], v[48:51]
    ds_read_b64_tr_b16 a[144:145], v8 offset:16384
    v_mfma_f32_16x16x32_bf16 v[80:83], a[176:179], v[108:111], v[80:83]
    ds_read_b64_tr_b16 a[146:147], v8 offset:20480
    v_mfma_f32_16x16x32_bf16 a[208:211], a[176:179], v[228:231], a[208:211]
    s_waitcnt lgkmcnt(14)
    v_mfma_f32_16x16x32_bf16 v[52:55], a[180:183], v[104:107], v[52:55]
    ds_read_b64_tr_b16 a[148:149], v9 offset:16384
    v_mfma_f32_16x16x32_bf16 v[84:87], a[180:183], v[108:111], v[84:87]
    ds_read_b64_tr_b16 a[150:151], v9 offset:20480
    s_add_u32 m0, s63, 90112
    s_mov_b32 s41, 1261568
    buffer_load_dwordx4 v236, s[16:19], s41 offen lds
    v_mfma_f32_16x16x32_bf16 a[212:215], a[180:183], v[228:231], a[212:215]
    s_waitcnt lgkmcnt(14)
    v_mfma_f32_16x16x32_bf16 v[56:59], a[184:187], v[104:107], v[56:59]
    ds_read_b64_tr_b16 a[152:153], v10 offset:16384
    v_mfma_f32_16x16x32_bf16 v[88:91], a[184:187], v[108:111], v[88:91]
    ds_read_b64_tr_b16 a[154:155], v10 offset:20480
    v_mfma_f32_16x16x32_bf16 a[216:219], a[184:187], v[228:231], a[216:219]
    s_waitcnt lgkmcnt(14)
    v_mfma_f32_16x16x32_bf16 v[60:63], a[188:191], v[104:107], v[60:63]
    ds_read_b64_tr_b16 a[156:157], v11 offset:16384
    v_mfma_f32_16x16x32_bf16 v[92:95], a[188:191], v[108:111], v[92:95]
    ds_read_b64_tr_b16 a[158:159], v11 offset:20480
    s_add_u32 m0, s63, 91136
    s_mov_b32 s41, 1261568
    buffer_load_dwordx4 v237, s[16:19], s41 offen lds
    v_mfma_f32_16x16x32_bf16 a[220:223], a[188:191], v[228:231], a[220:223]
    s_waitcnt vmcnt(18)
    s_barrier
    s_waitcnt lgkmcnt(14)
    v_mfma_f32_16x16x32_bf16 v[32:35], a[128:131], v[112:115], v[32:35]
    ds_read_b64_tr_b16 a[160:161], v4 offset:24576
    v_mfma_f32_16x16x32_bf16 v[64:67], a[128:131], v[116:119], v[64:67]
    ds_read_b64_tr_b16 a[162:163], v4 offset:28672
    v_mfma_f32_16x16x32_bf16 a[192:195], a[128:131], v[228:231], a[192:195]
    s_waitcnt lgkmcnt(14)
    v_mfma_f32_16x16x32_bf16 v[36:39], a[132:135], v[112:115], v[36:39]
    ds_read_b64_tr_b16 a[164:165], v5 offset:24576
    v_mfma_f32_16x16x32_bf16 v[68:71], a[132:135], v[116:119], v[68:71]
    ds_read_b64_tr_b16 a[166:167], v5 offset:28672
    s_mov_b32 s41, 10240
    buffer_load_dwordx4 v[176:179], v238, s[20:23], s41 offen sc1
    v_mfma_f32_16x16x32_bf16 a[196:199], a[132:135], v[228:231], a[196:199]
    s_waitcnt lgkmcnt(14)
    v_mfma_f32_16x16x32_bf16 v[40:43], a[136:139], v[112:115], v[40:43]
    ds_read_b64_tr_b16 a[168:169], v6 offset:24576
    v_mfma_f32_16x16x32_bf16 v[72:75], a[136:139], v[116:119], v[72:75]
    ds_read_b64_tr_b16 a[170:171], v6 offset:28672
    v_mfma_f32_16x16x32_bf16 a[200:203], a[136:139], v[228:231], a[200:203]
    s_waitcnt lgkmcnt(14)
    v_mfma_f32_16x16x32_bf16 v[44:47], a[140:143], v[112:115], v[44:47]
    ds_read_b64_tr_b16 a[172:173], v7 offset:24576
    v_mfma_f32_16x16x32_bf16 v[76:79], a[140:143], v[116:119], v[76:79]
    ds_read_b64_tr_b16 a[174:175], v7 offset:28672
    s_mov_b32 s41, 26624
    buffer_load_dwordx4 v[180:183], v238, s[20:23], s41 offen sc1
    v_mfma_f32_16x16x32_bf16 a[204:207], a[140:143], v[228:231], a[204:207]
    s_waitcnt lgkmcnt(14)
    v_mfma_f32_16x16x32_bf16 v[48:51], a[144:147], v[112:115], v[48:51]
    ds_read_b64_tr_b16 a[176:177], v8 offset:24576
    v_mfma_f32_16x16x32_bf16 v[80:83], a[144:147], v[116:119], v[80:83]
    ds_read_b64_tr_b16 a[178:179], v8 offset:28672
    v_mfma_f32_16x16x32_bf16 a[208:211], a[144:147], v[228:231], a[208:211]
    s_waitcnt lgkmcnt(14)
    v_mfma_f32_16x16x32_bf16 v[52:55], a[148:151], v[112:115], v[52:55]
    ds_read_b64_tr_b16 a[180:181], v9 offset:24576
    v_mfma_f32_16x16x32_bf16 v[84:87], a[148:151], v[116:119], v[84:87]
    ds_read_b64_tr_b16 a[182:183], v9 offset:28672
    s_add_u32 m0, s63, 98304
    s_mov_b32 s41, 1376256
    buffer_load_dwordx4 v236, s[16:19], s41 offen lds
    v_mfma_f32_16x16x32_bf16 a[212:215], a[148:151], v[228:231], a[212:215]
    s_waitcnt lgkmcnt(14)
    v_mfma_f32_16x16x32_bf16 v[56:59], a[152:155], v[112:115], v[56:59]
    ds_read_b64_tr_b16 a[184:185], v10 offset:24576
    v_mfma_f32_16x16x32_bf16 v[88:91], a[152:155], v[116:119], v[88:91]
    ds_read_b64_tr_b16 a[186:187], v10 offset:28672
    v_mfma_f32_16x16x32_bf16 a[216:219], a[152:155], v[228:231], a[216:219]
    s_waitcnt lgkmcnt(14)
    v_mfma_f32_16x16x32_bf16 v[60:63], a[156:159], v[112:115], v[60:63]
    ds_read_b64_tr_b16 a[188:189], v11 offset:24576
    v_mfma_f32_16x16x32_bf16 v[92:95], a[156:159], v[116:119], v[92:95]
    ds_read_b64_tr_b16 a[190:191], v11 offset:28672
    s_add_u32 m0, s63, 99328
    s_mov_b32 s41, 1376256
    buffer_load_dwordx4 v237, s[16:19], s41 offen lds
    v_mfma_f32_16x16x32_bf16 a[220:223], a[156:159], v[228:231], a[220:223]
    s_waitcnt lgkmcnt(14)
    v_mfma_f32_16x16x32_bf16 v[32:35], a[160:163], v[120:123], v[32:35]
    ds_read_b64_tr_b16 a[128:129], v4 offset:32768
    v_mfma_f32_16x16x32_bf16 v[64:67], a[160:163], v[124:127], v[64:67]
    ds_read_b64_tr_b16 a[130:131], v4 offset:36864
    v_mfma_f32_16x16x32_bf16 a[192:195], a[160:163], v[228:231], a[192:195]
    s_waitcnt lgkmcnt(14)
    v_mfma_f32_16x16x32_bf16 v[36:39], a[164:167], v[120:123], v[36:39]
    ds_read_b64_tr_b16 a[132:133], v5 offset:32768
    v_mfma_f32_16x16x32_bf16 v[68:71], a[164:167], v[124:127], v[68:71]
    ds_read_b64_tr_b16 a[134:135], v5 offset:36864
    s_mov_b32 s41, 11264
    buffer_load_dwordx4 v[184:187], v238, s[20:23], s41 offen sc1
    v_mfma_f32_16x16x32_bf16 a[196:199], a[164:167], v[228:231], a[196:199]
    s_waitcnt lgkmcnt(14)
    v_mfma_f32_16x16x32_bf16 v[40:43], a[168:171], v[120:123], v[40:43]
    ds_read_b64_tr_b16 a[136:137], v6 offset:32768
    v_mfma_f32_16x16x32_bf16 v[72:75], a[168:171], v[124:127], v[72:75]
    ds_read_b64_tr_b16 a[138:139], v6 offset:36864
    v_mfma_f32_16x16x32_bf16 a[200:203], a[168:171], v[228:231], a[200:203]
    s_waitcnt lgkmcnt(14)
    v_mfma_f32_16x16x32_bf16 v[44:47], a[172:175], v[120:123], v[44:47]
    ds_read_b64_tr_b16 a[140:141], v7 offset:32768
    v_mfma_f32_16x16x32_bf16 v[76:79], a[172:175], v[124:127], v[76:79]
    ds_read_b64_tr_b16 a[142:143], v7 offset:36864
    s_mov_b32 s41, 27648
    buffer_load_dwordx4 v[188:191], v238, s[20:23], s41 offen sc1
    v_mfma_f32_16x16x32_bf16 a[204:207], a[172:175], v[228:231], a[204:207]
    s_waitcnt lgkmcnt(14)
    v_mfma_f32_16x16x32_bf16 v[48:51], a[176:179], v[120:123], v[48:51]
    ds_read_b64_tr_b16 a[144:145], v8 offset:32768
    v_mfma_f32_16x16x32_bf16 v[80:83], a[176:179], v[124:127], v[80:83]
    ds_read_b64_tr_b16 a[146:147], v8 offset:36864
    v_mfma_f32_16x16x32_bf16 a[208:211], a[176:179], v[228:231], a[208:211]
    s_waitcnt lgkmcnt(14)
    v_mfma_f32_16x16x32_bf16 v[52:55], a[180:183], v[120:123], v[52:55]
    ds_read_b64_tr_b16 a[148:149], v9 offset:32768
    v_mfma_f32_16x16x32_bf16 v[84:87], a[180:183], v[124:127], v[84:87]
    ds_read_b64_tr_b16 a[150:151], v9 offset:36864
    s_add_u32 m0, s63, 106496
    s_mov_b32 s41, 1490944
    buffer_load_dwordx4 v236, s[16:19], s41 offen lds
    v_mfma_f32_16x16x32_bf16 a[212:215], a[180:183], v[228:231], a[212:215]
    s_waitcnt lgkmcnt(14)
    v_mfma_f32_16x16x32_bf16 v[56:59], a[184:187], v[120:123], v[56:59]
    ds_read_b64_tr_b16 a[152:153], v10 offset:32768
    v_mfma_f32_16x16x32_bf16 v[88:91], a[184:187], v[124:127], v[88:91]
    ds_read_b64_tr_b16 a[154:155], v10 offset:36864
    v_mfma_f32_16x16x32_bf16 a[216:219], a[184:187], v[228:231], a[216:219]
    s_waitcnt lgkmcnt(14)
    v_mfma_f32_16x16x32_bf16 v[60:63], a[188:191], v[120:123], v[60:63]
    ds_read_b64_tr_b16 a[156:157], v11 offset:32768
    v_mfma_f32_16x16x32_bf16 v[92:95], a[188:191], v[124:127], v[92:95]
    ds_read_b64_tr_b16 a[158:159], v11 offset:36864
    s_add_u32 m0, s63, 107520
    s_mov_b32 s41, 1490944
    buffer_load_dwordx4 v237, s[16:19], s41 offen lds
    v_mfma_f32_16x16x32_bf16 a[220:223], a[188:191], v[228:231], a[220:223]
    s_waitcnt vmcnt(22)
    s_barrier
    s_lshl_b32 s40, s39, 5
    s_add_u32 s40, s40, s38
    s_cmp_lg_u32 s3, 0
    s_cbranch_scc1 L_pub_fo
    s_lshl_b32 s60, s40, 7
    s_add_u32 s60, s60, 131072
    v_mov_b32 v30, s60
    v_mov_b32 v31, s36
    s_mov_b64 exec, 1
    buffer_store_dword v31, v30, s[44:47], 0 offen sc1
    s_mov_b64 exec, -1
L_pub_fo:
    s_waitcnt lgkmcnt(14)
    v_mfma_f32_16x16x32_bf16 v[32:35], a[128:131], v[128:131], v[32:35]
    ds_read_b64_tr_b16 a[160:161], v4 offset:40960
    v_mfma_f32_16x16x32_bf16 v[64:67], a[128:131], v[132:135], v[64:67]
    ds_read_b64_tr_b16 a[162:163], v4 offset:45056
    v_mfma_f32_16x16x32_bf16 a[192:195], a[128:131], v[228:231], a[192:195]
    s_waitcnt lgkmcnt(14)
    v_mfma_f32_16x16x32_bf16 v[36:39], a[132:135], v[128:131], v[36:39]
    ds_read_b64_tr_b16 a[164:165], v5 offset:40960
    v_mfma_f32_16x16x32_bf16 v[68:71], a[132:135], v[132:135], v[68:71]
    ds_read_b64_tr_b16 a[166:167], v5 offset:45056
    s_mov_b32 s41, 12288
    buffer_load_dwordx4 v[192:195], v238, s[20:23], s41 offen sc1
    v_mfma_f32_16x16x32_bf16 a[196:199], a[132:135], v[228:231], a[196:199]
    s_waitcnt lgkmcnt(14)
    v_mfma_f32_16x16x32_bf16 v[40:43], a[136:139], v[128:131], v[40:43]
    ds_read_b64_tr_b16 a[168:169], v6 offset:40960
    v_mfma_f32_16x16x32_bf16 v[72:75], a[136:139], v[132:135], v[72:75]
    ds_read_b64_tr_b16 a[170:171], v6 offset:45056
    v_mfma_f32_16x16x32_bf16 a[200:203], a[136:139], v[228:231], a[200:203]
    s_waitcnt lgkmcnt(14)
    v_mfma_f32_16x16x32_bf16 v[44:47], a[140:143], v[128:131], v[44:47]
    ds_read_b64_tr_b16 a[172:173], v7 offset:40960
    v_mfma_f32_16x16x32_bf16 v[76:79], a[140:143], v[132:135], v[76:79]
    ds_read_b64_tr_b16 a[174:175], v7 offset:45056
    s_mov_b32 s41, 28672
    buffer_load_dwordx4 v[196:199], v238, s[20:23], s41 offen sc1
    v_mfma_f32_16x16x32_bf16 a[204:207], a[140:143], v[228:231], a[204:207]
    s_waitcnt lgkmcnt(14)
    v_mfma_f32_16x16x32_bf16 v[48:51], a[144:147], v[128:131], v[48:51]
    ds_read_b64_tr_b16 a[176:177], v8 offset:40960
    v_mfma_f32_16x16x32_bf16 v[80:83], a[144:147], v[132:135], v[80:83]
    ds_read_b64_tr_b16 a[178:179], v8 offset:45056
    v_mfma_f32_16x16x32_bf16 a[208:211], a[144:147], v[228:231], a[208:211]
    s_waitcnt lgkmcnt(14)
    v_mfma_f32_16x16x32_bf16 v[52:55], a[148:151], v[128:131], v[52:55]
    ds_read_b64_tr_b16 a[180:181], v9 offset:40960
    v_mfma_f32_16x16x32_bf16 v[84:87], a[148:151], v[132:135], v[84:87]
    ds_read_b64_tr_b16 a[182:183], v9 offset:45056
    s_add_u32 m0, s63, 114688
    s_mov_b32 s41, 1605632
    buffer_load_dwordx4 v236, s[16:19], s41 offen lds
    v_mfma_f32_16x16x32_bf16 a[212:215], a[148:151], v[228:231], a[212:215]
    s_waitcnt lgkmcnt(14)
    v_mfma_f32_16x16x32_bf16 v[56:59], a[152:155], v[128:131], v[56:59]
    ds_read_b64_tr_b16 a[184:185], v10 offset:40960
    v_mfma_f32_16x16x32_bf16 v[88:91], a[152:155], v[132:135], v[88:91]
    ds_read_b64_tr_b16 a[186:187], v10 offset:45056
    v_mfma_f32_16x16x32_bf16 a[216:219], a[152:155], v[228:231], a[216:219]
    s_waitcnt lgkmcnt(14)
    v_mfma_f32_16x16x32_bf16 v[60:63], a[156:159], v[128:131], v[60:63]
    ds_read_b64_tr_b16 a[188:189], v11 offset:40960
    v_mfma_f32_16x16x32_bf16 v[92:95], a[156:159], v[132:135], v[92:95]
    ds_read_b64_tr_b16 a[190:191], v11 offset:45056
    s_add_u32 m0, s63, 115712
    s_mov_b32 s41, 1605632
    buffer_load_dwordx4 v237, s[16:19], s41 offen lds
    v_mfma_f32_16x16x32_bf16 a[220:223], a[156:159], v[228:231], a[220:223]
    s_waitcnt lgkmcnt(14)
    v_mfma_f32_16x16x32_bf16 v[32:35], a[160:163], v[136:139], v[32:35]
    ds_read_b64_tr_b16 a[128:129], v4 offset:49152
    v_mfma_f32_16x16x32_bf16 v[64:67], a[160:163], v[140:143], v[64:67]
    ds_read_b64_tr_b16 a[130:131], v4 offset:53248
    v_mfma_f32_16x16x32_bf16 a[192:195], a[160:163], v[228:231], a[192:195]
    s_waitcnt lgkmcnt(14)
    v_mfma_f32_16x16x32_bf16 v[36:39], a[164:167], v[136:139], v[36:39]
    ds_read_b64_tr_b16 a[132:133], v5 offset:49152
    v_mfma_f32_16x16x32_bf16 v[68:71], a[164:167], v[140:143], v[68:71]
    ds_read_b64_tr_b16 a[134:135], v5 offset:53248
    s_mov_b32 s41, 13312
    buffer_load_dwordx4 v[200:203], v238, s[20:23], s41 offen sc1
    v_mfma_f32_16x16x32_bf16 a[196:199], a[164:167], v[228:231], a[196:199]
    s_waitcnt lgkmcnt(14)
    v_mfma_f32_16x16x32_bf16 v[40:43], a[168:171], v[136:139], v[40:43]
    ds_read_b64_tr_b16 a[136:137], v6 offset:49152
    v_mfma_f32_16x16x32_bf16 v[72:75], a[168:171], v[140:143], v[72:75]
    ds_read_b64_tr_b16 a[138:139], v6 offset:53248
    v_mfma_f32_16x16x32_bf16 a[200:203], a[168:171], v[228:231], a[200:203]
    s_waitcnt lgkmcnt(14)
    v_mfma_f32_16x16x32_bf16 v[44:47], a[172:175], v[136:139], v[44:47]
    ds_read_b64_tr_b16 a[140:141], v7 offset:49152
    v_mfma_f32_16x16x32_bf16 v[76:79], a[172:175], v[140:143], v[76:79]
    ds_read_b64_tr_b16 a[142:143], v7 offset:53248
    s_mov_b32 s41, 29696
    buffer_load_dwordx4 v[204:207], v238, s[20:23], s41 offen sc1
    v_mfma_f32_16x16x32_bf16 a[204:207], a[172:175], v[228:231], a[204:207]
    s_waitcnt lgkmcnt(14)
    v_mfma_f32_16x16x32_bf16 v[48:51], a[176:179], v[136:139], v[48:51]
    ds_read_b64_tr_b16 a[144:145], v8 offset:49152
    v_mfma_f32_16x16x32_bf16 v[80:83], a[176:179], v[140:143], v[80:83]
    ds_read_b64_tr_b16 a[146:147], v8 offset:53248
    v_mfma_f32_16x16x32_bf16 a[208:211], a[176:179], v[228:231], a[208:211]
    s_waitcnt lgkmcnt(14)
    v_mfma_f32_16x16x32_bf16 v[52:55], a[180:183], v[136:139], v[52:55]
    ds_read_b64_tr_b16 a[148:149], v9 offset:49152
    v_mfma_f32_16x16x32_bf16 v[84:87], a[180:183], v[140:143], v[84:87]
    ds_read_b64_tr_b16 a[150:151], v9 offset:53248
    s_add_u32 m0, s63, 122880
    s_mov_b32 s41, 1720320
    buffer_load_dwordx4 v236, s[16:19], s41 offen lds
    v_mfma_f32_16x16x32_bf16 a[212:215], a[180:183], v[228:231], a[212:215]
    s_waitcnt lgkmcnt(14)
    v_mfma_f32_16x16x32_bf16 v[56:59], a[184:187], v[136:139], v[56:59]
    ds_read_b64_tr_b16 a[152:153], v10 offset:49152
    v_mfma_f32_16x16x32_bf16 v[88:91], a[184:187], v[140:143], v[88:91]
    ds_read_b64_tr_b16 a[154:155], v10 offset:53248
    v_mfma_f32_16x16x32_bf16 a[216:219], a[184:187], v[228:231], a[216:219]
    s_waitcnt lgkmcnt(14)
    v_mfma_f32_16x16x32_bf16 v[60:63], a[188:191], v[136:139], v[60:63]
    ds_read_b64_tr_b16 a[156:157], v11 offset:49152
    v_mfma_f32_16x16x32_bf16 v[92:95], a[188:191], v[140:143], v[92:95]
    ds_read_b64_tr_b16 a[158:159], v11 offset:53248
    s_add_u32 m0, s63, 123904
    s_mov_b32 s41, 1720320
    buffer_load_dwordx4 v237, s[16:19], s41 offen lds
    v_mfma_f32_16x16x32_bf16 a[220:223], a[188:191], v[228:231], a[220:223]
    s_waitcnt vmcnt(26)
    s_barrier
    v_mov_b32 v1, v238
    v_lshrrev_b32 v1, 4, v1
    s_lshl_b32 s40, s39, 5
    v_min_u32 v27, 31, v1
    v_add_u32 v27, s40, v27
    v_lshlrev_b32 v27, 7, v27
    v_add_u32 v27, 65536, v27
    buffer_load_dword v26, v27, s[44:47], 0 offen sc1
    s_waitcnt lgkmcnt(14)
    v_mfma_f32_16x16x32_bf16 v[32:35], a[128:131], v[144:147], v[32:35]
    ds_read_b64_tr_b16 a[160:161], v4 offset:57344
    v_mfma_f32_16x16x32_bf16 v[64:67], a[128:131], v[148:151], v[64:67]
    ds_read_b64_tr_b16 a[162:163], v4 offset:61440
    v_mfma_f32_16x16x32_bf16 a[192:195], a[128:131], v[228:231], a[192:195]
    s_waitcnt lgkmcnt(14)
    v_mfma_f32_16x16x32_bf16 v[36:39], a[132:135], v[144:147], v[36:39]
    ds_read_b64_tr_b16 a[164:165], v5 offset:57344
    v_mfma_f32_16x16x32_bf16 v[68:71], a[132:135], v[148:151], v[68:71]
    ds_read_b64_tr_b16 a[166:167], v5 offset:61440
    s_mov_b32 s41, 14336
    buffer_load_dwordx4 v[208:211], v238, s[20:23], s41 offen sc1
    v_mfma_f32_16x16x32_bf16 a[196:199], a[132:135], v[228:231], a[196:199]
    s_waitcnt lgkmcnt(14)
    v_mfma_f32_16x16x32_bf16 v[40:43], a[136:139], v[144:147], v[40:43]
    ds_read_b64_tr_b16 a[168:169], v6 offset:57344
    v_mfma_f32_16x16x32_bf16 v[72:75], a[136:139], v[148:151], v[72:75]
    ds_read_b64_tr_b16 a[170:171], v6 offset:61440
    v_mfma_f32_16x16x32_bf16 a[200:203], a[136:139], v[228:231], a[200:203]
    s_waitcnt lgkmcnt(14)
    v_mfma_f32_16x16x32_bf16 v[44:47], a[140:143], v[144:147], v[44:47]
    ds_read_b64_tr_b16 a[172:173], v7 offset:57344
    v_mfma_f32_16x16x32_bf16 v[76:79], a[140:143], v[148:151], v[76:79]
    ds_read_b64_tr_b16 a[174:175], v7 offset:61440
    s_mov_b32 s41, 30720
    buffer_load_dwordx4 v[212:215], v238, s[20:23], s41 offen sc1
    v_mfma_f32_16x16x32_bf16 a[204:207], a[140:143], v[228:231], a[204:207]
    s_waitcnt lgkmcnt(14)
    v_mfma_f32_16x16x32_bf16 v[48:51], a[144:147], v[144:147], v[48:51]
    ds_read_b64_tr_b16 a[176:177], v8 offset:57344
    v_mfma_f32_16x16x32_bf16 v[80:83], a[144:147], v[148:151], v[80:83]
    ds_read_b64_tr_b16 a[178:179], v8 offset:61440
    v_mfma_f32_16x16x32_bf16 a[208:211], a[144:147], v[228:231], a[208:211]
    s_waitcnt lgkmcnt(14)
    v_mfma_f32_16x16x32_bf16 v[52:55], a[148:151], v[144:147], v[52:55]
    ds_read_b64_tr_b16 a[180:181], v9 offset:57344
    v_mfma_f32_16x16x32_bf16 v[84:87], a[148:151], v[148:151], v[84:87]
    ds_read_b64_tr_b16 a[182:183], v9 offset:61440
    v_mfma_f32_16x16x32_bf16 a[212:215], a[148:151], v[228:231], a[212:215]
    s_waitcnt lgkmcnt(14)
    v_mfma_f32_16x16x32_bf16 v[56:59], a[152:155], v[144:147], v[56:59]
    ds_read_b64_tr_b16 a[184:185], v10 offset:57344
    v_mfma_f32_16x16x32_bf16 v[88:91], a[152:155], v[148:151], v[88:91]
    ds_read_b64_tr_b16 a[186:187], v10 offset:61440
    v_mfma_f32_16x16x32_bf16 a[216:219], a[152:155], v[228:231], a[216:219]
    s_waitcnt lgkmcnt(14)
    v_mfma_f32_16x16x32_bf16 v[60:63], a[156:159], v[144:147], v[60:63]
    ds_read_b64_tr_b16 a[188:189], v11 offset:57344
    v_mfma_f32_16x16x32_bf16 v[92:95], a[156:159], v[148:151], v[92:95]
    ds_read_b64_tr_b16 a[190:191], v11 offset:61440
    v_mfma_f32_16x16x32_bf16 a[220:223], a[156:159], v[228:231], a[220:223]
    s_waitcnt lgkmcnt(14)
    v_mfma_f32_16x16x32_bf16 v[32:35], a[160:163], v[152:155], v[32:35]
    ds_read_b64_tr_b16 a[128:129], v12 offset:0
    v_mfma_f32_16x16x32_bf16 v[64:67], a[160:163], v[156:159], v[64:67]
    ds_read_b64_tr_b16 a[130:131], v12 offset:4096
    v_mfma_f32_16x16x32_bf16 a[192:195], a[160:163], v[228:231], a[192:195]
    s_waitcnt lgkmcnt(14)
    v_mfma_f32_16x16x32_bf16 v[36:39], a[164:167], v[152:155], v[36:39]
    ds_read_b64_tr_b16 a[132:133], v13 offset:0
    v_mfma_f32_16x16x32_bf16 v[68:71], a[164:167], v[156:159], v[68:71]
    ds_read_b64_tr_b16 a[134:135], v13 offset:4096
    s_mov_b32 s41, 15360
    buffer_load_dwordx4 v[216:219], v238, s[20:23], s41 offen sc1
    v_mfma_f32_16x16x32_bf16 a[196:199], a[164:167], v[228:231], a[196:199]
    s_waitcnt lgkmcnt(14)
    v_mfma_f32_16x16x32_bf16 v[40:43], a[168:171], v[152:155], v[40:43]
    ds_read_b64_tr_b16 a[136:137], v14 offset:0
    v_mfma_f32_16x16x32_bf16 v[72:75], a[168:171], v[156:159], v[72:75]
    ds_read_b64_tr_b16 a[138:139], v14 offset:4096
    v_mfma_f32_16x16x32_bf16 a[200:203], a[168:171], v[228:231], a[200:203]
    s_waitcnt lgkmcnt(14)
    v_mfma_f32_16x16x32_bf16 v[44:47], a[172:175], v[152:155], v[44:47]
    ds_read_b64_tr_b16 a[140:141], v15 offset:0
    v_mfma_f32_16x16x32_bf16 v[76:79], a[172:175], v[156:159], v[76:79]
    ds_read_b64_tr_b16 a[142:143], v15 offset:4096
    s_mov_b32 s41, 31744
    buffer_load_dwordx4 v[220:223], v238, s[20:23], s41 offen sc1
    v_mfma_f32_16x16x32_bf16 a[204:207], a[172:175], v[228:231], a[204:207]
    s_waitcnt lgkmcnt(14)
    v_mfma_f32_16x16x32_bf16 v[48:51], a[176:179], v[152:155], v[48:51]
    ds_read_b64_tr_b16 a[144:145], v16 offset:0
    v_mfma_f32_16x16x32_bf16 v[80:83], a[176:179], v[156:159], v[80:83]
    ds_read_b64_tr_b16 a[146:147], v16 offset:4096
    v_mfma_f32_16x16x32_bf16 a[208:211], a[176:179], v[228:231], a[208:211]
    s_waitcnt lgkmcnt(14)
    v_mfma_f32_16x16x32_bf16 v[52:55], a[180:183], v[152:155], v[52:55]
    ds_read_b64_tr_b16 a[148:149], v17 offset:0
    v_mfma_f32_16x16x32_bf16 v[84:87], a[180:183], v[156:159], v[84:87]
    ds_read_b64_tr_b16 a[150:151], v17 offset:4096
    v_mfma_f32_16x16x32_bf16 a[212:215], a[180:183], v[228:231], a[212:215]
    s_waitcnt lgkmcnt(14)
    v_mfma_f32_16x16x32_bf16 v[56:59], a[184:187], v[152:155], v[56:59]
    ds_read_b64_tr_b16 a[152:153], v18 offset:0
    v_mfma_f32_16x16x32_bf16 v[88:91], a[184:187], v[156:159], v[88:91]
    ds_read_b64_tr_b16 a[154:155], v18 offset:4096
    v_mfma_f32_16x16x32_bf16 a[216:219], a[184:187], v[228:231], a[216:219]
    s_waitcnt lgkmcnt(14)
    v_mfma_f32_16x16x32_bf16 v[60:63], a[188:191], v[152:155], v[60:63]
    ds_read_b64_tr_b16 a[156:157], v19 offset:0
    v_mfma_f32_16x16x32_bf16 v[92:95], a[188:191], v[156:159], v[92:95]
    ds_read_b64_tr_b16 a[158:159], v19 offset:4096
    v_mfma_f32_16x16x32_bf16 a[220:223], a[188:191], v[228:231], a[220:223]
    s_waitcnt vmcnt(23)
    s_barrier
    s_waitcnt lgkmcnt(14)
    v_mfma_f32_16x16x32_bf16 v[32:35], a[128:131], v[160:163], v[32:35]
    ds_read_b64_tr_b16 a[160:161], v12 offset:8192
    v_mfma_f32_16x16x32_bf16 v[64:67], a[128:131], v[164:167], v[64:67]
    ds_read_b64_tr_b16 a[162:163], v12 offset:12288
    v_mfma_f32_16x16x32_bf16 a[192:195], a[128:131], v[228:231], a[192:195]
    s_waitcnt lgkmcnt(14)
    v_mfma_f32_16x16x32_bf16 v[36:39], a[132:135], v[160:163], v[36:39]
    ds_read_b64_tr_b16 a[164:165], v13 offset:8192
    v_mfma_f32_16x16x32_bf16 v[68:71], a[132:135], v[164:167], v[68:71]
    ds_read_b64_tr_b16 a[166:167], v13 offset:12288
    v_mfma_f32_16x16x32_bf16 a[196:199], a[132:135], v[228:231], a[196:199]
    s_waitcnt lgkmcnt(14)
    v_mfma_f32_16x16x32_bf16 v[40:43], a[136:139], v[160:163], v[40:43]
    ds_read_b64_tr_b16 a[168:169], v14 offset:8192
    v_mfma_f32_16x16x32_bf16 v[72:75], a[136:139], v[164:167], v[72:75]
    ds_read_b64_tr_b16 a[170:171], v14 offset:12288
    v_mfma_f32_16x16x32_bf16 a[200:203], a[136:139], v[228:231], a[200:203]
    s_waitcnt lgkmcnt(14)
    v_mfma_f32_16x16x32_bf16 v[44:47], a[140:143], v[160:163], v[44:47]
    ds_read_b64_tr_b16 a[172:173], v15 offset:8192
    v_mfma_f32_16x16x32_bf16 v[76:79], a[140:143], v[164:167], v[76:79]
    ds_read_b64_tr_b16 a[174:175], v15 offset:12288
    v_mfma_f32_16x16x32_bf16 a[204:207], a[140:143], v[228:231], a[204:207]
    s_waitcnt lgkmcnt(14)
    v_mfma_f32_16x16x32_bf16 v[48:51], a[144:147], v[160:163], v[48:51]
    ds_read_b64_tr_b16 a[176:177], v16 offset:8192
    v_mfma_f32_16x16x32_bf16 v[80:83], a[144:147], v[164:167], v[80:83]
    ds_read_b64_tr_b16 a[178:179], v16 offset:12288
    v_mfma_f32_16x16x32_bf16 a[208:211], a[144:147], v[228:231], a[208:211]
    s_waitcnt lgkmcnt(14)
    v_mfma_f32_16x16x32_bf16 v[52:55], a[148:151], v[160:163], v[52:55]
    ds_read_b64_tr_b16 a[180:181], v17 offset:8192
    v_mfma_f32_16x16x32_bf16 v[84:87], a[148:151], v[164:167], v[84:87]
    ds_read_b64_tr_b16 a[182:183], v17 offset:12288
    v_mfma_f32_16x16x32_bf16 a[212:215], a[148:151], v[228:231], a[212:215]
    s_waitcnt lgkmcnt(14)
    v_mfma_f32_16x16x32_bf16 v[56:59], a[152:155], v[160:163], v[56:59]
    ds_read_b64_tr_b16 a[184:185], v18 offset:8192
    v_mfma_f32_16x16x32_bf16 v[88:91], a[152:155], v[164:167], v[88:91]
    ds_read_b64_tr_b16 a[186:187], v18 offset:12288
    v_mfma_f32_16x16x32_bf16 a[216:219], a[152:155], v[228:231], a[216:219]
    s_waitcnt lgkmcnt(14)
    v_mfma_f32_16x16x32_bf16 v[60:63], a[156:159], v[160:163], v[60:63]
    ds_read_b64_tr_b16 a[188:189], v19 offset:8192
    v_mfma_f32_16x16x32_bf16 v[92:95], a[156:159], v[164:167], v[92:95]
    ds_read_b64_tr_b16 a[190:191], v19 offset:12288
    v_mfma_f32_16x16x32_bf16 a[220:223], a[156:159], v[228:231], a[220:223]
    s_waitcnt lgkmcnt(14)
    v_mfma_f32_16x16x32_bf16 v[32:35], a[160:163], v[168:171], v[32:35]
    ds_read_b64_tr_b16 a[128:129], v12 offset:16384
    v_mfma_f32_16x16x32_bf16 v[64:67], a[160:163], v[172:175], v[64:67]
    ds_read_b64_tr_b16 a[130:131], v12 offset:20480
    v_mfma_f32_16x16x32_bf16 a[192:195], a[160:163], v[228:231], a[192:195]
    s_waitcnt lgkmcnt(14)
    v_mfma_f32_16x16x32_bf16 v[36:39], a[164:167], v[168:171], v[36:39]
    ds_read_b64_tr_b16 a[132:133], v13 offset:16384
    v_mfma_f32_16x16x32_bf16 v[68:71], a[164:167], v[172:175], v[68:71]
    ds_read_b64_tr_b16 a[134:135], v13 offset:20480
    v_mfma_f32_16x16x32_bf16 a[196:199], a[164:167], v[228:231], a[196:199]
    s_waitcnt lgkmcnt(14)
    v_mfma_f32_16x16x32_bf16 v[40:43], a[168:171], v[168:171], v[40:43]
    ds_read_b64_tr_b16 a[136:137], v14 offset:16384
    v_mfma_f32_16x16x32_bf16 v[72:75], a[168:171], v[172:175], v[72:75]
    ds_read_b64_tr_b16 a[138:139], v14 offset:20480
    v_mfma_f32_16x16x32_bf16 a[200:203], a[168:171], v[228:231], a[200:203]
    s_waitcnt lgkmcnt(14)
    v_mfma_f32_16x16x32_bf16 v[44:47], a[172:175], v[168:171], v[44:47]
    ds_read_b64_tr_b16 a[140:141], v15 offset:16384
    v_mfma_f32_16x16x32_bf16 v[76:79], a[172:175], v[172:175], v[76:79]
    ds_read_b64_tr_b16 a[142:143], v15 offset:20480
    v_mfma_f32_16x16x32_bf16 a[204:207], a[172:175], v[228:231], a[204:207]
    s_waitcnt lgkmcnt(14)
    v_mfma_f32_16x16x32_bf16 v[48:51], a[176:179], v[168:171], v[48:51]
    ds_read_b64_tr_b16 a[144:145], v16 offset:16384
    v_mfma_f32_16x16x32_bf16 v[80:83], a[176:179], v[172:175], v[80:83]
    ds_read_b64_tr_b16 a[146:147], v16 offset:20480
    v_mfma_f32_16x16x32_bf16 a[208:211], a[176:179], v[228:231], a[208:211]
    s_waitcnt lgkmcnt(14)
    v_mfma_f32_16x16x32_bf16 v[52:55], a[180:183], v[168:171], v[52:55]
    ds_read_b64_tr_b16 a[148:149], v17 offset:16384
    v_mfma_f32_16x16x32_bf16 v[84:87], a[180:183], v[172:175], v[84:87]
    ds_read_b64_tr_b16 a[150:151], v17 offset:20480
    v_mfma_f32_16x16x32_bf16 a[212:215], a[180:183], v[228:231], a[212:215]
    s_waitcnt lgkmcnt(14)
    v_mfma_f32_16x16x32_bf16 v[56:59], a[184:187], v[168:171], v[56:59]
    ds_read_b64_tr_b16 a[152:153], v18 offset:16384
    v_mfma_f32_16x16x32_bf16 v[88:91], a[184:187], v[172:175], v[88:91]
    ds_read_b64_tr_b16 a[154:155], v18 offset:20480
    v_mfma_f32_16x16x32_bf16 a[216:219], a[184:187], v[228:231], a[216:219]
    s_waitcnt lgkmcnt(14)
    v_mfma_f32_16x16x32_bf16 v[60:63], a[188:191], v[168:171], v[60:63]
    ds_read_b64_tr_b16 a[156:157], v19 offset:16384
    v_mfma_f32_16x16x32_bf16 v[92:95], a[188:191], v[172:175], v[92:95]
    ds_read_b64_tr_b16 a[158:159], v19 offset:20480
    v_mfma_f32_16x16x32_bf16 a[220:223], a[188:191], v[228:231], a[220:223]
    s_waitcnt vmcnt(15)
    s_barrier
    s_waitcnt vmcnt(4)
    v_cmp_ne_u32 vcc, s36, v26
    s_nop 4
    s_cmp_eq_u64 vcc, 0
    s_cbranch_scc1 L_pok_fw
    s_mov_b32 s37, 0
L_spin_fw:
    buffer_load_dword v26, v27, s[44:47], 0 offen sc1
    s_add_u32 s37, s37, 1
    s_cmp_gt_u32 s37, 0x20000
    s_cbranch_scc1 recurrent_scan__mha_block_cached__mixer_s_mlp__prompt_kernel_end
    s_waitcnt vmcnt(0)
    v_cmp_ne_u32 vcc, s36, v26
    s_nop 4
    s_cmp_lg_u64 vcc, 0
    s_cbranch_scc1 L_spin_fw
L_pok_fw:
    s_lshl_b32 s40, s42, 7
    s_lshl_b32 s41, s3, 5
    s_add_u32 s40, s40, s41
    v_add_u32 v24, s40, v239
    v_lshlrev_b32 v24, 6, v24
    buffer_load_dwordx4 a[224:227], v24, s[48:51], 0 offen offset:0 sc1
    buffer_load_dwordx4 a[240:243], v24, s[48:51], 0 offen offset:1024 sc1
    buffer_load_dwordx4 a[228:231], v24, s[48:51], 0 offen offset:16 sc1
    buffer_load_dwordx4 a[244:247], v24, s[48:51], 0 offen offset:1040 sc1
    buffer_load_dwordx4 a[232:235], v24, s[48:51], 0 offen offset:32 sc1
    buffer_load_dwordx4 a[248:251], v24, s[48:51], 0 offen offset:1056 sc1
    buffer_load_dwordx4 a[236:239], v24, s[48:51], 0 offen offset:48 sc1
    buffer_load_dwordx4 a[252:255], v24, s[48:51], 0 offen offset:1072 sc1
    s_waitcnt lgkmcnt(14)
    v_mfma_f32_16x16x32_bf16 v[32:35], a[128:131], v[176:179], v[32:35]
    ds_read_b64_tr_b16 a[160:161], v12 offset:24576
    v_mfma_f32_16x16x32_bf16 v[64:67], a[128:131], v[180:183], v[64:67]
    ds_read_b64_tr_b16 a[162:163], v12 offset:28672
    v_mfma_f32_16x16x32_bf16 a[192:195], a[128:131], v[228:231], a[192:195]
    s_waitcnt lgkmcnt(14)
    v_mfma_f32_16x16x32_bf16 v[36:39], a[132:135], v[176:179], v[36:39]
    ds_read_b64_tr_b16 a[164:165], v13 offset:24576
    v_mfma_f32_16x16x32_bf16 v[68:71], a[132:135], v[180:183], v[68:71]
    ds_read_b64_tr_b16 a[166:167], v13 offset:28672
    v_mfma_f32_16x16x32_bf16 a[196:199], a[132:135], v[228:231], a[196:199]
    s_waitcnt lgkmcnt(14)
    v_mfma_f32_16x16x32_bf16 v[40:43], a[136:139], v[176:179], v[40:43]
    ds_read_b64_tr_b16 a[168:169], v14 offset:24576
    v_mfma_f32_16x16x32_bf16 v[72:75], a[136:139], v[180:183], v[72:75]
    ds_read_b64_tr_b16 a[170:171], v14 offset:28672
    v_mfma_f32_16x16x32_bf16 a[200:203], a[136:139], v[228:231], a[200:203]
    s_waitcnt lgkmcnt(14)
    v_mfma_f32_16x16x32_bf16 v[44:47], a[140:143], v[176:179], v[44:47]
    ds_read_b64_tr_b16 a[172:173], v15 offset:24576
    v_mfma_f32_16x16x32_bf16 v[76:79], a[140:143], v[180:183], v[76:79]
    ds_read_b64_tr_b16 a[174:175], v15 offset:28672
    v_mfma_f32_16x16x32_bf16 a[204:207], a[140:143], v[228:231], a[204:207]
    s_waitcnt lgkmcnt(14)
    v_mfma_f32_16x16x32_bf16 v[48:51], a[144:147], v[176:179], v[48:51]
    ds_read_b64_tr_b16 a[176:177], v16 offset:24576
    v_mfma_f32_16x16x32_bf16 v[80:83], a[144:147], v[180:183], v[80:83]
    ds_read_b64_tr_b16 a[178:179], v16 offset:28672
    v_mfma_f32_16x16x32_bf16 a[208:211], a[144:147], v[228:231], a[208:211]
    s_waitcnt lgkmcnt(14)
    v_mfma_f32_16x16x32_bf16 v[52:55], a[148:151], v[176:179], v[52:55]
    ds_read_b64_tr_b16 a[180:181], v17 offset:24576
    v_mfma_f32_16x16x32_bf16 v[84:87], a[148:151], v[180:183], v[84:87]
    ds_read_b64_tr_b16 a[182:183], v17 offset:28672
    v_mfma_f32_16x16x32_bf16 a[212:215], a[148:151], v[228:231], a[212:215]
    s_waitcnt lgkmcnt(14)
    v_mfma_f32_16x16x32_bf16 v[56:59], a[152:155], v[176:179], v[56:59]
    ds_read_b64_tr_b16 a[184:185], v18 offset:24576
    v_mfma_f32_16x16x32_bf16 v[88:91], a[152:155], v[180:183], v[88:91]
    ds_read_b64_tr_b16 a[186:187], v18 offset:28672
    v_mfma_f32_16x16x32_bf16 a[216:219], a[152:155], v[228:231], a[216:219]
    s_waitcnt lgkmcnt(14)
    v_mfma_f32_16x16x32_bf16 v[60:63], a[156:159], v[176:179], v[60:63]
    ds_read_b64_tr_b16 a[188:189], v19 offset:24576
    v_mfma_f32_16x16x32_bf16 v[92:95], a[156:159], v[180:183], v[92:95]
    ds_read_b64_tr_b16 a[190:191], v19 offset:28672
    v_mfma_f32_16x16x32_bf16 a[220:223], a[156:159], v[228:231], a[220:223]
    s_waitcnt lgkmcnt(14)
    v_mfma_f32_16x16x32_bf16 v[32:35], a[160:163], v[184:187], v[32:35]
    ds_read_b64_tr_b16 a[128:129], v12 offset:32768
    v_mfma_f32_16x16x32_bf16 v[64:67], a[160:163], v[188:191], v[64:67]
    ds_read_b64_tr_b16 a[130:131], v12 offset:36864
    v_mfma_f32_16x16x32_bf16 a[192:195], a[160:163], v[228:231], a[192:195]
    s_waitcnt lgkmcnt(14)
    v_mfma_f32_16x16x32_bf16 v[36:39], a[164:167], v[184:187], v[36:39]
    ds_read_b64_tr_b16 a[132:133], v13 offset:32768
    v_mfma_f32_16x16x32_bf16 v[68:71], a[164:167], v[188:191], v[68:71]
    ds_read_b64_tr_b16 a[134:135], v13 offset:36864
    v_mfma_f32_16x16x32_bf16 a[196:199], a[164:167], v[228:231], a[196:199]
    s_waitcnt lgkmcnt(14)
    v_mfma_f32_16x16x32_bf16 v[40:43], a[168:171], v[184:187], v[40:43]
    ds_read_b64_tr_b16 a[136:137], v14 offset:32768
    v_mfma_f32_16x16x32_bf16 v[72:75], a[168:171], v[188:191], v[72:75]
    ds_read_b64_tr_b16 a[138:139], v14 offset:36864
    v_mfma_f32_16x16x32_bf16 a[200:203], a[168:171], v[228:231], a[200:203]
    s_waitcnt lgkmcnt(14)
    v_mfma_f32_16x16x32_bf16 v[44:47], a[172:175], v[184:187], v[44:47]
    ds_read_b64_tr_b16 a[140:141], v15 offset:32768
    v_mfma_f32_16x16x32_bf16 v[76:79], a[172:175], v[188:191], v[76:79]
    ds_read_b64_tr_b16 a[142:143], v15 offset:36864
    v_mfma_f32_16x16x32_bf16 a[204:207], a[172:175], v[228:231], a[204:207]
    s_waitcnt lgkmcnt(14)
    v_mfma_f32_16x16x32_bf16 v[48:51], a[176:179], v[184:187], v[48:51]
    ds_read_b64_tr_b16 a[144:145], v16 offset:32768
    v_mfma_f32_16x16x32_bf16 v[80:83], a[176:179], v[188:191], v[80:83]
    ds_read_b64_tr_b16 a[146:147], v16 offset:36864
    v_mfma_f32_16x16x32_bf16 a[208:211], a[176:179], v[228:231], a[208:211]
    s_waitcnt lgkmcnt(14)
    v_mfma_f32_16x16x32_bf16 v[52:55], a[180:183], v[184:187], v[52:55]
    ds_read_b64_tr_b16 a[148:149], v17 offset:32768
    v_mfma_f32_16x16x32_bf16 v[84:87], a[180:183], v[188:191], v[84:87]
    ds_read_b64_tr_b16 a[150:151], v17 offset:36864
    v_mfma_f32_16x16x32_bf16 a[212:215], a[180:183], v[228:231], a[212:215]
    s_waitcnt lgkmcnt(14)
    v_mfma_f32_16x16x32_bf16 v[56:59], a[184:187], v[184:187], v[56:59]
    ds_read_b64_tr_b16 a[152:153], v18 offset:32768
    v_mfma_f32_16x16x32_bf16 v[88:91], a[184:187], v[188:191], v[88:91]
    ds_read_b64_tr_b16 a[154:155], v18 offset:36864
    v_mfma_f32_16x16x32_bf16 a[216:219], a[184:187], v[228:231], a[216:219]
    s_waitcnt lgkmcnt(14)
    v_mfma_f32_16x16x32_bf16 v[60:63], a[188:191], v[184:187], v[60:63]
    ds_read_b64_tr_b16 a[156:157], v19 offset:32768
    v_mfma_f32_16x16x32_bf16 v[92:95], a[188:191], v[188:191], v[92:95]
    ds_read_b64_tr_b16 a[158:159], v19 offset:36864
    v_mfma_f32_16x16x32_bf16 a[220:223], a[188:191], v[228:231], a[220:223]
    s_barrier
    s_lshl_b32 s61, s3, 15
    s_cmp_eq_u32 s3, 3
    s_cselect_b32 s61, 0x20000, s61
    s_mul_i32 s41, s39, 753664
    s_add_u32 s16, s34, 0x3000000
    s_addc_u32 s17, s35, 0
    s_add_u32 s16, s16, s41
    s_addc_u32 s17, s17, 0
    s_mov_b32 s18, 0xb8000
    s_mov_b32 s19, 0x20000
    s_lshl_b32 s62, s3, 17
    s_mul_i32 s63, s3, 57344
    s_add_u32 s63, s63, 524288
    s_waitcnt lgkmcnt(14)
    v_mfma_f32_16x16x32_bf16 v[32:35], a[128:131], v[192:195], v[32:35]
    ds_read_b64_tr_b16 a[160:161], v12 offset:40960
    v_mfma_f32_16x16x32_bf16 v[64:67], a[128:131], v[196:199], v[64:67]
    ds_read_b64_tr_b16 a[162:163], v12 offset:45056
    s_add_u32 m0, s61, 0
    s_add_u32 s33, s62, 0
    buffer_load_dwordx4 v238, s[16:19], s33 offen sc1 lds
    v_mfma_f32_16x16x32_bf16 a[192:195], a[128:131], v[228:231], a[192:195]
    s_waitcnt lgkmcnt(14)
    v_mfma_f32_16x16x32_bf16 v[36:39], a[132:135], v[192:195], v[36:39]
    ds_read_b64_tr_b16 a[164:165], v13 offset:40960
    v_mfma_f32_16x16x32_bf16 v[68:71], a[132:135], v[196:199], v[68:71]
    ds_read_b64_tr_b16 a[166:167], v13 offset:45056
    s_add_u32 m0, s61, 1024
    s_add_u32 s33, s62, 1024
    buffer_load_dwordx4 v238, s[16:19], s33 offen sc1 lds
    v_mfma_f32_16x16x32_bf16 a[196:199], a[132:135], v[228:231], a[196:199]
    s_waitcnt lgkmcnt(14)
    v_mfma_f32_16x16x32_bf16 v[40:43], a[136:139], v[192:195], v[40:43]
    ds_read_b64_tr_b16 a[168:169], v14 offset:40960
    v_mfma_f32_16x16x32_bf16 v[72:75], a[136:139], v[196:199], v[72:75]
    ds_read_b64_tr_b16 a[170:171], v14 offset:45056
    s_add_u32 m0, s61, 2048
    s_add_u32 s33, s62, 2048
    buffer_load_dwordx4 v238, s[16:19], s33 offen sc1 lds
    v_mfma_f32_16x16x32_bf16 a[200:203], a[136:139], v[228:231], a[200:203]
    s_waitcnt lgkmcnt(14)
    v_mfma_f32_16x16x32_bf16 v[44:47], a[140:143], v[192:195], v[44:47]
    ds_read_b64_tr_b16 a[172:173], v15 offset:40960
    v_mfma_f32_16x16x32_bf16 v[76:79], a[140:143], v[196:199], v[76:79]
    ds_read_b64_tr_b16 a[174:175], v15 offset:45056
    s_add_u32 m0, s61, 3072
    s_add_u32 s33, s62, 3072
    buffer_load_dwordx4 v238, s[16:19], s33 offen sc1 lds
    v_mfma_f32_16x16x32_bf16 a[204:207], a[140:143], v[228:231], a[204:207]
    s_waitcnt lgkmcnt(14)
    v_mfma_f32_16x16x32_bf16 v[48:51], a[144:147], v[192:195], v[48:51]
    ds_read_b64_tr_b16 a[176:177], v16 offset:40960
    v_mfma_f32_16x16x32_bf16 v[80:83], a[144:147], v[196:199], v[80:83]
    ds_read_b64_tr_b16 a[178:179], v16 offset:45056
    s_add_u32 m0, s61, 4096
    s_add_u32 s33, s62, 4096
    buffer_load_dwordx4 v238, s[16:19], s33 offen sc1 lds
    v_mfma_f32_16x16x32_bf16 a[208:211], a[144:147], v[228:231], a[208:211]
    s_waitcnt lgkmcnt(14)
    v_mfma_f32_16x16x32_bf16 v[52:55], a[148:151], v[192:195], v[52:55]
    ds_read_b64_tr_b16 a[180:181], v17 offset:40960
    v_mfma_f32_16x16x32_bf16 v[84:87], a[148:151], v[196:199], v[84:87]
    ds_read_b64_tr_b16 a[182:183], v17 offset:45056
    s_add_u32 m0, s61, 5120
    s_add_u32 s33, s62, 5120
    buffer_load_dwordx4 v238, s[16:19], s33 offen sc1 lds
    v_mfma_f32_16x16x32_bf16 a[212:215], a[148:151], v[228:231], a[212:215]
    s_waitcnt lgkmcnt(14)
    v_mfma_f32_16x16x32_bf16 v[56:59], a[152:155], v[192:195], v[56:59]
    ds_read_b64_tr_b16 a[184:185], v18 offset:40960
    v_mfma_f32_16x16x32_bf16 v[88:91], a[152:155], v[196:199], v[88:91]
    ds_read_b64_tr_b16 a[186:187], v18 offset:45056
    s_add_u32 m0, s61, 6144
    s_add_u32 s33, s62, 6144
    buffer_load_dwordx4 v238, s[16:19], s33 offen sc1 lds
    v_mfma_f32_16x16x32_bf16 a[216:219], a[152:155], v[228:231], a[216:219]
    s_waitcnt lgkmcnt(14)
    v_mfma_f32_16x16x32_bf16 v[60:63], a[156:159], v[192:195], v[60:63]
    ds_read_b64_tr_b16 a[188:189], v19 offset:40960
    v_mfma_f32_16x16x32_bf16 v[92:95], a[156:159], v[196:199], v[92:95]
    ds_read_b64_tr_b16 a[190:191], v19 offset:45056
    s_add_u32 m0, s61, 7168
    s_add_u32 s33, s62, 7168
    buffer_load_dwordx4 v238, s[16:19], s33 offen sc1 lds
    v_mfma_f32_16x16x32_bf16 a[220:223], a[156:159], v[228:231], a[220:223]
    s_waitcnt lgkmcnt(14)
    v_mfma_f32_16x16x32_bf16 v[32:35], a[160:163], v[200:203], v[32:35]
    ds_read_b64_tr_b16 a[128:129], v12 offset:49152
    v_mfma_f32_16x16x32_bf16 v[64:67], a[160:163], v[204:207], v[64:67]
    ds_read_b64_tr_b16 a[130:131], v12 offset:53248
    s_add_u32 m0, s61, 8192
    s_add_u32 s33, s62, 8192
    buffer_load_dwordx4 v238, s[16:19], s33 offen sc1 lds
    v_mfma_f32_16x16x32_bf16 a[192:195], a[160:163], v[228:231], a[192:195]
    s_waitcnt lgkmcnt(14)
    v_mfma_f32_16x16x32_bf16 v[36:39], a[164:167], v[200:203], v[36:39]
    ds_read_b64_tr_b16 a[132:133], v13 offset:49152
    v_mfma_f32_16x16x32_bf16 v[68:71], a[164:167], v[204:207], v[68:71]
    ds_read_b64_tr_b16 a[134:135], v13 offset:53248
    s_add_u32 m0, s61, 9216
    s_add_u32 s33, s62, 9216
    buffer_load_dwordx4 v238, s[16:19], s33 offen sc1 lds
    v_mfma_f32_16x16x32_bf16 a[196:199], a[164:167], v[228:231], a[196:199]
    s_waitcnt lgkmcnt(14)
    v_mfma_f32_16x16x32_bf16 v[40:43], a[168:171], v[200:203], v[40:43]
    ds_read_b64_tr_b16 a[136:137], v14 offset:49152
    v_mfma_f32_16x16x32_bf16 v[72:75], a[168:171], v[204:207], v[72:75]
    ds_read_b64_tr_b16 a[138:139], v14 offset:53248
    s_add_u32 m0, s61, 10240
    s_add_u32 s33, s62, 10240
    buffer_load_dwordx4 v238, s[16:19], s33 offen sc1 lds
    v_mfma_f32_16x16x32_bf16 a[200:203], a[168:171], v[228:231], a[200:203]
    s_waitcnt lgkmcnt(14)
    v_mfma_f32_16x16x32_bf16 v[44:47], a[172:175], v[200:203], v[44:47]
    ds_read_b64_tr_b16 a[140:141], v15 offset:49152
    v_mfma_f32_16x16x32_bf16 v[76:79], a[172:175], v[204:207], v[76:79]
    ds_read_b64_tr_b16 a[142:143], v15 offset:53248
    s_add_u32 m0, s61, 11264
    s_add_u32 s33, s62, 11264
    buffer_load_dwordx4 v238, s[16:19], s33 offen sc1 lds
    v_mfma_f32_16x16x32_bf16 a[204:207], a[172:175], v[228:231], a[204:207]
    s_waitcnt lgkmcnt(14)
    v_mfma_f32_16x16x32_bf16 v[48:51], a[176:179], v[200:203], v[48:51]
    ds_read_b64_tr_b16 a[144:145], v16 offset:49152
    v_mfma_f32_16x16x32_bf16 v[80:83], a[176:179], v[204:207], v[80:83]
    ds_read_b64_tr_b16 a[146:147], v16 offset:53248
    s_add_u32 m0, s61, 12288
    s_add_u32 s33, s62, 12288
    buffer_load_dwordx4 v238, s[16:19], s33 offen sc1 lds
    v_mfma_f32_16x16x32_bf16 a[208:211], a[176:179], v[228:231], a[208:211]
    s_waitcnt lgkmcnt(14)
    v_mfma_f32_16x16x32_bf16 v[52:55], a[180:183], v[200:203], v[52:55]
    ds_read_b64_tr_b16 a[148:149], v17 offset:49152
    v_mfma_f32_16x16x32_bf16 v[84:87], a[180:183], v[204:207], v[84:87]
    ds_read_b64_tr_b16 a[150:151], v17 offset:53248
    s_add_u32 m0, s61, 13312
    s_add_u32 s33, s62, 13312
    buffer_load_dwordx4 v238, s[16:19], s33 offen sc1 lds
    v_mfma_f32_16x16x32_bf16 a[212:215], a[180:183], v[228:231], a[212:215]
    s_waitcnt lgkmcnt(14)
    v_mfma_f32_16x16x32_bf16 v[56:59], a[184:187], v[200:203], v[56:59]
    ds_read_b64_tr_b16 a[152:153], v18 offset:49152
    v_mfma_f32_16x16x32_bf16 v[88:91], a[184:187], v[204:207], v[88:91]
    ds_read_b64_tr_b16 a[154:155], v18 offset:53248
    s_add_u32 m0, s61, 14336
    s_add_u32 s33, s62, 14336
    buffer_load_dwordx4 v238, s[16:19], s33 offen sc1 lds
    v_mfma_f32_16x16x32_bf16 a[216:219], a[184:187], v[228:231], a[216:219]
    s_waitcnt lgkmcnt(14)
    v_mfma_f32_16x16x32_bf16 v[60:63], a[188:191], v[200:203], v[60:63]
    ds_read_b64_tr_b16 a[156:157], v19 offset:49152
    v_mfma_f32_16x16x32_bf16 v[92:95], a[188:191], v[204:207], v[92:95]
    ds_read_b64_tr_b16 a[158:159], v19 offset:53248
    s_add_u32 m0, s61, 15360
    s_add_u32 s33, s62, 15360
    buffer_load_dwordx4 v238, s[16:19], s33 offen sc1 lds
    v_mfma_f32_16x16x32_bf16 a[220:223], a[188:191], v[228:231], a[220:223]
    s_waitcnt vmcnt(24)
    s_barrier
    s_lshr_b32 s40, s38, 2
    s_lshl_b32 s40, s40, 5
    v_mov_b32 v1, v238
    v_lshrrev_b32 v1, 4, v1
    v_min_u32 v29, 31, v1
    v_add_u32 v29, s40, v29
    v_lshlrev_b32 v29, 7, v29
    v_add_u32 v29, 131072, v29
    buffer_load_dword v28, v29, s[44:47], 0 offen sc1
    s_waitcnt lgkmcnt(14)
    v_mfma_f32_16x16x32_bf16 v[32:35], a[128:131], v[208:211], v[32:35]
    ds_read_b64_tr_b16 a[160:161], v12 offset:57344
    v_mfma_f32_16x16x32_bf16 v[64:67], a[128:131], v[212:215], v[64:67]
    ds_read_b64_tr_b16 a[162:163], v12 offset:61440
    s_add_u32 m0, s61, 16384
    s_add_u32 s33, s62, 16384
    buffer_load_dwordx4 v238, s[16:19], s33 offen sc1 lds
    v_mfma_f32_16x16x32_bf16 a[192:195], a[128:131], v[228:231], a[192:195]
    s_waitcnt lgkmcnt(14)
    v_mfma_f32_16x16x32_bf16 v[36:39], a[132:135], v[208:211], v[36:39]
    ds_read_b64_tr_b16 a[164:165], v13 offset:57344
    v_mfma_f32_16x16x32_bf16 v[68:71], a[132:135], v[212:215], v[68:71]
    ds_read_b64_tr_b16 a[166:167], v13 offset:61440
    s_add_u32 m0, s61, 17408
    s_add_u32 s33, s62, 17408
    buffer_load_dwordx4 v238, s[16:19], s33 offen sc1 lds
    v_mfma_f32_16x16x32_bf16 a[196:199], a[132:135], v[228:231], a[196:199]
    s_waitcnt lgkmcnt(14)
    v_mfma_f32_16x16x32_bf16 v[40:43], a[136:139], v[208:211], v[40:43]
    ds_read_b64_tr_b16 a[168:169], v14 offset:57344
    v_mfma_f32_16x16x32_bf16 v[72:75], a[136:139], v[212:215], v[72:75]
    ds_read_b64_tr_b16 a[170:171], v14 offset:61440
    s_add_u32 m0, s61, 18432
    s_add_u32 s33, s62, 18432
    buffer_load_dwordx4 v238, s[16:19], s33 offen sc1 lds
    v_mfma_f32_16x16x32_bf16 a[200:203], a[136:139], v[228:231], a[200:203]
    s_waitcnt lgkmcnt(14)
    v_mfma_f32_16x16x32_bf16 v[44:47], a[140:143], v[208:211], v[44:47]
    ds_read_b64_tr_b16 a[172:173], v15 offset:57344
    v_mfma_f32_16x16x32_bf16 v[76:79], a[140:143], v[212:215], v[76:79]
    ds_read_b64_tr_b16 a[174:175], v15 offset:61440
    s_add_u32 m0, s61, 19456
    s_add_u32 s33, s62, 19456
    buffer_load_dwordx4 v238, s[16:19], s33 offen sc1 lds
    v_mfma_f32_16x16x32_bf16 a[204:207], a[140:143], v[228:231], a[204:207]
    s_waitcnt lgkmcnt(14)
    v_mfma_f32_16x16x32_bf16 v[48:51], a[144:147], v[208:211], v[48:51]
    ds_read_b64_tr_b16 a[176:177], v16 offset:57344
    v_mfma_f32_16x16x32_bf16 v[80:83], a[144:147], v[212:215], v[80:83]
    ds_read_b64_tr_b16 a[178:179], v16 offset:61440
    s_add_u32 m0, s61, 20480
    s_add_u32 s33, s62, 20480
    buffer_load_dwordx4 v238, s[16:19], s33 offen sc1 lds
    v_mfma_f32_16x16x32_bf16 a[208:211], a[144:147], v[228:231], a[208:211]
    s_waitcnt lgkmcnt(14)
    v_mfma_f32_16x16x32_bf16 v[52:55], a[148:151], v[208:211], v[52:55]
    ds_read_b64_tr_b16 a[180:181], v17 offset:57344
    v_mfma_f32_16x16x32_bf16 v[84:87], a[148:151], v[212:215], v[84:87]
    ds_read_b64_tr_b16 a[182:183], v17 offset:61440
    s_add_u32 m0, s61, 21504
    s_add_u32 s33, s62, 21504
    buffer_load_dwordx4 v238, s[16:19], s33 offen sc1 lds
    v_mfma_f32_16x16x32_bf16 a[212:215], a[148:151], v[228:231], a[212:215]
    s_waitcnt lgkmcnt(14)
    v_mfma_f32_16x16x32_bf16 v[56:59], a[152:155], v[208:211], v[56:59]
    ds_read_b64_tr_b16 a[184:185], v18 offset:57344
    v_mfma_f32_16x16x32_bf16 v[88:91], a[152:155], v[212:215], v[88:91]
    ds_read_b64_tr_b16 a[186:187], v18 offset:61440
    s_add_u32 m0, s61, 22528
    s_add_u32 s33, s62, 22528
    buffer_load_dwordx4 v238, s[16:19], s33 offen sc1 lds
    v_mfma_f32_16x16x32_bf16 a[216:219], a[152:155], v[228:231], a[216:219]
    s_waitcnt lgkmcnt(14)
    v_mfma_f32_16x16x32_bf16 v[60:63], a[156:159], v[208:211], v[60:63]
    ds_read_b64_tr_b16 a[188:189], v19 offset:57344
    v_mfma_f32_16x16x32_bf16 v[92:95], a[156:159], v[212:215], v[92:95]
    ds_read_b64_tr_b16 a[190:191], v19 offset:61440
    s_add_u32 m0, s61, 23552
    s_add_u32 s33, s62, 23552
    buffer_load_dwordx4 v238, s[16:19], s33 offen sc1 lds
    v_mfma_f32_16x16x32_bf16 a[220:223], a[156:159], v[228:231], a[220:223]
    s_waitcnt lgkmcnt(14)
    v_mfma_f32_16x16x32_bf16 v[32:35], a[160:163], v[216:219], v[32:35]
    v_mfma_f32_16x16x32_bf16 v[64:67], a[160:163], v[220:223], v[64:67]
    s_add_u32 m0, s61, 24576
    s_add_u32 s33, s62, 24576
    buffer_load_dwordx4 v238, s[16:19], s33 offen sc1 lds
    v_mfma_f32_16x16x32_bf16 a[192:195], a[160:163], v[228:231], a[192:195]
    s_waitcnt lgkmcnt(12)
    v_mfma_f32_16x16x32_bf16 v[36:39], a[164:167], v[216:219], v[36:39]
    v_mfma_f32_16x16x32_bf16 v[68:71], a[164:167], v[220:223], v[68:71]
    s_add_u32 m0, s61, 25600
    s_add_u32 s33, s62, 25600
    buffer_load_dwordx4 v238, s[16:19], s33 offen sc1 lds
    v_mfma_f32_16x16x32_bf16 a[196:199], a[164:167], v[228:231], a[196:199]
    s_waitcnt lgkmcnt(10)
    v_mfma_f32_16x16x32_bf16 v[40:43], a[168:171], v[216:219], v[40:43]
    v_mfma_f32_16x16x32_bf16 v[72:75], a[168:171], v[220:223], v[72:75]
    s_add_u32 m0, s61, 26624
    s_add_u32 s33, s62, 26624
    buffer_load_dwordx4 v238, s[16:19], s33 offen sc1 lds
    v_mfma_f32_16x16x32_bf16 a[200:203], a[168:171], v[228:231], a[200:203]
    s_waitcnt lgkmcnt(8)
    v_mfma_f32_16x16x32_bf16 v[44:47], a[172:175], v[216:219], v[44:47]
    v_mfma_f32_16x16x32_bf16 v[76:79], a[172:175], v[220:223], v[76:79]
    s_add_u32 m0, s61, 27648
    s_add_u32 s33, s62, 27648
    buffer_load_dwordx4 v238, s[16:19], s33 offen sc1 lds
    v_mfma_f32_16x16x32_bf16 a[204:207], a[172:175], v[228:231], a[204:207]
    s_waitcnt lgkmcnt(6)
    v_mfma_f32_16x16x32_bf16 v[48:51], a[176:179], v[216:219], v[48:51]
    v_mfma_f32_16x16x32_bf16 v[80:83], a[176:179], v[220:223], v[80:83]
    v_mfma_f32_16x16x32_bf16 a[208:211], a[176:179], v[228:231], a[208:211]
    s_waitcnt lgkmcnt(4)
    v_mfma_f32_16x16x32_bf16 v[52:55], a[180:183], v[216:219], v[52:55]
    v_mfma_f32_16x16x32_bf16 v[84:87], a[180:183], v[220:223], v[84:87]
    v_mfma_f32_16x16x32_bf16 a[212:215], a[180:183], v[228:231], a[212:215]
    s_waitcnt lgkmcnt(2)
    v_mfma_f32_16x16x32_bf16 v[56:59], a[184:187], v[216:219], v[56:59]
    v_mfma_f32_16x16x32_bf16 v[88:91], a[184:187], v[220:223], v[88:91]
    v_mfma_f32_16x16x32_bf16 a[216:219], a[184:187], v[228:231], a[216:219]
    s_waitcnt lgkmcnt(0)
    v_mfma_f32_16x16x32_bf16 v[60:63], a[188:191], v[216:219], v[60:63]
    v_mfma_f32_16x16x32_bf16 v[92:95], a[188:191], v[220:223], v[92:95]
    v_mfma_f32_16x16x32_bf16 a[220:223], a[188:191], v[228:231], a[220:223]
    s_lshl_b32 s40, s42, 3
    s_lshl_b32 s41, s3, 1
    s_add_u32 s40, s40, s41
    s_mul_i32 s41, s40, 57344
    s_add_u32 s24, s34, 0x800000
    s_addc_u32 s25, s35, 0
    s_add_u32 s24, s24, s41
    s_addc_u32 s25, s25, 0
    s_mov_b32 s26, 0x1c000
    s_mov_b32 s27, 0x20000
    v_mov_b32 v20, v239
    v_mov_b32 v21, v240
    v_mov_b32 v19, v238
    v_lshrrev_b32 v22, 2, v20
    v_and_b32 v23, 3, v20
    v_lshl_add_u32 v24, v21, 2, v22
    v_lshrrev_b32 v25, 1, v24
    v_and_b32 v25, 3, v25
    v_lshlrev_b32 v24, 7, v24
    v_lshl_add_u32 v24, v23, 3, v24
    v_add_u32 v24, s61, v24
    v_xor_b32 v26, 0, v25
    v_lshl_add_u32 v4, v26, 5, v24
    v_xor_b32 v26, 1, v25
    v_lshl_add_u32 v5, v26, 5, v24
    v_xor_b32 v26, 2, v25
    v_lshl_add_u32 v6, v26, 5, v24
    v_xor_b32 v26, 3, v25
    v_lshl_add_u32 v7, v26, 5, v24
    s_lshl_b32 s41, s38, 19
    s_add_u32 s20, s34, 0x1000000
    s_addc_u32 s21, s35, 0
    s_add_u32 s20, s20, s41
    s_addc_u32 s21, s21, 0
    s_mov_b32 s22, 0x80000
    s_mov_b32 s23, 0x20000
    s_lshl_b32 s40, s3, 15
    v_add_u32 v9, s40, v19
    s_mul_i32 s40, s3, 14336
    v_add_u32 v10, s40, v19
    s_mul_i32 s41, s38, 229376
    s_add_u32 s8, s34, 0x800000
    s_addc_u32 s9, s35, 0
    s_add_u32 s8, s8, s41
    s_addc_u32 s9, s9, 0
    s_mov_b32 s10, 0x38000
    s_mov_b32 s11, 0x20000
    v_mov_b32 v96, 0
    s_waitcnt vmcnt(12)
    v_cmp_ne_u32 vcc, s36, v28
    s_nop 4
    s_cmp_eq_u64 vcc, 0
    s_cbranch_scc1 L_pok_fo
    s_mov_b32 s37, 0
L_spin_fo:
    buffer_load_dword v28, v29, s[44:47], 0 offen sc1
    s_add_u32 s37, s37, 1
    s_cmp_gt_u32 s37, 0x20000
    s_cbranch_scc1 recurrent_scan__mha_block_cached__mixer_s_mlp__prompt_kernel_end
    s_waitcnt vmcnt(0)
    v_cmp_ne_u32 vcc, s36, v28
    s_nop 4
    s_cmp_lg_u64 vcc, 0
    s_cbranch_scc1 L_spin_fo
L_pok_fo:
    v_mov_b32 v97, 0
    s_mov_b32 s33, 0
    buffer_load_dwordx4 a[0:3], v9, s[20:23], s33 offen sc1
    v_mov_b32 v98, 0
    s_mov_b32 s33, 131072
    buffer_load_dwordx4 a[4:7], v9, s[20:23], s33 offen sc1
    v_mov_b32 v99, 0
    s_mov_b32 s33, 262144
    buffer_load_dwordx4 a[8:11], v9, s[20:23], s33 offen sc1
    v_mov_b32 v100, 0
    s_mov_b32 s33, 393216
    buffer_load_dwordx4 a[12:15], v9, s[20:23], s33 offen sc1
    v_mov_b32 v101, 0
    s_mov_b32 s33, 1024
    buffer_load_dwordx4 a[16:19], v9, s[20:23], s33 offen sc1
    v_mov_b32 v102, 0
    s_mov_b32 s33, 132096
    buffer_load_dwordx4 a[20:23], v9, s[20:23], s33 offen sc1
    v_mov_b32 v103, 0
    s_mov_b32 s33, 263168
    buffer_load_dwordx4 a[24:27], v9, s[20:23], s33 offen sc1
    v_mov_b32 v104, 0
    s_mov_b32 s33, 394240
    buffer_load_dwordx4 a[28:31], v9, s[20:23], s33 offen sc1
    v_mov_b32 v105, 0
    s_mov_b32 s33, 2048
    buffer_load_dwordx4 a[32:35], v9, s[20:23], s33 offen sc1
    v_mov_b32 v106, 0
    s_mov_b32 s33, 133120
    buffer_load_dwordx4 a[36:39], v9, s[20:23], s33 offen sc1
    v_mov_b32 v107, 0
    s_mov_b32 s33, 264192
    buffer_load_dwordx4 a[40:43], v9, s[20:23], s33 offen sc1
    v_mov_b32 v108, 0
    s_mov_b32 s33, 395264
    buffer_load_dwordx4 a[44:47], v9, s[20:23], s33 offen sc1
    v_mov_b32 v109, 0
    s_mov_b32 s33, 3072
    buffer_load_dwordx4 a[48:51], v9, s[20:23], s33 offen sc1
    v_mov_b32 v110, 0
    s_mov_b32 s33, 134144
    buffer_load_dwordx4 a[52:55], v9, s[20:23], s33 offen sc1
    v_mov_b32 v111, 0
    s_mov_b32 s33, 265216
    buffer_load_dwordx4 a[56:59], v9, s[20:23], s33 offen sc1
    v_mov_b32 v112, 0
    s_mov_b32 s33, 396288
    buffer_load_dwordx4 a[60:63], v9, s[20:23], s33 offen sc1
    v_mov_b32 v113, 0
    s_mov_b32 s33, 4096
    buffer_load_dwordx4 a[64:67], v9, s[20:23], s33 offen sc1
    v_mov_b32 v114, 0
    s_mov_b32 s33, 135168
    buffer_load_dwordx4 a[68:71], v9, s[20:23], s33 offen sc1
    v_mov_b32 v115, 0
    s_mov_b32 s33, 266240
    buffer_load_dwordx4 a[72:75], v9, s[20:23], s33 offen sc1
    v_mov_b32 v116, 0
    s_mov_b32 s33, 397312
    buffer_load_dwordx4 a[76:79], v9, s[20:23], s33 offen sc1
    v_mov_b32 v117, 0
    v_mov_b32 v118, 0
    s_mov_b32 s33, 5120
    buffer_load_dwordx4 a[80:83], v9, s[20:23], s33 offen sc1
    v_mov_b32 v119, 0
    s_mov_b32 s33, 136192
    buffer_load_dwordx4 a[84:87], v9, s[20:23], s33 offen sc1
    v_mov_b32 v120, 0
    s_mov_b32 s33, 267264
    buffer_load_dwordx4 a[88:91], v9, s[20:23], s33 offen sc1
    v_mov_b32 v121, 0
    s_mov_b32 s33, 398336
    buffer_load_dwordx4 a[92:95], v9, s[20:23], s33 offen sc1
    v_mov_b32 v122, 0
    s_mov_b32 s33, 6144
    buffer_load_dwordx4 a[96:99], v9, s[20:23], s33 offen sc1
    v_mov_b32 v123, 0
    s_mov_b32 s33, 137216
    buffer_load_dwordx4 a[100:103], v9, s[20:23], s33 offen sc1
    v_mov_b32 v124, 0
    s_mov_b32 s33, 268288
    buffer_load_dwordx4 a[104:107], v9, s[20:23], s33 offen sc1
    v_mov_b32 v125, 0
    s_mov_b32 s33, 399360
    buffer_load_dwordx4 a[108:111], v9, s[20:23], s33 offen sc1
    v_mov_b32 v126, 0
    v_mov_b32 v127, 0
    v_mov_b32 v128, 0
    v_mov_b32 v129, 0
    v_mov_b32 v130, 0
    v_mov_b32 v131, 0
    v_mov_b32 v132, 0
    v_mov_b32 v133, 0
    v_mov_b32 v134, 0
    v_mov_b32 v135, 0
    v_mov_b32 v136, 0
    v_mov_b32 v137, 0
    v_mov_b32 v138, 0
    v_mov_b32 v139, 0
    v_mov_b32 v140, 0
    v_mov_b32 v141, 0
    v_mov_b32 v142, 0
    v_mov_b32 v143, 0
    v_mov_b32 v144, 0
    v_mov_b32 v145, 0
    v_mov_b32 v146, 0
    v_mov_b32 v147, 0
    v_mov_b32 v148, 0
    v_mov_b32 v149, 0
    v_mov_b32 v150, 0
    v_mov_b32 v151, 0
    v_mov_b32 v152, 0
    v_mov_b32 v153, 0
    v_mov_b32 v154, 0
    v_mov_b32 v155, 0
    v_mov_b32 v156, 0
    v_mov_b32 v157, 0
    v_mov_b32 v158, 0
    v_mov_b32 v159, 0
L_g3join:
    s_load_dwordx2 s[64:65], s[0:1], 0
    s_load_dwordx2 s[66:67], s[0:1], 80
    ds_read_b64_tr_b16 v[160:161], v4 offset:0
    ds_read_b64_tr_b16 v[162:163], v4 offset:2048
    ds_read_b64_tr_b16 v[164:165], v5 offset:0
    ds_read_b64_tr_b16 v[166:167], v5 offset:2048
    ds_read_b64_tr_b16 v[168:169], v6 offset:0
    ds_read_b64_tr_b16 v[170:171], v6 offset:2048
    ds_read_b64_tr_b16 v[172:173], v7 offset:0
    ds_read_b64_tr_b16 v[174:175], v7 offset:2048
    s_waitcnt vmcnt(24)
    s_waitcnt lgkmcnt(0)
    v_mfma_f32_16x16x32_bf16 v[96:99], v[160:163], a[0:3], v[96:99]
    ds_read_b64_tr_b16 v[176:177], v4 offset:4096
    v_mov_b32 v24, 0xbdd2d3e8
    v_mov_b32 v25, 0xc0135761
    v_mfma_f32_16x16x32_bf16 v[112:115], v[160:163], a[4:7], v[112:115]
    v_mov_b32 v26, 1.0
    v_mov_b32 v27, 1.0
    v_accvgpr_read_b32 v208, a224
    v_mfma_f32_16x16x32_bf16 v[128:131], v[160:163], a[8:11], v[128:131]
    ds_read_b64_tr_b16 v[178:179], v4 offset:6144
    v_accvgpr_read_b32 v209, a225
    v_accvgpr_read_b32 v210, a226
    v_mfma_f32_16x16x32_bf16 v[144:147], v[160:163], a[12:15], v[144:147]
    v_accvgpr_read_b32 v211, a227
    v_accvgpr_read_b32 v212, a228
    v_accvgpr_read_b32 v213, a229
    v_mfma_f32_16x16x32_bf16 v[100:103], v[164:167], a[0:3], v[100:103]
    ds_read_b64_tr_b16 v[180:181], v5 offset:4096
    v_accvgpr_read_b32 v214, a230
    v_accvgpr_read_b32 v215, a231
    v_mfma_f32_16x16x32_bf16 v[116:119], v[164:167], a[4:7], v[116:119]
    v_accvgpr_read_b32 v216, a232
    v_accvgpr_read_b32 v217, a233
    v_accvgpr_read_b32 v218, a234
    v_mfma_f32_16x16x32_bf16 v[132:135], v[164:167], a[8:11], v[132:135]
    ds_read_b64_tr_b16 v[182:183], v5 offset:6144
    v_accvgpr_read_b32 v219, a235
    v_accvgpr_read_b32 v220, a236
    v_mfma_f32_16x16x32_bf16 v[148:151], v[164:167], a[12:15], v[148:151]
    v_accvgpr_read_b32 v221, a237
    v_accvgpr_read_b32 v222, a238
    v_accvgpr_read_b32 v223, a239
    v_mfma_f32_16x16x32_bf16 v[104:107], v[168:171], a[0:3], v[104:107]
    ds_read_b64_tr_b16 v[184:185], v6 offset:4096
    v_add_f32 v192, v208, v210
    v_add_f32 v193, v209, v211
    v_mfma_f32_16x16x32_bf16 v[120:123], v[168:171], a[4:7], v[120:123]
    v_add_f32 v192, v192, v212
    v_add_f32 v193, v193, v213
    v_add_f32 v192, v192, v214
    v_mfma_f32_16x16x32_bf16 v[136:139], v[168:171], a[8:11], v[136:139]
    ds_read_b64_tr_b16 v[186:187], v6 offset:6144
    v_add_f32 v193, v193, v215
    v_add_f32 v192, v192, v216
    v_mfma_f32_16x16x32_bf16 v[152:155], v[168:171], a[12:15], v[152:155]
    v_add_f32 v193, v193, v217
    v_add_f32 v192, v192, v218
    v_add_f32 v193, v193, v219
    v_mfma_f32_16x16x32_bf16 v[108:111], v[172:175], a[0:3], v[108:111]
    ds_read_b64_tr_b16 v[188:189], v7 offset:4096
    v_add_f32 v192, v192, v220
    v_add_f32 v193, v193, v221
    v_mfma_f32_16x16x32_bf16 v[124:127], v[172:175], a[4:7], v[124:127]
    v_add_f32 v192, v192, v222
    v_add_f32 v193, v193, v223
    v_mul_f32 v192, 0x3b000000, v192
    v_mfma_f32_16x16x32_bf16 v[140:143], v[172:175], a[8:11], v[140:143]
    ds_read_b64_tr_b16 v[190:191], v7 offset:6144
    v_mul_f32 v193, 0x3b000000, v193
    v_fma_f32 v193, -v192, v192, v193
    v_mfma_f32_16x16x32_bf16 v[156:159], v[172:175], a[12:15], v[156:159]
    v_max_f32 v193, 0, v193
    v_cvt_pk_bf16_f32 v194, v192, v192
    v_and_b32 v194, 0xffff0000, v194
    s_add_u32 m0, s61, 28672
    s_add_u32 s33, s62, 28672
    buffer_load_dwordx4 v238, s[16:19], s33 offen sc1 lds
    v_cvt_pk_bf16_f32 v193, v193, v193
    v_and_b32 v193, 0xffff0000, v193
    v_add_f32 v193, 0x3727c5ac, v193
    v_cvt_pk_bf16_f32 v193, v193, v193
    v_and_b32 v193, 0xffff0000, v193
    s_add_u32 m0, s61, 29696
    s_add_u32 s33, s62, 29696
    buffer_load_dwordx4 v238, s[16:19], s33 offen sc1 lds
    v_sqrt_f32 v193, v193
    s_nop 0
    v_cvt_pk_bf16_f32 v193, v193, v193
    v_and_b32 v193, 0xffff0000, v193
    v_rcp_f32 v195, v193
    v_accvgpr_read_b32 v208, a192
    s_add_u32 m0, s61, 30720
    s_add_u32 s33, s62, 30720
    buffer_load_dwordx4 v238, s[16:19], s33 offen sc1 lds
    v_accvgpr_read_b32 v209, a193
    v_accvgpr_read_b32 v210, a194
    v_accvgpr_read_b32 v211, a195
    v_accvgpr_read_b32 v212, a196
    v_accvgpr_read_b32 v213, a197
    s_add_u32 m0, s61, 31744
    s_add_u32 s33, s62, 31744
    buffer_load_dwordx4 v238, s[16:19], s33 offen sc1 lds
    v_accvgpr_read_b32 v214, a198
    v_accvgpr_read_b32 v215, a199
    v_accvgpr_read_b32 v216, a200
    v_accvgpr_read_b32 v217, a201
    v_accvgpr_read_b32 v218, a202
    s_mov_b32 s33, 7168
    buffer_load_dwordx4 a[0:3], v9, s[20:23], s33 offen sc1
    v_accvgpr_read_b32 v219, a203
    v_accvgpr_read_b32 v220, a204
    v_accvgpr_read_b32 v221, a205
    v_accvgpr_read_b32 v222, a206
    v_accvgpr_read_b32 v223, a207
    s_mov_b32 s33, 138240
    buffer_load_dwordx4 a[4:7], v9, s[20:23], s33 offen sc1
    v_fma_f32 v32, -v194, v208, v32
    v_fma_f32 v33, -v194, v209, v33
    v_fma_f32 v34, -v194, v210, v34
    v_fma_f32 v35, -v194, v211, v35
    v_fma_f32 v36, -v194, v212, v36
    s_mov_b32 s33, 269312
    buffer_load_dwordx4 a[8:11], v9, s[20:23], s33 offen sc1
    v_fma_f32 v37, -v194, v213, v37
    v_fma_f32 v38, -v194, v214, v38
    v_fma_f32 v39, -v194, v215, v39
    v_fma_f32 v40, -v194, v216, v40
    v_fma_f32 v41, -v194, v217, v41
    s_mov_b32 s33, 400384
    buffer_load_dwordx4 a[12:15], v9, s[20:23], s33 offen sc1
    v_fma_f32 v42, -v194, v218, v42
    v_fma_f32 v43, -v194, v219, v43
    v_fma_f32 v44, -v194, v220, v44
    v_fma_f32 v45, -v194, v221, v45
    v_fma_f32 v46, -v194, v222, v46
    s_waitcnt vmcnt(28)
    s_waitcnt lgkmcnt(0)
    v_mfma_f32_16x16x32_bf16 v[96:99], v[176:179], a[16:19], v[96:99]
    ds_read_b64_tr_b16 v[160:161], v4 offset:8192
    v_fma_f32 v47, -v194, v223, v47
    v_mul_f32 v32, v195, v32
    v_mfma_f32_16x16x32_bf16 v[112:115], v[176:179], a[20:23], v[112:115]
    v_mul_f32 v33, v195, v33
    v_mul_f32 v34, v195, v34
    v_mul_f32 v35, v195, v35
    v_mfma_f32_16x16x32_bf16 v[128:131], v[176:179], a[24:27], v[128:131]
    ds_read_b64_tr_b16 v[162:163], v4 offset:10240
    v_mul_f32 v36, v195, v36
    v_mul_f32 v37, v195, v37
    v_mfma_f32_16x16x32_bf16 v[144:147], v[176:179], a[28:31], v[144:147]
    v_mul_f32 v38, v195, v38
    v_mul_f32 v39, v195, v39
    v_mul_f32 v40, v195, v40
    v_mfma_f32_16x16x32_bf16 v[100:103], v[180:183], a[16:19], v[100:103]
    ds_read_b64_tr_b16 v[164:165], v5 offset:8192
    v_mul_f32 v41, v195, v41
    v_mul_f32 v42, v195, v42
    v_mfma_f32_16x16x32_bf16 v[116:119], v[180:183], a[20:23], v[116:119]
    v_mul_f32 v43, v195, v43
    v_mul_f32 v44, v195, v44
    v_mul_f32 v45, v195, v45
    v_mfma_f32_16x16x32_bf16 v[132:135], v[180:183], a[24:27], v[132:135]
    ds_read_b64_tr_b16 v[166:167], v5 offset:10240
    v_mul_f32 v46, v195, v46
    v_mul_f32 v47, v195, v47
    v_mfma_f32_16x16x32_bf16 v[148:151], v[180:183], a[28:31], v[148:151]
    v_cvt_pk_bf16_f32 v208, v32, v33
    v_cvt_pk_bf16_f32 v209, v34, v35
    v_cvt_pk_bf16_f32 v210, v36, v37
    v_mfma_f32_16x16x32_bf16 v[104:107], v[184:187], a[16:19], v[104:107]
    ds_read_b64_tr_b16 v[168:169], v6 offset:8192
    v_cvt_pk_bf16_f32 v211, v38, v39
    v_cvt_pk_bf16_f32 v212, v40, v41
    v_mfma_f32_16x16x32_bf16 v[120:123], v[184:187], a[20:23], v[120:123]
    v_cvt_pk_bf16_f32 v213, v42, v43
    v_cvt_pk_bf16_f32 v214, v44, v45
    v_cvt_pk_bf16_f32 v215, v46, v47
    v_mfma_f32_16x16x32_bf16 v[136:139], v[184:187], a[24:27], v[136:139]
    ds_read_b64_tr_b16 v[170:171], v6 offset:10240
    v_lshlrev_b32 v32, 16, v208
    v_and_b32 v33, 0xffff0000, v208
    v_mfma_f32_16x16x32_bf16 v[152:155], v[184:187], a[28:31], v[152:155]
    v_lshlrev_b32 v34, 16, v209
    v_and_b32 v35, 0xffff0000, v209
    v_lshlrev_b32 v36, 16, v210
    v_mfma_f32_16x16x32_bf16 v[108:111], v[188:191], a[16:19], v[108:111]
    ds_read_b64_tr_b16 v[172:173], v7 offset:8192
    v_and_b32 v37, 0xffff0000, v210
    v_lshlrev_b32 v38, 16, v211
    v_mfma_f32_16x16x32_bf16 v[124:127], v[188:191], a[20:23], v[124:127]
    v_and_b32 v39, 0xffff0000, v211
    v_lshlrev_b32 v40, 16, v212
    v_and_b32 v41, 0xffff0000, v212
    v_mfma_f32_16x16x32_bf16 v[140:143], v[188:191], a[24:27], v[140:143]
    ds_read_b64_tr_b16 v[174:175], v7 offset:10240
    v_lshlrev_b32 v42, 16, v213
    v_and_b32 v43, 0xffff0000, v213
    v_mfma_f32_16x16x32_bf16 v[156:159], v[188:191], a[28:31], v[156:159]
    v_lshlrev_b32 v44, 16, v214
    v_and_b32 v45, 0xffff0000, v214
    v_lshlrev_b32 v46, 16, v215
    s_add_u32 m0, s61, 0
    s_add_u32 s33, s62, 32768
    buffer_load_dwordx4 v238, s[16:19], s33 offen sc1 lds
    v_and_b32 v47, 0xffff0000, v215
    v_mul_f32 v208, v32, v32
    v_mul_f32 v209, v33, v33
    v_mul_f32 v210, v34, v34
    v_mul_f32 v211, v35, v35
    s_add_u32 m0, s61, 1024
    s_add_u32 s33, s62, 33792
    buffer_load_dwordx4 v238, s[16:19], s33 offen sc1 lds
    v_mul_f32 v212, v36, v36
    v_mul_f32 v213, v37, v37
    v_mul_f32 v214, v38, v38
    v_mul_f32 v215, v39, v39
    v_mul_f32 v216, v40, v40
    s_add_u32 m0, s61, 2048
    s_add_u32 s33, s62, 34816
    buffer_load_dwordx4 v238, s[16:19], s33 offen sc1 lds
    v_mul_f32 v217, v41, v41
    v_mul_f32 v218, v42, v42
    v_mul_f32 v219, v43, v43
    v_mul_f32 v220, v44, v44
    v_mul_f32 v221, v45, v45
    s_add_u32 m0, s61, 3072
    s_add_u32 s33, s62, 35840
    buffer_load_dwordx4 v238, s[16:19], s33 offen sc1 lds
    v_mul_f32 v222, v46, v46
    v_mul_f32 v223, v47, v47
    v_fmaak_f32 v208, v208, v24, 0xc0135761
    v_fmaak_f32 v209, v209, v24, 0xc0135761
    v_fmaak_f32 v210, v210, v24, 0xc0135761
    s_mov_b32 s33, 8192
    buffer_load_dwordx4 a[16:19], v9, s[20:23], s33 offen sc1
    v_fmaak_f32 v211, v211, v24, 0xc0135761
    v_fmaak_f32 v212, v212, v24, 0xc0135761
    v_fmaak_f32 v213, v213, v24, 0xc0135761
    v_fmaak_f32 v214, v214, v24, 0xc0135761
    v_fmaak_f32 v215, v215, v24, 0xc0135761
    s_mov_b32 s33, 139264
    buffer_load_dwordx4 a[20:23], v9, s[20:23], s33 offen sc1
    v_fmaak_f32 v216, v216, v24, 0xc0135761
    v_fmaak_f32 v217, v217, v24, 0xc0135761
    v_fmaak_f32 v218, v218, v24, 0xc0135761
    v_fmaak_f32 v219, v219, v24, 0xc0135761
    v_fmaak_f32 v220, v220, v24, 0xc0135761
    s_mov_b32 s33, 270336
    buffer_load_dwordx4 a[24:27], v9, s[20:23], s33 offen sc1
    v_fmaak_f32 v221, v221, v24, 0xc0135761
    v_fmaak_f32 v222, v222, v24, 0xc0135761
    v_fmaak_f32 v223, v223, v24, 0xc0135761
    v_mul_f32 v208, v208, v32
    v_mul_f32 v209, v209, v33
    s_mov_b32 s33, 401408
    buffer_load_dwordx4 a[28:31], v9, s[20:23], s33 offen sc1
    v_mul_f32 v210, v210, v34
    v_mul_f32 v211, v211, v35
    v_mul_f32 v212, v212, v36
    v_mul_f32 v213, v213, v37
    v_mul_f32 v214, v214, v38
    s_waitcnt vmcnt(32)
    s_waitcnt lgkmcnt(0)
    v_mfma_f32_16x16x32_bf16 v[96:99], v[160:163], a[32:35], v[96:99]
    ds_read_b64_tr_b16 v[176:177], v4 offset:12288
    v_mul_f32 v215, v215, v39
    v_mul_f32 v216, v216, v40
    v_mfma_f32_16x16x32_bf16 v[112:115], v[160:163], a[36:39], v[112:115]
    v_mul_f32 v217, v217, v41
    v_mul_f32 v218, v218, v42
    v_mul_f32 v219, v219, v43
    v_mfma_f32_16x16x32_bf16 v[128:131], v[160:163], a[40:43], v[128:131]
    ds_read_b64_tr_b16 v[178:179], v4 offset:14336
    v_mul_f32 v220, v220, v44
    v_mul_f32 v221, v221, v45
    v_mfma_f32_16x16x32_bf16 v[144:147], v[160:163], a[44:47], v[144:147]
    v_mul_f32 v222, v222, v46
    v_mul_f32 v223, v223, v47
    v_exp_f32 v208, v208
    v_mfma_f32_16x16x32_bf16 v[100:103], v[164:167], a[32:35], v[100:103]
    ds_read_b64_tr_b16 v[180:181], v5 offset:12288
    v_exp_f32 v209, v209
    v_exp_f32 v210, v210
    v_mfma_f32_16x16x32_bf16 v[116:119], v[164:167], a[36:39], v[116:119]
    v_exp_f32 v211, v211
    v_exp_f32 v212, v212
    v_exp_f32 v213, v213
    v_mfma_f32_16x16x32_bf16 v[132:135], v[164:167], a[40:43], v[132:135]
    ds_read_b64_tr_b16 v[182:183], v5 offset:14336
    v_exp_f32 v214, v214
    v_exp_f32 v215, v215
    v_mfma_f32_16x16x32_bf16 v[148:151], v[164:167], a[44:47], v[148:151]
    v_exp_f32 v216, v216
    v_exp_f32 v217, v217
    v_exp_f32 v218, v218
    v_mfma_f32_16x16x32_bf16 v[104:107], v[168:171], a[32:35], v[104:107]
    ds_read_b64_tr_b16 v[184:185], v6 offset:12288
    v_exp_f32 v219, v219
    v_exp_f32 v220, v220
    v_mfma_f32_16x16x32_bf16 v[120:123], v[168:171], a[36:39], v[120:123]
    v_exp_f32 v221, v221
    v_exp_f32 v222, v222
    v_exp_f32 v223, v223
    v_mfma_f32_16x16x32_bf16 v[136:139], v[168:171], a[40:43], v[136:139]
    ds_read_b64_tr_b16 v[186:187], v6 offset:14336
    v_add_f32 v208, 1.0, v208
    v_add_f32 v209, 1.0, v209
    v_mfma_f32_16x16x32_bf16 v[152:155], v[168:171], a[44:47], v[152:155]
    v_add_f32 v210, 1.0, v210
    v_add_f32 v211, 1.0, v211
    v_add_f32 v212, 1.0, v212
    v_mfma_f32_16x16x32_bf16 v[108:111], v[172:175], a[32:35], v[108:111]
    ds_read_b64_tr_b16 v[188:189], v7 offset:12288
    v_add_f32 v213, 1.0, v213
    v_add_f32 v214, 1.0, v214
    v_mfma_f32_16x16x32_bf16 v[124:127], v[172:175], a[36:39], v[124:127]
    v_add_f32 v215, 1.0, v215
    v_add_f32 v216, 1.0, v216
    v_add_f32 v217, 1.0, v217
    v_mfma_f32_16x16x32_bf16 v[140:143], v[172:175], a[40:43], v[140:143]
    ds_read_b64_tr_b16 v[190:191], v7 offset:14336
    v_add_f32 v218, 1.0, v218
    v_add_f32 v219, 1.0, v219
    v_mfma_f32_16x16x32_bf16 v[156:159], v[172:175], a[44:47], v[156:159]
    v_add_f32 v220, 1.0, v220
    v_add_f32 v221, 1.0, v221
    v_add_f32 v222, 1.0, v222
    s_add_u32 m0, s61, 4096
    s_add_u32 s33, s62, 36864
    buffer_load_dwordx4 v238, s[16:19], s33 offen sc1 lds
    v_add_f32 v223, 1.0, v223
    v_rcp_f32 v208, v208
    v_rcp_f32 v209, v209
    v_rcp_f32 v210, v210
    v_rcp_f32 v211, v211
    s_add_u32 m0, s61, 5120
    s_add_u32 s33, s62, 37888
    buffer_load_dwordx4 v238, s[16:19], s33 offen sc1 lds
    v_rcp_f32 v212, v212
    v_rcp_f32 v213, v213
    v_rcp_f32 v214, v214
    v_rcp_f32 v215, v215
    v_rcp_f32 v216, v216
    s_add_u32 m0, s61, 6144
    s_add_u32 s33, s62, 38912
    buffer_load_dwordx4 v238, s[16:19], s33 offen sc1 lds
    v_rcp_f32 v217, v217
    v_rcp_f32 v218, v218
    v_rcp_f32 v219, v219
    v_rcp_f32 v220, v220
    v_rcp_f32 v221, v221
    s_add_u32 m0, s61, 7168
    s_add_u32 s33, s62, 39936
    buffer_load_dwordx4 v238, s[16:19], s33 offen sc1 lds
    v_rcp_f32 v222, v222
    v_rcp_f32 v223, v223
    v_mul_f32 v32, v32, v208
    v_mul_f32 v33, v33, v209
    v_mul_f32 v34, v34, v210
    s_mov_b32 s33, 9216
    buffer_load_dwordx4 a[32:35], v9, s[20:23], s33 offen sc1
    v_mul_f32 v35, v35, v211
    v_mul_f32 v36, v36, v212
    v_mul_f32 v37, v37, v213
    v_mul_f32 v38, v38, v214
    v_mul_f32 v39, v39, v215
    s_mov_b32 s33, 140288
    buffer_load_dwordx4 a[36:39], v9, s[20:23], s33 offen sc1
    v_mul_f32 v40, v40, v216
    v_mul_f32 v41, v41, v217
    v_mul_f32 v42, v42, v218
    v_mul_f32 v43, v43, v219
    v_mul_f32 v44, v44, v220
    s_mov_b32 s33, 271360
    buffer_load_dwordx4 a[40:43], v9, s[20:23], s33 offen sc1
    v_mul_f32 v45, v45, v221
    v_mul_f32 v46, v46, v222
    v_mul_f32 v47, v47, v223
    v_cvt_pk_bf16_f32 v224, v32, v33
    v_cvt_pk_bf16_f32 v225, v34, v35
    s_mov_b32 s33, 402432
    buffer_load_dwordx4 a[44:47], v9, s[20:23], s33 offen sc1
    v_cvt_pk_bf16_f32 v226, v36, v37
    v_cvt_pk_bf16_f32 v227, v38, v39
    v_cvt_pk_bf16_f32 v228, v40, v41
    v_cvt_pk_bf16_f32 v229, v42, v43
    v_cvt_pk_bf16_f32 v230, v44, v45
    s_waitcnt vmcnt(36)
    s_waitcnt lgkmcnt(0)
    v_mfma_f32_16x16x32_bf16 v[96:99], v[176:179], a[48:51], v[96:99]
    ds_read_b64_tr_b16 v[160:161], v4 offset:16384
    v_cvt_pk_bf16_f32 v231, v46, v47
    s_lshl_b32 s40, s43, 12
    v_mfma_f32_16x16x32_bf16 v[112:115], v[176:179], a[52:55], v[112:115]
    s_add_u32 s40, s40, 0
    buffer_store_dwordx4 v[224:227], v238, s[24:27], s40 offen sc1
    s_lshl_b32 s40, s43, 12
    v_mfma_f32_16x16x32_bf16 v[128:131], v[176:179], a[56:59], v[128:131]
    ds_read_b64_tr_b16 v[162:163], v4 offset:18432
    s_add_u32 s40, s40, 1024
    buffer_store_dwordx4 v[228:231], v238, s[24:27], s40 offen sc1
    v_mfma_f32_16x16x32_bf16 v[144:147], v[176:179], a[60:63], v[144:147]
    v_accvgpr_read_b32 v208, a208
    v_accvgpr_read_b32 v209, a209
    v_accvgpr_read_b32 v210, a210
    v_mfma_f32_16x16x32_bf16 v[100:103], v[180:183], a[48:51], v[100:103]
    ds_read_b64_tr_b16 v[164:165], v5 offset:16384
    v_accvgpr_read_b32 v211, a211
    v_accvgpr_read_b32 v212, a212
    v_mfma_f32_16x16x32_bf16 v[116:119], v[180:183], a[52:55], v[116:119]
    v_accvgpr_read_b32 v213, a213
    v_accvgpr_read_b32 v214, a214
    v_accvgpr_read_b32 v215, a215
    v_mfma_f32_16x16x32_bf16 v[132:135], v[180:183], a[56:59], v[132:135]
    ds_read_b64_tr_b16 v[166:167], v5 offset:18432
    v_accvgpr_read_b32 v216, a216
    v_accvgpr_read_b32 v217, a217
    v_mfma_f32_16x16x32_bf16 v[148:151], v[180:183], a[60:63], v[148:151]
    v_accvgpr_read_b32 v218, a218
    v_accvgpr_read_b32 v219, a219
    v_accvgpr_read_b32 v220, a220
    v_mfma_f32_16x16x32_bf16 v[104:107], v[184:187], a[48:51], v[104:107]
    ds_read_b64_tr_b16 v[168:169], v6 offset:16384
    v_accvgpr_read_b32 v221, a221
    v_accvgpr_read_b32 v222, a222
    v_mfma_f32_16x16x32_bf16 v[120:123], v[184:187], a[52:55], v[120:123]
    v_accvgpr_read_b32 v223, a223
    v_fma_f32 v48, -v194, v208, v48
    v_fma_f32 v49, -v194, v209, v49
    v_mfma_f32_16x16x32_bf16 v[136:139], v[184:187], a[56:59], v[136:139]
    ds_read_b64_tr_b16 v[170:171], v6 offset:18432
    v_fma_f32 v50, -v194, v210, v50
    v_fma_f32 v51, -v194, v211, v51
    v_mfma_f32_16x16x32_bf16 v[152:155], v[184:187], a[60:63], v[152:155]
    v_fma_f32 v52, -v194, v212, v52
    v_fma_f32 v53, -v194, v213, v53
    v_fma_f32 v54, -v194, v214, v54
    v_mfma_f32_16x16x32_bf16 v[108:111], v[188:191], a[48:51], v[108:111]
    ds_read_b64_tr_b16 v[172:173], v7 offset:16384
    v_fma_f32 v55, -v194, v215, v55
    v_fma_f32 v56, -v194, v216, v56
    v_mfma_f32_16x16x32_bf16 v[124:127], v[188:191], a[52:55], v[124:127]
    v_fma_f32 v57, -v194, v217, v57
    v_fma_f32 v58, -v194, v218, v58
    v_fma_f32 v59, -v194, v219, v59
    v_mfma_f32_16x16x32_bf16 v[140:143], v[188:191], a[56:59], v[140:143]
    ds_read_b64_tr_b16 v[174:175], v7 offset:18432
    v_fma_f32 v60, -v194, v220, v60
    v_fma_f32 v61, -v194, v221, v61
    v_mfma_f32_16x16x32_bf16 v[156:159], v[188:191], a[60:63], v[156:159]
    v_fma_f32 v62, -v194, v222, v62
    v_fma_f32 v63, -v194, v223, v63
    v_mul_f32 v48, v195, v48
    s_add_u32 m0, s61, 8192
    s_add_u32 s33, s62, 40960
    buffer_load_dwordx4 v238, s[16:19], s33 offen sc1 lds
    v_mul_f32 v49, v195, v49
    v_mul_f32 v50, v195, v50
    v_mul_f32 v51, v195, v51
    v_mul_f32 v52, v195, v52
    v_mul_f32 v53, v195, v53
    s_add_u32 m0, s61, 9216
    s_add_u32 s33, s62, 41984
    buffer_load_dwordx4 v238, s[16:19], s33 offen sc1 lds
    v_mul_f32 v54, v195, v54
    v_mul_f32 v55, v195, v55
    v_mul_f32 v56, v195, v56
    v_mul_f32 v57, v195, v57
    v_mul_f32 v58, v195, v58
    s_add_u32 m0, s61, 10240
    s_add_u32 s33, s62, 43008
    buffer_load_dwordx4 v238, s[16:19], s33 offen sc1 lds
    v_mul_f32 v59, v195, v59
    v_mul_f32 v60, v195, v60
    v_mul_f32 v61, v195, v61
    v_mul_f32 v62, v195, v62
    v_mul_f32 v63, v195, v63
    s_add_u32 m0, s61, 11264
    s_add_u32 s33, s62, 44032
    buffer_load_dwordx4 v238, s[16:19], s33 offen sc1 lds
    v_cvt_pk_bf16_f32 v208, v48, v49
    v_cvt_pk_bf16_f32 v209, v50, v51
    v_cvt_pk_bf16_f32 v210, v52, v53
    v_cvt_pk_bf16_f32 v211, v54, v55
    v_cvt_pk_bf16_f32 v212, v56, v57
    s_mov_b32 s33, 10240
    buffer_load_dwordx4 a[48:51], v9, s[20:23], s33 offen sc1
    v_cvt_pk_bf16_f32 v213, v58, v59
    v_cvt_pk_bf16_f32 v214, v60, v61
    v_cvt_pk_bf16_f32 v215, v62, v63
    v_lshlrev_b32 v48, 16, v208
    v_and_b32 v49, 0xffff0000, v208
    s_mov_b32 s33, 141312
    buffer_load_dwordx4 a[52:55], v9, s[20:23], s33 offen sc1
    v_lshlrev_b32 v50, 16, v209
    v_and_b32 v51, 0xffff0000, v209
    v_lshlrev_b32 v52, 16, v210
    v_and_b32 v53, 0xffff0000, v210
    v_lshlrev_b32 v54, 16, v211
    s_mov_b32 s33, 272384
    buffer_load_dwordx4 a[56:59], v9, s[20:23], s33 offen sc1
    v_and_b32 v55, 0xffff0000, v211
    v_lshlrev_b32 v56, 16, v212
    v_and_b32 v57, 0xffff0000, v212
    v_lshlrev_b32 v58, 16, v213
    v_and_b32 v59, 0xffff0000, v213
    s_mov_b32 s33, 403456
    buffer_load_dwordx4 a[60:63], v9, s[20:23], s33 offen sc1
    v_lshlrev_b32 v60, 16, v214
    v_and_b32 v61, 0xffff0000, v214
    v_lshlrev_b32 v62, 16, v215
    v_and_b32 v63, 0xffff0000, v215
    v_mul_f32 v208, v48, v48
    s_waitcnt vmcnt(42)
    s_waitcnt lgkmcnt(0)
    v_mfma_f32_16x16x32_bf16 v[96:99], v[160:163], a[64:67], v[96:99]
    ds_read_b64_tr_b16 v[176:177], v4 offset:20480
    v_mul_f32 v209, v49, v49
    v_mul_f32 v210, v50, v50
    v_mfma_f32_16x16x32_bf16 v[112:115], v[160:163], a[68:71], v[112:115]
    v_mul_f32 v211, v51, v51
    v_mul_f32 v212, v52, v52
    v_mul_f32 v213, v53, v53
    v_mfma_f32_16x16x32_bf16 v[128:131], v[160:163], a[72:75], v[128:131]
    ds_read_b64_tr_b16 v[178:179], v4 offset:22528
    v_mul_f32 v214, v54, v54
    v_mul_f32 v215, v55, v55
    v_mfma_f32_16x16x32_bf16 v[144:147], v[160:163], a[76:79], v[144:147]
    v_mul_f32 v216, v56, v56
    v_mul_f32 v217, v57, v57
    v_mul_f32 v218, v58, v58
    v_mfma_f32_16x16x32_bf16 v[100:103], v[164:167], a[64:67], v[100:103]
    ds_read_b64_tr_b16 v[180:181], v5 offset:20480
    v_mul_f32 v219, v59, v59
    v_mul_f32 v220, v60, v60
    v_mfma_f32_16x16x32_bf16 v[116:119], v[164:167], a[68:71], v[116:119]
    v_mul_f32 v221, v61, v61
    v_mul_f32 v222, v62, v62
    v_mul_f32 v223, v63, v63
    v_mfma_f32_16x16x32_bf16 v[132:135], v[164:167], a[72:75], v[132:135]
    ds_read_b64_tr_b16 v[182:183], v5 offset:22528
    v_fmaak_f32 v208, v208, v24, 0xc0135761
    v_fmaak_f32 v209, v209, v24, 0xc0135761
    v_mfma_f32_16x16x32_bf16 v[148:151], v[164:167], a[76:79], v[148:151]
    v_fmaak_f32 v210, v210, v24, 0xc0135761
    v_fmaak_f32 v211, v211, v24, 0xc0135761
    v_fmaak_f32 v212, v212, v24, 0xc0135761
    v_mfma_f32_16x16x32_bf16 v[104:107], v[168:171], a[64:67], v[104:107]
    ds_read_b64_tr_b16 v[184:185], v6 offset:20480
    v_fmaak_f32 v213, v213, v24, 0xc0135761
    v_fmaak_f32 v214, v214, v24, 0xc0135761
    v_mfma_f32_16x16x32_bf16 v[120:123], v[168:171], a[68:71], v[120:123]
    v_fmaak_f32 v215, v215, v24, 0xc0135761
    v_fmaak_f32 v216, v216, v24, 0xc0135761
    v_fmaak_f32 v217, v217, v24, 0xc0135761
    v_mfma_f32_16x16x32_bf16 v[136:139], v[168:171], a[72:75], v[136:139]
    ds_read_b64_tr_b16 v[186:187], v6 offset:22528
    v_fmaak_f32 v218, v218, v24, 0xc0135761
    v_fmaak_f32 v219, v219, v24, 0xc0135761
    v_mfma_f32_16x16x32_bf16 v[152:155], v[168:171], a[76:79], v[152:155]
    v_fmaak_f32 v220, v220, v24, 0xc0135761
    v_fmaak_f32 v221, v221, v24, 0xc0135761
    v_fmaak_f32 v222, v222, v24, 0xc0135761
    v_mfma_f32_16x16x32_bf16 v[108:111], v[172:175], a[64:67], v[108:111]
    ds_read_b64_tr_b16 v[188:189], v7 offset:20480
    v_fmaak_f32 v223, v223, v24, 0xc0135761
    v_mul_f32 v208, v208, v48
    v_mfma_f32_16x16x32_bf16 v[124:127], v[172:175], a[68:71], v[124:127]
    v_mul_f32 v209, v209, v49
    v_mul_f32 v210, v210, v50
    v_mul_f32 v211, v211, v51
    v_mfma_f32_16x16x32_bf16 v[140:143], v[172:175], a[72:75], v[140:143]
    ds_read_b64_tr_b16 v[190:191], v7 offset:22528
    v_mul_f32 v212, v212, v52
    v_mul_f32 v213, v213, v53
    v_mfma_f32_16x16x32_bf16 v[156:159], v[172:175], a[76:79], v[156:159]
    v_mul_f32 v214, v214, v54
    v_mul_f32 v215, v215, v55
    v_mul_f32 v216, v216, v56
    s_add_u32 m0, s61, 12288
    s_add_u32 s33, s62, 45056
    buffer_load_dwordx4 v238, s[16:19], s33 offen sc1 lds
    v_mul_f32 v217, v217, v57
    v_mul_f32 v218, v218, v58
    v_mul_f32 v219, v219, v59
    v_mul_f32 v220, v220, v60
    v_mul_f32 v221, v221, v61
    s_add_u32 m0, s61, 13312
    s_add_u32 s33, s62, 46080
    buffer_load_dwordx4 v238, s[16:19], s33 offen sc1 lds
    v_mul_f32 v222, v222, v62
    v_mul_f32 v223, v223, v63
    v_exp_f32 v208, v208
    v_exp_f32 v209, v209
    v_exp_f32 v210, v210
    s_add_u32 m0, s61, 14336
    s_add_u32 s33, s62, 47104
    buffer_load_dwordx4 v238, s[16:19], s33 offen sc1 lds
    v_exp_f32 v211, v211
    v_exp_f32 v212, v212
    v_exp_f32 v213, v213
    v_exp_f32 v214, v214
    v_exp_f32 v215, v215
    s_add_u32 m0, s61, 15360
    s_add_u32 s33, s62, 48128
    buffer_load_dwordx4 v238, s[16:19], s33 offen sc1 lds
    v_exp_f32 v216, v216
    v_exp_f32 v217, v217
    v_exp_f32 v218, v218
    v_exp_f32 v219, v219
    v_exp_f32 v220, v220
    s_mov_b32 s33, 11264
    buffer_load_dwordx4 a[64:67], v9, s[20:23], s33 offen sc1
    v_exp_f32 v221, v221
    v_exp_f32 v222, v222
    v_exp_f32 v223, v223
    v_add_f32 v208, 1.0, v208
    v_add_f32 v209, 1.0, v209
    s_mov_b32 s33, 142336
    buffer_load_dwordx4 a[68:71], v9, s[20:23], s33 offen sc1
    v_add_f32 v210, 1.0, v210
    v_add_f32 v211, 1.0, v211
    v_add_f32 v212, 1.0, v212
    v_add_f32 v213, 1.0, v213
    v_add_f32 v214, 1.0, v214
    s_mov_b32 s33, 273408
    buffer_load_dwordx4 a[72:75], v9, s[20:23], s33 offen sc1
    v_add_f32 v215, 1.0, v215
    v_add_f32 v216, 1.0, v216
    v_add_f32 v217, 1.0, v217
    v_add_f32 v218, 1.0, v218
    v_add_f32 v219, 1.0, v219
    s_mov_b32 s33, 404480
    buffer_load_dwordx4 a[76:79], v9, s[20:23], s33 offen sc1
    v_add_f32 v220, 1.0, v220
    v_add_f32 v221, 1.0, v221
    v_add_f32 v222, 1.0, v222
    v_add_f32 v223, 1.0, v223
    v_rcp_f32 v208, v208
    s_waitcnt vmcnt(46)
    s_waitcnt lgkmcnt(0)
    v_mfma_f32_16x16x32_bf16 v[96:99], v[176:179], a[80:83], v[96:99]
    ds_read_b64_tr_b16 v[160:161], v4 offset:24576
    v_rcp_f32 v209, v209
    v_rcp_f32 v210, v210
    v_mfma_f32_16x16x32_bf16 v[112:115], v[176:179], a[84:87], v[112:115]
    v_rcp_f32 v211, v211
    v_rcp_f32 v212, v212
    v_rcp_f32 v213, v213
    v_mfma_f32_16x16x32_bf16 v[128:131], v[176:179], a[88:91], v[128:131]
    ds_read_b64_tr_b16 v[162:163], v4 offset:26624
    v_rcp_f32 v214, v214
    v_rcp_f32 v215, v215
    v_mfma_f32_16x16x32_bf16 v[144:147], v[176:179], a[92:95], v[144:147]
    v_rcp_f32 v216, v216
    v_rcp_f32 v217, v217
    v_rcp_f32 v218, v218
    v_mfma_f32_16x16x32_bf16 v[100:103], v[180:183], a[80:83], v[100:103]
    ds_read_b64_tr_b16 v[164:165], v5 offset:24576
    v_rcp_f32 v219, v219
    v_rcp_f32 v220, v220
    v_mfma_f32_16x16x32_bf16 v[116:119], v[180:183], a[84:87], v[116:119]
    v_rcp_f32 v221, v221
    v_rcp_f32 v222, v222
    v_rcp_f32 v223, v223
    v_mfma_f32_16x16x32_bf16 v[132:135], v[180:183], a[88:91], v[132:135]
    ds_read_b64_tr_b16 v[166:167], v5 offset:26624
    v_mul_f32 v48, v48, v208
    v_mul_f32 v49, v49, v209
    v_mfma_f32_16x16x32_bf16 v[148:151], v[180:183], a[92:95], v[148:151]
    v_mul_f32 v50, v50, v210
    v_mul_f32 v51, v51, v211
    v_mul_f32 v52, v52, v212
    v_mfma_f32_16x16x32_bf16 v[104:107], v[184:187], a[80:83], v[104:107]
    ds_read_b64_tr_b16 v[168:169], v6 offset:24576
    v_mul_f32 v53, v53, v213
    v_mul_f32 v54, v54, v214
    v_mfma_f32_16x16x32_bf16 v[120:123], v[184:187], a[84:87], v[120:123]
    v_mul_f32 v55, v55, v215
    v_mul_f32 v56, v56, v216
    v_mul_f32 v57, v57, v217
    v_mfma_f32_16x16x32_bf16 v[136:139], v[184:187], a[88:91], v[136:139]
    ds_read_b64_tr_b16 v[170:171], v6 offset:26624
    v_mul_f32 v58, v58, v218
    v_mul_f32 v59, v59, v219
    v_mfma_f32_16x16x32_bf16 v[152:155], v[184:187], a[92:95], v[152:155]
    v_mul_f32 v60, v60, v220
    v_mul_f32 v61, v61, v221
    v_mul_f32 v62, v62, v222
    v_mfma_f32_16x16x32_bf16 v[108:111], v[188:191], a[80:83], v[108:111]
    ds_read_b64_tr_b16 v[172:173], v7 offset:24576
    v_mul_f32 v63, v63, v223
    v_cvt_pk_bf16_f32 v224, v48, v49
    v_mfma_f32_16x16x32_bf16 v[124:127], v[188:191], a[84:87], v[124:127]
    v_cvt_pk_bf16_f32 v225, v50, v51
    v_cvt_pk_bf16_f32 v226, v52, v53
    v_cvt_pk_bf16_f32 v227, v54, v55
    v_mfma_f32_16x16x32_bf16 v[140:143], v[188:191], a[88:91], v[140:143]
    ds_read_b64_tr_b16 v[174:175], v7 offset:26624
    v_cvt_pk_bf16_f32 v228, v56, v57
    v_cvt_pk_bf16_f32 v229, v58, v59
    v_mfma_f32_16x16x32_bf16 v[156:159], v[188:191], a[92:95], v[156:159]
    v_cvt_pk_bf16_f32 v230, v60, v61
    v_cvt_pk_bf16_f32 v231, v62, v63
    s_lshl_b32 s40, s43, 12
    s_add_u32 m0, s61, 16384
    s_add_u32 s33, s62, 49152
    buffer_load_dwordx4 v238, s[16:19], s33 offen sc1 lds
    s_add_u32 s40, s40, 2048
    buffer_store_dwordx4 v[224:227], v238, s[24:27], s40 offen sc1
    s_lshl_b32 s40, s43, 12
    s_add_u32 s40, s40, 3072
    buffer_store_dwordx4 v[228:231], v238, s[24:27], s40 offen sc1
    s_add_u32 m0, s61, 17408
    s_add_u32 s33, s62, 50176
    buffer_load_dwordx4 v238, s[16:19], s33 offen sc1 lds
    v_accvgpr_read_b32 v208, a240
    v_accvgpr_read_b32 v209, a241
    v_accvgpr_read_b32 v210, a242
    v_accvgpr_read_b32 v211, a243
    v_accvgpr_read_b32 v212, a244
    s_add_u32 m0, s61, 18432
    s_add_u32 s33, s62, 51200
    buffer_load_dwordx4 v238, s[16:19], s33 offen sc1 lds
    v_accvgpr_read_b32 v213, a245
    v_accvgpr_read_b32 v214, a246
    v_accvgpr_read_b32 v215, a247
    v_accvgpr_read_b32 v216, a248
    v_accvgpr_read_b32 v217, a249
    s_add_u32 m0, s61, 19456
    s_add_u32 s33, s62, 52224
    buffer_load_dwordx4 v238, s[16:19], s33 offen sc1 lds
    v_accvgpr_read_b32 v218, a250
    v_accvgpr_read_b32 v219, a251
    v_accvgpr_read_b32 v220, a252
    v_accvgpr_read_b32 v221, a253
    v_accvgpr_read_b32 v222, a254
    s_mov_b32 s33, 12288
    buffer_load_dwordx4 a[80:83], v9, s[20:23], s33 offen sc1
    v_accvgpr_read_b32 v223, a255
    v_add_f32 v192, v208, v210
    v_add_f32 v193, v209, v211
    v_add_f32 v192, v192, v212
    v_add_f32 v193, v193, v213
    s_mov_b32 s33, 143360
    buffer_load_dwordx4 a[84:87], v9, s[20:23], s33 offen sc1
    v_add_f32 v192, v192, v214
    v_add_f32 v193, v193, v215
    v_add_f32 v192, v192, v216
    v_add_f32 v193, v193, v217
    v_add_f32 v192, v192, v218
    s_mov_b32 s33, 274432
    buffer_load_dwordx4 a[88:91], v9, s[20:23], s33 offen sc1
    v_add_f32 v193, v193, v219
    v_add_f32 v192, v192, v220
    v_add_f32 v193, v193, v221
    v_add_f32 v192, v192, v222
    v_add_f32 v193, v193, v223
    s_mov_b32 s33, 405504
    buffer_load_dwordx4 a[92:95], v9, s[20:23], s33 offen sc1
    v_mul_f32 v192, 0x3b000000, v192
    v_mul_f32 v193, 0x3b000000, v193
    v_fma_f32 v193, -v192, v192, v193
    v_max_f32 v193, 0, v193
    v_cvt_pk_bf16_f32 v194, v192, v192
    s_waitcnt vmcnt(48)
    s_waitcnt lgkmcnt(0)
    v_mfma_f32_16x16x32_bf16 v[96:99], v[160:163], a[96:99], v[96:99]
    ds_read_b64_tr_b16 v[176:177], v4 offset:28672
    v_and_b32 v194, 0xffff0000, v194
    v_cvt_pk_bf16_f32 v193, v193, v193
    v_mfma_f32_16x16x32_bf16 v[112:115], v[160:163], a[100:103], v[112:115]
    v_and_b32 v193, 0xffff0000, v193
    v_add_f32 v193, 0x3727c5ac, v193
    v_cvt_pk_bf16_f32 v193, v193, v193
    v_mfma_f32_16x16x32_bf16 v[128:131], v[160:163], a[104:107], v[128:131]
    ds_read_b64_tr_b16 v[178:179], v4 offset:30720
    v_and_b32 v193, 0xffff0000, v193
    v_sqrt_f32 v193, v193
    v_mfma_f32_16x16x32_bf16 v[144:147], v[160:163], a[108:111], v[144:147]
    v_cvt_pk_bf16_f32 v193, v193, v193
    v_and_b32 v193, 0xffff0000, v193
    v_rcp_f32 v195, v193
    v_mfma_f32_16x16x32_bf16 v[100:103], v[164:167], a[96:99], v[100:103]
    ds_read_b64_tr_b16 v[180:181], v5 offset:28672
    v_accvgpr_read_b32 v208, a192
    v_accvgpr_read_b32 v209, a193
    v_mfma_f32_16x16x32_bf16 v[116:119], v[164:167], a[100:103], v[116:119]
    v_accvgpr_read_b32 v210, a194
    v_accvgpr_read_b32 v211, a195
    v_accvgpr_read_b32 v212, a196
    v_mfma_f32_16x16x32_bf16 v[132:135], v[164:167], a[104:107], v[132:135]
    ds_read_b64_tr_b16 v[182:183], v5 offset:30720
    v_accvgpr_read_b32 v213, a197
    v_accvgpr_read_b32 v214, a198
    v_mfma_f32_16x16x32_bf16 v[148:151], v[164:167], a[108:111], v[148:151]
    v_accvgpr_read_b32 v215, a199
    v_accvgpr_read_b32 v216, a200
    v_accvgpr_read_b32 v217, a201
    v_mfma_f32_16x16x32_bf16 v[104:107], v[168:171], a[96:99], v[104:107]
    ds_read_b64_tr_b16 v[184:185], v6 offset:28672
    v_accvgpr_read_b32 v218, a202
    v_accvgpr_read_b32 v219, a203
    v_mfma_f32_16x16x32_bf16 v[120:123], v[168:171], a[100:103], v[120:123]
    v_accvgpr_read_b32 v220, a204
    v_accvgpr_read_b32 v221, a205
    v_accvgpr_read_b32 v222, a206
    v_mfma_f32_16x16x32_bf16 v[136:139], v[168:171], a[104:107], v[136:139]
    ds_read_b64_tr_b16 v[186:187], v6 offset:30720
    v_accvgpr_read_b32 v223, a207
    v_fma_f32 v64, -v194, v208, v64
    v_mfma_f32_16x16x32_bf16 v[152:155], v[168:171], a[108:111], v[152:155]
    v_fma_f32 v65, -v194, v209, v65
    v_fma_f32 v66, -v194, v210, v66
    v_fma_f32 v67, -v194, v211, v67
    v_mfma_f32_16x16x32_bf16 v[108:111], v[172:175], a[96:99], v[108:111]
    ds_read_b64_tr_b16 v[188:189], v7 offset:28672
    v_fma_f32 v68, -v194, v212, v68
    v_fma_f32 v69, -v194, v213, v69
    v_mfma_f32_16x16x32_bf16 v[124:127], v[172:175], a[100:103], v[124:127]
    v_fma_f32 v70, -v194, v214, v70
    v_fma_f32 v71, -v194, v215, v71
    v_fma_f32 v72, -v194, v216, v72
    v_mfma_f32_16x16x32_bf16 v[140:143], v[172:175], a[104:107], v[140:143]
    ds_read_b64_tr_b16 v[190:191], v7 offset:30720
    v_fma_f32 v73, -v194, v217, v73
    v_fma_f32 v74, -v194, v218, v74
    v_mfma_f32_16x16x32_bf16 v[156:159], v[172:175], a[108:111], v[156:159]
    v_fma_f32 v75, -v194, v219, v75
    v_fma_f32 v76, -v194, v220, v76
    v_fma_f32 v77, -v194, v221, v77
    s_add_u32 m0, s61, 20480
    s_add_u32 s33, s62, 53248
    buffer_load_dwordx4 v238, s[16:19], s33 offen sc1 lds
    v_fma_f32 v78, -v194, v222, v78
    v_fma_f32 v79, -v194, v223, v79
    v_mul_f32 v64, v195, v64
    v_mul_f32 v65, v195, v65
    v_mul_f32 v66, v195, v66
    s_add_u32 m0, s61, 21504
    s_add_u32 s33, s62, 54272
    buffer_load_dwordx4 v238, s[16:19], s33 offen sc1 lds
    v_mul_f32 v67, v195, v67
    v_mul_f32 v68, v195, v68
    v_mul_f32 v69, v195, v69
    v_mul_f32 v70, v195, v70
    v_mul_f32 v71, v195, v71
    s_add_u32 m0, s61, 22528
    s_add_u32 s33, s62, 55296
    buffer_load_dwordx4 v238, s[16:19], s33 offen sc1 lds
    v_mul_f32 v72, v195, v72
    v_mul_f32 v73, v195, v73
    v_mul_f32 v74, v195, v74
    v_mul_f32 v75, v195, v75
    v_mul_f32 v76, v195, v76
    s_add_u32 m0, s61, 23552
    s_add_u32 s33, s62, 56320
    buffer_load_dwordx4 v238, s[16:19], s33 offen sc1 lds
    v_mul_f32 v77, v195, v77
    v_mul_f32 v78, v195, v78
    v_mul_f32 v79, v195, v79
    v_cvt_pk_bf16_f32 v208, v64, v65
    v_cvt_pk_bf16_f32 v209, v66, v67
    s_mov_b32 s33, 13312
    buffer_load_dwordx4 a[96:99], v9, s[20:23], s33 offen sc1
    v_cvt_pk_bf16_f32 v210, v68, v69
    v_cvt_pk_bf16_f32 v211, v70, v71
    v_cvt_pk_bf16_f32 v212, v72, v73
    v_cvt_pk_bf16_f32 v213, v74, v75
    v_cvt_pk_bf16_f32 v214, v76, v77
    s_mov_b32 s33, 144384
    buffer_load_dwordx4 a[100:103], v9, s[20:23], s33 offen sc1
    v_cvt_pk_bf16_f32 v215, v78, v79
    v_lshlrev_b32 v64, 16, v208
    v_and_b32 v65, 0xffff0000, v208
    v_lshlrev_b32 v66, 16, v209
    v_and_b32 v67, 0xffff0000, v209
    s_mov_b32 s33, 275456
    buffer_load_dwordx4 a[104:107], v9, s[20:23], s33 offen sc1
    v_lshlrev_b32 v68, 16, v210
    v_and_b32 v69, 0xffff0000, v210
    v_lshlrev_b32 v70, 16, v211
    v_and_b32 v71, 0xffff0000, v211
    v_lshlrev_b32 v72, 16, v212
    s_mov_b32 s33, 406528
    buffer_load_dwordx4 a[108:111], v9, s[20:23], s33 offen sc1
    v_and_b32 v73, 0xffff0000, v212
    v_lshlrev_b32 v74, 16, v213
    v_and_b32 v75, 0xffff0000, v213
    v_lshlrev_b32 v76, 16, v214
    v_and_b32 v77, 0xffff0000, v214
    s_waitcnt vmcnt(48)
    s_waitcnt lgkmcnt(0)
    v_mfma_f32_16x16x32_bf16 v[96:99], v[176:179], a[0:3], v[96:99]
    ds_read_b64_tr_b16 v[160:161], v4 offset:0
    v_lshlrev_b32 v78, 16, v215
    v_and_b32 v79, 0xffff0000, v215
    v_mfma_f32_16x16x32_bf16 v[112:115], v[176:179], a[4:7], v[112:115]
    v_mul_f32 v208, v64, v64
    v_mul_f32 v209, v65, v65
    v_mul_f32 v210, v66, v66
    v_mfma_f32_16x16x32_bf16 v[128:131], v[176:179], a[8:11], v[128:131]
    ds_read_b64_tr_b16 v[162:163], v4 offset:2048
    v_mul_f32 v211, v67, v67
    v_mul_f32 v212, v68, v68
    v_mfma_f32_16x16x32_bf16 v[144:147], v[176:179], a[12:15], v[144:147]
    v_mul_f32 v213, v69, v69
    v_mul_f32 v214, v70, v70
    v_mul_f32 v215, v71, v71
    v_mfma_f32_16x16x32_bf16 v[100:103], v[180:183], a[0:3], v[100:103]
    ds_read_b64_tr_b16 v[164:165], v5 offset:0
    v_mul_f32 v216, v72, v72
    v_mul_f32 v217, v73, v73
    v_mfma_f32_16x16x32_bf16 v[116:119], v[180:183], a[4:7], v[116:119]
    v_mul_f32 v218, v74, v74
    v_mul_f32 v219, v75, v75
    v_mul_f32 v220, v76, v76
    v_mfma_f32_16x16x32_bf16 v[132:135], v[180:183], a[8:11], v[132:135]
    ds_read_b64_tr_b16 v[166:167], v5 offset:2048
    v_mul_f32 v221, v77, v77
    v_mul_f32 v222, v78, v78
    v_mfma_f32_16x16x32_bf16 v[148:151], v[180:183], a[12:15], v[148:151]
    v_mul_f32 v223, v79, v79
    v_fmaak_f32 v208, v208, v24, 0xc0135761
    v_fmaak_f32 v209, v209, v24, 0xc0135761
    v_mfma_f32_16x16x32_bf16 v[104:107], v[184:187], a[0:3], v[104:107]
    ds_read_b64_tr_b16 v[168:169], v6 offset:0
    v_fmaak_f32 v210, v210, v24, 0xc0135761
    v_fmaak_f32 v211, v211, v24, 0xc0135761
    v_mfma_f32_16x16x32_bf16 v[120:123], v[184:187], a[4:7], v[120:123]
    v_fmaak_f32 v212, v212, v24, 0xc0135761
    v_fmaak_f32 v213, v213, v24, 0xc0135761
    v_fmaak_f32 v214, v214, v24, 0xc0135761
    v_mfma_f32_16x16x32_bf16 v[136:139], v[184:187], a[8:11], v[136:139]
    ds_read_b64_tr_b16 v[170:171], v6 offset:2048
    v_fmaak_f32 v215, v215, v24, 0xc0135761
    v_fmaak_f32 v216, v216, v24, 0xc0135761
    v_mfma_f32_16x16x32_bf16 v[152:155], v[184:187], a[12:15], v[152:155]
    v_fmaak_f32 v217, v217, v24, 0xc0135761
    v_fmaak_f32 v218, v218, v24, 0xc0135761
    v_fmaak_f32 v219, v219, v24, 0xc0135761
    v_mfma_f32_16x16x32_bf16 v[108:111], v[188:191], a[0:3], v[108:111]
    ds_read_b64_tr_b16 v[172:173], v7 offset:0
    v_fmaak_f32 v220, v220, v24, 0xc0135761
    v_fmaak_f32 v221, v221, v24, 0xc0135761
    v_mfma_f32_16x16x32_bf16 v[124:127], v[188:191], a[4:7], v[124:127]
    v_fmaak_f32 v222, v222, v24, 0xc0135761
    v_fmaak_f32 v223, v223, v24, 0xc0135761
    v_mul_f32 v208, v208, v64
    v_mfma_f32_16x16x32_bf16 v[140:143], v[188:191], a[8:11], v[140:143]
    ds_read_b64_tr_b16 v[174:175], v7 offset:2048
    v_mul_f32 v209, v209, v65
    v_mul_f32 v210, v210, v66
    v_mfma_f32_16x16x32_bf16 v[156:159], v[188:191], a[12:15], v[156:159]
    v_mul_f32 v211, v211, v67
    v_mul_f32 v212, v212, v68
    v_mul_f32 v213, v213, v69
    s_add_u32 m0, s61, 24576
    s_add_u32 s33, s62, 57344
    buffer_load_dwordx4 v238, s[16:19], s33 offen sc1 lds
    v_mul_f32 v214, v214, v70
    v_mul_f32 v215, v215, v71
    v_mul_f32 v216, v216, v72
    v_mul_f32 v217, v217, v73
    v_mul_f32 v218, v218, v74
    s_add_u32 m0, s61, 25600
    s_add_u32 s33, s62, 58368
    buffer_load_dwordx4 v238, s[16:19], s33 offen sc1 lds
    v_mul_f32 v219, v219, v75
    v_mul_f32 v220, v220, v76
    v_mul_f32 v221, v221, v77
    v_mul_f32 v222, v222, v78
    v_mul_f32 v223, v223, v79
    s_add_u32 m0, s61, 26624
    s_add_u32 s33, s62, 59392
    buffer_load_dwordx4 v238, s[16:19], s33 offen sc1 lds
    v_exp_f32 v208, v208
    v_exp_f32 v209, v209
    v_exp_f32 v210, v210
    v_exp_f32 v211, v211
    v_exp_f32 v212, v212
    s_add_u32 m0, s61, 27648
    s_add_u32 s33, s62, 60416
    buffer_load_dwordx4 v238, s[16:19], s33 offen sc1 lds
    v_exp_f32 v213, v213
    v_exp_f32 v214, v214
    v_exp_f32 v215, v215
    v_exp_f32 v216, v216
    v_exp_f32 v217, v217
    s_mov_b32 s33, 14336
    buffer_load_dwordx4 a[0:3], v9, s[20:23], s33 offen sc1
    v_exp_f32 v218, v218
    v_exp_f32 v219, v219
    v_exp_f32 v220, v220
    v_exp_f32 v221, v221
    v_exp_f32 v222, v222
    s_mov_b32 s33, 145408
    buffer_load_dwordx4 a[4:7], v9, s[20:23], s33 offen sc1
    v_exp_f32 v223, v223
    v_add_f32 v208, 1.0, v208
    v_add_f32 v209, 1.0, v209
    v_add_f32 v210, 1.0, v210
    v_add_f32 v211, 1.0, v211
    s_mov_b32 s33, 276480
    buffer_load_dwordx4 a[8:11], v9, s[20:23], s33 offen sc1
    v_add_f32 v212, 1.0, v212
    v_add_f32 v213, 1.0, v213
    v_add_f32 v214, 1.0, v214
    v_add_f32 v215, 1.0, v215
    v_add_f32 v216, 1.0, v216
    s_mov_b32 s33, 407552
    buffer_load_dwordx4 a[12:15], v9, s[20:23], s33 offen sc1
    v_add_f32 v217, 1.0, v217
    v_add_f32 v218, 1.0, v218
    v_add_f32 v219, 1.0, v219
    v_add_f32 v220, 1.0, v220
    v_add_f32 v221, 1.0, v221
    s_waitcnt vmcnt(48)
    s_waitcnt lgkmcnt(0)
    v_mfma_f32_16x16x32_bf16 v[96:99], v[160:163], a[16:19], v[96:99]
    ds_read_b64_tr_b16 v[176:177], v4 offset:4096
    v_add_f32 v222, 1.0, v222
    v_add_f32 v223, 1.0, v223
    v_mfma_f32_16x16x32_bf16 v[112:115], v[160:163], a[20:23], v[112:115]
    v_rcp_f32 v208, v208
    v_rcp_f32 v209, v209
    v_rcp_f32 v210, v210
    v_mfma_f32_16x16x32_bf16 v[128:131], v[160:163], a[24:27], v[128:131]
    ds_read_b64_tr_b16 v[178:179], v4 offset:6144
    v_rcp_f32 v211, v211
    v_rcp_f32 v212, v212
    v_mfma_f32_16x16x32_bf16 v[144:147], v[160:163], a[28:31], v[144:147]
    v_rcp_f32 v213, v213
    v_rcp_f32 v214, v214
    v_rcp_f32 v215, v215
    v_mfma_f32_16x16x32_bf16 v[100:103], v[164:167], a[16:19], v[100:103]
    ds_read_b64_tr_b16 v[180:181], v5 offset:4096
    v_rcp_f32 v216, v216
    v_rcp_f32 v217, v217
    v_mfma_f32_16x16x32_bf16 v[116:119], v[164:167], a[20:23], v[116:119]
    v_rcp_f32 v218, v218
    v_rcp_f32 v219, v219
    v_rcp_f32 v220, v220
    v_mfma_f32_16x16x32_bf16 v[132:135], v[164:167], a[24:27], v[132:135]
    ds_read_b64_tr_b16 v[182:183], v5 offset:6144
    v_rcp_f32 v221, v221
    v_rcp_f32 v222, v222
    v_mfma_f32_16x16x32_bf16 v[148:151], v[164:167], a[28:31], v[148:151]
    v_rcp_f32 v223, v223
    v_mul_f32 v64, v64, v208
    v_mul_f32 v65, v65, v209
    v_mfma_f32_16x16x32_bf16 v[104:107], v[168:171], a[16:19], v[104:107]
    ds_read_b64_tr_b16 v[184:185], v6 offset:4096
    v_mul_f32 v66, v66, v210
    v_mul_f32 v67, v67, v211
    v_mfma_f32_16x16x32_bf16 v[120:123], v[168:171], a[20:23], v[120:123]
    v_mul_f32 v68, v68, v212
    v_mul_f32 v69, v69, v213
    v_mul_f32 v70, v70, v214
    v_mfma_f32_16x16x32_bf16 v[136:139], v[168:171], a[24:27], v[136:139]
    ds_read_b64_tr_b16 v[186:187], v6 offset:6144
    v_mul_f32 v71, v71, v215
    v_mul_f32 v72, v72, v216
    v_mfma_f32_16x16x32_bf16 v[152:155], v[168:171], a[28:31], v[152:155]
    v_mul_f32 v73, v73, v217
    v_mul_f32 v74, v74, v218
    v_mul_f32 v75, v75, v219
    v_mfma_f32_16x16x32_bf16 v[108:111], v[172:175], a[16:19], v[108:111]
    ds_read_b64_tr_b16 v[188:189], v7 offset:4096
    v_mul_f32 v76, v76, v220
    v_mul_f32 v77, v77, v221
    v_mfma_f32_16x16x32_bf16 v[124:127], v[172:175], a[20:23], v[124:127]
    v_mul_f32 v78, v78, v222
    v_mul_f32 v79, v79, v223
    v_cvt_pk_bf16_f32 v224, v64, v65
    v_mfma_f32_16x16x32_bf16 v[140:143], v[172:175], a[24:27], v[140:143]
    ds_read_b64_tr_b16 v[190:191], v7 offset:6144
    v_cvt_pk_bf16_f32 v225, v66, v67
    v_cvt_pk_bf16_f32 v226, v68, v69
    v_mfma_f32_16x16x32_bf16 v[156:159], v[172:175], a[28:31], v[156:159]
    v_cvt_pk_bf16_f32 v227, v70, v71
    v_cvt_pk_bf16_f32 v228, v72, v73
    v_cvt_pk_bf16_f32 v229, v74, v75
    s_add_u32 m0, s61, 28672
    s_add_u32 s33, s62, 61440
    buffer_load_dwordx4 v238, s[16:19], s33 offen sc1 lds
    v_cvt_pk_bf16_f32 v230, v76, v77
    v_cvt_pk_bf16_f32 v231, v78, v79
    s_lshl_b32 s40, s43, 12
    s_add_u32 s40, s40, 57344
    buffer_store_dwordx4 v[224:227], v238, s[24:27], s40 offen sc1
    s_add_u32 m0, s61, 29696
    s_add_u32 s33, s62, 62464
    buffer_load_dwordx4 v238, s[16:19], s33 offen sc1 lds
    s_lshl_b32 s40, s43, 12
    s_add_u32 s40, s40, 58368
    buffer_store_dwordx4 v[228:231], v238, s[24:27], s40 offen sc1
    v_accvgpr_read_b32 v208, a208
    v_accvgpr_read_b32 v209, a209
    s_add_u32 m0, s61, 30720
    s_add_u32 s33, s62, 63488
    buffer_load_dwordx4 v238, s[16:19], s33 offen sc1 lds
    v_accvgpr_read_b32 v210, a210
    v_accvgpr_read_b32 v211, a211
    v_accvgpr_read_b32 v212, a212
    v_accvgpr_read_b32 v213, a213
    v_accvgpr_read_b32 v214, a214
    s_add_u32 m0, s61, 31744
    s_add_u32 s33, s62, 64512
    buffer_load_dwordx4 v238, s[16:19], s33 offen sc1 lds
    v_accvgpr_read_b32 v215, a215
    v_accvgpr_read_b32 v216, a216
    v_accvgpr_read_b32 v217, a217
    v_accvgpr_read_b32 v218, a218
    v_accvgpr_read_b32 v219, a219
    s_mov_b32 s33, 15360
    buffer_load_dwordx4 a[16:19], v9, s[20:23], s33 offen sc1
    v_accvgpr_read_b32 v220, a220
    v_accvgpr_read_b32 v221, a221
    v_accvgpr_read_b32 v222, a222
    v_accvgpr_read_b32 v223, a223
    v_fma_f32 v80, -v194, v208, v80
    s_mov_b32 s33, 146432
    buffer_load_dwordx4 a[20:23], v9, s[20:23], s33 offen sc1
    v_fma_f32 v81, -v194, v209, v81
    v_fma_f32 v82, -v194, v210, v82
    v_fma_f32 v83, -v194, v211, v83
    v_fma_f32 v84, -v194, v212, v84
    v_fma_f32 v85, -v194, v213, v85
    s_mov_b32 s33, 277504
    buffer_load_dwordx4 a[24:27], v9, s[20:23], s33 offen sc1
    v_fma_f32 v86, -v194, v214, v86
    v_fma_f32 v87, -v194, v215, v87
    v_fma_f32 v88, -v194, v216, v88
    v_fma_f32 v89, -v194, v217, v89
    v_fma_f32 v90, -v194, v218, v90
    s_mov_b32 s33, 408576
    buffer_load_dwordx4 a[28:31], v9, s[20:23], s33 offen sc1
    v_fma_f32 v91, -v194, v219, v91
    v_fma_f32 v92, -v194, v220, v92
    v_fma_f32 v93, -v194, v221, v93
    v_fma_f32 v94, -v194, v222, v94
    v_fma_f32 v95, -v194, v223, v95
    s_waitcnt vmcnt(48)
    s_waitcnt lgkmcnt(0)
    v_mfma_f32_16x16x32_bf16 v[96:99], v[176:179], a[32:35], v[96:99]
    ds_read_b64_tr_b16 v[160:161], v4 offset:8192
    v_mul_f32 v80, v195, v80
    v_mul_f32 v81, v195, v81
    v_mfma_f32_16x16x32_bf16 v[112:115], v[176:179], a[36:39], v[112:115]
    v_mul_f32 v82, v195, v82
    v_mul_f32 v83, v195, v83
    v_mul_f32 v84, v195, v84
    v_mfma_f32_16x16x32_bf16 v[128:131], v[176:179], a[40:43], v[128:131]
    ds_read_b64_tr_b16 v[162:163], v4 offset:10240
    v_mul_f32 v85, v195, v85
    v_mul_f32 v86, v195, v86
    v_mfma_f32_16x16x32_bf16 v[144:147], v[176:179], a[44:47], v[144:147]
    v_mul_f32 v87, v195, v87
    v_mul_f32 v88, v195, v88
    v_mul_f32 v89, v195, v89
    v_mfma_f32_16x16x32_bf16 v[100:103], v[180:183], a[32:35], v[100:103]
    ds_read_b64_tr_b16 v[164:165], v5 offset:8192
    v_mul_f32 v90, v195, v90
    v_mul_f32 v91, v195, v91
    v_mfma_f32_16x16x32_bf16 v[116:119], v[180:183], a[36:39], v[116:119]
    v_mul_f32 v92, v195, v92
    v_mul_f32 v93, v195, v93
    v_mul_f32 v94, v195, v94
    v_mfma_f32_16x16x32_bf16 v[132:135], v[180:183], a[40:43], v[132:135]
    ds_read_b64_tr_b16 v[166:167], v5 offset:10240
    v_mul_f32 v95, v195, v95
    v_cvt_pk_bf16_f32 v208, v80, v81
    v_mfma_f32_16x16x32_bf16 v[148:151], v[180:183], a[44:47], v[148:151]
    v_cvt_pk_bf16_f32 v209, v82, v83
    v_cvt_pk_bf16_f32 v210, v84, v85
    v_cvt_pk_bf16_f32 v211, v86, v87
    v_mfma_f32_16x16x32_bf16 v[104:107], v[184:187], a[32:35], v[104:107]
    ds_read_b64_tr_b16 v[168:169], v6 offset:8192
    v_cvt_pk_bf16_f32 v212, v88, v89
    v_cvt_pk_bf16_f32 v213, v90, v91
    v_mfma_f32_16x16x32_bf16 v[120:123], v[184:187], a[36:39], v[120:123]
    v_cvt_pk_bf16_f32 v214, v92, v93
    v_cvt_pk_bf16_f32 v215, v94, v95
    v_lshlrev_b32 v80, 16, v208
    v_mfma_f32_16x16x32_bf16 v[136:139], v[184:187], a[40:43], v[136:139]
    ds_read_b64_tr_b16 v[170:171], v6 offset:10240
    v_and_b32 v81, 0xffff0000, v208
    v_lshlrev_b32 v82, 16, v209
    v_mfma_f32_16x16x32_bf16 v[152:155], v[184:187], a[44:47], v[152:155]
    v_and_b32 v83, 0xffff0000, v209
    v_lshlrev_b32 v84, 16, v210
    v_and_b32 v85, 0xffff0000, v210
    v_mfma_f32_16x16x32_bf16 v[108:111], v[188:191], a[32:35], v[108:111]
    ds_read_b64_tr_b16 v[172:173], v7 offset:8192
    v_lshlrev_b32 v86, 16, v211
    v_and_b32 v87, 0xffff0000, v211
    v_mfma_f32_16x16x32_bf16 v[124:127], v[188:191], a[36:39], v[124:127]
    v_lshlrev_b32 v88, 16, v212
    v_and_b32 v89, 0xffff0000, v212
    v_lshlrev_b32 v90, 16, v213
    v_mfma_f32_16x16x32_bf16 v[140:143], v[188:191], a[40:43], v[140:143]
    ds_read_b64_tr_b16 v[174:175], v7 offset:10240
    v_and_b32 v91, 0xffff0000, v213
    v_lshlrev_b32 v92, 16, v214
    v_mfma_f32_16x16x32_bf16 v[156:159], v[188:191], a[44:47], v[156:159]
    v_and_b32 v93, 0xffff0000, v214
    v_lshlrev_b32 v94, 16, v215
    v_and_b32 v95, 0xffff0000, v215
    s_add_u32 m0, s61, 0
    s_add_u32 s33, s62, 65536
    buffer_load_dwordx4 v238, s[16:19], s33 offen sc1 lds
    v_mul_f32 v208, v80, v80
    v_mul_f32 v209, v81, v81
    v_mul_f32 v210, v82, v82
    v_mul_f32 v211, v83, v83
    v_mul_f32 v212, v84, v84
    s_add_u32 m0, s61, 1024
    s_add_u32 s33, s62, 66560
    buffer_load_dwordx4 v238, s[16:19], s33 offen sc1 lds
    v_mul_f32 v213, v85, v85
    v_mul_f32 v214, v86, v86
    v_mul_f32 v215, v87, v87
    v_mul_f32 v216, v88, v88
    v_mul_f32 v217, v89, v89
    s_add_u32 m0, s61, 2048
    s_add_u32 s33, s62, 67584
    buffer_load_dwordx4 v238, s[16:19], s33 offen sc1 lds
    v_mul_f32 v218, v90, v90
    v_mul_f32 v219, v91, v91
    v_mul_f32 v220, v92, v92
    v_mul_f32 v221, v93, v93
    v_mul_f32 v222, v94, v94
    s_add_u32 m0, s61, 3072
    s_add_u32 s33, s62, 68608
    buffer_load_dwordx4 v238, s[16:19], s33 offen sc1 lds
    v_mul_f32 v223, v95, v95
    v_fmaak_f32 v208, v208, v24, 0xc0135761
    v_fmaak_f32 v209, v209, v24, 0xc0135761
    v_fmaak_f32 v210, v210, v24, 0xc0135761
    v_fmaak_f32 v211, v211, v24, 0xc0135761
    s_mov_b32 s33, 16384
    buffer_load_dwordx4 a[32:35], v9, s[20:23], s33 offen sc1
    v_fmaak_f32 v212, v212, v24, 0xc0135761
    v_fmaak_f32 v213, v213, v24, 0xc0135761
    v_fmaak_f32 v214, v214, v24, 0xc0135761
    v_fmaak_f32 v215, v215, v24, 0xc0135761
    v_fmaak_f32 v216, v216, v24, 0xc0135761
    s_mov_b32 s33, 147456
    buffer_load_dwordx4 a[36:39], v9, s[20:23], s33 offen sc1
    v_fmaak_f32 v217, v217, v24, 0xc0135761
    v_fmaak_f32 v218, v218, v24, 0xc0135761
    v_fmaak_f32 v219, v219, v24, 0xc0135761
    v_fmaak_f32 v220, v220, v24, 0xc0135761
    v_fmaak_f32 v221, v221, v24, 0xc0135761
    s_mov_b32 s33, 278528
    buffer_load_dwordx4 a[40:43], v9, s[20:23], s33 offen sc1
    v_fmaak_f32 v222, v222, v24, 0xc0135761
    v_fmaak_f32 v223, v223, v24, 0xc0135761
    v_mul_f32 v208, v208, v80
    v_mul_f32 v209, v209, v81
    v_mul_f32 v210, v210, v82
    s_mov_b32 s33, 409600
    buffer_load_dwordx4 a[44:47], v9, s[20:23], s33 offen sc1
    v_mul_f32 v211, v211, v83
    v_mul_f32 v212, v212, v84
    v_mul_f32 v213, v213, v85
    v_mul_f32 v214, v214, v86
    v_mul_f32 v215, v215, v87
    s_waitcnt vmcnt(48)
    s_waitcnt lgkmcnt(0)
    v_mfma_f32_16x16x32_bf16 v[96:99], v[160:163], a[48:51], v[96:99]
    ds_read_b64_tr_b16 v[176:177], v4 offset:12288
    v_mul_f32 v216, v216, v88
    v_mul_f32 v217, v217, v89
    v_mfma_f32_16x16x32_bf16 v[112:115], v[160:163], a[52:55], v[112:115]
    v_mul_f32 v218, v218, v90
    v_mul_f32 v219, v219, v91
    v_mul_f32 v220, v220, v92
    v_mfma_f32_16x16x32_bf16 v[128:131], v[160:163], a[56:59], v[128:131]
    ds_read_b64_tr_b16 v[178:179], v4 offset:14336
    v_mul_f32 v221, v221, v93
    v_mul_f32 v222, v222, v94
    v_mfma_f32_16x16x32_bf16 v[144:147], v[160:163], a[60:63], v[144:147]
    v_mul_f32 v223, v223, v95
    v_exp_f32 v208, v208
    v_exp_f32 v209, v209
    v_mfma_f32_16x16x32_bf16 v[100:103], v[164:167], a[48:51], v[100:103]
    ds_read_b64_tr_b16 v[180:181], v5 offset:12288
    v_exp_f32 v210, v210
    v_exp_f32 v211, v211
    v_mfma_f32_16x16x32_bf16 v[116:119], v[164:167], a[52:55], v[116:119]
    v_exp_f32 v212, v212
    v_exp_f32 v213, v213
    v_exp_f32 v214, v214
    v_mfma_f32_16x16x32_bf16 v[132:135], v[164:167], a[56:59], v[132:135]
    ds_read_b64_tr_b16 v[182:183], v5 offset:14336
    v_exp_f32 v215, v215
    v_exp_f32 v216, v216
    v_mfma_f32_16x16x32_bf16 v[148:151], v[164:167], a[60:63], v[148:151]
    v_exp_f32 v217, v217
    v_exp_f32 v218, v218
    v_exp_f32 v219, v219
    v_mfma_f32_16x16x32_bf16 v[104:107], v[168:171], a[48:51], v[104:107]
    ds_read_b64_tr_b16 v[184:185], v6 offset:12288
    v_exp_f32 v220, v220
    v_exp_f32 v221, v221
    v_mfma_f32_16x16x32_bf16 v[120:123], v[168:171], a[52:55], v[120:123]
    v_exp_f32 v222, v222
    v_exp_f32 v223, v223
    v_add_f32 v208, 1.0, v208
    v_mfma_f32_16x16x32_bf16 v[136:139], v[168:171], a[56:59], v[136:139]
    ds_read_b64_tr_b16 v[186:187], v6 offset:14336
    v_add_f32 v209, 1.0, v209
    v_add_f32 v210, 1.0, v210
    v_mfma_f32_16x16x32_bf16 v[152:155], v[168:171], a[60:63], v[152:155]
    v_add_f32 v211, 1.0, v211
    v_add_f32 v212, 1.0, v212
    v_add_f32 v213, 1.0, v213
    v_mfma_f32_16x16x32_bf16 v[108:111], v[172:175], a[48:51], v[108:111]
    ds_read_b64_tr_b16 v[188:189], v7 offset:12288
    v_add_f32 v214, 1.0, v214
    v_add_f32 v215, 1.0, v215
    v_mfma_f32_16x16x32_bf16 v[124:127], v[172:175], a[52:55], v[124:127]
    v_add_f32 v216, 1.0, v216
    v_add_f32 v217, 1.0, v217
    v_add_f32 v218, 1.0, v218
    v_mfma_f32_16x16x32_bf16 v[140:143], v[172:175], a[56:59], v[140:143]
    ds_read_b64_tr_b16 v[190:191], v7 offset:14336
    v_add_f32 v219, 1.0, v219
    v_add_f32 v220, 1.0, v220
    v_mfma_f32_16x16x32_bf16 v[156:159], v[172:175], a[60:63], v[156:159]
    v_add_f32 v221, 1.0, v221
    v_add_f32 v222, 1.0, v222
    v_add_f32 v223, 1.0, v223
    s_add_u32 m0, s61, 4096
    s_add_u32 s33, s62, 69632
    buffer_load_dwordx4 v238, s[16:19], s33 offen sc1 lds
    v_rcp_f32 v208, v208
    v_rcp_f32 v209, v209
    v_rcp_f32 v210, v210
    v_rcp_f32 v211, v211
    v_rcp_f32 v212, v212
    s_add_u32 m0, s61, 5120
    s_add_u32 s33, s62, 70656
    buffer_load_dwordx4 v238, s[16:19], s33 offen sc1 lds
    v_rcp_f32 v213, v213
    v_rcp_f32 v214, v214
    v_rcp_f32 v215, v215
    v_rcp_f32 v216, v216
    v_rcp_f32 v217, v217
    s_add_u32 m0, s61, 6144
    s_add_u32 s33, s62, 71680
    buffer_load_dwordx4 v238, s[16:19], s33 offen sc1 lds
    v_rcp_f32 v218, v218
    v_rcp_f32 v219, v219
    v_rcp_f32 v220, v220
    v_rcp_f32 v221, v221
    v_rcp_f32 v222, v222
    s_add_u32 m0, s61, 7168
    s_add_u32 s33, s62, 72704
    buffer_load_dwordx4 v238, s[16:19], s33 offen sc1 lds
    v_rcp_f32 v223, v223
    v_mul_f32 v80, v80, v208
    v_mul_f32 v81, v81, v209
    v_mul_f32 v82, v82, v210
    v_mul_f32 v83, v83, v211
    s_mov_b32 s33, 17408
    buffer_load_dwordx4 a[48:51], v9, s[20:23], s33 offen sc1
    v_mul_f32 v84, v84, v212
    v_mul_f32 v85, v85, v213
    v_mul_f32 v86, v86, v214
    v_mul_f32 v87, v87, v215
    v_mul_f32 v88, v88, v216
    s_mov_b32 s33, 148480
    buffer_load_dwordx4 a[52:55], v9, s[20:23], s33 offen sc1
    v_mul_f32 v89, v89, v217
    v_mul_f32 v90, v90, v218
    v_mul_f32 v91, v91, v219
    v_mul_f32 v92, v92, v220
    v_mul_f32 v93, v93, v221
    s_mov_b32 s33, 279552
    buffer_load_dwordx4 a[56:59], v9, s[20:23], s33 offen sc1
    v_mul_f32 v94, v94, v222
    v_mul_f32 v95, v95, v223
    v_cvt_pk_bf16_f32 v224, v80, v81
    v_cvt_pk_bf16_f32 v225, v82, v83
    v_cvt_pk_bf16_f32 v226, v84, v85
    s_mov_b32 s33, 410624
    buffer_load_dwordx4 a[60:63], v9, s[20:23], s33 offen sc1
    v_cvt_pk_bf16_f32 v227, v86, v87
    v_cvt_pk_bf16_f32 v228, v88, v89
    v_cvt_pk_bf16_f32 v229, v90, v91
    v_cvt_pk_bf16_f32 v230, v92, v93
    v_cvt_pk_bf16_f32 v231, v94, v95
    s_waitcnt vmcnt(46)
    s_waitcnt lgkmcnt(0)
    v_mfma_f32_16x16x32_bf16 v[96:99], v[176:179], a[64:67], v[96:99]
    ds_read_b64_tr_b16 v[160:161], v4 offset:16384
    s_lshl_b32 s40, s43, 12
    s_add_u32 s40, s40, 59392
    v_mfma_f32_16x16x32_bf16 v[112:115], v[176:179], a[68:71], v[112:115]
    buffer_store_dwordx4 v[224:227], v238, s[24:27], s40 offen sc1
    s_lshl_b32 s40, s43, 12
    s_add_u32 s40, s40, 60416
    v_mfma_f32_16x16x32_bf16 v[128:131], v[176:179], a[72:75], v[128:131]
    ds_read_b64_tr_b16 v[162:163], v4 offset:18432
    buffer_store_dwordx4 v[228:231], v238, s[24:27], s40 offen sc1
    v_mov_b32 v32, 0
    v_mfma_f32_16x16x32_bf16 v[144:147], v[176:179], a[76:79], v[144:147]
    v_mov_b32 v33, 0
    v_mov_b32 v34, 0
    v_mov_b32 v35, 0
    v_mfma_f32_16x16x32_bf16 v[100:103], v[180:183], a[64:67], v[100:103]
    ds_read_b64_tr_b16 v[164:165], v5 offset:16384
    v_mov_b32 v36, 0
    v_mov_b32 v37, 0
    v_mfma_f32_16x16x32_bf16 v[116:119], v[180:183], a[68:71], v[116:119]
    v_mov_b32 v38, 0
    v_mov_b32 v39, 0
    v_mov_b32 v40, 0
    v_mfma_f32_16x16x32_bf16 v[132:135], v[180:183], a[72:75], v[132:135]
    ds_read_b64_tr_b16 v[166:167], v5 offset:18432
    v_mov_b32 v41, 0
    v_mov_b32 v42, 0
    v_mfma_f32_16x16x32_bf16 v[148:151], v[180:183], a[76:79], v[148:151]
    v_mov_b32 v43, 0
    v_mov_b32 v44, 0
    v_mov_b32 v45, 0
    v_mfma_f32_16x16x32_bf16 v[104:107], v[184:187], a[64:67], v[104:107]
    ds_read_b64_tr_b16 v[168:169], v6 offset:16384
    v_mov_b32 v46, 0
    v_mov_b32 v47, 0
    v_mfma_f32_16x16x32_bf16 v[120:123], v[184:187], a[68:71], v[120:123]
    v_mov_b32 v48, 0
    v_mov_b32 v49, 0
    v_mov_b32 v50, 0
    v_mfma_f32_16x16x32_bf16 v[136:139], v[184:187], a[72:75], v[136:139]
    ds_read_b64_tr_b16 v[170:171], v6 offset:18432
    v_mov_b32 v51, 0
    v_mov_b32 v52, 0
    v_mfma_f32_16x16x32_bf16 v[152:155], v[184:187], a[76:79], v[152:155]
    v_mov_b32 v53, 0
    v_mov_b32 v54, 0
    v_mov_b32 v55, 0
    v_mfma_f32_16x16x32_bf16 v[108:111], v[188:191], a[64:67], v[108:111]
    ds_read_b64_tr_b16 v[172:173], v7 offset:16384
    v_mov_b32 v56, 0
    v_mov_b32 v57, 0
    v_mfma_f32_16x16x32_bf16 v[124:127], v[188:191], a[68:71], v[124:127]
    v_mov_b32 v58, 0
    v_mov_b32 v59, 0
    v_mov_b32 v60, 0
    v_mfma_f32_16x16x32_bf16 v[140:143], v[188:191], a[72:75], v[140:143]
    ds_read_b64_tr_b16 v[174:175], v7 offset:18432
    v_mov_b32 v61, 0
    v_mov_b32 v62, 0
    v_mfma_f32_16x16x32_bf16 v[156:159], v[188:191], a[76:79], v[156:159]
    v_mov_b32 v63, 0
    v_mov_b32 v64, 0
    v_mov_b32 v65, 0
    s_add_u32 m0, s61, 8192
    s_add_u32 s33, s62, 73728
    buffer_load_dwordx4 v238, s[16:19], s33 offen sc1 lds
    v_mov_b32 v66, 0
    v_mov_b32 v67, 0
    v_mov_b32 v68, 0
    v_mov_b32 v69, 0
    v_mov_b32 v70, 0
    s_add_u32 m0, s61, 9216
    s_add_u32 s33, s62, 74752
    buffer_load_dwordx4 v238, s[16:19], s33 offen sc1 lds
    v_mov_b32 v71, 0
    v_mov_b32 v72, 0
    v_mov_b32 v73, 0
    v_mov_b32 v74, 0
    v_mov_b32 v75, 0
    s_add_u32 m0, s61, 10240
    s_add_u32 s33, s62, 75776
    buffer_load_dwordx4 v238, s[16:19], s33 offen sc1 lds
    v_mov_b32 v76, 0
    v_mov_b32 v77, 0
    v_mov_b32 v78, 0
    v_mov_b32 v79, 0
    v_mov_b32 v80, 0
    s_add_u32 m0, s61, 11264
    s_add_u32 s33, s62, 76800
    buffer_load_dwordx4 v238, s[16:19], s33 offen sc1 lds
    v_mov_b32 v81, 0
    v_mov_b32 v82, 0
    v_mov_b32 v83, 0
    v_mov_b32 v84, 0
    v_mov_b32 v85, 0
    s_mov_b32 s33, 18432
    buffer_load_dwordx4 a[64:67], v9, s[20:23], s33 offen sc1
    v_mov_b32 v86, 0
    v_mov_b32 v87, 0
    v_mov_b32 v88, 0
    v_mov_b32 v89, 0
    v_mov_b32 v90, 0
    s_mov_b32 s33, 149504
    buffer_load_dwordx4 a[68:71], v9, s[20:23], s33 offen sc1
    v_mov_b32 v91, 0
    v_mov_b32 v92, 0
    v_mov_b32 v93, 0
    v_mov_b32 v94, 0
    v_mov_b32 v95, 0
    s_mov_b32 s33, 280576
    buffer_load_dwordx4 a[72:75], v9, s[20:23], s33 offen sc1
    s_mov_b32 s33, 411648
    buffer_load_dwordx4 a[76:79], v9, s[20:23], s33 offen sc1
    s_waitcnt vmcnt(48)
    s_waitcnt lgkmcnt(0)
    v_mfma_f32_16x16x32_bf16 v[96:99], v[160:163], a[80:83], v[96:99]
    ds_read_b64_tr_b16 v[176:177], v4 offset:20480
    v_mfma_f32_16x16x32_bf16 v[112:115], v[160:163], a[84:87], v[112:115]
    v_mfma_f32_16x16x32_bf16 v[128:131], v[160:163], a[88:91], v[128:131]
    ds_read_b64_tr_b16 v[178:179], v4 offset:22528
    v_mfma_f32_16x16x32_bf16 v[144:147], v[160:163], a[92:95], v[144:147]
    v_mfma_f32_16x16x32_bf16 v[100:103], v[164:167], a[80:83], v[100:103]
    ds_read_b64_tr_b16 v[180:181], v5 offset:20480
    v_mfma_f32_16x16x32_bf16 v[116:119], v[164:167], a[84:87], v[116:119]
    v_mfma_f32_16x16x32_bf16 v[132:135], v[164:167], a[88:91], v[132:135]
    ds_read_b64_tr_b16 v[182:183], v5 offset:22528
    v_mfma_f32_16x16x32_bf16 v[148:151], v[164:167], a[92:95], v[148:151]
    v_mfma_f32_16x16x32_bf16 v[104:107], v[168:171], a[80:83], v[104:107]
    ds_read_b64_tr_b16 v[184:185], v6 offset:20480
    v_mfma_f32_16x16x32_bf16 v[120:123], v[168:171], a[84:87], v[120:123]
    v_mfma_f32_16x16x32_bf16 v[136:139], v[168:171], a[88:91], v[136:139]
    ds_read_b64_tr_b16 v[186:187], v6 offset:22528
    v_mfma_f32_16x16x32_bf16 v[152:155], v[168:171], a[92:95], v[152:155]
    v_mfma_f32_16x16x32_bf16 v[108:111], v[172:175], a[80:83], v[108:111]
    ds_read_b64_tr_b16 v[188:189], v7 offset:20480
    v_mfma_f32_16x16x32_bf16 v[124:127], v[172:175], a[84:87], v[124:127]
    v_mfma_f32_16x16x32_bf16 v[140:143], v[172:175], a[88:91], v[140:143]
    ds_read_b64_tr_b16 v[190:191], v7 offset:22528
    v_mfma_f32_16x16x32_bf16 v[156:159], v[172:175], a[92:95], v[156:159]
    s_add_u32 m0, s61, 12288
    s_add_u32 s33, s62, 77824
    buffer_load_dwordx4 v238, s[16:19], s33 offen sc1 lds
    s_add_u32 m0, s61, 13312
    s_add_u32 s33, s62, 78848
    buffer_load_dwordx4 v238, s[16:19], s33 offen sc1 lds
    s_add_u32 m0, s61, 14336
    s_add_u32 s33, s62, 79872
    buffer_load_dwordx4 v238, s[16:19], s33 offen sc1 lds
    s_add_u32 m0, s61, 15360
    s_add_u32 s33, s62, 80896
    buffer_load_dwordx4 v238, s[16:19], s33 offen sc1 lds
    s_mov_b32 s33, 19456
    buffer_load_dwordx4 a[80:83], v9, s[20:23], s33 offen sc1
    s_mov_b32 s33, 150528
    buffer_load_dwordx4 a[84:87], v9, s[20:23], s33 offen sc1
    s_mov_b32 s33, 281600
    buffer_load_dwordx4 a[88:91], v9, s[20:23], s33 offen sc1
    s_mov_b32 s33, 412672
    buffer_load_dwordx4 a[92:95], v9, s[20:23], s33 offen sc1
    s_waitcnt vmcnt(48)
    s_waitcnt lgkmcnt(0)
    v_mfma_f32_16x16x32_bf16 v[96:99], v[176:179], a[96:99], v[96:99]
    ds_read_b64_tr_b16 v[160:161], v4 offset:24576
    v_mfma_f32_16x16x32_bf16 v[112:115], v[176:179], a[100:103], v[112:115]
    v_mfma_f32_16x16x32_bf16 v[128:131], v[176:179], a[104:107], v[128:131]
    ds_read_b64_tr_b16 v[162:163], v4 offset:26624
    v_mfma_f32_16x16x32_bf16 v[144:147], v[176:179], a[108:111], v[144:147]
    v_mfma_f32_16x16x32_bf16 v[100:103], v[180:183], a[96:99], v[100:103]
    ds_read_b64_tr_b16 v[164:165], v5 offset:24576
    v_mfma_f32_16x16x32_bf16 v[116:119], v[180:183], a[100:103], v[116:119]
    v_mfma_f32_16x16x32_bf16 v[132:135], v[180:183], a[104:107], v[132:135]
    ds_read_b64_tr_b16 v[166:167], v5 offset:26624
    v_mfma_f32_16x16x32_bf16 v[148:151], v[180:183], a[108:111], v[148:151]
    v_mfma_f32_16x16x32_bf16 v[104:107], v[184:187], a[96:99], v[104:107]
    ds_read_b64_tr_b16 v[168:169], v6 offset:24576
    v_mfma_f32_16x16x32_bf16 v[120:123], v[184:187], a[100:103], v[120:123]
    v_mfma_f32_16x16x32_bf16 v[136:139], v[184:187], a[104:107], v[136:139]
    ds_read_b64_tr_b16 v[170:171], v6 offset:26624
    v_mfma_f32_16x16x32_bf16 v[152:155], v[184:187], a[108:111], v[152:155]
    v_mfma_f32_16x16x32_bf16 v[108:111], v[188:191], a[96:99], v[108:111]
    ds_read_b64_tr_b16 v[172:173], v7 offset:24576
    v_mfma_f32_16x16x32_bf16 v[124:127], v[188:191], a[100:103], v[124:127]
    v_mfma_f32_16x16x32_bf16 v[140:143], v[188:191], a[104:107], v[140:143]
    ds_read_b64_tr_b16 v[174:175], v7 offset:26624
    v_mfma_f32_16x16x32_bf16 v[156:159], v[188:191], a[108:111], v[156:159]
    s_add_u32 m0, s61, 16384
    s_add_u32 s33, s62, 81920
    buffer_load_dwordx4 v238, s[16:19], s33 offen sc1 lds
    s_add_u32 m0, s61, 17408
    s_add_u32 s33, s62, 82944
    buffer_load_dwordx4 v238, s[16:19], s33 offen sc1 lds
    s_add_u32 m0, s61, 18432
    s_add_u32 s33, s62, 83968
    buffer_load_dwordx4 v238, s[16:19], s33 offen sc1 lds
    s_add_u32 m0, s61, 19456
    s_add_u32 s33, s62, 84992
    buffer_load_dwordx4 v238, s[16:19], s33 offen sc1 lds
    s_mov_b32 s33, 20480
    buffer_load_dwordx4 a[96:99], v9, s[20:23], s33 offen sc1
    s_mov_b32 s33, 151552
    buffer_load_dwordx4 a[100:103], v9, s[20:23], s33 offen sc1
    s_mov_b32 s33, 282624
    buffer_load_dwordx4 a[104:107], v9, s[20:23], s33 offen sc1
    s_mov_b32 s33, 413696
    buffer_load_dwordx4 a[108:111], v9, s[20:23], s33 offen sc1
    s_waitcnt vmcnt(46)
    s_waitcnt lgkmcnt(0)
    v_mfma_f32_16x16x32_bf16 v[96:99], v[160:163], a[0:3], v[96:99]
    ds_read_b64_tr_b16 v[176:177], v4 offset:28672
    v_mfma_f32_16x16x32_bf16 v[112:115], v[160:163], a[4:7], v[112:115]
    v_mfma_f32_16x16x32_bf16 v[128:131], v[160:163], a[8:11], v[128:131]
    ds_read_b64_tr_b16 v[178:179], v4 offset:30720
    v_mfma_f32_16x16x32_bf16 v[144:147], v[160:163], a[12:15], v[144:147]
    v_mfma_f32_16x16x32_bf16 v[100:103], v[164:167], a[0:3], v[100:103]
    ds_read_b64_tr_b16 v[180:181], v5 offset:28672
    v_mfma_f32_16x16x32_bf16 v[116:119], v[164:167], a[4:7], v[116:119]
    v_mfma_f32_16x16x32_bf16 v[132:135], v[164:167], a[8:11], v[132:135]
    ds_read_b64_tr_b16 v[182:183], v5 offset:30720
    v_mfma_f32_16x16x32_bf16 v[148:151], v[164:167], a[12:15], v[148:151]
    v_mfma_f32_16x16x32_bf16 v[104:107], v[168:171], a[0:3], v[104:107]
    ds_read_b64_tr_b16 v[184:185], v6 offset:28672
    v_mfma_f32_16x16x32_bf16 v[120:123], v[168:171], a[4:7], v[120:123]
    v_mfma_f32_16x16x32_bf16 v[136:139], v[168:171], a[8:11], v[136:139]
    ds_read_b64_tr_b16 v[186:187], v6 offset:30720
    v_mfma_f32_16x16x32_bf16 v[152:155], v[168:171], a[12:15], v[152:155]
    v_mfma_f32_16x16x32_bf16 v[108:111], v[172:175], a[0:3], v[108:111]
    ds_read_b64_tr_b16 v[188:189], v7 offset:28672
    v_mfma_f32_16x16x32_bf16 v[124:127], v[172:175], a[4:7], v[124:127]
    v_mfma_f32_16x16x32_bf16 v[140:143], v[172:175], a[8:11], v[140:143]
    ds_read_b64_tr_b16 v[190:191], v7 offset:30720
    v_mfma_f32_16x16x32_bf16 v[156:159], v[172:175], a[12:15], v[156:159]
    s_add_u32 m0, s61, 20480
    s_add_u32 s33, s62, 86016
    buffer_load_dwordx4 v238, s[16:19], s33 offen sc1 lds
    s_add_u32 m0, s61, 21504
    s_add_u32 s33, s62, 87040
    buffer_load_dwordx4 v238, s[16:19], s33 offen sc1 lds
    s_add_u32 m0, s61, 22528
    s_add_u32 s33, s62, 88064
    buffer_load_dwordx4 v238, s[16:19], s33 offen sc1 lds
    s_add_u32 m0, s61, 23552
    s_add_u32 s33, s62, 89088
    buffer_load_dwordx4 v238, s[16:19], s33 offen sc1 lds
    s_mov_b32 s33, 21504
    buffer_load_dwordx4 a[0:3], v9, s[20:23], s33 offen sc1
    s_mov_b32 s33, 152576
    buffer_load_dwordx4 a[4:7], v9, s[20:23], s33 offen sc1
    s_mov_b32 s33, 283648
    buffer_load_dwordx4 a[8:11], v9, s[20:23], s33 offen sc1
    s_mov_b32 s33, 414720
    buffer_load_dwordx4 a[12:15], v9, s[20:23], s33 offen sc1
    s_waitcnt vmcnt(46)
    s_waitcnt lgkmcnt(0)
    v_mfma_f32_16x16x32_bf16 v[96:99], v[176:179], a[16:19], v[96:99]
    ds_read_b64_tr_b16 v[160:161], v4 offset:0
    v_mfma_f32_16x16x32_bf16 v[112:115], v[176:179], a[20:23], v[112:115]
    v_mfma_f32_16x16x32_bf16 v[128:131], v[176:179], a[24:27], v[128:131]
    ds_read_b64_tr_b16 v[162:163], v4 offset:2048
    v_mfma_f32_16x16x32_bf16 v[144:147], v[176:179], a[28:31], v[144:147]
    v_mfma_f32_16x16x32_bf16 v[100:103], v[180:183], a[16:19], v[100:103]
    ds_read_b64_tr_b16 v[164:165], v5 offset:0
    v_mfma_f32_16x16x32_bf16 v[116:119], v[180:183], a[20:23], v[116:119]
    v_mfma_f32_16x16x32_bf16 v[132:135], v[180:183], a[24:27], v[132:135]
    ds_read_b64_tr_b16 v[166:167], v5 offset:2048
    v_mfma_f32_16x16x32_bf16 v[148:151], v[180:183], a[28:31], v[148:151]
    v_mfma_f32_16x16x32_bf16 v[104:107], v[184:187], a[16:19], v[104:107]
    ds_read_b64_tr_b16 v[168:169], v6 offset:0
    v_mfma_f32_16x16x32_bf16 v[120:123], v[184:187], a[20:23], v[120:123]
    v_mfma_f32_16x16x32_bf16 v[136:139], v[184:187], a[24:27], v[136:139]
    ds_read_b64_tr_b16 v[170:171], v6 offset:2048
    v_mfma_f32_16x16x32_bf16 v[152:155], v[184:187], a[28:31], v[152:155]
    v_mfma_f32_16x16x32_bf16 v[108:111], v[188:191], a[16:19], v[108:111]
    ds_read_b64_tr_b16 v[172:173], v7 offset:0
    v_mfma_f32_16x16x32_bf16 v[124:127], v[188:191], a[20:23], v[124:127]
    v_mfma_f32_16x16x32_bf16 v[140:143], v[188:191], a[24:27], v[140:143]
    ds_read_b64_tr_b16 v[174:175], v7 offset:2048
    v_mfma_f32_16x16x32_bf16 v[156:159], v[188:191], a[28:31], v[156:159]
    s_add_u32 m0, s61, 24576
    s_add_u32 s33, s62, 90112
    buffer_load_dwordx4 v238, s[16:19], s33 offen sc1 lds
    s_add_u32 m0, s61, 25600
    s_add_u32 s33, s62, 91136
    buffer_load_dwordx4 v238, s[16:19], s33 offen sc1 lds
    s_add_u32 m0, s61, 26624
    s_add_u32 s33, s62, 92160
    buffer_load_dwordx4 v238, s[16:19], s33 offen sc1 lds
    s_add_u32 m0, s61, 27648
    s_add_u32 s33, s62, 93184
    buffer_load_dwordx4 v238, s[16:19], s33 offen sc1 lds
    s_mov_b32 s33, 22528
    buffer_load_dwordx4 a[16:19], v9, s[20:23], s33 offen sc1
    s_mov_b32 s33, 153600
    buffer_load_dwordx4 a[20:23], v9, s[20:23], s33 offen sc1
    s_mov_b32 s33, 284672
    buffer_load_dwordx4 a[24:27], v9, s[20:23], s33 offen sc1
    s_mov_b32 s33, 415744
    buffer_load_dwordx4 a[28:31], v9, s[20:23], s33 offen sc1
    s_waitcnt vmcnt(40)
    s_barrier
    s_lshl_b32 s40, s42, 4
    s_add_u32 s40, s40, s43
    s_cmp_lg_u32 s3, 0
    s_cbranch_scc1 L_pub_f3
    s_lshl_b32 s60, s40, 7
    s_add_u32 s60, s60, 163840
    v_mov_b32 v30, s60
    v_mov_b32 v31, s36
    s_mov_b64 exec, 1
    buffer_store_dword v31, v30, s[44:47], 0 offen sc1
    s_mov_b64 exec, -1
L_pub_f3:
    s_waitcnt lgkmcnt(0)
    v_mfma_f32_16x16x32_bf16 v[96:99], v[160:163], a[32:35], v[96:99]
    ds_read_b64_tr_b16 v[176:177], v4 offset:4096
    v_mfma_f32_16x16x32_bf16 v[112:115], v[160:163], a[36:39], v[112:115]
    v_mfma_f32_16x16x32_bf16 v[128:131], v[160:163], a[40:43], v[128:131]
    ds_read_b64_tr_b16 v[178:179], v4 offset:6144
    v_mfma_f32_16x16x32_bf16 v[144:147], v[160:163], a[44:47], v[144:147]
    v_mfma_f32_16x16x32_bf16 v[100:103], v[164:167], a[32:35], v[100:103]
    ds_read_b64_tr_b16 v[180:181], v5 offset:4096
    v_mfma_f32_16x16x32_bf16 v[116:119], v[164:167], a[36:39], v[116:119]
    v_mfma_f32_16x16x32_bf16 v[132:135], v[164:167], a[40:43], v[132:135]
    ds_read_b64_tr_b16 v[182:183], v5 offset:6144
    v_mfma_f32_16x16x32_bf16 v[148:151], v[164:167], a[44:47], v[148:151]
    v_mfma_f32_16x16x32_bf16 v[104:107], v[168:171], a[32:35], v[104:107]
    ds_read_b64_tr_b16 v[184:185], v6 offset:4096
    v_mfma_f32_16x16x32_bf16 v[120:123], v[168:171], a[36:39], v[120:123]
    v_mfma_f32_16x16x32_bf16 v[136:139], v[168:171], a[40:43], v[136:139]
    ds_read_b64_tr_b16 v[186:187], v6 offset:6144
    v_mfma_f32_16x16x32_bf16 v[152:155], v[168:171], a[44:47], v[152:155]
    v_mfma_f32_16x16x32_bf16 v[108:111], v[172:175], a[32:35], v[108:111]
    ds_read_b64_tr_b16 v[188:189], v7 offset:4096
    v_mfma_f32_16x16x32_bf16 v[124:127], v[172:175], a[36:39], v[124:127]
    v_mfma_f32_16x16x32_bf16 v[140:143], v[172:175], a[40:43], v[140:143]
    ds_read_b64_tr_b16 v[190:191], v7 offset:6144
    v_mfma_f32_16x16x32_bf16 v[156:159], v[172:175], a[44:47], v[156:159]
    s_add_u32 m0, s61, 28672
    s_add_u32 s33, s62, 94208
    buffer_load_dwordx4 v238, s[16:19], s33 offen sc1 lds
    s_add_u32 m0, s61, 29696
    s_add_u32 s33, s62, 95232
    buffer_load_dwordx4 v238, s[16:19], s33 offen sc1 lds
    s_add_u32 m0, s61, 30720
    s_add_u32 s33, s62, 96256
    buffer_load_dwordx4 v238, s[16:19], s33 offen sc1 lds
    s_add_u32 m0, s61, 31744
    s_add_u32 s33, s62, 97280
    buffer_load_dwordx4 v238, s[16:19], s33 offen sc1 lds
    s_mov_b32 s33, 23552
    buffer_load_dwordx4 a[32:35], v9, s[20:23], s33 offen sc1
    s_mov_b32 s33, 154624
    buffer_load_dwordx4 a[36:39], v9, s[20:23], s33 offen sc1
    s_mov_b32 s33, 285696
    buffer_load_dwordx4 a[40:43], v9, s[20:23], s33 offen sc1
    s_mov_b32 s33, 416768
    buffer_load_dwordx4 a[44:47], v9, s[20:23], s33 offen sc1
    s_waitcnt vmcnt(44)
    s_waitcnt lgkmcnt(0)
    v_mfma_f32_16x16x32_bf16 v[96:99], v[176:179], a[48:51], v[96:99]
    ds_read_b64_tr_b16 v[160:161], v4 offset:8192
    v_mfma_f32_16x16x32_bf16 v[112:115], v[176:179], a[52:55], v[112:115]
    v_mfma_f32_16x16x32_bf16 v[128:131], v[176:179], a[56:59], v[128:131]
    ds_read_b64_tr_b16 v[162:163], v4 offset:10240
    v_mfma_f32_16x16x32_bf16 v[144:147], v[176:179], a[60:63], v[144:147]
    v_mfma_f32_16x16x32_bf16 v[100:103], v[180:183], a[48:51], v[100:103]
    ds_read_b64_tr_b16 v[164:165], v5 offset:8192
    v_mfma_f32_16x16x32_bf16 v[116:119], v[180:183], a[52:55], v[116:119]
    v_mfma_f32_16x16x32_bf16 v[132:135], v[180:183], a[56:59], v[132:135]
    ds_read_b64_tr_b16 v[166:167], v5 offset:10240
    v_mfma_f32_16x16x32_bf16 v[148:151], v[180:183], a[60:63], v[148:151]
    v_mfma_f32_16x16x32_bf16 v[104:107], v[184:187], a[48:51], v[104:107]
    ds_read_b64_tr_b16 v[168:169], v6 offset:8192
    v_mfma_f32_16x16x32_bf16 v[120:123], v[184:187], a[52:55], v[120:123]
    v_mfma_f32_16x16x32_bf16 v[136:139], v[184:187], a[56:59], v[136:139]
    ds_read_b64_tr_b16 v[170:171], v6 offset:10240
    v_mfma_f32_16x16x32_bf16 v[152:155], v[184:187], a[60:63], v[152:155]
    v_mfma_f32_16x16x32_bf16 v[108:111], v[188:191], a[48:51], v[108:111]
    ds_read_b64_tr_b16 v[172:173], v7 offset:8192
    v_mfma_f32_16x16x32_bf16 v[124:127], v[188:191], a[52:55], v[124:127]
    v_mfma_f32_16x16x32_bf16 v[140:143], v[188:191], a[56:59], v[140:143]
    ds_read_b64_tr_b16 v[174:175], v7 offset:10240
    v_mfma_f32_16x16x32_bf16 v[156:159], v[188:191], a[60:63], v[156:159]
    s_add_u32 m0, s61, 0
    s_add_u32 s33, s62, 98304
    buffer_load_dwordx4 v238, s[16:19], s33 offen sc1 lds
    s_add_u32 m0, s61, 1024
    s_add_u32 s33, s62, 99328
    buffer_load_dwordx4 v238, s[16:19], s33 offen sc1 lds
    s_add_u32 m0, s61, 2048
    s_add_u32 s33, s62, 100352
    buffer_load_dwordx4 v238, s[16:19], s33 offen sc1 lds
    s_add_u32 m0, s61, 3072
    s_add_u32 s33, s62, 101376
    buffer_load_dwordx4 v238, s[16:19], s33 offen sc1 lds
    s_mov_b32 s33, 24576
    buffer_load_dwordx4 a[48:51], v9, s[20:23], s33 offen sc1
    s_mov_b32 s33, 155648
    buffer_load_dwordx4 a[52:55], v9, s[20:23], s33 offen sc1
    s_mov_b32 s33, 286720
    buffer_load_dwordx4 a[56:59], v9, s[20:23], s33 offen sc1
    s_mov_b32 s33, 417792
    buffer_load_dwordx4 a[60:63], v9, s[20:23], s33 offen sc1
    s_waitcnt vmcnt(44)
    s_waitcnt lgkmcnt(0)
    v_mfma_f32_16x16x32_bf16 v[96:99], v[160:163], a[64:67], v[96:99]
    ds_read_b64_tr_b16 v[176:177], v4 offset:12288
    v_mfma_f32_16x16x32_bf16 v[112:115], v[160:163], a[68:71], v[112:115]
    v_mfma_f32_16x16x32_bf16 v[128:131], v[160:163], a[72:75], v[128:131]
    ds_read_b64_tr_b16 v[178:179], v4 offset:14336
    v_mfma_f32_16x16x32_bf16 v[144:147], v[160:163], a[76:79], v[144:147]
    v_mfma_f32_16x16x32_bf16 v[100:103], v[164:167], a[64:67], v[100:103]
    ds_read_b64_tr_b16 v[180:181], v5 offset:12288
    v_mfma_f32_16x16x32_bf16 v[116:119], v[164:167], a[68:71], v[116:119]
    v_mfma_f32_16x16x32_bf16 v[132:135], v[164:167], a[72:75], v[132:135]
    ds_read_b64_tr_b16 v[182:183], v5 offset:14336
    v_mfma_f32_16x16x32_bf16 v[148:151], v[164:167], a[76:79], v[148:151]
    v_mfma_f32_16x16x32_bf16 v[104:107], v[168:171], a[64:67], v[104:107]
    ds_read_b64_tr_b16 v[184:185], v6 offset:12288
    v_mfma_f32_16x16x32_bf16 v[120:123], v[168:171], a[68:71], v[120:123]
    v_mfma_f32_16x16x32_bf16 v[136:139], v[168:171], a[72:75], v[136:139]
    ds_read_b64_tr_b16 v[186:187], v6 offset:14336
    v_mfma_f32_16x16x32_bf16 v[152:155], v[168:171], a[76:79], v[152:155]
    v_mfma_f32_16x16x32_bf16 v[108:111], v[172:175], a[64:67], v[108:111]
    ds_read_b64_tr_b16 v[188:189], v7 offset:12288
    v_mfma_f32_16x16x32_bf16 v[124:127], v[172:175], a[68:71], v[124:127]
    v_mfma_f32_16x16x32_bf16 v[140:143], v[172:175], a[72:75], v[140:143]
    ds_read_b64_tr_b16 v[190:191], v7 offset:14336
    v_mfma_f32_16x16x32_bf16 v[156:159], v[172:175], a[76:79], v[156:159]
    s_add_u32 m0, s61, 4096
    s_add_u32 s33, s62, 102400
    buffer_load_dwordx4 v238, s[16:19], s33 offen sc1 lds
    s_add_u32 m0, s61, 5120
    s_add_u32 s33, s62, 103424
    buffer_load_dwordx4 v238, s[16:19], s33 offen sc1 lds
    s_add_u32 m0, s61, 6144
    s_add_u32 s33, s62, 104448
    buffer_load_dwordx4 v238, s[16:19], s33 offen sc1 lds
    s_add_u32 m0, s61, 7168
    s_add_u32 s33, s62, 105472
    buffer_load_dwordx4 v238, s[16:19], s33 offen sc1 lds
    s_mov_b32 s33, 25600
    buffer_load_dwordx4 a[64:67], v9, s[20:23], s33 offen sc1
    s_mov_b32 s33, 156672
    buffer_load_dwordx4 a[68:71], v9, s[20:23], s33 offen sc1
    s_mov_b32 s33, 287744
    buffer_load_dwordx4 a[72:75], v9, s[20:23], s33 offen sc1
    s_mov_b32 s33, 418816
    buffer_load_dwordx4 a[76:79], v9, s[20:23], s33 offen sc1
    s_waitcnt vmcnt(44)
    s_waitcnt lgkmcnt(0)
    v_mfma_f32_16x16x32_bf16 v[96:99], v[176:179], a[80:83], v[96:99]
    ds_read_b64_tr_b16 v[160:161], v4 offset:16384
    v_mfma_f32_16x16x32_bf16 v[112:115], v[176:179], a[84:87], v[112:115]
    v_mfma_f32_16x16x32_bf16 v[128:131], v[176:179], a[88:91], v[128:131]
    ds_read_b64_tr_b16 v[162:163], v4 offset:18432
    v_mfma_f32_16x16x32_bf16 v[144:147], v[176:179], a[92:95], v[144:147]
    v_mfma_f32_16x16x32_bf16 v[100:103], v[180:183], a[80:83], v[100:103]
    ds_read_b64_tr_b16 v[164:165], v5 offset:16384
    v_mfma_f32_16x16x32_bf16 v[116:119], v[180:183], a[84:87], v[116:119]
    v_mfma_f32_16x16x32_bf16 v[132:135], v[180:183], a[88:91], v[132:135]
    ds_read_b64_tr_b16 v[166:167], v5 offset:18432
    v_mfma_f32_16x16x32_bf16 v[148:151], v[180:183], a[92:95], v[148:151]
    v_mfma_f32_16x16x32_bf16 v[104:107], v[184:187], a[80:83], v[104:107]
    ds_read_b64_tr_b16 v[168:169], v6 offset:16384
    v_mfma_f32_16x16x32_bf16 v[120:123], v[184:187], a[84:87], v[120:123]
    v_mfma_f32_16x16x32_bf16 v[136:139], v[184:187], a[88:91], v[136:139]
    ds_read_b64_tr_b16 v[170:171], v6 offset:18432
    v_mfma_f32_16x16x32_bf16 v[152:155], v[184:187], a[92:95], v[152:155]
    v_mfma_f32_16x16x32_bf16 v[108:111], v[188:191], a[80:83], v[108:111]
    ds_read_b64_tr_b16 v[172:173], v7 offset:16384
    v_mfma_f32_16x16x32_bf16 v[124:127], v[188:191], a[84:87], v[124:127]
    v_mfma_f32_16x16x32_bf16 v[140:143], v[188:191], a[88:91], v[140:143]
    ds_read_b64_tr_b16 v[174:175], v7 offset:18432
    v_mfma_f32_16x16x32_bf16 v[156:159], v[188:191], a[92:95], v[156:159]
    s_add_u32 m0, s61, 8192
    s_add_u32 s33, s62, 106496
    buffer_load_dwordx4 v238, s[16:19], s33 offen sc1 lds
    s_add_u32 m0, s61, 9216
    s_add_u32 s33, s62, 107520
    buffer_load_dwordx4 v238, s[16:19], s33 offen sc1 lds
    s_add_u32 m0, s61, 10240
    s_add_u32 s33, s62, 108544
    buffer_load_dwordx4 v238, s[16:19], s33 offen sc1 lds
    s_add_u32 m0, s61, 11264
    s_add_u32 s33, s62, 109568
    buffer_load_dwordx4 v238, s[16:19], s33 offen sc1 lds
    s_mov_b32 s33, 26624
    buffer_load_dwordx4 a[80:83], v9, s[20:23], s33 offen sc1
    s_mov_b32 s33, 157696
    buffer_load_dwordx4 a[84:87], v9, s[20:23], s33 offen sc1
    s_mov_b32 s33, 288768
    buffer_load_dwordx4 a[88:91], v9, s[20:23], s33 offen sc1
    s_mov_b32 s33, 419840
    buffer_load_dwordx4 a[92:95], v9, s[20:23], s33 offen sc1
    s_waitcnt vmcnt(44)
    s_waitcnt lgkmcnt(0)
    v_mfma_f32_16x16x32_bf16 v[96:99], v[160:163], a[96:99], v[96:99]
    ds_read_b64_tr_b16 v[176:177], v4 offset:20480
    v_mfma_f32_16x16x32_bf16 v[112:115], v[160:163], a[100:103], v[112:115]
    v_mfma_f32_16x16x32_bf16 v[128:131], v[160:163], a[104:107], v[128:131]
    ds_read_b64_tr_b16 v[178:179], v4 offset:22528
    v_mfma_f32_16x16x32_bf16 v[144:147], v[160:163], a[108:111], v[144:147]
    v_mfma_f32_16x16x32_bf16 v[100:103], v[164:167], a[96:99], v[100:103]
    ds_read_b64_tr_b16 v[180:181], v5 offset:20480
    v_mfma_f32_16x16x32_bf16 v[116:119], v[164:167], a[100:103], v[116:119]
    v_mfma_f32_16x16x32_bf16 v[132:135], v[164:167], a[104:107], v[132:135]
    ds_read_b64_tr_b16 v[182:183], v5 offset:22528
    v_mfma_f32_16x16x32_bf16 v[148:151], v[164:167], a[108:111], v[148:151]
    v_mfma_f32_16x16x32_bf16 v[104:107], v[168:171], a[96:99], v[104:107]
    ds_read_b64_tr_b16 v[184:185], v6 offset:20480
    v_mfma_f32_16x16x32_bf16 v[120:123], v[168:171], a[100:103], v[120:123]
    v_mfma_f32_16x16x32_bf16 v[136:139], v[168:171], a[104:107], v[136:139]
    ds_read_b64_tr_b16 v[186:187], v6 offset:22528
    v_mfma_f32_16x16x32_bf16 v[152:155], v[168:171], a[108:111], v[152:155]
    v_mfma_f32_16x16x32_bf16 v[108:111], v[172:175], a[96:99], v[108:111]
    ds_read_b64_tr_b16 v[188:189], v7 offset:20480
    v_mfma_f32_16x16x32_bf16 v[124:127], v[172:175], a[100:103], v[124:127]
    v_mfma_f32_16x16x32_bf16 v[140:143], v[172:175], a[104:107], v[140:143]
    ds_read_b64_tr_b16 v[190:191], v7 offset:22528
    v_mfma_f32_16x16x32_bf16 v[156:159], v[172:175], a[108:111], v[156:159]
    s_add_u32 m0, s61, 12288
    s_add_u32 s33, s62, 110592
    buffer_load_dwordx4 v238, s[16:19], s33 offen sc1 lds
    s_add_u32 m0, s61, 13312
    s_add_u32 s33, s62, 111616
    buffer_load_dwordx4 v238, s[16:19], s33 offen sc1 lds
    s_add_u32 m0, s61, 14336
    s_add_u32 s33, s62, 112640
    buffer_load_dwordx4 v238, s[16:19], s33 offen sc1 lds
    s_add_u32 m0, s61, 15360
    s_add_u32 s33, s62, 113664
    buffer_load_dwordx4 v238, s[16:19], s33 offen sc1 lds
    s_mov_b32 s33, 27648
    buffer_load_dwordx4 a[96:99], v9, s[20:23], s33 offen sc1
    s_mov_b32 s33, 158720
    buffer_load_dwordx4 a[100:103], v9, s[20:23], s33 offen sc1
    s_mov_b32 s33, 289792
    buffer_load_dwordx4 a[104:107], v9, s[20:23], s33 offen sc1
    s_mov_b32 s33, 420864
    buffer_load_dwordx4 a[108:111], v9, s[20:23], s33 offen sc1
    s_lshr_b32 s40, s38, 1
    s_lshl_b32 s40, s40, 4
    v_min_u32 v23, 13, v1
    v_add_u32 v23, s40, v23
    v_lshlrev_b32 v23, 7, v23
    v_add_u32 v23, 163840, v23
    buffer_load_dword v22, v23, s[44:47], 0 offen sc1
    s_waitcnt vmcnt(45)
    s_waitcnt lgkmcnt(0)
    v_mfma_f32_16x16x32_bf16 v[96:99], v[176:179], a[0:3], v[96:99]
    ds_read_b64_tr_b16 v[160:161], v4 offset:24576
    v_mfma_f32_16x16x32_bf16 v[112:115], v[176:179], a[4:7], v[112:115]
    v_mfma_f32_16x16x32_bf16 v[128:131], v[176:179], a[8:11], v[128:131]
    ds_read_b64_tr_b16 v[162:163], v4 offset:26624
    v_mfma_f32_16x16x32_bf16 v[144:147], v[176:179], a[12:15], v[144:147]
    v_mfma_f32_16x16x32_bf16 v[100:103], v[180:183], a[0:3], v[100:103]
    ds_read_b64_tr_b16 v[164:165], v5 offset:24576
    v_mfma_f32_16x16x32_bf16 v[116:119], v[180:183], a[4:7], v[116:119]
    v_mfma_f32_16x16x32_bf16 v[132:135], v[180:183], a[8:11], v[132:135]
    ds_read_b64_tr_b16 v[166:167], v5 offset:26624
    v_mfma_f32_16x16x32_bf16 v[148:151], v[180:183], a[12:15], v[148:151]
    v_mfma_f32_16x16x32_bf16 v[104:107], v[184:187], a[0:3], v[104:107]
    ds_read_b64_tr_b16 v[168:169], v6 offset:24576
    v_mfma_f32_16x16x32_bf16 v[120:123], v[184:187], a[4:7], v[120:123]
    v_mfma_f32_16x16x32_bf16 v[136:139], v[184:187], a[8:11], v[136:139]
    ds_read_b64_tr_b16 v[170:171], v6 offset:26624
    v_mfma_f32_16x16x32_bf16 v[152:155], v[184:187], a[12:15], v[152:155]
    v_mfma_f32_16x16x32_bf16 v[108:111], v[188:191], a[0:3], v[108:111]
    ds_read_b64_tr_b16 v[172:173], v7 offset:24576
    v_mfma_f32_16x16x32_bf16 v[124:127], v[188:191], a[4:7], v[124:127]
    v_mfma_f32_16x16x32_bf16 v[140:143], v[188:191], a[8:11], v[140:143]
    ds_read_b64_tr_b16 v[174:175], v7 offset:26624
    v_mfma_f32_16x16x32_bf16 v[156:159], v[188:191], a[12:15], v[156:159]
    s_add_u32 m0, s61, 16384
    s_add_u32 s33, s62, 114688
    buffer_load_dwordx4 v238, s[16:19], s33 offen sc1 lds
    s_add_u32 m0, s61, 17408
    s_add_u32 s33, s62, 115712
    buffer_load_dwordx4 v238, s[16:19], s33 offen sc1 lds
    s_add_u32 m0, s61, 18432
    s_add_u32 s33, s62, 116736
    buffer_load_dwordx4 v238, s[16:19], s33 offen sc1 lds
    s_add_u32 m0, s61, 19456
    s_add_u32 s33, s62, 117760
    buffer_load_dwordx4 v238, s[16:19], s33 offen sc1 lds
    s_mov_b32 s33, 28672
    buffer_load_dwordx4 a[0:3], v9, s[20:23], s33 offen sc1
    s_mov_b32 s33, 159744
    buffer_load_dwordx4 a[4:7], v9, s[20:23], s33 offen sc1
    s_mov_b32 s33, 290816
    buffer_load_dwordx4 a[8:11], v9, s[20:23], s33 offen sc1
    s_mov_b32 s33, 421888
    buffer_load_dwordx4 a[12:15], v9, s[20:23], s33 offen sc1
    s_waitcnt vmcnt(45)
    s_waitcnt lgkmcnt(0)
    v_mfma_f32_16x16x32_bf16 v[96:99], v[160:163], a[16:19], v[96:99]
    ds_read_b64_tr_b16 v[176:177], v4 offset:28672
    v_mfma_f32_16x16x32_bf16 v[112:115], v[160:163], a[20:23], v[112:115]
    v_mfma_f32_16x16x32_bf16 v[128:131], v[160:163], a[24:27], v[128:131]
    ds_read_b64_tr_b16 v[178:179], v4 offset:30720
    v_mfma_f32_16x16x32_bf16 v[144:147], v[160:163], a[28:31], v[144:147]
    v_mfma_f32_16x16x32_bf16 v[100:103], v[164:167], a[16:19], v[100:103]
    ds_read_b64_tr_b16 v[180:181], v5 offset:28672
    v_mfma_f32_16x16x32_bf16 v[116:119], v[164:167], a[20:23], v[116:119]
    v_mfma_f32_16x16x32_bf16 v[132:135], v[164:167], a[24:27], v[132:135]
    ds_read_b64_tr_b16 v[182:183], v5 offset:30720
    v_mfma_f32_16x16x32_bf16 v[148:151], v[164:167], a[28:31], v[148:151]
    v_mfma_f32_16x16x32_bf16 v[104:107], v[168:171], a[16:19], v[104:107]
    ds_read_b64_tr_b16 v[184:185], v6 offset:28672
    v_mfma_f32_16x16x32_bf16 v[120:123], v[168:171], a[20:23], v[120:123]
    v_mfma_f32_16x16x32_bf16 v[136:139], v[168:171], a[24:27], v[136:139]
    ds_read_b64_tr_b16 v[186:187], v6 offset:30720
    v_mfma_f32_16x16x32_bf16 v[152:155], v[168:171], a[28:31], v[152:155]
    v_mfma_f32_16x16x32_bf16 v[108:111], v[172:175], a[16:19], v[108:111]
    ds_read_b64_tr_b16 v[188:189], v7 offset:28672
    v_mfma_f32_16x16x32_bf16 v[124:127], v[172:175], a[20:23], v[124:127]
    v_mfma_f32_16x16x32_bf16 v[140:143], v[172:175], a[24:27], v[140:143]
    ds_read_b64_tr_b16 v[190:191], v7 offset:30720
    v_mfma_f32_16x16x32_bf16 v[156:159], v[172:175], a[28:31], v[156:159]
    s_add_u32 m0, s61, 20480
    s_add_u32 s33, s62, 118784
    buffer_load_dwordx4 v238, s[16:19], s33 offen sc1 lds
    s_add_u32 m0, s61, 21504
    s_add_u32 s33, s62, 119808
    buffer_load_dwordx4 v238, s[16:19], s33 offen sc1 lds
    s_add_u32 m0, s61, 22528
    s_add_u32 s33, s62, 120832
    buffer_load_dwordx4 v238, s[16:19], s33 offen sc1 lds
    s_add_u32 m0, s61, 23552
    s_add_u32 s33, s62, 121856
    buffer_load_dwordx4 v238, s[16:19], s33 offen sc1 lds
    s_mov_b32 s33, 29696
    buffer_load_dwordx4 a[16:19], v9, s[20:23], s33 offen sc1
    s_mov_b32 s33, 160768
    buffer_load_dwordx4 a[20:23], v9, s[20:23], s33 offen sc1
    s_mov_b32 s33, 291840
    buffer_load_dwordx4 a[24:27], v9, s[20:23], s33 offen sc1
    s_mov_b32 s33, 422912
    buffer_load_dwordx4 a[28:31], v9, s[20:23], s33 offen sc1
    s_waitcnt vmcnt(45)
    s_waitcnt lgkmcnt(0)
    v_mfma_f32_16x16x32_bf16 v[96:99], v[176:179], a[32:35], v[96:99]
    ds_read_b64_tr_b16 v[160:161], v4 offset:0
    v_mfma_f32_16x16x32_bf16 v[112:115], v[176:179], a[36:39], v[112:115]
    v_mfma_f32_16x16x32_bf16 v[128:131], v[176:179], a[40:43], v[128:131]
    ds_read_b64_tr_b16 v[162:163], v4 offset:2048
    v_mfma_f32_16x16x32_bf16 v[144:147], v[176:179], a[44:47], v[144:147]
    v_mfma_f32_16x16x32_bf16 v[100:103], v[180:183], a[32:35], v[100:103]
    ds_read_b64_tr_b16 v[164:165], v5 offset:0
    v_mfma_f32_16x16x32_bf16 v[116:119], v[180:183], a[36:39], v[116:119]
    v_mfma_f32_16x16x32_bf16 v[132:135], v[180:183], a[40:43], v[132:135]
    ds_read_b64_tr_b16 v[166:167], v5 offset:2048
    v_mfma_f32_16x16x32_bf16 v[148:151], v[180:183], a[44:47], v[148:151]
    v_mfma_f32_16x16x32_bf16 v[104:107], v[184:187], a[32:35], v[104:107]
    ds_read_b64_tr_b16 v[168:169], v6 offset:0
    v_mfma_f32_16x16x32_bf16 v[120:123], v[184:187], a[36:39], v[120:123]
    v_mfma_f32_16x16x32_bf16 v[136:139], v[184:187], a[40:43], v[136:139]
    ds_read_b64_tr_b16 v[170:171], v6 offset:2048
    v_mfma_f32_16x16x32_bf16 v[152:155], v[184:187], a[44:47], v[152:155]
    v_mfma_f32_16x16x32_bf16 v[108:111], v[188:191], a[32:35], v[108:111]
    ds_read_b64_tr_b16 v[172:173], v7 offset:0
    v_mfma_f32_16x16x32_bf16 v[124:127], v[188:191], a[36:39], v[124:127]
    v_mfma_f32_16x16x32_bf16 v[140:143], v[188:191], a[40:43], v[140:143]
    ds_read_b64_tr_b16 v[174:175], v7 offset:2048
    v_mfma_f32_16x16x32_bf16 v[156:159], v[188:191], a[44:47], v[156:159]
    s_add_u32 m0, s61, 24576
    s_add_u32 s33, s62, 122880
    buffer_load_dwordx4 v238, s[16:19], s33 offen sc1 lds
    s_add_u32 m0, s61, 25600
    s_add_u32 s33, s62, 123904
    buffer_load_dwordx4 v238, s[16:19], s33 offen sc1 lds
    s_add_u32 m0, s61, 26624
    s_add_u32 s33, s62, 124928
    buffer_load_dwordx4 v238, s[16:19], s33 offen sc1 lds
    s_add_u32 m0, s61, 27648
    s_add_u32 s33, s62, 125952
    buffer_load_dwordx4 v238, s[16:19], s33 offen sc1 lds
    s_mov_b32 s33, 30720
    buffer_load_dwordx4 a[32:35], v9, s[20:23], s33 offen sc1
    s_mov_b32 s33, 161792
    buffer_load_dwordx4 a[36:39], v9, s[20:23], s33 offen sc1
    s_mov_b32 s33, 292864
    buffer_load_dwordx4 a[40:43], v9, s[20:23], s33 offen sc1
    s_mov_b32 s33, 423936
    buffer_load_dwordx4 a[44:47], v9, s[20:23], s33 offen sc1
    s_waitcnt vmcnt(45)
    s_waitcnt lgkmcnt(0)
    v_mfma_f32_16x16x32_bf16 v[96:99], v[160:163], a[48:51], v[96:99]
    ds_read_b64_tr_b16 v[176:177], v4 offset:4096
    v_mfma_f32_16x16x32_bf16 v[112:115], v[160:163], a[52:55], v[112:115]
    v_mfma_f32_16x16x32_bf16 v[128:131], v[160:163], a[56:59], v[128:131]
    ds_read_b64_tr_b16 v[178:179], v4 offset:6144
    v_mfma_f32_16x16x32_bf16 v[144:147], v[160:163], a[60:63], v[144:147]
    v_mfma_f32_16x16x32_bf16 v[100:103], v[164:167], a[48:51], v[100:103]
    ds_read_b64_tr_b16 v[180:181], v5 offset:4096
    v_mfma_f32_16x16x32_bf16 v[116:119], v[164:167], a[52:55], v[116:119]
    v_mfma_f32_16x16x32_bf16 v[132:135], v[164:167], a[56:59], v[132:135]
    ds_read_b64_tr_b16 v[182:183], v5 offset:6144
    v_mfma_f32_16x16x32_bf16 v[148:151], v[164:167], a[60:63], v[148:151]
    v_mfma_f32_16x16x32_bf16 v[104:107], v[168:171], a[48:51], v[104:107]
    ds_read_b64_tr_b16 v[184:185], v6 offset:4096
    v_mfma_f32_16x16x32_bf16 v[120:123], v[168:171], a[52:55], v[120:123]
    v_mfma_f32_16x16x32_bf16 v[136:139], v[168:171], a[56:59], v[136:139]
    ds_read_b64_tr_b16 v[186:187], v6 offset:6144
    v_mfma_f32_16x16x32_bf16 v[152:155], v[168:171], a[60:63], v[152:155]
    v_mfma_f32_16x16x32_bf16 v[108:111], v[172:175], a[48:51], v[108:111]
    ds_read_b64_tr_b16 v[188:189], v7 offset:4096
    v_mfma_f32_16x16x32_bf16 v[124:127], v[172:175], a[52:55], v[124:127]
    v_mfma_f32_16x16x32_bf16 v[140:143], v[172:175], a[56:59], v[140:143]
    ds_read_b64_tr_b16 v[190:191], v7 offset:6144
    v_mfma_f32_16x16x32_bf16 v[156:159], v[172:175], a[60:63], v[156:159]
    s_add_u32 m0, s61, 28672
    s_add_u32 s33, s62, 126976
    buffer_load_dwordx4 v238, s[16:19], s33 offen sc1 lds
    s_add_u32 m0, s61, 29696
    s_add_u32 s33, s62, 128000
    buffer_load_dwordx4 v238, s[16:19], s33 offen sc1 lds
    s_add_u32 m0, s61, 30720
    s_add_u32 s33, s62, 129024
    buffer_load_dwordx4 v238, s[16:19], s33 offen sc1 lds
    s_add_u32 m0, s61, 31744
    s_add_u32 s33, s62, 130048
    buffer_load_dwordx4 v238, s[16:19], s33 offen sc1 lds
    s_mov_b32 s33, 31744
    buffer_load_dwordx4 a[48:51], v9, s[20:23], s33 offen sc1
    s_mov_b32 s33, 162816
    buffer_load_dwordx4 a[52:55], v9, s[20:23], s33 offen sc1
    s_mov_b32 s33, 293888
    buffer_load_dwordx4 a[56:59], v9, s[20:23], s33 offen sc1
    s_mov_b32 s33, 424960
    buffer_load_dwordx4 a[60:63], v9, s[20:23], s33 offen sc1
    s_waitcnt vmcnt(32)
    v_cmp_ne_u32 vcc, s36, v22
    s_nop 4
    s_cmp_eq_u64 vcc, 0
    s_cbranch_scc1 L_pok_f3
    s_mov_b32 s37, 0
L_spin_f3:
    buffer_load_dword v22, v23, s[44:47], 0 offen sc1
    s_add_u32 s37, s37, 1
    s_cmp_gt_u32 s37, 0x20000
    s_cbranch_scc1 recurrent_scan__mha_block_cached__mixer_s_mlp__prompt_kernel_end
    s_waitcnt vmcnt(0)
    v_cmp_ne_u32 vcc, s36, v22
    s_nop 4
    s_cmp_lg_u64 vcc, 0
    s_cbranch_scc1 L_spin_f3
L_pok_f3:
    s_waitcnt lgkmcnt(0)
    v_mfma_f32_16x16x32_bf16 v[96:99], v[176:179], a[64:67], v[96:99]
    ds_read_b64_tr_b16 v[160:161], v4 offset:8192
    v_mfma_f32_16x16x32_bf16 v[112:115], v[176:179], a[68:71], v[112:115]
    v_mfma_f32_16x16x32_bf16 v[128:131], v[176:179], a[72:75], v[128:131]
    ds_read_b64_tr_b16 v[162:163], v4 offset:10240
    v_mfma_f32_16x16x32_bf16 v[144:147], v[176:179], a[76:79], v[144:147]
    v_mfma_f32_16x16x32_bf16 v[100:103], v[180:183], a[64:67], v[100:103]
    ds_read_b64_tr_b16 v[164:165], v5 offset:8192
    v_mfma_f32_16x16x32_bf16 v[116:119], v[180:183], a[68:71], v[116:119]
    v_mfma_f32_16x16x32_bf16 v[132:135], v[180:183], a[72:75], v[132:135]
    ds_read_b64_tr_b16 v[166:167], v5 offset:10240
    v_mfma_f32_16x16x32_bf16 v[148:151], v[180:183], a[76:79], v[148:151]
    v_mfma_f32_16x16x32_bf16 v[104:107], v[184:187], a[64:67], v[104:107]
    ds_read_b64_tr_b16 v[168:169], v6 offset:8192
    v_mfma_f32_16x16x32_bf16 v[120:123], v[184:187], a[68:71], v[120:123]
    v_mfma_f32_16x16x32_bf16 v[136:139], v[184:187], a[72:75], v[136:139]
    ds_read_b64_tr_b16 v[170:171], v6 offset:10240
    v_mfma_f32_16x16x32_bf16 v[152:155], v[184:187], a[76:79], v[152:155]
    v_mfma_f32_16x16x32_bf16 v[108:111], v[188:191], a[64:67], v[108:111]
    ds_read_b64_tr_b16 v[172:173], v7 offset:8192
    v_mfma_f32_16x16x32_bf16 v[124:127], v[188:191], a[68:71], v[124:127]
    v_mfma_f32_16x16x32_bf16 v[140:143], v[188:191], a[72:75], v[140:143]
    ds_read_b64_tr_b16 v[174:175], v7 offset:10240
    v_mfma_f32_16x16x32_bf16 v[156:159], v[188:191], a[76:79], v[156:159]
    s_add_u32 m0, s61, 0
    s_add_u32 s33, s63, 0
    buffer_load_dwordx4 v238, s[16:19], s33 offen sc1 lds
    s_add_u32 m0, s61, 1024
    s_add_u32 s33, s63, 1024
    buffer_load_dwordx4 v238, s[16:19], s33 offen sc1 lds
    s_add_u32 m0, s61, 2048
    s_add_u32 s33, s63, 2048
    buffer_load_dwordx4 v238, s[16:19], s33 offen sc1 lds
    s_add_u32 m0, s61, 3072
    s_add_u32 s33, s63, 3072
    buffer_load_dwordx4 v238, s[16:19], s33 offen sc1 lds
    s_mov_b32 s33, 0
    buffer_load_dwordx4 a[64:67], v10, s[8:11], s33 offen sc1
    s_mov_b32 s33, 57344
    buffer_load_dwordx4 a[68:71], v10, s[8:11], s33 offen sc1
    s_mov_b32 s33, 114688
    buffer_load_dwordx4 a[72:75], v10, s[8:11], s33 offen sc1
    s_mov_b32 s33, 172032
    buffer_load_dwordx4 a[76:79], v10, s[8:11], s33 offen sc1
    s_waitcnt lgkmcnt(0)
    v_mfma_f32_16x16x32_bf16 v[96:99], v[160:163], a[80:83], v[96:99]
    ds_read_b64_tr_b16 v[176:177], v4 offset:12288
    v_mfma_f32_16x16x32_bf16 v[112:115], v[160:163], a[84:87], v[112:115]
    v_mfma_f32_16x16x32_bf16 v[128:131], v[160:163], a[88:91], v[128:131]
    ds_read_b64_tr_b16 v[178:179], v4 offset:14336
    v_mfma_f32_16x16x32_bf16 v[144:147], v[160:163], a[92:95], v[144:147]
    v_mfma_f32_16x16x32_bf16 v[100:103], v[164:167], a[80:83], v[100:103]
    ds_read_b64_tr_b16 v[180:181], v5 offset:12288
    v_mfma_f32_16x16x32_bf16 v[116:119], v[164:167], a[84:87], v[116:119]
    v_mfma_f32_16x16x32_bf16 v[132:135], v[164:167], a[88:91], v[132:135]
    ds_read_b64_tr_b16 v[182:183], v5 offset:14336
    v_mfma_f32_16x16x32_bf16 v[148:151], v[164:167], a[92:95], v[148:151]
    v_mfma_f32_16x16x32_bf16 v[104:107], v[168:171], a[80:83], v[104:107]
    ds_read_b64_tr_b16 v[184:185], v6 offset:12288
    v_mfma_f32_16x16x32_bf16 v[120:123], v[168:171], a[84:87], v[120:123]
    v_mfma_f32_16x16x32_bf16 v[136:139], v[168:171], a[88:91], v[136:139]
    ds_read_b64_tr_b16 v[186:187], v6 offset:14336
    v_mfma_f32_16x16x32_bf16 v[152:155], v[168:171], a[92:95], v[152:155]
    v_mfma_f32_16x16x32_bf16 v[108:111], v[172:175], a[80:83], v[108:111]
    ds_read_b64_tr_b16 v[188:189], v7 offset:12288
    v_mfma_f32_16x16x32_bf16 v[124:127], v[172:175], a[84:87], v[124:127]
    v_mfma_f32_16x16x32_bf16 v[140:143], v[172:175], a[88:91], v[140:143]
    ds_read_b64_tr_b16 v[190:191], v7 offset:14336
    v_mfma_f32_16x16x32_bf16 v[156:159], v[172:175], a[92:95], v[156:159]
    s_add_u32 m0, s61, 4096
    s_add_u32 s33, s63, 4096
    buffer_load_dwordx4 v238, s[16:19], s33 offen sc1 lds
    s_add_u32 m0, s61, 5120
    s_add_u32 s33, s63, 5120
    buffer_load_dwordx4 v238, s[16:19], s33 offen sc1 lds
    s_add_u32 m0, s61, 6144
    s_add_u32 s33, s63, 6144
    buffer_load_dwordx4 v238, s[16:19], s33 offen sc1 lds
    s_add_u32 m0, s61, 7168
    s_add_u32 s33, s63, 7168
    buffer_load_dwordx4 v238, s[16:19], s33 offen sc1 lds
    s_mov_b32 s33, 1024
    buffer_load_dwordx4 a[80:83], v10, s[8:11], s33 offen sc1
    s_mov_b32 s33, 58368
    buffer_load_dwordx4 a[84:87], v10, s[8:11], s33 offen sc1
    s_mov_b32 s33, 115712
    buffer_load_dwordx4 a[88:91], v10, s[8:11], s33 offen sc1
    s_mov_b32 s33, 173056
    buffer_load_dwordx4 a[92:95], v10, s[8:11], s33 offen sc1
    s_waitcnt vmcnt(44)
    s_waitcnt lgkmcnt(0)
    v_mfma_f32_16x16x32_bf16 v[96:99], v[176:179], a[96:99], v[96:99]
    ds_read_b64_tr_b16 v[160:161], v4 offset:16384
    v_mfma_f32_16x16x32_bf16 v[112:115], v[176:179], a[100:103], v[112:115]
    v_mfma_f32_16x16x32_bf16 v[128:131], v[176:179], a[104:107], v[128:131]
    ds_read_b64_tr_b16 v[162:163], v4 offset:18432
    v_mfma_f32_16x16x32_bf16 v[144:147], v[176:179], a[108:111], v[144:147]
    v_mfma_f32_16x16x32_bf16 v[100:103], v[180:183], a[96:99], v[100:103]
    ds_read_b64_tr_b16 v[164:165], v5 offset:16384
    v_mfma_f32_16x16x32_bf16 v[116:119], v[180:183], a[100:103], v[116:119]
    v_mfma_f32_16x16x32_bf16 v[132:135], v[180:183], a[104:107], v[132:135]
    ds_read_b64_tr_b16 v[166:167], v5 offset:18432
    v_mfma_f32_16x16x32_bf16 v[148:151], v[180:183], a[108:111], v[148:151]
    v_mfma_f32_16x16x32_bf16 v[104:107], v[184:187], a[96:99], v[104:107]
    ds_read_b64_tr_b16 v[168:169], v6 offset:16384
    v_mfma_f32_16x16x32_bf16 v[120:123], v[184:187], a[100:103], v[120:123]
    v_mfma_f32_16x16x32_bf16 v[136:139], v[184:187], a[104:107], v[136:139]
    ds_read_b64_tr_b16 v[170:171], v6 offset:18432
    v_mfma_f32_16x16x32_bf16 v[152:155], v[184:187], a[108:111], v[152:155]
    v_mfma_f32_16x16x32_bf16 v[108:111], v[188:191], a[96:99], v[108:111]
    ds_read_b64_tr_b16 v[172:173], v7 offset:16384
    v_mfma_f32_16x16x32_bf16 v[124:127], v[188:191], a[100:103], v[124:127]
    v_mfma_f32_16x16x32_bf16 v[140:143], v[188:191], a[104:107], v[140:143]
    ds_read_b64_tr_b16 v[174:175], v7 offset:18432
    v_mfma_f32_16x16x32_bf16 v[156:159], v[188:191], a[108:111], v[156:159]
    s_add_u32 m0, s61, 8192
    s_add_u32 s33, s63, 8192
    buffer_load_dwordx4 v238, s[16:19], s33 offen sc1 lds
    s_add_u32 m0, s61, 9216
    s_add_u32 s33, s63, 9216
    buffer_load_dwordx4 v238, s[16:19], s33 offen sc1 lds
    s_add_u32 m0, s61, 10240
    s_add_u32 s33, s63, 10240
    buffer_load_dwordx4 v238, s[16:19], s33 offen sc1 lds
    s_add_u32 m0, s61, 11264
    s_add_u32 s33, s63, 11264
    buffer_load_dwordx4 v238, s[16:19], s33 offen sc1 lds
    s_mov_b32 s33, 2048
    buffer_load_dwordx4 a[96:99], v10, s[8:11], s33 offen sc1
    s_mov_b32 s33, 59392
    buffer_load_dwordx4 a[100:103], v10, s[8:11], s33 offen sc1
    s_mov_b32 s33, 116736
    buffer_load_dwordx4 a[104:107], v10, s[8:11], s33 offen sc1
    s_mov_b32 s33, 174080
    buffer_load_dwordx4 a[108:111], v10, s[8:11], s33 offen sc1
    s_waitcnt vmcnt(44)
    s_waitcnt lgkmcnt(0)
    v_mfma_f32_16x16x32_bf16 v[96:99], v[160:163], a[0:3], v[96:99]
    ds_read_b64_tr_b16 v[176:177], v4 offset:20480
    v_mfma_f32_16x16x32_bf16 v[112:115], v[160:163], a[4:7], v[112:115]
    v_mfma_f32_16x16x32_bf16 v[128:131], v[160:163], a[8:11], v[128:131]
    ds_read_b64_tr_b16 v[178:179], v4 offset:22528
    v_mfma_f32_16x16x32_bf16 v[144:147], v[160:163], a[12:15], v[144:147]
    v_mfma_f32_16x16x32_bf16 v[100:103], v[164:167], a[0:3], v[100:103]
    ds_read_b64_tr_b16 v[180:181], v5 offset:20480
    v_mfma_f32_16x16x32_bf16 v[116:119], v[164:167], a[4:7], v[116:119]
    v_mfma_f32_16x16x32_bf16 v[132:135], v[164:167], a[8:11], v[132:135]
    ds_read_b64_tr_b16 v[182:183], v5 offset:22528
    v_mfma_f32_16x16x32_bf16 v[148:151], v[164:167], a[12:15], v[148:151]
    v_mfma_f32_16x16x32_bf16 v[104:107], v[168:171], a[0:3], v[104:107]
    ds_read_b64_tr_b16 v[184:185], v6 offset:20480
    v_mfma_f32_16x16x32_bf16 v[120:123], v[168:171], a[4:7], v[120:123]
    v_mfma_f32_16x16x32_bf16 v[136:139], v[168:171], a[8:11], v[136:139]
    ds_read_b64_tr_b16 v[186:187], v6 offset:22528
    v_mfma_f32_16x16x32_bf16 v[152:155], v[168:171], a[12:15], v[152:155]
    v_mfma_f32_16x16x32_bf16 v[108:111], v[172:175], a[0:3], v[108:111]
    ds_read_b64_tr_b16 v[188:189], v7 offset:20480
    v_mfma_f32_16x16x32_bf16 v[124:127], v[172:175], a[4:7], v[124:127]
    v_mfma_f32_16x16x32_bf16 v[140:143], v[172:175], a[8:11], v[140:143]
    ds_read_b64_tr_b16 v[190:191], v7 offset:22528
    v_mfma_f32_16x16x32_bf16 v[156:159], v[172:175], a[12:15], v[156:159]
    s_add_u32 m0, s61, 12288
    s_add_u32 s33, s63, 12288
    buffer_load_dwordx4 v238, s[16:19], s33 offen sc1 lds
    s_add_u32 m0, s61, 13312
    s_add_u32 s33, s63, 13312
    buffer_load_dwordx4 v238, s[16:19], s33 offen sc1 lds
    s_add_u32 m0, s61, 14336
    s_add_u32 s33, s63, 14336
    buffer_load_dwordx4 v238, s[16:19], s33 offen sc1 lds
    s_add_u32 m0, s61, 15360
    s_add_u32 s33, s63, 15360
    buffer_load_dwordx4 v238, s[16:19], s33 offen sc1 lds
    s_mov_b32 s33, 3072
    buffer_load_dwordx4 a[0:3], v10, s[8:11], s33 offen sc1
    s_mov_b32 s33, 60416
    buffer_load_dwordx4 a[4:7], v10, s[8:11], s33 offen sc1
    s_mov_b32 s33, 117760
    buffer_load_dwordx4 a[8:11], v10, s[8:11], s33 offen sc1
    s_mov_b32 s33, 175104
    buffer_load_dwordx4 a[12:15], v10, s[8:11], s33 offen sc1
    s_waitcnt vmcnt(44)
    s_waitcnt lgkmcnt(0)
    v_mfma_f32_16x16x32_bf16 v[96:99], v[176:179], a[16:19], v[96:99]
    ds_read_b64_tr_b16 v[160:161], v4 offset:24576
    v_mfma_f32_16x16x32_bf16 v[112:115], v[176:179], a[20:23], v[112:115]
    v_mfma_f32_16x16x32_bf16 v[128:131], v[176:179], a[24:27], v[128:131]
    ds_read_b64_tr_b16 v[162:163], v4 offset:26624
    v_mfma_f32_16x16x32_bf16 v[144:147], v[176:179], a[28:31], v[144:147]
    v_mfma_f32_16x16x32_bf16 v[100:103], v[180:183], a[16:19], v[100:103]
    ds_read_b64_tr_b16 v[164:165], v5 offset:24576
    v_mfma_f32_16x16x32_bf16 v[116:119], v[180:183], a[20:23], v[116:119]
    v_mfma_f32_16x16x32_bf16 v[132:135], v[180:183], a[24:27], v[132:135]
    ds_read_b64_tr_b16 v[166:167], v5 offset:26624
    v_mfma_f32_16x16x32_bf16 v[148:151], v[180:183], a[28:31], v[148:151]
    v_mfma_f32_16x16x32_bf16 v[104:107], v[184:187], a[16:19], v[104:107]
    ds_read_b64_tr_b16 v[168:169], v6 offset:24576
    v_mfma_f32_16x16x32_bf16 v[120:123], v[184:187], a[20:23], v[120:123]
    v_mfma_f32_16x16x32_bf16 v[136:139], v[184:187], a[24:27], v[136:139]
    ds_read_b64_tr_b16 v[170:171], v6 offset:26624
    v_mfma_f32_16x16x32_bf16 v[152:155], v[184:187], a[28:31], v[152:155]
    v_mfma_f32_16x16x32_bf16 v[108:111], v[188:191], a[16:19], v[108:111]
    ds_read_b64_tr_b16 v[172:173], v7 offset:24576
    v_mfma_f32_16x16x32_bf16 v[124:127], v[188:191], a[20:23], v[124:127]
    v_mfma_f32_16x16x32_bf16 v[140:143], v[188:191], a[24:27], v[140:143]
    ds_read_b64_tr_b16 v[174:175], v7 offset:26624
    v_mfma_f32_16x16x32_bf16 v[156:159], v[188:191], a[28:31], v[156:159]
    s_add_u32 m0, s61, 16384
    s_add_u32 s33, s63, 16384
    buffer_load_dwordx4 v238, s[16:19], s33 offen sc1 lds
    s_add_u32 m0, s61, 17408
    s_add_u32 s33, s63, 17408
    buffer_load_dwordx4 v238, s[16:19], s33 offen sc1 lds
    s_add_u32 m0, s61, 18432
    s_add_u32 s33, s63, 18432
    buffer_load_dwordx4 v238, s[16:19], s33 offen sc1 lds
    s_add_u32 m0, s61, 19456
    s_add_u32 s33, s63, 19456
    buffer_load_dwordx4 v238, s[16:19], s33 offen sc1 lds
    s_mov_b32 s33, 4096
    buffer_load_dwordx4 a[16:19], v10, s[8:11], s33 offen sc1
    s_mov_b32 s33, 61440
    buffer_load_dwordx4 a[20:23], v10, s[8:11], s33 offen sc1
    s_mov_b32 s33, 118784
    buffer_load_dwordx4 a[24:27], v10, s[8:11], s33 offen sc1
    s_mov_b32 s33, 176128
    buffer_load_dwordx4 a[28:31], v10, s[8:11], s33 offen sc1
    s_waitcnt vmcnt(44)
    s_waitcnt lgkmcnt(0)
    v_mfma_f32_16x16x32_bf16 v[96:99], v[160:163], a[32:35], v[96:99]
    ds_read_b64_tr_b16 v[176:177], v4 offset:28672
    v_mfma_f32_16x16x32_bf16 v[112:115], v[160:163], a[36:39], v[112:115]
    v_mfma_f32_16x16x32_bf16 v[128:131], v[160:163], a[40:43], v[128:131]
    ds_read_b64_tr_b16 v[178:179], v4 offset:30720
    v_mfma_f32_16x16x32_bf16 v[144:147], v[160:163], a[44:47], v[144:147]
    v_mfma_f32_16x16x32_bf16 v[100:103], v[164:167], a[32:35], v[100:103]
    ds_read_b64_tr_b16 v[180:181], v5 offset:28672
    v_mfma_f32_16x16x32_bf16 v[116:119], v[164:167], a[36:39], v[116:119]
    v_mfma_f32_16x16x32_bf16 v[132:135], v[164:167], a[40:43], v[132:135]
    ds_read_b64_tr_b16 v[182:183], v5 offset:30720
    v_mfma_f32_16x16x32_bf16 v[148:151], v[164:167], a[44:47], v[148:151]
    v_mfma_f32_16x16x32_bf16 v[104:107], v[168:171], a[32:35], v[104:107]
    ds_read_b64_tr_b16 v[184:185], v6 offset:28672
    v_mfma_f32_16x16x32_bf16 v[120:123], v[168:171], a[36:39], v[120:123]
    v_mfma_f32_16x16x32_bf16 v[136:139], v[168:171], a[40:43], v[136:139]
    ds_read_b64_tr_b16 v[186:187], v6 offset:30720
    v_mfma_f32_16x16x32_bf16 v[152:155], v[168:171], a[44:47], v[152:155]
    v_mfma_f32_16x16x32_bf16 v[108:111], v[172:175], a[32:35], v[108:111]
    ds_read_b64_tr_b16 v[188:189], v7 offset:28672
    v_mfma_f32_16x16x32_bf16 v[124:127], v[172:175], a[36:39], v[124:127]
    v_mfma_f32_16x16x32_bf16 v[140:143], v[172:175], a[40:43], v[140:143]
    ds_read_b64_tr_b16 v[190:191], v7 offset:30720
    v_mfma_f32_16x16x32_bf16 v[156:159], v[172:175], a[44:47], v[156:159]
    s_add_u32 m0, s61, 20480
    s_add_u32 s33, s63, 20480
    buffer_load_dwordx4 v238, s[16:19], s33 offen sc1 lds
    s_add_u32 m0, s61, 21504
    s_add_u32 s33, s63, 21504
    buffer_load_dwordx4 v238, s[16:19], s33 offen sc1 lds
    s_add_u32 m0, s61, 22528
    s_add_u32 s33, s63, 22528
    buffer_load_dwordx4 v238, s[16:19], s33 offen sc1 lds
    s_add_u32 m0, s61, 23552
    s_add_u32 s33, s63, 23552
    buffer_load_dwordx4 v238, s[16:19], s33 offen sc1 lds
    s_mov_b32 s33, 5120
    buffer_load_dwordx4 a[32:35], v10, s[8:11], s33 offen sc1
    s_mov_b32 s33, 62464
    buffer_load_dwordx4 a[36:39], v10, s[8:11], s33 offen sc1
    s_mov_b32 s33, 119808
    buffer_load_dwordx4 a[40:43], v10, s[8:11], s33 offen sc1
    s_mov_b32 s33, 177152
    buffer_load_dwordx4 a[44:47], v10, s[8:11], s33 offen sc1
    s_waitcnt vmcnt(44)
    s_waitcnt lgkmcnt(0)
    v_mfma_f32_16x16x32_bf16 v[96:99], v[176:179], a[48:51], v[96:99]
    ds_read_b64_tr_b16 v[160:161], v4 offset:0
    v_mfma_f32_16x16x32_bf16 v[112:115], v[176:179], a[52:55], v[112:115]
    v_mfma_f32_16x16x32_bf16 v[128:131], v[176:179], a[56:59], v[128:131]
    ds_read_b64_tr_b16 v[162:163], v4 offset:2048
    v_mfma_f32_16x16x32_bf16 v[144:147], v[176:179], a[60:63], v[144:147]
    v_mfma_f32_16x16x32_bf16 v[100:103], v[180:183], a[48:51], v[100:103]
    ds_read_b64_tr_b16 v[164:165], v5 offset:0
    v_mfma_f32_16x16x32_bf16 v[116:119], v[180:183], a[52:55], v[116:119]
    v_mfma_f32_16x16x32_bf16 v[132:135], v[180:183], a[56:59], v[132:135]
    ds_read_b64_tr_b16 v[166:167], v5 offset:2048
    v_mfma_f32_16x16x32_bf16 v[148:151], v[180:183], a[60:63], v[148:151]
    v_mfma_f32_16x16x32_bf16 v[104:107], v[184:187], a[48:51], v[104:107]
    ds_read_b64_tr_b16 v[168:169], v6 offset:0
    v_mfma_f32_16x16x32_bf16 v[120:123], v[184:187], a[52:55], v[120:123]
    v_mfma_f32_16x16x32_bf16 v[136:139], v[184:187], a[56:59], v[136:139]
    ds_read_b64_tr_b16 v[170:171], v6 offset:2048
    v_mfma_f32_16x16x32_bf16 v[152:155], v[184:187], a[60:63], v[152:155]
    v_mfma_f32_16x16x32_bf16 v[108:111], v[188:191], a[48:51], v[108:111]
    ds_read_b64_tr_b16 v[172:173], v7 offset:0
    v_mfma_f32_16x16x32_bf16 v[124:127], v[188:191], a[52:55], v[124:127]
    v_mfma_f32_16x16x32_bf16 v[140:143], v[188:191], a[56:59], v[140:143]
    ds_read_b64_tr_b16 v[174:175], v7 offset:2048
    v_mfma_f32_16x16x32_bf16 v[156:159], v[188:191], a[60:63], v[156:159]
    s_add_u32 m0, s61, 24576
    s_add_u32 s33, s63, 24576
    buffer_load_dwordx4 v238, s[16:19], s33 offen sc1 lds
    s_add_u32 m0, s61, 25600
    s_add_u32 s33, s63, 25600
    buffer_load_dwordx4 v238, s[16:19], s33 offen sc1 lds
    s_add_u32 m0, s61, 26624
    s_add_u32 s33, s63, 26624
    buffer_load_dwordx4 v238, s[16:19], s33 offen sc1 lds
    s_add_u32 m0, s61, 27648
    s_add_u32 s33, s63, 27648
    buffer_load_dwordx4 v238, s[16:19], s33 offen sc1 lds
    s_mov_b32 s33, 6144
    buffer_load_dwordx4 a[48:51], v10, s[8:11], s33 offen sc1
    s_mov_b32 s33, 63488
    buffer_load_dwordx4 a[52:55], v10, s[8:11], s33 offen sc1
    s_mov_b32 s33, 120832
    buffer_load_dwordx4 a[56:59], v10, s[8:11], s33 offen sc1
    s_mov_b32 s33, 178176
    buffer_load_dwordx4 a[60:63], v10, s[8:11], s33 offen sc1
    s_waitcnt vmcnt(44)
    s_waitcnt lgkmcnt(0)
    v_mfma_f32_16x16x32_bf16 v[32:35], v[160:163], a[64:67], v[32:35]
    ds_read_b64_tr_b16 v[176:177], v4 offset:4096
    v_mfma_f32_16x16x32_bf16 v[48:51], v[160:163], a[68:71], v[48:51]
    v_mfma_f32_16x16x32_bf16 v[64:67], v[160:163], a[72:75], v[64:67]
    ds_read_b64_tr_b16 v[178:179], v4 offset:6144
    v_mfma_f32_16x16x32_bf16 v[80:83], v[160:163], a[76:79], v[80:83]
    v_mfma_f32_16x16x32_bf16 v[36:39], v[164:167], a[64:67], v[36:39]
    ds_read_b64_tr_b16 v[180:181], v5 offset:4096
    v_mfma_f32_16x16x32_bf16 v[52:55], v[164:167], a[68:71], v[52:55]
    v_mfma_f32_16x16x32_bf16 v[68:71], v[164:167], a[72:75], v[68:71]
    ds_read_b64_tr_b16 v[182:183], v5 offset:6144
    v_mfma_f32_16x16x32_bf16 v[84:87], v[164:167], a[76:79], v[84:87]
    v_mfma_f32_16x16x32_bf16 v[40:43], v[168:171], a[64:67], v[40:43]
    ds_read_b64_tr_b16 v[184:185], v6 offset:4096
    v_mfma_f32_16x16x32_bf16 v[56:59], v[168:171], a[68:71], v[56:59]
    v_mfma_f32_16x16x32_bf16 v[72:75], v[168:171], a[72:75], v[72:75]
    ds_read_b64_tr_b16 v[186:187], v6 offset:6144
    v_mfma_f32_16x16x32_bf16 v[88:91], v[168:171], a[76:79], v[88:91]
    v_mfma_f32_16x16x32_bf16 v[44:47], v[172:175], a[64:67], v[44:47]
    ds_read_b64_tr_b16 v[188:189], v7 offset:4096
    v_mfma_f32_16x16x32_bf16 v[60:63], v[172:175], a[68:71], v[60:63]
    v_mfma_f32_16x16x32_bf16 v[76:79], v[172:175], a[72:75], v[76:79]
    ds_read_b64_tr_b16 v[190:191], v7 offset:6144
    v_mfma_f32_16x16x32_bf16 v[92:95], v[172:175], a[76:79], v[92:95]
    s_add_u32 m0, s61, 28672
    s_add_u32 s33, s63, 28672
    buffer_load_dwordx4 v238, s[16:19], s33 offen sc1 lds
    s_add_u32 m0, s61, 29696
    s_add_u32 s33, s63, 29696
    buffer_load_dwordx4 v238, s[16:19], s33 offen sc1 lds
    s_add_u32 m0, s61, 30720
    s_add_u32 s33, s63, 30720
    buffer_load_dwordx4 v238, s[16:19], s33 offen sc1 lds
    s_add_u32 m0, s61, 31744
    s_add_u32 s33, s63, 31744
    buffer_load_dwordx4 v238, s[16:19], s33 offen sc1 lds
    s_mov_b32 s33, 7168
    buffer_load_dwordx4 a[64:67], v10, s[8:11], s33 offen sc1
    s_mov_b32 s33, 64512
    buffer_load_dwordx4 a[68:71], v10, s[8:11], s33 offen sc1
    s_mov_b32 s33, 121856
    buffer_load_dwordx4 a[72:75], v10, s[8:11], s33 offen sc1
    s_mov_b32 s33, 179200
    buffer_load_dwordx4 a[76:79], v10, s[8:11], s33 offen sc1
    s_waitcnt vmcnt(44)
    s_waitcnt lgkmcnt(0)
    v_mfma_f32_16x16x32_bf16 v[32:35], v[176:179], a[80:83], v[32:35]
    ds_read_b64_tr_b16 v[160:161], v4 offset:8192
    v_mfma_f32_16x16x32_bf16 v[48:51], v[176:179], a[84:87], v[48:51]
    v_mfma_f32_16x16x32_bf16 v[64:67], v[176:179], a[88:91], v[64:67]
    ds_read_b64_tr_b16 v[162:163], v4 offset:10240
    v_mfma_f32_16x16x32_bf16 v[80:83], v[176:179], a[92:95], v[80:83]
    v_mfma_f32_16x16x32_bf16 v[36:39], v[180:183], a[80:83], v[36:39]
    ds_read_b64_tr_b16 v[164:165], v5 offset:8192
    v_mfma_f32_16x16x32_bf16 v[52:55], v[180:183], a[84:87], v[52:55]
    v_mfma_f32_16x16x32_bf16 v[68:71], v[180:183], a[88:91], v[68:71]
    ds_read_b64_tr_b16 v[166:167], v5 offset:10240
    v_mfma_f32_16x16x32_bf16 v[84:87], v[180:183], a[92:95], v[84:87]
    v_mfma_f32_16x16x32_bf16 v[40:43], v[184:187], a[80:83], v[40:43]
    ds_read_b64_tr_b16 v[168:169], v6 offset:8192
    v_mfma_f32_16x16x32_bf16 v[56:59], v[184:187], a[84:87], v[56:59]
    v_mfma_f32_16x16x32_bf16 v[72:75], v[184:187], a[88:91], v[72:75]
    ds_read_b64_tr_b16 v[170:171], v6 offset:10240
    v_mfma_f32_16x16x32_bf16 v[88:91], v[184:187], a[92:95], v[88:91]
    v_mfma_f32_16x16x32_bf16 v[44:47], v[188:191], a[80:83], v[44:47]
    ds_read_b64_tr_b16 v[172:173], v7 offset:8192
    v_mfma_f32_16x16x32_bf16 v[60:63], v[188:191], a[84:87], v[60:63]
    v_mfma_f32_16x16x32_bf16 v[76:79], v[188:191], a[88:91], v[76:79]
    ds_read_b64_tr_b16 v[174:175], v7 offset:10240
    v_mfma_f32_16x16x32_bf16 v[92:95], v[188:191], a[92:95], v[92:95]
    s_add_u32 m0, s61, 0
    s_add_u32 s33, s63, 32768
    buffer_load_dwordx4 v238, s[16:19], s33 offen sc1 lds
    s_add_u32 m0, s61, 1024
    s_add_u32 s33, s63, 33792
    buffer_load_dwordx4 v238, s[16:19], s33 offen sc1 lds
    s_add_u32 m0, s61, 2048
    s_add_u32 s33, s63, 34816
    buffer_load_dwordx4 v238, s[16:19], s33 offen sc1 lds
    s_add_u32 m0, s61, 3072
    s_add_u32 s33, s63, 35840
    buffer_load_dwordx4 v238, s[16:19], s33 offen sc1 lds
    s_mov_b32 s33, 8192
    buffer_load_dwordx4 a[80:83], v10, s[8:11], s33 offen sc1
    s_mov_b32 s33, 65536
    buffer_load_dwordx4 a[84:87], v10, s[8:11], s33 offen sc1
    s_mov_b32 s33, 122880
    buffer_load_dwordx4 a[88:91], v10, s[8:11], s33 offen sc1
    s_mov_b32 s33, 180224
    buffer_load_dwordx4 a[92:95], v10, s[8:11], s33 offen sc1
    s_waitcnt vmcnt(44)
    s_waitcnt lgkmcnt(0)
    v_mfma_f32_16x16x32_bf16 v[32:35], v[160:163], a[96:99], v[32:35]
    ds_read_b64_tr_b16 v[176:177], v4 offset:12288
    v_mfma_f32_16x16x32_bf16 v[48:51], v[160:163], a[100:103], v[48:51]
    v_mfma_f32_16x16x32_bf16 v[64:67], v[160:163], a[104:107], v[64:67]
    ds_read_b64_tr_b16 v[178:179], v4 offset:14336
    v_mfma_f32_16x16x32_bf16 v[80:83], v[160:163], a[108:111], v[80:83]
    v_mfma_f32_16x16x32_bf16 v[36:39], v[164:167], a[96:99], v[36:39]
    ds_read_b64_tr_b16 v[180:181], v5 offset:12288
    v_mfma_f32_16x16x32_bf16 v[52:55], v[164:167], a[100:103], v[52:55]
    v_mfma_f32_16x16x32_bf16 v[68:71], v[164:167], a[104:107], v[68:71]
    ds_read_b64_tr_b16 v[182:183], v5 offset:14336
    v_mfma_f32_16x16x32_bf16 v[84:87], v[164:167], a[108:111], v[84:87]
    v_mfma_f32_16x16x32_bf16 v[40:43], v[168:171], a[96:99], v[40:43]
    ds_read_b64_tr_b16 v[184:185], v6 offset:12288
    v_mfma_f32_16x16x32_bf16 v[56:59], v[168:171], a[100:103], v[56:59]
    v_mfma_f32_16x16x32_bf16 v[72:75], v[168:171], a[104:107], v[72:75]
    ds_read_b64_tr_b16 v[186:187], v6 offset:14336
    v_mfma_f32_16x16x32_bf16 v[88:91], v[168:171], a[108:111], v[88:91]
    v_mfma_f32_16x16x32_bf16 v[44:47], v[172:175], a[96:99], v[44:47]
    ds_read_b64_tr_b16 v[188:189], v7 offset:12288
    v_mfma_f32_16x16x32_bf16 v[60:63], v[172:175], a[100:103], v[60:63]
    v_mfma_f32_16x16x32_bf16 v[76:79], v[172:175], a[104:107], v[76:79]
    ds_read_b64_tr_b16 v[190:191], v7 offset:14336
    v_mfma_f32_16x16x32_bf16 v[92:95], v[172:175], a[108:111], v[92:95]
    s_add_u32 m0, s61, 4096
    s_add_u32 s33, s63, 36864
    buffer_load_dwordx4 v238, s[16:19], s33 offen sc1 lds
    s_add_u32 m0, s61, 5120
    s_add_u32 s33, s63, 37888
    buffer_load_dwordx4 v238, s[16:19], s33 offen sc1 lds
    s_add_u32 m0, s61, 6144
    s_add_u32 s33, s63, 38912
    buffer_load_dwordx4 v238, s[16:19], s33 offen sc1 lds
    s_add_u32 m0, s61, 7168
    s_add_u32 s33, s63, 39936
    buffer_load_dwordx4 v238, s[16:19], s33 offen sc1 lds
    s_mov_b32 s33, 9216
    buffer_load_dwordx4 a[96:99], v10, s[8:11], s33 offen sc1
    s_mov_b32 s33, 66560
    buffer_load_dwordx4 a[100:103], v10, s[8:11], s33 offen sc1
    s_mov_b32 s33, 123904
    buffer_load_dwordx4 a[104:107], v10, s[8:11], s33 offen sc1
    s_mov_b32 s33, 181248
    buffer_load_dwordx4 a[108:111], v10, s[8:11], s33 offen sc1
    s_waitcnt vmcnt(44)
    s_waitcnt lgkmcnt(0)
    v_mfma_f32_16x16x32_bf16 v[32:35], v[176:179], a[0:3], v[32:35]
    ds_read_b64_tr_b16 v[160:161], v4 offset:16384
    v_mfma_f32_16x16x32_bf16 v[48:51], v[176:179], a[4:7], v[48:51]
    v_mfma_f32_16x16x32_bf16 v[64:67], v[176:179], a[8:11], v[64:67]
    ds_read_b64_tr_b16 v[162:163], v4 offset:18432
    v_mfma_f32_16x16x32_bf16 v[80:83], v[176:179], a[12:15], v[80:83]
    v_mfma_f32_16x16x32_bf16 v[36:39], v[180:183], a[0:3], v[36:39]
    ds_read_b64_tr_b16 v[164:165], v5 offset:16384
    v_mfma_f32_16x16x32_bf16 v[52:55], v[180:183], a[4:7], v[52:55]
    v_mfma_f32_16x16x32_bf16 v[68:71], v[180:183], a[8:11], v[68:71]
    ds_read_b64_tr_b16 v[166:167], v5 offset:18432
    v_mfma_f32_16x16x32_bf16 v[84:87], v[180:183], a[12:15], v[84:87]
    v_mfma_f32_16x16x32_bf16 v[40:43], v[184:187], a[0:3], v[40:43]
    ds_read_b64_tr_b16 v[168:169], v6 offset:16384
    v_mfma_f32_16x16x32_bf16 v[56:59], v[184:187], a[4:7], v[56:59]
    v_mfma_f32_16x16x32_bf16 v[72:75], v[184:187], a[8:11], v[72:75]
    ds_read_b64_tr_b16 v[170:171], v6 offset:18432
    v_mfma_f32_16x16x32_bf16 v[88:91], v[184:187], a[12:15], v[88:91]
    v_mfma_f32_16x16x32_bf16 v[44:47], v[188:191], a[0:3], v[44:47]
    ds_read_b64_tr_b16 v[172:173], v7 offset:16384
    v_mfma_f32_16x16x32_bf16 v[60:63], v[188:191], a[4:7], v[60:63]
    v_mfma_f32_16x16x32_bf16 v[76:79], v[188:191], a[8:11], v[76:79]
    ds_read_b64_tr_b16 v[174:175], v7 offset:18432
    v_mfma_f32_16x16x32_bf16 v[92:95], v[188:191], a[12:15], v[92:95]
    s_add_u32 m0, s61, 8192
    s_add_u32 s33, s63, 40960
    buffer_load_dwordx4 v238, s[16:19], s33 offen sc1 lds
    s_add_u32 m0, s61, 9216
    s_add_u32 s33, s63, 41984
    buffer_load_dwordx4 v238, s[16:19], s33 offen sc1 lds
    s_add_u32 m0, s61, 10240
    s_add_u32 s33, s63, 43008
    buffer_load_dwordx4 v238, s[16:19], s33 offen sc1 lds
    s_add_u32 m0, s61, 11264
    s_add_u32 s33, s63, 44032
    buffer_load_dwordx4 v238, s[16:19], s33 offen sc1 lds
    s_mov_b32 s33, 10240
    buffer_load_dwordx4 a[0:3], v10, s[8:11], s33 offen sc1
    s_mov_b32 s33, 67584
    buffer_load_dwordx4 a[4:7], v10, s[8:11], s33 offen sc1
    s_mov_b32 s33, 124928
    buffer_load_dwordx4 a[8:11], v10, s[8:11], s33 offen sc1
    s_mov_b32 s33, 182272
    buffer_load_dwordx4 a[12:15], v10, s[8:11], s33 offen sc1
    s_waitcnt vmcnt(44)
    s_waitcnt lgkmcnt(0)
    v_mfma_f32_16x16x32_bf16 v[32:35], v[160:163], a[16:19], v[32:35]
    ds_read_b64_tr_b16 v[176:177], v4 offset:20480
    v_mfma_f32_16x16x32_bf16 v[48:51], v[160:163], a[20:23], v[48:51]
    v_mfma_f32_16x16x32_bf16 v[64:67], v[160:163], a[24:27], v[64:67]
    ds_read_b64_tr_b16 v[178:179], v4 offset:22528
    v_mfma_f32_16x16x32_bf16 v[80:83], v[160:163], a[28:31], v[80:83]
    v_mfma_f32_16x16x32_bf16 v[36:39], v[164:167], a[16:19], v[36:39]
    ds_read_b64_tr_b16 v[180:181], v5 offset:20480
    v_mfma_f32_16x16x32_bf16 v[52:55], v[164:167], a[20:23], v[52:55]
    v_mfma_f32_16x16x32_bf16 v[68:71], v[164:167], a[24:27], v[68:71]
    ds_read_b64_tr_b16 v[182:183], v5 offset:22528
    v_mfma_f32_16x16x32_bf16 v[84:87], v[164:167], a[28:31], v[84:87]
    v_mfma_f32_16x16x32_bf16 v[40:43], v[168:171], a[16:19], v[40:43]
    ds_read_b64_tr_b16 v[184:185], v6 offset:20480
    v_mfma_f32_16x16x32_bf16 v[56:59], v[168:171], a[20:23], v[56:59]
    v_mfma_f32_16x16x32_bf16 v[72:75], v[168:171], a[24:27], v[72:75]
    ds_read_b64_tr_b16 v[186:187], v6 offset:22528
    v_mfma_f32_16x16x32_bf16 v[88:91], v[168:171], a[28:31], v[88:91]
    v_mfma_f32_16x16x32_bf16 v[44:47], v[172:175], a[16:19], v[44:47]
    ds_read_b64_tr_b16 v[188:189], v7 offset:20480
    v_mfma_f32_16x16x32_bf16 v[60:63], v[172:175], a[20:23], v[60:63]
    v_mfma_f32_16x16x32_bf16 v[76:79], v[172:175], a[24:27], v[76:79]
    ds_read_b64_tr_b16 v[190:191], v7 offset:22528
    v_mfma_f32_16x16x32_bf16 v[92:95], v[172:175], a[28:31], v[92:95]
    s_add_u32 m0, s61, 12288
    s_add_u32 s33, s63, 45056
    buffer_load_dwordx4 v238, s[16:19], s33 offen sc1 lds
    s_add_u32 m0, s61, 13312
    s_add_u32 s33, s63, 46080
    buffer_load_dwordx4 v238, s[16:19], s33 offen sc1 lds
    s_add_u32 m0, s61, 14336
    s_add_u32 s33, s63, 47104
    buffer_load_dwordx4 v238, s[16:19], s33 offen sc1 lds
    s_add_u32 m0, s61, 15360
    s_add_u32 s33, s63, 48128
    buffer_load_dwordx4 v238, s[16:19], s33 offen sc1 lds
    s_mov_b32 s33, 11264
    buffer_load_dwordx4 a[16:19], v10, s[8:11], s33 offen sc1
    s_mov_b32 s33, 68608
    buffer_load_dwordx4 a[20:23], v10, s[8:11], s33 offen sc1
    s_mov_b32 s33, 125952
    buffer_load_dwordx4 a[24:27], v10, s[8:11], s33 offen sc1
    s_mov_b32 s33, 183296
    buffer_load_dwordx4 a[28:31], v10, s[8:11], s33 offen sc1
    s_waitcnt vmcnt(44)
    s_waitcnt lgkmcnt(0)
    v_mfma_f32_16x16x32_bf16 v[32:35], v[176:179], a[32:35], v[32:35]
    ds_read_b64_tr_b16 v[160:161], v4 offset:24576
    v_mfma_f32_16x16x32_bf16 v[48:51], v[176:179], a[36:39], v[48:51]
    v_mfma_f32_16x16x32_bf16 v[64:67], v[176:179], a[40:43], v[64:67]
    ds_read_b64_tr_b16 v[162:163], v4 offset:26624
    v_mfma_f32_16x16x32_bf16 v[80:83], v[176:179], a[44:47], v[80:83]
    v_mfma_f32_16x16x32_bf16 v[36:39], v[180:183], a[32:35], v[36:39]
    ds_read_b64_tr_b16 v[164:165], v5 offset:24576
    v_mfma_f32_16x16x32_bf16 v[52:55], v[180:183], a[36:39], v[52:55]
    v_mfma_f32_16x16x32_bf16 v[68:71], v[180:183], a[40:43], v[68:71]
    ds_read_b64_tr_b16 v[166:167], v5 offset:26624
    v_mfma_f32_16x16x32_bf16 v[84:87], v[180:183], a[44:47], v[84:87]
    v_mfma_f32_16x16x32_bf16 v[40:43], v[184:187], a[32:35], v[40:43]
    ds_read_b64_tr_b16 v[168:169], v6 offset:24576
    v_mfma_f32_16x16x32_bf16 v[56:59], v[184:187], a[36:39], v[56:59]
    v_mfma_f32_16x16x32_bf16 v[72:75], v[184:187], a[40:43], v[72:75]
    ds_read_b64_tr_b16 v[170:171], v6 offset:26624
    v_mfma_f32_16x16x32_bf16 v[88:91], v[184:187], a[44:47], v[88:91]
    v_mfma_f32_16x16x32_bf16 v[44:47], v[188:191], a[32:35], v[44:47]
    ds_read_b64_tr_b16 v[172:173], v7 offset:24576
    v_mfma_f32_16x16x32_bf16 v[60:63], v[188:191], a[36:39], v[60:63]
    v_mfma_f32_16x16x32_bf16 v[76:79], v[188:191], a[40:43], v[76:79]
    ds_read_b64_tr_b16 v[174:175], v7 offset:26624
    v_mfma_f32_16x16x32_bf16 v[92:95], v[188:191], a[44:47], v[92:95]
    s_add_u32 m0, s61, 16384
    s_add_u32 s33, s63, 49152
    buffer_load_dwordx4 v238, s[16:19], s33 offen sc1 lds
    s_add_u32 m0, s61, 17408
    s_add_u32 s33, s63, 50176
    buffer_load_dwordx4 v238, s[16:19], s33 offen sc1 lds
    s_add_u32 m0, s61, 18432
    s_add_u32 s33, s63, 51200
    buffer_load_dwordx4 v238, s[16:19], s33 offen sc1 lds
    s_add_u32 m0, s61, 19456
    s_add_u32 s33, s63, 52224
    buffer_load_dwordx4 v238, s[16:19], s33 offen sc1 lds
    s_mov_b32 s33, 12288
    buffer_load_dwordx4 a[32:35], v10, s[8:11], s33 offen sc1
    s_mov_b32 s33, 69632
    buffer_load_dwordx4 a[36:39], v10, s[8:11], s33 offen sc1
    s_mov_b32 s33, 126976
    buffer_load_dwordx4 a[40:43], v10, s[8:11], s33 offen sc1
    s_mov_b32 s33, 184320
    buffer_load_dwordx4 a[44:47], v10, s[8:11], s33 offen sc1
    s_waitcnt vmcnt(44)
    s_waitcnt lgkmcnt(0)
    v_mfma_f32_16x16x32_bf16 v[32:35], v[160:163], a[48:51], v[32:35]
    ds_read_b64_tr_b16 v[176:177], v4 offset:28672
    v_mfma_f32_16x16x32_bf16 v[48:51], v[160:163], a[52:55], v[48:51]
    v_mfma_f32_16x16x32_bf16 v[64:67], v[160:163], a[56:59], v[64:67]
    ds_read_b64_tr_b16 v[178:179], v4 offset:30720
    v_mfma_f32_16x16x32_bf16 v[80:83], v[160:163], a[60:63], v[80:83]
    v_mfma_f32_16x16x32_bf16 v[36:39], v[164:167], a[48:51], v[36:39]
    ds_read_b64_tr_b16 v[180:181], v5 offset:28672
    v_mfma_f32_16x16x32_bf16 v[52:55], v[164:167], a[52:55], v[52:55]
    v_mfma_f32_16x16x32_bf16 v[68:71], v[164:167], a[56:59], v[68:71]
    ds_read_b64_tr_b16 v[182:183], v5 offset:30720
    v_mfma_f32_16x16x32_bf16 v[84:87], v[164:167], a[60:63], v[84:87]
    v_mfma_f32_16x16x32_bf16 v[40:43], v[168:171], a[48:51], v[40:43]
    ds_read_b64_tr_b16 v[184:185], v6 offset:28672
    v_mfma_f32_16x16x32_bf16 v[56:59], v[168:171], a[52:55], v[56:59]
    v_mfma_f32_16x16x32_bf16 v[72:75], v[168:171], a[56:59], v[72:75]
    ds_read_b64_tr_b16 v[186:187], v6 offset:30720
    v_mfma_f32_16x16x32_bf16 v[88:91], v[168:171], a[60:63], v[88:91]
    v_mfma_f32_16x16x32_bf16 v[44:47], v[172:175], a[48:51], v[44:47]
    ds_read_b64_tr_b16 v[188:189], v7 offset:28672
    v_mfma_f32_16x16x32_bf16 v[60:63], v[172:175], a[52:55], v[60:63]
    v_mfma_f32_16x16x32_bf16 v[76:79], v[172:175], a[56:59], v[76:79]
    ds_read_b64_tr_b16 v[190:191], v7 offset:30720
    v_mfma_f32_16x16x32_bf16 v[92:95], v[172:175], a[60:63], v[92:95]
    s_add_u32 m0, s61, 20480
    s_add_u32 s33, s63, 53248
    buffer_load_dwordx4 v238, s[16:19], s33 offen sc1 lds
    s_add_u32 m0, s61, 21504
    s_add_u32 s33, s63, 54272
    buffer_load_dwordx4 v238, s[16:19], s33 offen sc1 lds
    s_add_u32 m0, s61, 22528
    s_add_u32 s33, s63, 55296
    buffer_load_dwordx4 v238, s[16:19], s33 offen sc1 lds
    s_add_u32 m0, s61, 23552
    s_add_u32 s33, s63, 56320
    buffer_load_dwordx4 v238, s[16:19], s33 offen sc1 lds
    s_mov_b32 s33, 13312
    buffer_load_dwordx4 a[48:51], v10, s[8:11], s33 offen sc1
    s_mov_b32 s33, 70656
    buffer_load_dwordx4 a[52:55], v10, s[8:11], s33 offen sc1
    s_mov_b32 s33, 128000
    buffer_load_dwordx4 a[56:59], v10, s[8:11], s33 offen sc1
    s_mov_b32 s33, 185344
    buffer_load_dwordx4 a[60:63], v10, s[8:11], s33 offen sc1
    s_waitcnt vmcnt(44)
    s_waitcnt lgkmcnt(0)
    v_mfma_f32_16x16x32_bf16 v[32:35], v[176:179], a[64:67], v[32:35]
    ds_read_b64_tr_b16 v[160:161], v4 offset:0
    v_mfma_f32_16x16x32_bf16 v[48:51], v[176:179], a[68:71], v[48:51]
    v_mfma_f32_16x16x32_bf16 v[64:67], v[176:179], a[72:75], v[64:67]
    ds_read_b64_tr_b16 v[162:163], v4 offset:2048
    v_mfma_f32_16x16x32_bf16 v[80:83], v[176:179], a[76:79], v[80:83]
    v_mfma_f32_16x16x32_bf16 v[36:39], v[180:183], a[64:67], v[36:39]
    ds_read_b64_tr_b16 v[164:165], v5 offset:0
    v_mfma_f32_16x16x32_bf16 v[52:55], v[180:183], a[68:71], v[52:55]
    v_mfma_f32_16x16x32_bf16 v[68:71], v[180:183], a[72:75], v[68:71]
    ds_read_b64_tr_b16 v[166:167], v5 offset:2048
    v_mfma_f32_16x16x32_bf16 v[84:87], v[180:183], a[76:79], v[84:87]
    v_mfma_f32_16x16x32_bf16 v[40:43], v[184:187], a[64:67], v[40:43]
    ds_read_b64_tr_b16 v[168:169], v6 offset:0
    v_mfma_f32_16x16x32_bf16 v[56:59], v[184:187], a[68:71], v[56:59]
    v_mfma_f32_16x16x32_bf16 v[72:75], v[184:187], a[72:75], v[72:75]
    ds_read_b64_tr_b16 v[170:171], v6 offset:2048
    v_mfma_f32_16x16x32_bf16 v[88:91], v[184:187], a[76:79], v[88:91]
    v_mfma_f32_16x16x32_bf16 v[44:47], v[188:191], a[64:67], v[44:47]
    ds_read_b64_tr_b16 v[172:173], v7 offset:0
    v_mfma_f32_16x16x32_bf16 v[60:63], v[188:191], a[68:71], v[60:63]
    v_mfma_f32_16x16x32_bf16 v[76:79], v[188:191], a[72:75], v[76:79]
    ds_read_b64_tr_b16 v[174:175], v7 offset:2048
    v_mfma_f32_16x16x32_bf16 v[92:95], v[188:191], a[76:79], v[92:95]
    s_waitcnt vmcnt(36)
    s_waitcnt lgkmcnt(0)
    v_mfma_f32_16x16x32_bf16 v[32:35], v[160:163], a[80:83], v[32:35]
    ds_read_b64_tr_b16 v[176:177], v4 offset:4096
    v_mfma_f32_16x16x32_bf16 v[48:51], v[160:163], a[84:87], v[48:51]
    v_mfma_f32_16x16x32_bf16 v[64:67], v[160:163], a[88:91], v[64:67]
    ds_read_b64_tr_b16 v[178:179], v4 offset:6144
    v_mfma_f32_16x16x32_bf16 v[80:83], v[160:163], a[92:95], v[80:83]
    v_mfma_f32_16x16x32_bf16 v[36:39], v[164:167], a[80:83], v[36:39]
    ds_read_b64_tr_b16 v[180:181], v5 offset:4096
    v_mfma_f32_16x16x32_bf16 v[52:55], v[164:167], a[84:87], v[52:55]
    v_mfma_f32_16x16x32_bf16 v[68:71], v[164:167], a[88:91], v[68:71]
    ds_read_b64_tr_b16 v[182:183], v5 offset:6144
    v_mfma_f32_16x16x32_bf16 v[84:87], v[164:167], a[92:95], v[84:87]
    v_mfma_f32_16x16x32_bf16 v[40:43], v[168:171], a[80:83], v[40:43]
    ds_read_b64_tr_b16 v[184:185], v6 offset:4096
    v_mfma_f32_16x16x32_bf16 v[56:59], v[168:171], a[84:87], v[56:59]
    v_mfma_f32_16x16x32_bf16 v[72:75], v[168:171], a[88:91], v[72:75]
    ds_read_b64_tr_b16 v[186:187], v6 offset:6144
    v_mfma_f32_16x16x32_bf16 v[88:91], v[168:171], a[92:95], v[88:91]
    v_mfma_f32_16x16x32_bf16 v[44:47], v[172:175], a[80:83], v[44:47]
    ds_read_b64_tr_b16 v[188:189], v7 offset:4096
    v_mfma_f32_16x16x32_bf16 v[60:63], v[172:175], a[84:87], v[60:63]
    v_mfma_f32_16x16x32_bf16 v[76:79], v[172:175], a[88:91], v[76:79]
    ds_read_b64_tr_b16 v[190:191], v7 offset:6144
    v_mfma_f32_16x16x32_bf16 v[92:95], v[172:175], a[92:95], v[92:95]
    s_waitcnt vmcnt(28)
    s_waitcnt lgkmcnt(0)
    v_mfma_f32_16x16x32_bf16 v[32:35], v[176:179], a[96:99], v[32:35]
    ds_read_b64_tr_b16 v[160:161], v4 offset:8192
    v_mfma_f32_16x16x32_bf16 v[48:51], v[176:179], a[100:103], v[48:51]
    v_mfma_f32_16x16x32_bf16 v[64:67], v[176:179], a[104:107], v[64:67]
    ds_read_b64_tr_b16 v[162:163], v4 offset:10240
    v_mfma_f32_16x16x32_bf16 v[80:83], v[176:179], a[108:111], v[80:83]
    v_mfma_f32_16x16x32_bf16 v[36:39], v[180:183], a[96:99], v[36:39]
    ds_read_b64_tr_b16 v[164:165], v5 offset:8192
    v_mfma_f32_16x16x32_bf16 v[52:55], v[180:183], a[100:103], v[52:55]
    v_mfma_f32_16x16x32_bf16 v[68:71], v[180:183], a[104:107], v[68:71]
    ds_read_b64_tr_b16 v[166:167], v5 offset:10240
    v_mfma_f32_16x16x32_bf16 v[84:87], v[180:183], a[108:111], v[84:87]
    v_mfma_f32_16x16x32_bf16 v[40:43], v[184:187], a[96:99], v[40:43]
    ds_read_b64_tr_b16 v[168:169], v6 offset:8192
    v_mfma_f32_16x16x32_bf16 v[56:59], v[184:187], a[100:103], v[56:59]
    v_mfma_f32_16x16x32_bf16 v[72:75], v[184:187], a[104:107], v[72:75]
    ds_read_b64_tr_b16 v[170:171], v6 offset:10240
    v_mfma_f32_16x16x32_bf16 v[88:91], v[184:187], a[108:111], v[88:91]
    v_mfma_f32_16x16x32_bf16 v[44:47], v[188:191], a[96:99], v[44:47]
    ds_read_b64_tr_b16 v[172:173], v7 offset:8192
    v_mfma_f32_16x16x32_bf16 v[60:63], v[188:191], a[100:103], v[60:63]
    v_mfma_f32_16x16x32_bf16 v[76:79], v[188:191], a[104:107], v[76:79]
    ds_read_b64_tr_b16 v[174:175], v7 offset:10240
    v_mfma_f32_16x16x32_bf16 v[92:95], v[188:191], a[108:111], v[92:95]
    s_waitcnt vmcnt(20)
    s_waitcnt lgkmcnt(0)
    v_mfma_f32_16x16x32_bf16 v[32:35], v[160:163], a[0:3], v[32:35]
    ds_read_b64_tr_b16 v[176:177], v4 offset:12288
    v_mfma_f32_16x16x32_bf16 v[48:51], v[160:163], a[4:7], v[48:51]
    v_mfma_f32_16x16x32_bf16 v[64:67], v[160:163], a[8:11], v[64:67]
    ds_read_b64_tr_b16 v[178:179], v4 offset:14336
    v_mfma_f32_16x16x32_bf16 v[80:83], v[160:163], a[12:15], v[80:83]
    v_mfma_f32_16x16x32_bf16 v[36:39], v[164:167], a[0:3], v[36:39]
    ds_read_b64_tr_b16 v[180:181], v5 offset:12288
    v_mfma_f32_16x16x32_bf16 v[52:55], v[164:167], a[4:7], v[52:55]
    v_mfma_f32_16x16x32_bf16 v[68:71], v[164:167], a[8:11], v[68:71]
    ds_read_b64_tr_b16 v[182:183], v5 offset:14336
    v_mfma_f32_16x16x32_bf16 v[84:87], v[164:167], a[12:15], v[84:87]
    v_mfma_f32_16x16x32_bf16 v[40:43], v[168:171], a[0:3], v[40:43]
    ds_read_b64_tr_b16 v[184:185], v6 offset:12288
    v_mfma_f32_16x16x32_bf16 v[56:59], v[168:171], a[4:7], v[56:59]
    v_mfma_f32_16x16x32_bf16 v[72:75], v[168:171], a[8:11], v[72:75]
    ds_read_b64_tr_b16 v[186:187], v6 offset:14336
    v_mfma_f32_16x16x32_bf16 v[88:91], v[168:171], a[12:15], v[88:91]
    v_mfma_f32_16x16x32_bf16 v[44:47], v[172:175], a[0:3], v[44:47]
    ds_read_b64_tr_b16 v[188:189], v7 offset:12288
    v_mfma_f32_16x16x32_bf16 v[60:63], v[172:175], a[4:7], v[60:63]
    v_mfma_f32_16x16x32_bf16 v[76:79], v[172:175], a[8:11], v[76:79]
    ds_read_b64_tr_b16 v[190:191], v7 offset:14336
    v_mfma_f32_16x16x32_bf16 v[92:95], v[172:175], a[12:15], v[92:95]
    s_waitcnt vmcnt(12)
    s_waitcnt lgkmcnt(0)
    v_mfma_f32_16x16x32_bf16 v[32:35], v[176:179], a[16:19], v[32:35]
    ds_read_b64_tr_b16 v[160:161], v4 offset:16384
    v_mfma_f32_16x16x32_bf16 v[48:51], v[176:179], a[20:23], v[48:51]
    v_mfma_f32_16x16x32_bf16 v[64:67], v[176:179], a[24:27], v[64:67]
    ds_read_b64_tr_b16 v[162:163], v4 offset:18432
    v_mfma_f32_16x16x32_bf16 v[80:83], v[176:179], a[28:31], v[80:83]
    v_mfma_f32_16x16x32_bf16 v[36:39], v[180:183], a[16:19], v[36:39]
    ds_read_b64_tr_b16 v[164:165], v5 offset:16384
    v_mfma_f32_16x16x32_bf16 v[52:55], v[180:183], a[20:23], v[52:55]
    v_mfma_f32_16x16x32_bf16 v[68:71], v[180:183], a[24:27], v[68:71]
    ds_read_b64_tr_b16 v[166:167], v5 offset:18432
    v_mfma_f32_16x16x32_bf16 v[84:87], v[180:183], a[28:31], v[84:87]
    v_mfma_f32_16x16x32_bf16 v[40:43], v[184:187], a[16:19], v[40:43]
    ds_read_b64_tr_b16 v[168:169], v6 offset:16384
    v_mfma_f32_16x16x32_bf16 v[56:59], v[184:187], a[20:23], v[56:59]
    v_mfma_f32_16x16x32_bf16 v[72:75], v[184:187], a[24:27], v[72:75]
    ds_read_b64_tr_b16 v[170:171], v6 offset:18432
    v_mfma_f32_16x16x32_bf16 v[88:91], v[184:187], a[28:31], v[88:91]
    v_mfma_f32_16x16x32_bf16 v[44:47], v[188:191], a[16:19], v[44:47]
    ds_read_b64_tr_b16 v[172:173], v7 offset:16384
    v_mfma_f32_16x16x32_bf16 v[60:63], v[188:191], a[20:23], v[60:63]
    v_mfma_f32_16x16x32_bf16 v[76:79], v[188:191], a[24:27], v[76:79]
    ds_read_b64_tr_b16 v[174:175], v7 offset:18432
    v_mfma_f32_16x16x32_bf16 v[92:95], v[188:191], a[28:31], v[92:95]
    s_waitcnt vmcnt(4)
    s_waitcnt lgkmcnt(0)
    v_mfma_f32_16x16x32_bf16 v[32:35], v[160:163], a[32:35], v[32:35]
    ds_read_b64_tr_b16 v[176:177], v4 offset:20480
    v_mfma_f32_16x16x32_bf16 v[48:51], v[160:163], a[36:39], v[48:51]
    v_mfma_f32_16x16x32_bf16 v[64:67], v[160:163], a[40:43], v[64:67]
    ds_read_b64_tr_b16 v[178:179], v4 offset:22528
    v_mfma_f32_16x16x32_bf16 v[80:83], v[160:163], a[44:47], v[80:83]
    v_mfma_f32_16x16x32_bf16 v[36:39], v[164:167], a[32:35], v[36:39]
    ds_read_b64_tr_b16 v[180:181], v5 offset:20480
    v_mfma_f32_16x16x32_bf16 v[52:55], v[164:167], a[36:39], v[52:55]
    v_mfma_f32_16x16x32_bf16 v[68:71], v[164:167], a[40:43], v[68:71]
    ds_read_b64_tr_b16 v[182:183], v5 offset:22528
    v_mfma_f32_16x16x32_bf16 v[84:87], v[164:167], a[44:47], v[84:87]
    v_mfma_f32_16x16x32_bf16 v[40:43], v[168:171], a[32:35], v[40:43]
    ds_read_b64_tr_b16 v[184:185], v6 offset:20480
    v_mfma_f32_16x16x32_bf16 v[56:59], v[168:171], a[36:39], v[56:59]
    v_mfma_f32_16x16x32_bf16 v[72:75], v[168:171], a[40:43], v[72:75]
    ds_read_b64_tr_b16 v[186:187], v6 offset:22528
    v_mfma_f32_16x16x32_bf16 v[88:91], v[168:171], a[44:47], v[88:91]
    v_mfma_f32_16x16x32_bf16 v[44:47], v[172:175], a[32:35], v[44:47]
    ds_read_b64_tr_b16 v[188:189], v7 offset:20480
    v_mfma_f32_16x16x32_bf16 v[60:63], v[172:175], a[36:39], v[60:63]
    v_mfma_f32_16x16x32_bf16 v[76:79], v[172:175], a[40:43], v[76:79]
    ds_read_b64_tr_b16 v[190:191], v7 offset:22528
    v_mfma_f32_16x16x32_bf16 v[92:95], v[172:175], a[44:47], v[92:95]
    s_waitcnt vmcnt(0)
    s_waitcnt lgkmcnt(0)
    v_mfma_f32_16x16x32_bf16 v[32:35], v[176:179], a[48:51], v[32:35]
    v_mfma_f32_16x16x32_bf16 v[48:51], v[176:179], a[52:55], v[48:51]
    v_mfma_f32_16x16x32_bf16 v[64:67], v[176:179], a[56:59], v[64:67]
    v_mfma_f32_16x16x32_bf16 v[80:83], v[176:179], a[60:63], v[80:83]
    v_mfma_f32_16x16x32_bf16 v[36:39], v[180:183], a[48:51], v[36:39]
    v_mfma_f32_16x16x32_bf16 v[52:55], v[180:183], a[52:55], v[52:55]
    v_mfma_f32_16x16x32_bf16 v[68:71], v[180:183], a[56:59], v[68:71]
    v_mfma_f32_16x16x32_bf16 v[84:87], v[180:183], a[60:63], v[84:87]
    v_mfma_f32_16x16x32_bf16 v[40:43], v[184:187], a[48:51], v[40:43]
    v_mfma_f32_16x16x32_bf16 v[56:59], v[184:187], a[52:55], v[56:59]
    v_mfma_f32_16x16x32_bf16 v[72:75], v[184:187], a[56:59], v[72:75]
    v_mfma_f32_16x16x32_bf16 v[88:91], v[184:187], a[60:63], v[88:91]
    v_mfma_f32_16x16x32_bf16 v[44:47], v[188:191], a[48:51], v[44:47]
    v_mfma_f32_16x16x32_bf16 v[60:63], v[188:191], a[52:55], v[60:63]
    v_mfma_f32_16x16x32_bf16 v[76:79], v[188:191], a[56:59], v[76:79]
    v_mfma_f32_16x16x32_bf16 v[92:95], v[188:191], a[60:63], v[92:95]
    s_waitcnt lgkmcnt(0)
    s_lshl_b32 s41, s38, 16
    s_add_u32 s48, s34, 0x600000
    s_addc_u32 s49, s35, 0
    s_add_u32 s48, s48, s41
    s_addc_u32 s49, s49, 0
    s_mov_b32 s50, 0x10000
    s_mov_b32 s51, 0x20000
    s_mov_b32 s52, s64
    s_mov_b32 s53, s65
    s_mov_b32 s54, 0x200000
    s_mov_b32 s55, 0x20000
    s_mov_b32 s24, s66
    s_mov_b32 s25, s67
    s_mov_b32 s26, 0x200000
    s_mov_b32 s27, 0x20000
    s_lshl_b32 s40, s3, 14
    s_lshl_b32 s41, s39, 11
    s_add_u32 s40, s40, s41
    s_add_u32 s41, s40, 1024
    buffer_load_dwordx4 a[0:3], v19, s[48:51], s40 offen sc1
    buffer_load_dwordx4 a[4:7], v19, s[48:51], s41 offen sc1
    s_lshl_b32 s40, s38, 6
    s_lshl_b32 s41, s3, 4
    s_add_u32 s40, s40, s41
    v_add_u32 v14, s40, v20
    v_lshlrev_b32 v14, 10, v14
    v_lshl_add_u32 v14, v21, 3, v14
    s_lshl_b32 s41, s39, 7
    v_add_u32 v14, s41, v14
    buffer_load_dwordx2 a[8:9], v14, s[52:55], 0 offen offset:0
    buffer_load_dwordx2 a[10:11], v14, s[52:55], 0 offen offset:32
    buffer_load_dwordx2 a[12:13], v14, s[52:55], 0 offen offset:64
    buffer_load_dwordx2 a[14:15], v14, s[52:55], 0 offen offset:96
    s_lshl_b32 s61, s3, 14
    s_nop 7
    s_barrier
    v_add_u32 v24, s61, v19
    ds_write_b128 v24, v[96:99] offset:0
    ds_write_b128 v24, v[100:103] offset:1024
    ds_write_b128 v24, v[104:107] offset:2048
    ds_write_b128 v24, v[108:111] offset:3072
    ds_write_b128 v24, v[112:115] offset:4096
    ds_write_b128 v24, v[116:119] offset:5120
    ds_write_b128 v24, v[120:123] offset:6144
    ds_write_b128 v24, v[124:127] offset:7168
    ds_write_b128 v24, v[128:131] offset:8192
    ds_write_b128 v24, v[132:135] offset:9216
    ds_write_b128 v24, v[136:139] offset:10240
    ds_write_b128 v24, v[140:143] offset:11264
    ds_write_b128 v24, v[144:147] offset:12288
    ds_write_b128 v24, v[148:151] offset:13312
    ds_write_b128 v24, v[152:155] offset:14336
    ds_write_b128 v24, v[156:159] offset:15360
    v_add_u32 v24, 65536, v24
    ds_write_b128 v24, v[32:35] offset:0
    ds_write_b128 v24, v[36:39] offset:1024
    ds_write_b128 v24, v[40:43] offset:2048
    ds_write_b128 v24, v[44:47] offset:3072
    ds_write_b128 v24, v[48:51] offset:4096
    ds_write_b128 v24, v[52:55] offset:5120
    ds_write_b128 v24, v[56:59] offset:6144
    ds_write_b128 v24, v[60:63] offset:7168
    ds_write_b128 v24, v[64:67] offset:8192
    ds_write_b128 v24, v[68:71] offset:9216
    ds_write_b128 v24, v[72:75] offset:10240
    ds_write_b128 v24, v[76:79] offset:11264
    ds_write_b128 v24, v[80:83] offset:12288
    ds_write_b128 v24, v[84:87] offset:13312
    ds_write_b128 v24, v[88:91] offset:14336
    ds_write_b128 v24, v[92:95] offset:15360
    s_waitcnt lgkmcnt(0)
    s_barrier
    s_lshl_b32 s60, s3, 12
    v_add_u32 v24, s60, v19
    v_add_u32 v25, 0, v24
    v_add_u32 v26, 32768, v24
    ds_read_b128 v[96:99], v25 offset:0
    ds_read_b128 v[100:103], v25 offset:1024
    ds_read_b128 v[104:107], v25 offset:2048
    ds_read_b128 v[108:111], v25 offset:3072
    ds_read_b128 v[112:115], v25 offset:16384
    ds_read_b128 v[116:119], v25 offset:17408
    ds_read_b128 v[120:123], v25 offset:18432
    ds_read_b128 v[124:127], v25 offset:19456
    ds_read_b128 v[128:131], v26 offset:0
    ds_read_b128 v[132:135], v26 offset:1024
    ds_read_b128 v[136:139], v26 offset:2048
    ds_read_b128 v[140:143], v26 offset:3072
    ds_read_b128 v[144:147], v26 offset:16384
    ds_read_b128 v[148:151], v26 offset:17408
    ds_read_b128 v[152:155], v26 offset:18432
    ds_read_b128 v[156:159], v26 offset:19456
    v_add_u32 v25, 65536, v24
    v_add_u32 v26, 98304, v24
    ds_read_b128 v[32:35], v25 offset:0
    ds_read_b128 v[36:39], v25 offset:1024
    ds_read_b128 v[40:43], v25 offset:2048
    ds_read_b128 v[44:47], v25 offset:3072
    ds_read_b128 v[48:51], v25 offset:16384
    ds_read_b128 v[52:55], v25 offset:17408
    ds_read_b128 v[56:59], v25 offset:18432
    ds_read_b128 v[60:63], v25 offset:19456
    ds_read_b128 v[64:67], v26 offset:0
    ds_read_b128 v[68:71], v26 offset:1024
    ds_read_b128 v[72:75], v26 offset:2048
    ds_read_b128 v[76:79], v26 offset:3072
    ds_read_b128 v[80:83], v26 offset:16384
    ds_read_b128 v[84:87], v26 offset:17408
    ds_read_b128 v[88:91], v26 offset:18432
    ds_read_b128 v[92:95], v26 offset:19456
    s_waitcnt lgkmcnt(0)
    v_pk_add_f32 v[96:97], v[96:97], v[112:113]
    v_pk_add_f32 v[128:129], v[128:129], v[144:145]
    v_pk_add_f32 v[98:99], v[98:99], v[114:115]
    v_pk_add_f32 v[130:131], v[130:131], v[146:147]
    v_pk_add_f32 v[100:101], v[100:101], v[116:117]
    v_pk_add_f32 v[132:133], v[132:133], v[148:149]
    v_pk_add_f32 v[102:103], v[102:103], v[118:119]
    v_pk_add_f32 v[134:135], v[134:135], v[150:151]
    v_pk_add_f32 v[104:105], v[104:105], v[120:121]
    v_pk_add_f32 v[136:137], v[136:137], v[152:153]
    v_pk_add_f32 v[106:107], v[106:107], v[122:123]
    v_pk_add_f32 v[138:139], v[138:139], v[154:155]
    v_pk_add_f32 v[108:109], v[108:109], v[124:125]
    v_pk_add_f32 v[140:141], v[140:141], v[156:157]
    v_pk_add_f32 v[110:111], v[110:111], v[126:127]
    v_pk_add_f32 v[142:143], v[142:143], v[158:159]
    v_pk_add_f32 v[96:97], v[96:97], v[128:129]
    v_pk_add_f32 v[98:99], v[98:99], v[130:131]
    v_pk_add_f32 v[100:101], v[100:101], v[132:133]
    v_pk_add_f32 v[102:103], v[102:103], v[134:135]
    v_pk_add_f32 v[104:105], v[104:105], v[136:137]
    v_pk_add_f32 v[106:107], v[106:107], v[138:139]
    v_pk_add_f32 v[108:109], v[108:109], v[140:141]
    v_pk_add_f32 v[110:111], v[110:111], v[142:143]
    v_pk_add_f32 v[32:33], v[32:33], v[48:49]
    v_pk_add_f32 v[64:65], v[64:65], v[80:81]
    v_pk_add_f32 v[34:35], v[34:35], v[50:51]
    v_pk_add_f32 v[66:67], v[66:67], v[82:83]
    v_pk_add_f32 v[36:37], v[36:37], v[52:53]
    v_pk_add_f32 v[68:69], v[68:69], v[84:85]
    v_pk_add_f32 v[38:39], v[38:39], v[54:55]
    v_pk_add_f32 v[70:71], v[70:71], v[86:87]
    v_pk_add_f32 v[40:41], v[40:41], v[56:57]
    v_pk_add_f32 v[72:73], v[72:73], v[88:89]
    v_pk_add_f32 v[42:43], v[42:43], v[58:59]
    v_pk_add_f32 v[74:75], v[74:75], v[90:91]
    v_pk_add_f32 v[44:45], v[44:45], v[60:61]
    v_pk_add_f32 v[76:77], v[76:77], v[92:93]
    v_pk_add_f32 v[46:47], v[46:47], v[62:63]
    v_pk_add_f32 v[78:79], v[78:79], v[94:95]
    v_pk_add_f32 v[32:33], v[32:33], v[64:65]
    v_pk_add_f32 v[34:35], v[34:35], v[66:67]
    v_pk_add_f32 v[36:37], v[36:37], v[68:69]
    v_pk_add_f32 v[38:39], v[38:39], v[70:71]
    v_pk_add_f32 v[40:41], v[40:41], v[72:73]
    v_pk_add_f32 v[42:43], v[42:43], v[74:75]
    v_pk_add_f32 v[44:45], v[44:45], v[76:77]
    v_pk_add_f32 v[46:47], v[46:47], v[78:79]
    v_cvt_pk_bf16_f32 v112, v96, v97
    v_cvt_pk_bf16_f32 v113, v98, v99
    v_cvt_pk_bf16_f32 v114, v100, v101
    v_cvt_pk_bf16_f32 v115, v102, v103
    v_cvt_pk_bf16_f32 v116, v104, v105
    v_cvt_pk_bf16_f32 v117, v106, v107
    v_cvt_pk_bf16_f32 v118, v108, v109
    v_cvt_pk_bf16_f32 v119, v110, v111
    v_lshlrev_b32 v96, 16, v112
    v_and_b32 v97, 0xffff0000, v112
    v_lshlrev_b32 v98, 16, v113
    v_and_b32 v99, 0xffff0000, v113
    v_lshlrev_b32 v100, 16, v114
    v_and_b32 v101, 0xffff0000, v114
    v_lshlrev_b32 v102, 16, v115
    v_and_b32 v103, 0xffff0000, v115
    v_lshlrev_b32 v104, 16, v116
    v_and_b32 v105, 0xffff0000, v116
    v_lshlrev_b32 v106, 16, v117
    v_and_b32 v107, 0xffff0000, v117
    v_lshlrev_b32 v108, 16, v118
    v_and_b32 v109, 0xffff0000, v118
    v_lshlrev_b32 v110, 16, v119
    v_and_b32 v111, 0xffff0000, v119
    v_cvt_pk_bf16_f32 v112, v32, v33
    v_cvt_pk_bf16_f32 v113, v34, v35
    v_cvt_pk_bf16_f32 v114, v36, v37
    v_cvt_pk_bf16_f32 v115, v38, v39
    v_cvt_pk_bf16_f32 v116, v40, v41
    v_cvt_pk_bf16_f32 v117, v42, v43
    v_cvt_pk_bf16_f32 v118, v44, v45
    v_cvt_pk_bf16_f32 v119, v46, v47
    v_lshlrev_b32 v32, 16, v112
    v_and_b32 v33, 0xffff0000, v112
    v_lshlrev_b32 v34, 16, v113
    v_and_b32 v35, 0xffff0000, v113
    v_lshlrev_b32 v36, 16, v114
    v_and_b32 v37, 0xffff0000, v114
    v_lshlrev_b32 v38, 16, v115
    v_and_b32 v39, 0xffff0000, v115
    v_lshlrev_b32 v40, 16, v116
    v_and_b32 v41, 0xffff0000, v116
    v_lshlrev_b32 v42, 16, v117
    v_and_b32 v43, 0xffff0000, v117
    v_lshlrev_b32 v44, 16, v118
    v_and_b32 v45, 0xffff0000, v118
    v_lshlrev_b32 v46, 16, v119
    v_and_b32 v47, 0xffff0000, v119
    s_waitcnt vmcnt(0)
    v_accvgpr_read_b32 v128, a0
    v_accvgpr_read_b32 v129, a1
    v_accvgpr_read_b32 v130, a2
    v_accvgpr_read_b32 v131, a3
    v_accvgpr_read_b32 v132, a4
    v_accvgpr_read_b32 v133, a5
    v_accvgpr_read_b32 v134, a6
    v_accvgpr_read_b32 v135, a7
    v_lshlrev_b32 v112, 16, v128
    v_and_b32 v113, 0xffff0000, v128
    v_lshlrev_b32 v114, 16, v129
    v_and_b32 v115, 0xffff0000, v129
    v_lshlrev_b32 v116, 16, v130
    v_and_b32 v117, 0xffff0000, v130
    v_lshlrev_b32 v118, 16, v131
    v_and_b32 v119, 0xffff0000, v131
    v_lshlrev_b32 v120, 16, v132
    v_and_b32 v121, 0xffff0000, v132
    v_lshlrev_b32 v122, 16, v133
    v_and_b32 v123, 0xffff0000, v133
    v_lshlrev_b32 v124, 16, v134
    v_and_b32 v125, 0xffff0000, v134
    v_lshlrev_b32 v126, 16, v135
    v_and_b32 v127, 0xffff0000, v135
    v_pk_add_f32 v[32:33], v[32:33], v[112:113]
    v_pk_add_f32 v[34:35], v[34:35], v[114:115]
    v_pk_add_f32 v[36:37], v[36:37], v[116:117]
    v_pk_add_f32 v[38:39], v[38:39], v[118:119]
    v_pk_add_f32 v[40:41], v[40:41], v[120:121]
    v_pk_add_f32 v[42:43], v[42:43], v[122:123]
    v_pk_add_f32 v[44:45], v[44:45], v[124:125]
    v_pk_add_f32 v[46:47], v[46:47], v[126:127]
    v_cvt_pk_bf16_f32 v112, v32, v33
    v_cvt_pk_bf16_f32 v113, v34, v35
    v_cvt_pk_bf16_f32 v114, v36, v37
    v_cvt_pk_bf16_f32 v115, v38, v39
    v_cvt_pk_bf16_f32 v116, v40, v41
    v_cvt_pk_bf16_f32 v117, v42, v43
    v_cvt_pk_bf16_f32 v118, v44, v45
    v_cvt_pk_bf16_f32 v119, v46, v47
    v_lshlrev_b32 v32, 16, v112
    v_and_b32 v33, 0xffff0000, v112
    v_lshlrev_b32 v34, 16, v113
    v_and_b32 v35, 0xffff0000, v113
    v_lshlrev_b32 v36, 16, v114
    v_and_b32 v37, 0xffff0000, v114
    v_lshlrev_b32 v38, 16, v115
    v_and_b32 v39, 0xffff0000, v115
    v_lshlrev_b32 v40, 16, v116
    v_and_b32 v41, 0xffff0000, v116
    v_lshlrev_b32 v42, 16, v117
    v_and_b32 v43, 0xffff0000, v117
    v_lshlrev_b32 v44, 16, v118
    v_and_b32 v45, 0xffff0000, v118
    v_lshlrev_b32 v46, 16, v119
    v_and_b32 v47, 0xffff0000, v119
    s_mov_b32 s33, 0xbfb8aa3b
    v_mov_b32 v26, 1.0
    v_mov_b32 v27, 1.0
    v_pk_mul_f32 v[112:113], s[32:33], v[32:33] op_sel:[1,0] op_sel_hi:[1,1]
    v_pk_mul_f32 v[114:115], s[32:33], v[34:35] op_sel:[1,0] op_sel_hi:[1,1]
    v_pk_mul_f32 v[116:117], s[32:33], v[36:37] op_sel:[1,0] op_sel_hi:[1,1]
    v_pk_mul_f32 v[118:119], s[32:33], v[38:39] op_sel:[1,0] op_sel_hi:[1,1]
    v_pk_mul_f32 v[120:121], s[32:33], v[40:41] op_sel:[1,0] op_sel_hi:[1,1]
    v_pk_mul_f32 v[122:123], s[32:33], v[42:43] op_sel:[1,0] op_sel_hi:[1,1]
    v_pk_mul_f32 v[124:125], s[32:33], v[44:45] op_sel:[1,0] op_sel_hi:[1,1]
    v_pk_mul_f32 v[126:127], s[32:33], v[46:47] op_sel:[1,0] op_sel_hi:[1,1]
    v_exp_f32 v112, v112
    v_exp_f32 v113, v113
    v_exp_f32 v114, v114
    v_exp_f32 v115, v115
    v_exp_f32 v116, v116
    v_exp_f32 v117, v117
    v_exp_f32 v118, v118
    v_exp_f32 v119, v119
    v_exp_f32 v120, v120
    v_exp_f32 v121, v121
    v_exp_f32 v122, v122
    v_exp_f32 v123, v123
    v_exp_f32 v124, v124
    v_exp_f32 v125, v125
    v_exp_f32 v126, v126
    v_exp_f32 v127, v127
    v_pk_add_f32 v[112:113], v[112:113], v[26:27]
    v_pk_add_f32 v[114:115], v[114:115], v[26:27]
    v_pk_add_f32 v[116:117], v[116:117], v[26:27]
    v_pk_add_f32 v[118:119], v[118:119], v[26:27]
    v_pk_add_f32 v[120:121], v[120:121], v[26:27]
    v_pk_add_f32 v[122:123], v[122:123], v[26:27]
    v_pk_add_f32 v[124:125], v[124:125], v[26:27]
    v_pk_add_f32 v[126:127], v[126:127], v[26:27]
    v_rcp_f32 v112, v112
    v_rcp_f32 v113, v113
    v_rcp_f32 v114, v114
    v_rcp_f32 v115, v115
    v_rcp_f32 v116, v116
    v_rcp_f32 v117, v117
    v_rcp_f32 v118, v118
    v_rcp_f32 v119, v119
    v_rcp_f32 v120, v120
    v_rcp_f32 v121, v121
    v_rcp_f32 v122, v122
    v_rcp_f32 v123, v123
    v_rcp_f32 v124, v124
    v_rcp_f32 v125, v125
    v_rcp_f32 v126, v126
    v_rcp_f32 v127, v127
    v_pk_mul_f32 v[32:33], v[32:33], v[112:113]
    v_pk_mul_f32 v[34:35], v[34:35], v[114:115]
    v_pk_mul_f32 v[36:37], v[36:37], v[116:117]
    v_pk_mul_f32 v[38:39], v[38:39], v[118:119]
    v_pk_mul_f32 v[40:41], v[40:41], v[120:121]
    v_pk_mul_f32 v[42:43], v[42:43], v[122:123]
    v_pk_mul_f32 v[44:45], v[44:45], v[124:125]
    v_pk_mul_f32 v[46:47], v[46:47], v[126:127]
    v_cvt_pk_bf16_f32 v112, v32, v33
    v_cvt_pk_bf16_f32 v113, v34, v35
    v_cvt_pk_bf16_f32 v114, v36, v37
    v_cvt_pk_bf16_f32 v115, v38, v39
    v_cvt_pk_bf16_f32 v116, v40, v41
    v_cvt_pk_bf16_f32 v117, v42, v43
    v_cvt_pk_bf16_f32 v118, v44, v45
    v_cvt_pk_bf16_f32 v119, v46, v47
    v_lshlrev_b32 v32, 16, v112
    v_and_b32 v33, 0xffff0000, v112
    v_lshlrev_b32 v34, 16, v113
    v_and_b32 v35, 0xffff0000, v113
    v_lshlrev_b32 v36, 16, v114
    v_and_b32 v37, 0xffff0000, v114
    v_lshlrev_b32 v38, 16, v115
    v_and_b32 v39, 0xffff0000, v115
    v_lshlrev_b32 v40, 16, v116
    v_and_b32 v41, 0xffff0000, v116
    v_lshlrev_b32 v42, 16, v117
    v_and_b32 v43, 0xffff0000, v117
    v_lshlrev_b32 v44, 16, v118
    v_and_b32 v45, 0xffff0000, v118
    v_lshlrev_b32 v46, 16, v119
    v_and_b32 v47, 0xffff0000, v119
    v_pk_mul_f32 v[96:97], v[96:97], v[32:33]
    v_pk_mul_f32 v[98:99], v[98:99], v[34:35]
    v_pk_mul_f32 v[100:101], v[100:101], v[36:37]
    v_pk_mul_f32 v[102:103], v[102:103], v[38:39]
    v_pk_mul_f32 v[104:105], v[104:105], v[40:41]
    v_pk_mul_f32 v[106:107], v[106:107], v[42:43]
    v_pk_mul_f32 v[108:109], v[108:109], v[44:45]
    v_pk_mul_f32 v[110:111], v[110:111], v[46:47]
    v_cvt_pk_bf16_f32 v112, v96, v97
    v_cvt_pk_bf16_f32 v113, v98, v99
    v_cvt_pk_bf16_f32 v114, v100, v101
    v_cvt_pk_bf16_f32 v115, v102, v103
    v_cvt_pk_bf16_f32 v116, v104, v105
    v_cvt_pk_bf16_f32 v117, v106, v107
    v_cvt_pk_bf16_f32 v118, v108, v109
    v_cvt_pk_bf16_f32 v119, v110, v111
    v_lshlrev_b32 v96, 16, v112
    v_and_b32 v97, 0xffff0000, v112
    v_lshlrev_b32 v98, 16, v113
    v_and_b32 v99, 0xffff0000, v113
    v_lshlrev_b32 v100, 16, v114
    v_and_b32 v101, 0xffff0000, v114
    v_lshlrev_b32 v102, 16, v115
    v_and_b32 v103, 0xffff0000, v115
    v_lshlrev_b32 v104, 16, v116
    v_and_b32 v105, 0xffff0000, v116
    v_lshlrev_b32 v106, 16, v117
    v_and_b32 v107, 0xffff0000, v117
    v_lshlrev_b32 v108, 16, v118
    v_and_b32 v109, 0xffff0000, v118
    v_lshlrev_b32 v110, 16, v119
    v_and_b32 v111, 0xffff0000, v119
    v_accvgpr_read_b32 v128, a8
    v_accvgpr_read_b32 v129, a9
    v_accvgpr_read_b32 v130, a10
    v_accvgpr_read_b32 v131, a11
    v_accvgpr_read_b32 v132, a12
    v_accvgpr_read_b32 v133, a13
    v_accvgpr_read_b32 v134, a14
    v_accvgpr_read_b32 v135, a15
    v_lshlrev_b32 v112, 16, v128
    v_and_b32 v113, 0xffff0000, v128
    v_lshlrev_b32 v114, 16, v129
    v_and_b32 v115, 0xffff0000, v129
    v_lshlrev_b32 v116, 16, v130
    v_and_b32 v117, 0xffff0000, v130
    v_lshlrev_b32 v118, 16, v131
    v_and_b32 v119, 0xffff0000, v131
    v_lshlrev_b32 v120, 16, v132
    v_and_b32 v121, 0xffff0000, v132
    v_lshlrev_b32 v122, 16, v133
    v_and_b32 v123, 0xffff0000, v133
    v_lshlrev_b32 v124, 16, v134
    v_and_b32 v125, 0xffff0000, v134
    v_lshlrev_b32 v126, 16, v135
    v_and_b32 v127, 0xffff0000, v135
    v_add_f32 v96, v96, v112
    v_add_f32 v97, v97, v113
    v_add_f32 v98, v98, v114
    v_add_f32 v99, v99, v115
    v_add_f32 v100, v100, v116
    v_add_f32 v101, v101, v117
    v_add_f32 v102, v102, v118
    v_add_f32 v103, v103, v119
    v_add_f32 v104, v104, v120
    v_add_f32 v105, v105, v121
    v_add_f32 v106, v106, v122
    v_add_f32 v107, v107, v123
    v_add_f32 v108, v108, v124
    v_add_f32 v109, v109, v125
    v_add_f32 v110, v110, v126
    v_add_f32 v111, v111, v127
    v_cvt_pk_bf16_f32 v48, v96, v97
    v_cvt_pk_bf16_f32 v49, v98, v99
    v_cvt_pk_bf16_f32 v50, v100, v101
    v_cvt_pk_bf16_f32 v51, v102, v103
    v_cvt_pk_bf16_f32 v52, v104, v105
    v_cvt_pk_bf16_f32 v53, v106, v107
    v_cvt_pk_bf16_f32 v54, v108, v109
    v_cvt_pk_bf16_f32 v55, v110, v111
    v_and_b32 v24, 1, v21
    v_lshrrev_b32 v25, 1, v21
    v_lshlrev_b32 v24, 5, v24
    v_lshl_add_u32 v24, v25, 4, v24
    v_lshlrev_b32 v25, 3, v21
    v_sub_u32 v24, v24, v25
    v_add_u32 v14, v14, v24
    v_permlane16_swap_b32 v48, v50
    v_permlane16_swap_b32 v49, v51
    s_nop 1
    buffer_store_dwordx4 v[48:51], v14, s[24:27], 0 offen offset:0 sc1
    v_permlane16_swap_b32 v52, v54
    v_permlane16_swap_b32 v53, v55
    s_nop 1
    buffer_store_dwordx4 v[52:55], v14, s[24:27], 0 offen offset:64 sc1
recurrent_scan__mha_block_cached__mixer_s_mlp__prompt_kernel_end:
    s_endpgm
recurrent_scan__mha_block_cached__mixer_s_mlp__prompt_kernel_slow:
    v_accvgpr_write_b32 a0, 0
    v_accvgpr_write_b32 a1, 0
    v_accvgpr_write_b32 a2, 0
    v_accvgpr_write_b32 a3, 0
    v_accvgpr_write_b32 a4, 0
    v_accvgpr_write_b32 a5, 0
    v_accvgpr_write_b32 a6, 0
    v_accvgpr_write_b32 a7, 0
    v_accvgpr_write_b32 a8, 0
    v_accvgpr_write_b32 a9, 0
    v_accvgpr_write_b32 a10, 0
    v_accvgpr_write_b32 a11, 0
    v_accvgpr_write_b32 a12, 0
    v_accvgpr_write_b32 a13, 0
    v_accvgpr_write_b32 a14, 0
    v_accvgpr_write_b32 a15, 0
    v_accvgpr_write_b32 a16, 0
    v_accvgpr_write_b32 a17, 0
    v_accvgpr_write_b32 a18, 0
    v_accvgpr_write_b32 a19, 0
    v_accvgpr_write_b32 a20, 0
    v_accvgpr_write_b32 a21, 0
    v_accvgpr_write_b32 a22, 0
    v_accvgpr_write_b32 a23, 0
    v_accvgpr_write_b32 a24, 0
    v_accvgpr_write_b32 a25, 0
    v_accvgpr_write_b32 a26, 0
    v_accvgpr_write_b32 a27, 0
    v_accvgpr_write_b32 a28, 0
    v_accvgpr_write_b32 a29, 0
    v_accvgpr_write_b32 a30, 0
    v_accvgpr_write_b32 a31, 0
    v_accvgpr_write_b32 a32, 0
    v_accvgpr_write_b32 a33, 0
    v_accvgpr_write_b32 a34, 0
    v_accvgpr_write_b32 a35, 0
    v_accvgpr_write_b32 a36, 0
    v_accvgpr_write_b32 a37, 0
    v_accvgpr_write_b32 a38, 0
    v_accvgpr_write_b32 a39, 0
    v_accvgpr_write_b32 a40, 0
    v_accvgpr_write_b32 a41, 0
    v_accvgpr_write_b32 a42, 0
    v_accvgpr_write_b32 a43, 0
    v_accvgpr_write_b32 a44, 0
    v_accvgpr_write_b32 a45, 0
    v_accvgpr_write_b32 a46, 0
    v_accvgpr_write_b32 a47, 0
    v_accvgpr_write_b32 a48, 0
    v_accvgpr_write_b32 a49, 0
    v_accvgpr_write_b32 a50, 0
    v_accvgpr_write_b32 a51, 0
    v_accvgpr_write_b32 a52, 0
    v_accvgpr_write_b32 a53, 0
    v_accvgpr_write_b32 a54, 0
    v_accvgpr_write_b32 a55, 0
    v_accvgpr_write_b32 a56, 0
    v_accvgpr_write_b32 a57, 0
    v_accvgpr_write_b32 a58, 0
    v_accvgpr_write_b32 a59, 0
    v_accvgpr_write_b32 a60, 0
    v_accvgpr_write_b32 a61, 0
    v_accvgpr_write_b32 a62, 0
    v_accvgpr_write_b32 a63, 0
    v_accvgpr_write_b32 a64, 0
    v_accvgpr_write_b32 a65, 0
    v_accvgpr_write_b32 a66, 0
    v_accvgpr_write_b32 a67, 0
    v_accvgpr_write_b32 a68, 0
    v_accvgpr_write_b32 a69, 0
    v_accvgpr_write_b32 a70, 0
    v_accvgpr_write_b32 a71, 0
    v_accvgpr_write_b32 a72, 0
    v_accvgpr_write_b32 a73, 0
    v_accvgpr_write_b32 a74, 0
    v_accvgpr_write_b32 a75, 0
    v_accvgpr_write_b32 a76, 0
    v_accvgpr_write_b32 a77, 0
    v_accvgpr_write_b32 a78, 0
    v_accvgpr_write_b32 a79, 0
    v_accvgpr_write_b32 a80, 0
    v_accvgpr_write_b32 a81, 0
    v_accvgpr_write_b32 a82, 0
    v_accvgpr_write_b32 a83, 0
    v_accvgpr_write_b32 a84, 0
    v_accvgpr_write_b32 a85, 0
    v_accvgpr_write_b32 a86, 0
    v_accvgpr_write_b32 a87, 0
    v_accvgpr_write_b32 a88, 0
    v_accvgpr_write_b32 a89, 0
    v_accvgpr_write_b32 a90, 0
    v_accvgpr_write_b32 a91, 0
    v_accvgpr_write_b32 a92, 0
    v_accvgpr_write_b32 a93, 0
    v_accvgpr_write_b32 a94, 0
    v_accvgpr_write_b32 a95, 0
    v_accvgpr_write_b32 a96, 0
    v_accvgpr_write_b32 a97, 0
    v_accvgpr_write_b32 a98, 0
    v_accvgpr_write_b32 a99, 0
    v_accvgpr_write_b32 a100, 0
    v_accvgpr_write_b32 a101, 0
    v_accvgpr_write_b32 a102, 0
    v_accvgpr_write_b32 a103, 0
    v_accvgpr_write_b32 a104, 0
    v_accvgpr_write_b32 a105, 0
    v_accvgpr_write_b32 a106, 0
    v_accvgpr_write_b32 a107, 0
    v_accvgpr_write_b32 a108, 0
    v_accvgpr_write_b32 a109, 0
    v_accvgpr_write_b32 a110, 0
    v_accvgpr_write_b32 a111, 0
    v_accvgpr_write_b32 a112, 0
    v_accvgpr_write_b32 a113, 0
    v_accvgpr_write_b32 a114, 0
    v_accvgpr_write_b32 a115, 0
    v_accvgpr_write_b32 a116, 0
    v_accvgpr_write_b32 a117, 0
    v_accvgpr_write_b32 a118, 0
    v_accvgpr_write_b32 a119, 0
    v_accvgpr_write_b32 a120, 0
    v_accvgpr_write_b32 a121, 0
    v_accvgpr_write_b32 a122, 0
    v_accvgpr_write_b32 a123, 0
    v_accvgpr_write_b32 a124, 0
    v_accvgpr_write_b32 a125, 0
    v_accvgpr_write_b32 a126, 0
    v_accvgpr_write_b32 a127, 0
    v_mov_b32 v144, 0
    v_mov_b32 v145, 0
    v_mov_b32 v146, 0
    v_mov_b32 v147, 0
    v_mov_b32 v148, 0
    v_mov_b32 v149, 0
    v_mov_b32 v150, 0
    v_mov_b32 v151, 0
    v_mov_b32 v152, 0
    v_mov_b32 v153, 0
    v_mov_b32 v154, 0
    v_mov_b32 v155, 0
    v_mov_b32 v156, 0
    v_mov_b32 v157, 0
    v_mov_b32 v158, 0
    v_mov_b32 v159, 0
    v_mov_b32 v128, 0xff7fffff
    v_mov_b32 v129, 0xff7fffff
    v_mov_b32 v130, 0xff7fffff
    v_mov_b32 v131, 0xff7fffff
    s_mov_b32 s28, 0
recurrent_scan__mha_block_cached__mixer_s_mlp__prompt_kernel_slowloop:
    s_barrier
    s_mov_b32 m0, s30
    s_nop 0
    buffer_load_dwordx4 v16, s[8:11], s28 offen offset:0 lds
    buffer_load_dwordx4 v16, s[8:11], s28 offen offset:1024 lds
    s_mov_b32 m0, s31
    s_nop 0
    buffer_load_dwordx4 v17, s[12:15], s28 offen offset:0 lds
    buffer_load_dwordx4 v17, s[12:15], s28 offen offset:1024 lds
    s_waitcnt vmcnt(0)
    s_barrier
    ds_read_b128 a[192:195], v4 offset:0
    ds_read_b128 a[196:199], v5 offset:0
    ds_read_b128 a[200:203], v6 offset:0
    ds_read_b128 a[204:207], v7 offset:0
    ds_read_b128 a[208:211], v4 offset:1024
    ds_read_b128 a[212:215], v5 offset:1024
    ds_read_b128 a[216:219], v6 offset:1024
    ds_read_b128 a[220:223], v7 offset:1024
    s_waitcnt lgkmcnt(7)
    v_mfma_f32_16x16x32_bf16 v[32:35], a[192:195], v[164:167], 0
    v_mfma_f32_16x16x32_bf16 v[36:39], a[192:195], v[180:183], 0
    v_mfma_f32_16x16x32_bf16 v[40:43], a[192:195], v[196:199], 0
    v_mfma_f32_16x16x32_bf16 v[44:47], a[192:195], v[212:215], 0
    s_waitcnt lgkmcnt(6)
    v_mfma_f32_16x16x32_bf16 v[32:35], a[196:199], v[168:171], v[32:35]
    v_mfma_f32_16x16x32_bf16 v[36:39], a[196:199], v[184:187], v[36:39]
    v_mfma_f32_16x16x32_bf16 v[40:43], a[196:199], v[200:203], v[40:43]
    v_mfma_f32_16x16x32_bf16 v[44:47], a[196:199], v[216:219], v[44:47]
    s_waitcnt lgkmcnt(5)
    v_mfma_f32_16x16x32_bf16 v[32:35], a[200:203], v[172:175], v[32:35]
    v_mfma_f32_16x16x32_bf16 v[36:39], a[200:203], v[188:191], v[36:39]
    v_mfma_f32_16x16x32_bf16 v[40:43], a[200:203], v[204:207], v[40:43]
    v_mfma_f32_16x16x32_bf16 v[44:47], a[200:203], v[220:223], v[44:47]
    s_waitcnt lgkmcnt(4)
    v_mfma_f32_16x16x32_bf16 v[32:35], a[204:207], v[176:179], v[32:35]
    v_mfma_f32_16x16x32_bf16 v[36:39], a[204:207], v[192:195], v[36:39]
    v_mfma_f32_16x16x32_bf16 v[40:43], a[204:207], v[208:211], v[40:43]
    v_mfma_f32_16x16x32_bf16 v[44:47], a[204:207], v[224:227], v[44:47]
    s_waitcnt lgkmcnt(3)
    v_mfma_f32_16x16x32_bf16 v[48:51], a[208:211], v[164:167], 0
    v_mfma_f32_16x16x32_bf16 v[52:55], a[208:211], v[180:183], 0
    v_mfma_f32_16x16x32_bf16 v[56:59], a[208:211], v[196:199], 0
    v_mfma_f32_16x16x32_bf16 v[60:63], a[208:211], v[212:215], 0
    s_waitcnt lgkmcnt(2)
    v_mfma_f32_16x16x32_bf16 v[48:51], a[212:215], v[168:171], v[48:51]
    v_mfma_f32_16x16x32_bf16 v[52:55], a[212:215], v[184:187], v[52:55]
    v_mfma_f32_16x16x32_bf16 v[56:59], a[212:215], v[200:203], v[56:59]
    v_mfma_f32_16x16x32_bf16 v[60:63], a[212:215], v[216:219], v[60:63]
    s_waitcnt lgkmcnt(1)
    v_mfma_f32_16x16x32_bf16 v[48:51], a[216:219], v[172:175], v[48:51]
    v_mfma_f32_16x16x32_bf16 v[52:55], a[216:219], v[188:191], v[52:55]
    v_mfma_f32_16x16x32_bf16 v[56:59], a[216:219], v[204:207], v[56:59]
    v_mfma_f32_16x16x32_bf16 v[60:63], a[216:219], v[220:223], v[60:63]
    s_waitcnt lgkmcnt(0)
    v_mfma_f32_16x16x32_bf16 v[48:51], a[220:223], v[176:179], v[48:51]
    v_mfma_f32_16x16x32_bf16 v[52:55], a[220:223], v[192:195], v[52:55]
    v_mfma_f32_16x16x32_bf16 v[56:59], a[220:223], v[208:211], v[56:59]
    v_mfma_f32_16x16x32_bf16 v[60:63], a[220:223], v[224:227], v[60:63]
    ds_read_b64_tr_b16 a[224:225], v8 offset:0
    ds_read_b64_tr_b16 a[226:227], v8 offset:1024
    ds_read_b64_tr_b16 a[228:229], v9 offset:0
    ds_read_b64_tr_b16 a[230:231], v9 offset:1024
    ds_read_b64_tr_b16 a[232:233], v10 offset:0
    ds_read_b64_tr_b16 a[234:235], v10 offset:1024
    ds_read_b64_tr_b16 a[236:237], v11 offset:0
    ds_read_b64_tr_b16 a[238:239], v11 offset:1024
    ds_read_b64_tr_b16 a[240:241], v12 offset:0
    ds_read_b64_tr_b16 a[242:243], v12 offset:1024
    ds_read_b64_tr_b16 a[244:245], v13 offset:0
    ds_read_b64_tr_b16 a[246:247], v13 offset:1024
    ds_read_b64_tr_b16 a[248:249], v14 offset:0
    ds_read_b64_tr_b16 a[250:251], v14 offset:1024
    ds_read_b64_tr_b16 a[252:253], v15 offset:0
    ds_read_b64_tr_b16 a[254:255], v15 offset:1024
    s_nop 7
    v_max3_f32 v228, v32, v33, v34
    v_max3_f32 v228, v228, v35, v48
    v_max3_f32 v228, v228, v49, v50
    v_max_f32 v228, v228, v51
    v_mov_b32 v232, v228
    s_nop 1
    v_permlane16_swap_b32 v228, v232
    v_max_f32 v228, v228, v232
    v_mov_b32 v232, v228
    s_nop 1
    v_permlane32_swap_b32 v228, v232
    v_max_f32 v228, v228, v232
    v_max_f32 v228, v228, v128
    v_sub_f32 v229, v128, v228
    v_exp_f32 v229, v229
    v_mov_b32 v128, v228
    v_sub_f32 v32, v32, v228
    v_exp_f32 v32, v32
    v_sub_f32 v33, v33, v228
    v_exp_f32 v33, v33
    v_sub_f32 v34, v34, v228
    v_exp_f32 v34, v34
    v_sub_f32 v35, v35, v228
    v_exp_f32 v35, v35
    v_sub_f32 v48, v48, v228
    v_exp_f32 v48, v48
    v_sub_f32 v49, v49, v228
    v_exp_f32 v49, v49
    v_sub_f32 v50, v50, v228
    v_exp_f32 v50, v50
    v_sub_f32 v51, v51, v228
    v_exp_f32 v51, v51
    v_cvt_pk_bf16_f32 v96, v32, v33
    v_cvt_pk_bf16_f32 v97, v34, v35
    v_cvt_pk_bf16_f32 v98, v48, v49
    v_cvt_pk_bf16_f32 v99, v50, v51
    v_mul_f32 v144, v229, v144
    v_mul_f32 v145, v229, v145
    v_mul_f32 v146, v229, v146
    v_mul_f32 v147, v229, v147
    v_accvgpr_read_b32 v240, a0
    v_accvgpr_read_b32 v241, a1
    v_accvgpr_read_b32 v242, a2
    v_accvgpr_read_b32 v243, a3
    v_mul_f32 v240, v229, v240
    v_mul_f32 v241, v229, v241
    v_mul_f32 v242, v229, v242
    v_mul_f32 v243, v229, v243
    v_accvgpr_write_b32 a0, v240
    v_accvgpr_write_b32 a1, v241
    v_accvgpr_write_b32 a2, v242
    v_accvgpr_write_b32 a3, v243
    v_accvgpr_read_b32 v240, a16
    v_accvgpr_read_b32 v241, a17
    v_accvgpr_read_b32 v242, a18
    v_accvgpr_read_b32 v243, a19
    v_mul_f32 v240, v229, v240
    v_mul_f32 v241, v229, v241
    v_mul_f32 v242, v229, v242
    v_mul_f32 v243, v229, v243
    v_accvgpr_write_b32 a16, v240
    v_accvgpr_write_b32 a17, v241
    v_accvgpr_write_b32 a18, v242
    v_accvgpr_write_b32 a19, v243
    v_accvgpr_read_b32 v240, a32
    v_accvgpr_read_b32 v241, a33
    v_accvgpr_read_b32 v242, a34
    v_accvgpr_read_b32 v243, a35
    v_mul_f32 v240, v229, v240
    v_mul_f32 v241, v229, v241
    v_mul_f32 v242, v229, v242
    v_mul_f32 v243, v229, v243
    v_accvgpr_write_b32 a32, v240
    v_accvgpr_write_b32 a33, v241
    v_accvgpr_write_b32 a34, v242
    v_accvgpr_write_b32 a35, v243
    v_accvgpr_read_b32 v240, a48
    v_accvgpr_read_b32 v241, a49
    v_accvgpr_read_b32 v242, a50
    v_accvgpr_read_b32 v243, a51
    v_mul_f32 v240, v229, v240
    v_mul_f32 v241, v229, v241
    v_mul_f32 v242, v229, v242
    v_mul_f32 v243, v229, v243
    v_accvgpr_write_b32 a48, v240
    v_accvgpr_write_b32 a49, v241
    v_accvgpr_write_b32 a50, v242
    v_accvgpr_write_b32 a51, v243
    v_accvgpr_read_b32 v240, a64
    v_accvgpr_read_b32 v241, a65
    v_accvgpr_read_b32 v242, a66
    v_accvgpr_read_b32 v243, a67
    v_mul_f32 v240, v229, v240
    v_mul_f32 v241, v229, v241
    v_mul_f32 v242, v229, v242
    v_mul_f32 v243, v229, v243
    v_accvgpr_write_b32 a64, v240
    v_accvgpr_write_b32 a65, v241
    v_accvgpr_write_b32 a66, v242
    v_accvgpr_write_b32 a67, v243
    v_accvgpr_read_b32 v240, a80
    v_accvgpr_read_b32 v241, a81
    v_accvgpr_read_b32 v242, a82
    v_accvgpr_read_b32 v243, a83
    v_mul_f32 v240, v229, v240
    v_mul_f32 v241, v229, v241
    v_mul_f32 v242, v229, v242
    v_mul_f32 v243, v229, v243
    v_accvgpr_write_b32 a80, v240
    v_accvgpr_write_b32 a81, v241
    v_accvgpr_write_b32 a82, v242
    v_accvgpr_write_b32 a83, v243
    v_accvgpr_read_b32 v240, a96
    v_accvgpr_read_b32 v241, a97
    v_accvgpr_read_b32 v242, a98
    v_accvgpr_read_b32 v243, a99
    v_mul_f32 v240, v229, v240
    v_mul_f32 v241, v229, v241
    v_mul_f32 v242, v229, v242
    v_mul_f32 v243, v229, v243
    v_accvgpr_write_b32 a96, v240
    v_accvgpr_write_b32 a97, v241
    v_accvgpr_write_b32 a98, v242
    v_accvgpr_write_b32 a99, v243
    v_accvgpr_read_b32 v240, a112
    v_accvgpr_read_b32 v241, a113
    v_accvgpr_read_b32 v242, a114
    v_accvgpr_read_b32 v243, a115
    v_mul_f32 v240, v229, v240
    v_mul_f32 v241, v229, v241
    v_mul_f32 v242, v229, v242
    v_mul_f32 v243, v229, v243
    v_accvgpr_write_b32 a112, v240
    v_accvgpr_write_b32 a113, v241
    v_accvgpr_write_b32 a114, v242
    v_accvgpr_write_b32 a115, v243
    v_max3_f32 v228, v36, v37, v38
    v_max3_f32 v228, v228, v39, v52
    v_max3_f32 v228, v228, v53, v54
    v_max_f32 v228, v228, v55
    v_mov_b32 v232, v228
    s_nop 1
    v_permlane16_swap_b32 v228, v232
    v_max_f32 v228, v228, v232
    v_mov_b32 v232, v228
    s_nop 1
    v_permlane32_swap_b32 v228, v232
    v_max_f32 v228, v228, v232
    v_max_f32 v228, v228, v129
    v_sub_f32 v229, v129, v228
    v_exp_f32 v229, v229
    v_mov_b32 v129, v228
    v_sub_f32 v36, v36, v228
    v_exp_f32 v36, v36
    v_sub_f32 v37, v37, v228
    v_exp_f32 v37, v37
    v_sub_f32 v38, v38, v228
    v_exp_f32 v38, v38
    v_sub_f32 v39, v39, v228
    v_exp_f32 v39, v39
    v_sub_f32 v52, v52, v228
    v_exp_f32 v52, v52
    v_sub_f32 v53, v53, v228
    v_exp_f32 v53, v53
    v_sub_f32 v54, v54, v228
    v_exp_f32 v54, v54
    v_sub_f32 v55, v55, v228
    v_exp_f32 v55, v55
    v_cvt_pk_bf16_f32 v100, v36, v37
    v_cvt_pk_bf16_f32 v101, v38, v39
    v_cvt_pk_bf16_f32 v102, v52, v53
    v_cvt_pk_bf16_f32 v103, v54, v55
    v_mul_f32 v148, v229, v148
    v_mul_f32 v149, v229, v149
    v_mul_f32 v150, v229, v150
    v_mul_f32 v151, v229, v151
    v_accvgpr_read_b32 v240, a4
    v_accvgpr_read_b32 v241, a5
    v_accvgpr_read_b32 v242, a6
    v_accvgpr_read_b32 v243, a7
    v_mul_f32 v240, v229, v240
    v_mul_f32 v241, v229, v241
    v_mul_f32 v242, v229, v242
    v_mul_f32 v243, v229, v243
    v_accvgpr_write_b32 a4, v240
    v_accvgpr_write_b32 a5, v241
    v_accvgpr_write_b32 a6, v242
    v_accvgpr_write_b32 a7, v243
    v_accvgpr_read_b32 v240, a20
    v_accvgpr_read_b32 v241, a21
    v_accvgpr_read_b32 v242, a22
    v_accvgpr_read_b32 v243, a23
    v_mul_f32 v240, v229, v240
    v_mul_f32 v241, v229, v241
    v_mul_f32 v242, v229, v242
    v_mul_f32 v243, v229, v243
    v_accvgpr_write_b32 a20, v240
    v_accvgpr_write_b32 a21, v241
    v_accvgpr_write_b32 a22, v242
    v_accvgpr_write_b32 a23, v243
    v_accvgpr_read_b32 v240, a36
    v_accvgpr_read_b32 v241, a37
    v_accvgpr_read_b32 v242, a38
    v_accvgpr_read_b32 v243, a39
    v_mul_f32 v240, v229, v240
    v_mul_f32 v241, v229, v241
    v_mul_f32 v242, v229, v242
    v_mul_f32 v243, v229, v243
    v_accvgpr_write_b32 a36, v240
    v_accvgpr_write_b32 a37, v241
    v_accvgpr_write_b32 a38, v242
    v_accvgpr_write_b32 a39, v243
    v_accvgpr_read_b32 v240, a52
    v_accvgpr_read_b32 v241, a53
    v_accvgpr_read_b32 v242, a54
    v_accvgpr_read_b32 v243, a55
    v_mul_f32 v240, v229, v240
    v_mul_f32 v241, v229, v241
    v_mul_f32 v242, v229, v242
    v_mul_f32 v243, v229, v243
    v_accvgpr_write_b32 a52, v240
    v_accvgpr_write_b32 a53, v241
    v_accvgpr_write_b32 a54, v242
    v_accvgpr_write_b32 a55, v243
    v_accvgpr_read_b32 v240, a68
    v_accvgpr_read_b32 v241, a69
    v_accvgpr_read_b32 v242, a70
    v_accvgpr_read_b32 v243, a71
    v_mul_f32 v240, v229, v240
    v_mul_f32 v241, v229, v241
    v_mul_f32 v242, v229, v242
    v_mul_f32 v243, v229, v243
    v_accvgpr_write_b32 a68, v240
    v_accvgpr_write_b32 a69, v241
    v_accvgpr_write_b32 a70, v242
    v_accvgpr_write_b32 a71, v243
    v_accvgpr_read_b32 v240, a84
    v_accvgpr_read_b32 v241, a85
    v_accvgpr_read_b32 v242, a86
    v_accvgpr_read_b32 v243, a87
    v_mul_f32 v240, v229, v240
    v_mul_f32 v241, v229, v241
    v_mul_f32 v242, v229, v242
    v_mul_f32 v243, v229, v243
    v_accvgpr_write_b32 a84, v240
    v_accvgpr_write_b32 a85, v241
    v_accvgpr_write_b32 a86, v242
    v_accvgpr_write_b32 a87, v243
    v_accvgpr_read_b32 v240, a100
    v_accvgpr_read_b32 v241, a101
    v_accvgpr_read_b32 v242, a102
    v_accvgpr_read_b32 v243, a103
    v_mul_f32 v240, v229, v240
    v_mul_f32 v241, v229, v241
    v_mul_f32 v242, v229, v242
    v_mul_f32 v243, v229, v243
    v_accvgpr_write_b32 a100, v240
    v_accvgpr_write_b32 a101, v241
    v_accvgpr_write_b32 a102, v242
    v_accvgpr_write_b32 a103, v243
    v_accvgpr_read_b32 v240, a116
    v_accvgpr_read_b32 v241, a117
    v_accvgpr_read_b32 v242, a118
    v_accvgpr_read_b32 v243, a119
    v_mul_f32 v240, v229, v240
    v_mul_f32 v241, v229, v241
    v_mul_f32 v242, v229, v242
    v_mul_f32 v243, v229, v243
    v_accvgpr_write_b32 a116, v240
    v_accvgpr_write_b32 a117, v241
    v_accvgpr_write_b32 a118, v242
    v_accvgpr_write_b32 a119, v243
    v_max3_f32 v228, v40, v41, v42
    v_max3_f32 v228, v228, v43, v56
    v_max3_f32 v228, v228, v57, v58
    v_max_f32 v228, v228, v59
    v_mov_b32 v232, v228
    s_nop 1
    v_permlane16_swap_b32 v228, v232
    v_max_f32 v228, v228, v232
    v_mov_b32 v232, v228
    s_nop 1
    v_permlane32_swap_b32 v228, v232
    v_max_f32 v228, v228, v232
    v_max_f32 v228, v228, v130
    v_sub_f32 v229, v130, v228
    v_exp_f32 v229, v229
    v_mov_b32 v130, v228
    v_sub_f32 v40, v40, v228
    v_exp_f32 v40, v40
    v_sub_f32 v41, v41, v228
    v_exp_f32 v41, v41
    v_sub_f32 v42, v42, v228
    v_exp_f32 v42, v42
    v_sub_f32 v43, v43, v228
    v_exp_f32 v43, v43
    v_sub_f32 v56, v56, v228
    v_exp_f32 v56, v56
    v_sub_f32 v57, v57, v228
    v_exp_f32 v57, v57
    v_sub_f32 v58, v58, v228
    v_exp_f32 v58, v58
    v_sub_f32 v59, v59, v228
    v_exp_f32 v59, v59
    v_cvt_pk_bf16_f32 v104, v40, v41
    v_cvt_pk_bf16_f32 v105, v42, v43
    v_cvt_pk_bf16_f32 v106, v56, v57
    v_cvt_pk_bf16_f32 v107, v58, v59
    v_mul_f32 v152, v229, v152
    v_mul_f32 v153, v229, v153
    v_mul_f32 v154, v229, v154
    v_mul_f32 v155, v229, v155
    v_accvgpr_read_b32 v240, a8
    v_accvgpr_read_b32 v241, a9
    v_accvgpr_read_b32 v242, a10
    v_accvgpr_read_b32 v243, a11
    v_mul_f32 v240, v229, v240
    v_mul_f32 v241, v229, v241
    v_mul_f32 v242, v229, v242
    v_mul_f32 v243, v229, v243
    v_accvgpr_write_b32 a8, v240
    v_accvgpr_write_b32 a9, v241
    v_accvgpr_write_b32 a10, v242
    v_accvgpr_write_b32 a11, v243
    v_accvgpr_read_b32 v240, a24
    v_accvgpr_read_b32 v241, a25
    v_accvgpr_read_b32 v242, a26
    v_accvgpr_read_b32 v243, a27
    v_mul_f32 v240, v229, v240
    v_mul_f32 v241, v229, v241
    v_mul_f32 v242, v229, v242
    v_mul_f32 v243, v229, v243
    v_accvgpr_write_b32 a24, v240
    v_accvgpr_write_b32 a25, v241
    v_accvgpr_write_b32 a26, v242
    v_accvgpr_write_b32 a27, v243
    v_accvgpr_read_b32 v240, a40
    v_accvgpr_read_b32 v241, a41
    v_accvgpr_read_b32 v242, a42
    v_accvgpr_read_b32 v243, a43
    v_mul_f32 v240, v229, v240
    v_mul_f32 v241, v229, v241
    v_mul_f32 v242, v229, v242
    v_mul_f32 v243, v229, v243
    v_accvgpr_write_b32 a40, v240
    v_accvgpr_write_b32 a41, v241
    v_accvgpr_write_b32 a42, v242
    v_accvgpr_write_b32 a43, v243
    v_accvgpr_read_b32 v240, a56
    v_accvgpr_read_b32 v241, a57
    v_accvgpr_read_b32 v242, a58
    v_accvgpr_read_b32 v243, a59
    v_mul_f32 v240, v229, v240
    v_mul_f32 v241, v229, v241
    v_mul_f32 v242, v229, v242
    v_mul_f32 v243, v229, v243
    v_accvgpr_write_b32 a56, v240
    v_accvgpr_write_b32 a57, v241
    v_accvgpr_write_b32 a58, v242
    v_accvgpr_write_b32 a59, v243
    v_accvgpr_read_b32 v240, a72
    v_accvgpr_read_b32 v241, a73
    v_accvgpr_read_b32 v242, a74
    v_accvgpr_read_b32 v243, a75
    v_mul_f32 v240, v229, v240
    v_mul_f32 v241, v229, v241
    v_mul_f32 v242, v229, v242
    v_mul_f32 v243, v229, v243
    v_accvgpr_write_b32 a72, v240
    v_accvgpr_write_b32 a73, v241
    v_accvgpr_write_b32 a74, v242
    v_accvgpr_write_b32 a75, v243
    v_accvgpr_read_b32 v240, a88
    v_accvgpr_read_b32 v241, a89
    v_accvgpr_read_b32 v242, a90
    v_accvgpr_read_b32 v243, a91
    v_mul_f32 v240, v229, v240
    v_mul_f32 v241, v229, v241
    v_mul_f32 v242, v229, v242
    v_mul_f32 v243, v229, v243
    v_accvgpr_write_b32 a88, v240
    v_accvgpr_write_b32 a89, v241
    v_accvgpr_write_b32 a90, v242
    v_accvgpr_write_b32 a91, v243
    v_accvgpr_read_b32 v240, a104
    v_accvgpr_read_b32 v241, a105
    v_accvgpr_read_b32 v242, a106
    v_accvgpr_read_b32 v243, a107
    v_mul_f32 v240, v229, v240
    v_mul_f32 v241, v229, v241
    v_mul_f32 v242, v229, v242
    v_mul_f32 v243, v229, v243
    v_accvgpr_write_b32 a104, v240
    v_accvgpr_write_b32 a105, v241
    v_accvgpr_write_b32 a106, v242
    v_accvgpr_write_b32 a107, v243
    v_accvgpr_read_b32 v240, a120
    v_accvgpr_read_b32 v241, a121
    v_accvgpr_read_b32 v242, a122
    v_accvgpr_read_b32 v243, a123
    v_mul_f32 v240, v229, v240
    v_mul_f32 v241, v229, v241
    v_mul_f32 v242, v229, v242
    v_mul_f32 v243, v229, v243
    v_accvgpr_write_b32 a120, v240
    v_accvgpr_write_b32 a121, v241
    v_accvgpr_write_b32 a122, v242
    v_accvgpr_write_b32 a123, v243
    v_max3_f32 v228, v44, v45, v46
    v_max3_f32 v228, v228, v47, v60
    v_max3_f32 v228, v228, v61, v62
    v_max_f32 v228, v228, v63
    v_mov_b32 v232, v228
    s_nop 1
    v_permlane16_swap_b32 v228, v232
    v_max_f32 v228, v228, v232
    v_mov_b32 v232, v228
    s_nop 1
    v_permlane32_swap_b32 v228, v232
    v_max_f32 v228, v228, v232
    v_max_f32 v228, v228, v131
    v_sub_f32 v229, v131, v228
    v_exp_f32 v229, v229
    v_mov_b32 v131, v228
    v_sub_f32 v44, v44, v228
    v_exp_f32 v44, v44
    v_sub_f32 v45, v45, v228
    v_exp_f32 v45, v45
    v_sub_f32 v46, v46, v228
    v_exp_f32 v46, v46
    v_sub_f32 v47, v47, v228
    v_exp_f32 v47, v47
    v_sub_f32 v60, v60, v228
    v_exp_f32 v60, v60
    v_sub_f32 v61, v61, v228
    v_exp_f32 v61, v61
    v_sub_f32 v62, v62, v228
    v_exp_f32 v62, v62
    v_sub_f32 v63, v63, v228
    v_exp_f32 v63, v63
    v_cvt_pk_bf16_f32 v108, v44, v45
    v_cvt_pk_bf16_f32 v109, v46, v47
    v_cvt_pk_bf16_f32 v110, v60, v61
    v_cvt_pk_bf16_f32 v111, v62, v63
    v_mul_f32 v156, v229, v156
    v_mul_f32 v157, v229, v157
    v_mul_f32 v158, v229, v158
    v_mul_f32 v159, v229, v159
    v_accvgpr_read_b32 v240, a12
    v_accvgpr_read_b32 v241, a13
    v_accvgpr_read_b32 v242, a14
    v_accvgpr_read_b32 v243, a15
    v_mul_f32 v240, v229, v240
    v_mul_f32 v241, v229, v241
    v_mul_f32 v242, v229, v242
    v_mul_f32 v243, v229, v243
    v_accvgpr_write_b32 a12, v240
    v_accvgpr_write_b32 a13, v241
    v_accvgpr_write_b32 a14, v242
    v_accvgpr_write_b32 a15, v243
    v_accvgpr_read_b32 v240, a28
    v_accvgpr_read_b32 v241, a29
    v_accvgpr_read_b32 v242, a30
    v_accvgpr_read_b32 v243, a31
    v_mul_f32 v240, v229, v240
    v_mul_f32 v241, v229, v241
    v_mul_f32 v242, v229, v242
    v_mul_f32 v243, v229, v243
    v_accvgpr_write_b32 a28, v240
    v_accvgpr_write_b32 a29, v241
    v_accvgpr_write_b32 a30, v242
    v_accvgpr_write_b32 a31, v243
    v_accvgpr_read_b32 v240, a44
    v_accvgpr_read_b32 v241, a45
    v_accvgpr_read_b32 v242, a46
    v_accvgpr_read_b32 v243, a47
    v_mul_f32 v240, v229, v240
    v_mul_f32 v241, v229, v241
    v_mul_f32 v242, v229, v242
    v_mul_f32 v243, v229, v243
    v_accvgpr_write_b32 a44, v240
    v_accvgpr_write_b32 a45, v241
    v_accvgpr_write_b32 a46, v242
    v_accvgpr_write_b32 a47, v243
    v_accvgpr_read_b32 v240, a60
    v_accvgpr_read_b32 v241, a61
    v_accvgpr_read_b32 v242, a62
    v_accvgpr_read_b32 v243, a63
    v_mul_f32 v240, v229, v240
    v_mul_f32 v241, v229, v241
    v_mul_f32 v242, v229, v242
    v_mul_f32 v243, v229, v243
    v_accvgpr_write_b32 a60, v240
    v_accvgpr_write_b32 a61, v241
    v_accvgpr_write_b32 a62, v242
    v_accvgpr_write_b32 a63, v243
    v_accvgpr_read_b32 v240, a76
    v_accvgpr_read_b32 v241, a77
    v_accvgpr_read_b32 v242, a78
    v_accvgpr_read_b32 v243, a79
    v_mul_f32 v240, v229, v240
    v_mul_f32 v241, v229, v241
    v_mul_f32 v242, v229, v242
    v_mul_f32 v243, v229, v243
    v_accvgpr_write_b32 a76, v240
    v_accvgpr_write_b32 a77, v241
    v_accvgpr_write_b32 a78, v242
    v_accvgpr_write_b32 a79, v243
    v_accvgpr_read_b32 v240, a92
    v_accvgpr_read_b32 v241, a93
    v_accvgpr_read_b32 v242, a94
    v_accvgpr_read_b32 v243, a95
    v_mul_f32 v240, v229, v240
    v_mul_f32 v241, v229, v241
    v_mul_f32 v242, v229, v242
    v_mul_f32 v243, v229, v243
    v_accvgpr_write_b32 a92, v240
    v_accvgpr_write_b32 a93, v241
    v_accvgpr_write_b32 a94, v242
    v_accvgpr_write_b32 a95, v243
    v_accvgpr_read_b32 v240, a108
    v_accvgpr_read_b32 v241, a109
    v_accvgpr_read_b32 v242, a110
    v_accvgpr_read_b32 v243, a111
    v_mul_f32 v240, v229, v240
    v_mul_f32 v241, v229, v241
    v_mul_f32 v242, v229, v242
    v_mul_f32 v243, v229, v243
    v_accvgpr_write_b32 a108, v240
    v_accvgpr_write_b32 a109, v241
    v_accvgpr_write_b32 a110, v242
    v_accvgpr_write_b32 a111, v243
    v_accvgpr_read_b32 v240, a124
    v_accvgpr_read_b32 v241, a125
    v_accvgpr_read_b32 v242, a126
    v_accvgpr_read_b32 v243, a127
    v_mul_f32 v240, v229, v240
    v_mul_f32 v241, v229, v241
    v_mul_f32 v242, v229, v242
    v_mul_f32 v243, v229, v243
    v_accvgpr_write_b32 a124, v240
    v_accvgpr_write_b32 a125, v241
    v_accvgpr_write_b32 a126, v242
    v_accvgpr_write_b32 a127, v243
    s_waitcnt lgkmcnt(0)
    s_nop 3
    v_mfma_f32_16x16x32_bf16 a[0:3], a[224:227], v[96:99], a[0:3]
    v_mfma_f32_16x16x32_bf16 a[4:7], a[224:227], v[100:103], a[4:7]
    v_mfma_f32_16x16x32_bf16 a[8:11], a[224:227], v[104:107], a[8:11]
    v_mfma_f32_16x16x32_bf16 a[12:15], a[224:227], v[108:111], a[12:15]
    v_mfma_f32_16x16x32_bf16 a[16:19], a[228:231], v[96:99], a[16:19]
    v_mfma_f32_16x16x32_bf16 a[20:23], a[228:231], v[100:103], a[20:23]
    v_mfma_f32_16x16x32_bf16 a[24:27], a[228:231], v[104:107], a[24:27]
    v_mfma_f32_16x16x32_bf16 a[28:31], a[228:231], v[108:111], a[28:31]
    v_mfma_f32_16x16x32_bf16 a[32:35], a[232:235], v[96:99], a[32:35]
    v_mfma_f32_16x16x32_bf16 a[36:39], a[232:235], v[100:103], a[36:39]
    v_mfma_f32_16x16x32_bf16 a[40:43], a[232:235], v[104:107], a[40:43]
    v_mfma_f32_16x16x32_bf16 a[44:47], a[232:235], v[108:111], a[44:47]
    v_mfma_f32_16x16x32_bf16 a[48:51], a[236:239], v[96:99], a[48:51]
    v_mfma_f32_16x16x32_bf16 a[52:55], a[236:239], v[100:103], a[52:55]
    v_mfma_f32_16x16x32_bf16 a[56:59], a[236:239], v[104:107], a[56:59]
    v_mfma_f32_16x16x32_bf16 a[60:63], a[236:239], v[108:111], a[60:63]
    v_mfma_f32_16x16x32_bf16 a[64:67], a[240:243], v[96:99], a[64:67]
    v_mfma_f32_16x16x32_bf16 a[68:71], a[240:243], v[100:103], a[68:71]
    v_mfma_f32_16x16x32_bf16 a[72:75], a[240:243], v[104:107], a[72:75]
    v_mfma_f32_16x16x32_bf16 a[76:79], a[240:243], v[108:111], a[76:79]
    v_mfma_f32_16x16x32_bf16 a[80:83], a[244:247], v[96:99], a[80:83]
    v_mfma_f32_16x16x32_bf16 a[84:87], a[244:247], v[100:103], a[84:87]
    v_mfma_f32_16x16x32_bf16 a[88:91], a[244:247], v[104:107], a[88:91]
    v_mfma_f32_16x16x32_bf16 a[92:95], a[244:247], v[108:111], a[92:95]
    v_mfma_f32_16x16x32_bf16 a[96:99], a[248:251], v[96:99], a[96:99]
    v_mfma_f32_16x16x32_bf16 a[100:103], a[248:251], v[100:103], a[100:103]
    v_mfma_f32_16x16x32_bf16 a[104:107], a[248:251], v[104:107], a[104:107]
    v_mfma_f32_16x16x32_bf16 a[108:111], a[248:251], v[108:111], a[108:111]
    v_mfma_f32_16x16x32_bf16 a[112:115], a[252:255], v[96:99], a[112:115]
    v_mfma_f32_16x16x32_bf16 a[116:119], a[252:255], v[100:103], a[116:119]
    v_mfma_f32_16x16x32_bf16 a[120:123], a[252:255], v[104:107], a[120:123]
    v_mfma_f32_16x16x32_bf16 a[124:127], a[252:255], v[108:111], a[124:127]
    v_mfma_f32_16x16x32_bf16 v[144:147], v[160:163], v[96:99], v[144:147]
    v_mfma_f32_16x16x32_bf16 v[148:151], v[160:163], v[100:103], v[148:151]
    v_mfma_f32_16x16x32_bf16 v[152:155], v[160:163], v[104:107], v[152:155]
    v_mfma_f32_16x16x32_bf16 v[156:159], v[160:163], v[108:111], v[156:159]
    s_add_u32 s28, s28, 8192
    s_cmp_lt_u32 s28, 524288
    s_cbranch_scc1 recurrent_scan__mha_block_cached__mixer_s_mlp__prompt_kernel_slowloop
    s_nop 7
    s_barrier
    s_add_u32 m0, s63, 0
    s_mov_b32 s41, 0
    buffer_load_dwordx4 v236, s[16:19], s41 offen lds
    s_add_u32 m0, s63, 1024
    s_mov_b32 s41, 0
    buffer_load_dwordx4 v237, s[16:19], s41 offen lds
    s_add_u32 m0, s63, 8192
    s_mov_b32 s41, 114688
    buffer_load_dwordx4 v236, s[16:19], s41 offen lds
    s_add_u32 m0, s63, 9216
    s_mov_b32 s41, 114688
    buffer_load_dwordx4 v237, s[16:19], s41 offen lds
    s_add_u32 m0, s63, 16384
    s_mov_b32 s41, 229376
    buffer_load_dwordx4 v236, s[16:19], s41 offen lds
    s_add_u32 m0, s63, 17408
    s_mov_b32 s41, 229376
    buffer_load_dwordx4 v237, s[16:19], s41 offen lds
    s_add_u32 m0, s63, 24576
    s_mov_b32 s41, 344064
    buffer_load_dwordx4 v236, s[16:19], s41 offen lds
    s_add_u32 m0, s63, 25600
    s_mov_b32 s41, 344064
    buffer_load_dwordx4 v237, s[16:19], s41 offen lds
    s_waitcnt vmcnt(0)
    s_mov_b32 s32, 1
    s_branch recurrent_scan__mha_block_cached__mixer_s_mlp__prompt_kernel_store
L_g3idle:
    s_waitcnt vmcnt(0)
    s_barrier
    s_lshl_b32 s40, s39, 5
    s_add_u32 s40, s40, s38
    s_cmp_lg_u32 s3, 0
    s_cbranch_scc1 L_pub_fo_i
    s_lshl_b32 s60, s40, 7
    s_add_u32 s60, s60, 131072
    v_mov_b32 v30, s60
    v_mov_b32 v31, s36
    s_mov_b64 exec, 1
    buffer_store_dword v31, v30, s[44:47], 0 offen sc1
    s_mov_b64 exec, -1
L_pub_fo_i:
    v_mov_b32 v1, v238
    v_lshrrev_b32 v1, 4, v1
    s_lshl_b32 s40, s39, 5
    v_min_u32 v27, 31, v1
    v_add_u32 v27, s40, v27
    v_lshlrev_b32 v27, 7, v27
    v_add_u32 v27, 65536, v27
    buffer_load_dword v26, v27, s[44:47], 0 offen sc1
    s_waitcnt vmcnt(0)
    v_cmp_ne_u32 vcc, s36, v26
    s_nop 4
    s_cmp_eq_u64 vcc, 0
    s_cbranch_scc1 L_pok_fw_i
    s_mov_b32 s37, 0
L_spin_fw_i:
    buffer_load_dword v26, v27, s[44:47], 0 offen sc1
    s_add_u32 s37, s37, 1
    s_cmp_gt_u32 s37, 0x20000
    s_cbranch_scc1 recurrent_scan__mha_block_cached__mixer_s_mlp__prompt_kernel_end
    s_waitcnt vmcnt(0)
    v_cmp_ne_u32 vcc, s36, v26
    s_nop 4
    s_cmp_lg_u64 vcc, 0
    s_cbranch_scc1 L_spin_fw_i
L_pok_fw_i:
    s_lshr_b32 s40, s38, 2
    s_lshl_b32 s40, s40, 5
    v_mov_b32 v1, v238
    v_lshrrev_b32 v1, 4, v1
    v_min_u32 v29, 31, v1
    v_add_u32 v29, s40, v29
    v_lshlrev_b32 v29, 7, v29
    v_add_u32 v29, 131072, v29
    buffer_load_dword v28, v29, s[44:47], 0 offen sc1
    s_lshl_b32 s61, s3, 15
    s_cmp_eq_u32 s3, 3
    s_cselect_b32 s61, 0x20000, s61
    s_mul_i32 s41, s39, 753664
    s_add_u32 s16, s34, 0x3000000
    s_addc_u32 s17, s35, 0
    s_add_u32 s16, s16, s41
    s_addc_u32 s17, s17, 0
    s_mov_b32 s18, 0xb8000
    s_mov_b32 s19, 0x20000
    s_lshl_b32 s62, s3, 17
    s_mul_i32 s63, s3, 57344
    s_add_u32 s63, s63, 524288
    v_mov_b32 v20, v239
    v_mov_b32 v21, v240
    v_mov_b32 v19, v238
    v_lshrrev_b32 v22, 2, v20
    v_and_b32 v23, 3, v20
    v_lshl_add_u32 v24, v21, 2, v22
    v_lshrrev_b32 v25, 1, v24
    v_and_b32 v25, 3, v25
    v_lshlrev_b32 v24, 7, v24
    v_lshl_add_u32 v24, v23, 3, v24
    v_add_u32 v24, s61, v24
    v_xor_b32 v26, 0, v25
    v_lshl_add_u32 v4, v26, 5, v24
    v_xor_b32 v26, 1, v25
    v_lshl_add_u32 v5, v26, 5, v24
    v_xor_b32 v26, 2, v25
    v_lshl_add_u32 v6, v26, 5, v24
    v_xor_b32 v26, 3, v25
    v_lshl_add_u32 v7, v26, 5, v24
    s_lshl_b32 s41, s38, 19
    s_add_u32 s20, s34, 0x1000000
    s_addc_u32 s21, s35, 0
    s_add_u32 s20, s20, s41
    s_addc_u32 s21, s21, 0
    s_mov_b32 s22, 0x80000
    s_mov_b32 s23, 0x20000
    s_lshl_b32 s40, s3, 15
    v_add_u32 v9, s40, v19
    s_mul_i32 s40, s3, 14336
    v_add_u32 v10, s40, v19
    s_mul_i32 s41, s38, 229376
    s_add_u32 s8, s34, 0x800000
    s_addc_u32 s9, s35, 0
    s_add_u32 s8, s8, s41
    s_addc_u32 s9, s9, 0
    s_mov_b32 s10, 0x38000
    s_mov_b32 s11, 0x20000
    s_waitcnt vmcnt(0)
    v_cmp_ne_u32 vcc, s36, v28
    s_nop 4
    s_cmp_eq_u64 vcc, 0
    s_cbranch_scc1 L_pok_fo_i
    s_mov_b32 s37, 0
L_spin_fo_i:
    buffer_load_dword v28, v29, s[44:47], 0 offen sc1
    s_add_u32 s37, s37, 1
    s_cmp_gt_u32 s37, 0x20000
    s_cbranch_scc1 recurrent_scan__mha_block_cached__mixer_s_mlp__prompt_kernel_end
    s_waitcnt vmcnt(0)
    v_cmp_ne_u32 vcc, s36, v28
    s_nop 4
    s_cmp_lg_u64 vcc, 0
    s_cbranch_scc1 L_spin_fo_i
L_pok_fo_i:
    s_add_u32 m0, s61, 0
    s_add_u32 s33, s62, 0
    buffer_load_dwordx4 v238, s[16:19], s33 offen sc1 lds
    s_add_u32 m0, s61, 1024
    s_add_u32 s33, s62, 1024
    buffer_load_dwordx4 v238, s[16:19], s33 offen sc1 lds
    s_add_u32 m0, s61, 2048
    s_add_u32 s33, s62, 2048
    buffer_load_dwordx4 v238, s[16:19], s33 offen sc1 lds
    s_add_u32 m0, s61, 3072
    s_add_u32 s33, s62, 3072
    buffer_load_dwordx4 v238, s[16:19], s33 offen sc1 lds
    s_mov_b32 s33, 0
    buffer_load_dwordx4 a[0:3], v9, s[20:23], s33 offen sc1
    s_mov_b32 s33, 131072
    buffer_load_dwordx4 a[4:7], v9, s[20:23], s33 offen sc1
    s_mov_b32 s33, 262144
    buffer_load_dwordx4 a[8:11], v9, s[20:23], s33 offen sc1
    s_mov_b32 s33, 393216
    buffer_load_dwordx4 a[12:15], v9, s[20:23], s33 offen sc1
    s_add_u32 m0, s61, 4096
    s_add_u32 s33, s62, 4096
    buffer_load_dwordx4 v238, s[16:19], s33 offen sc1 lds
    s_add_u32 m0, s61, 5120
    s_add_u32 s33, s62, 5120
    buffer_load_dwordx4 v238, s[16:19], s33 offen sc1 lds
    s_add_u32 m0, s61, 6144
    s_add_u32 s33, s62, 6144
    buffer_load_dwordx4 v238, s[16:19], s33 offen sc1 lds
    s_add_u32 m0, s61, 7168
    s_add_u32 s33, s62, 7168
    buffer_load_dwordx4 v238, s[16:19], s33 offen sc1 lds
    s_mov_b32 s33, 1024
    buffer_load_dwordx4 a[16:19], v9, s[20:23], s33 offen sc1
    s_mov_b32 s33, 132096
    buffer_load_dwordx4 a[20:23], v9, s[20:23], s33 offen sc1
    s_mov_b32 s33, 263168
    buffer_load_dwordx4 a[24:27], v9, s[20:23], s33 offen sc1
    s_mov_b32 s33, 394240
    buffer_load_dwordx4 a[28:31], v9, s[20:23], s33 offen sc1
    s_add_u32 m0, s61, 8192
    s_add_u32 s33, s62, 8192
    buffer_load_dwordx4 v238, s[16:19], s33 offen sc1 lds
    s_add_u32 m0, s61, 9216
    s_add_u32 s33, s62, 9216
    buffer_load_dwordx4 v238, s[16:19], s33 offen sc1 lds
    s_add_u32 m0, s61, 10240
    s_add_u32 s33, s62, 10240
    buffer_load_dwordx4 v238, s[16:19], s33 offen sc1 lds
    s_add_u32 m0, s61, 11264
    s_add_u32 s33, s62, 11264
    buffer_load_dwordx4 v238, s[16:19], s33 offen sc1 lds
    s_mov_b32 s33, 2048
    buffer_load_dwordx4 a[32:35], v9, s[20:23], s33 offen sc1
    s_mov_b32 s33, 133120
    buffer_load_dwordx4 a[36:39], v9, s[20:23], s33 offen sc1
    s_mov_b32 s33, 264192
    buffer_load_dwordx4 a[40:43], v9, s[20:23], s33 offen sc1
    s_mov_b32 s33, 395264
    buffer_load_dwordx4 a[44:47], v9, s[20:23], s33 offen sc1
    s_add_u32 m0, s61, 12288
    s_add_u32 s33, s62, 12288
    buffer_load_dwordx4 v238, s[16:19], s33 offen sc1 lds
    s_add_u32 m0, s61, 13312
    s_add_u32 s33, s62, 13312
    buffer_load_dwordx4 v238, s[16:19], s33 offen sc1 lds
    s_add_u32 m0, s61, 14336
    s_add_u32 s33, s62, 14336
    buffer_load_dwordx4 v238, s[16:19], s33 offen sc1 lds
    s_add_u32 m0, s61, 15360
    s_add_u32 s33, s62, 15360
    buffer_load_dwordx4 v238, s[16:19], s33 offen sc1 lds
    s_mov_b32 s33, 3072
    buffer_load_dwordx4 a[48:51], v9, s[20:23], s33 offen sc1
    s_mov_b32 s33, 134144
    buffer_load_dwordx4 a[52:55], v9, s[20:23], s33 offen sc1
    s_mov_b32 s33, 265216
    buffer_load_dwordx4 a[56:59], v9, s[20:23], s33 offen sc1
    s_mov_b32 s33, 396288
    buffer_load_dwordx4 a[60:63], v9, s[20:23], s33 offen sc1
    s_add_u32 m0, s61, 16384
    s_add_u32 s33, s62, 16384
    buffer_load_dwordx4 v238, s[16:19], s33 offen sc1 lds
    s_add_u32 m0, s61, 17408
    s_add_u32 s33, s62, 17408
    buffer_load_dwordx4 v238, s[16:19], s33 offen sc1 lds
    s_add_u32 m0, s61, 18432
    s_add_u32 s33, s62, 18432
    buffer_load_dwordx4 v238, s[16:19], s33 offen sc1 lds
    s_add_u32 m0, s61, 19456
    s_add_u32 s33, s62, 19456
    buffer_load_dwordx4 v238, s[16:19], s33 offen sc1 lds
    s_mov_b32 s33, 4096
    buffer_load_dwordx4 a[64:67], v9, s[20:23], s33 offen sc1
    s_mov_b32 s33, 135168
    buffer_load_dwordx4 a[68:71], v9, s[20:23], s33 offen sc1
    s_mov_b32 s33, 266240
    buffer_load_dwordx4 a[72:75], v9, s[20:23], s33 offen sc1
    s_mov_b32 s33, 397312
    buffer_load_dwordx4 a[76:79], v9, s[20:23], s33 offen sc1
    s_add_u32 m0, s61, 20480
    s_add_u32 s33, s62, 20480
    buffer_load_dwordx4 v238, s[16:19], s33 offen sc1 lds
    s_add_u32 m0, s61, 21504
    s_add_u32 s33, s62, 21504
    buffer_load_dwordx4 v238, s[16:19], s33 offen sc1 lds
    s_add_u32 m0, s61, 22528
    s_add_u32 s33, s62, 22528
    buffer_load_dwordx4 v238, s[16:19], s33 offen sc1 lds
    s_add_u32 m0, s61, 23552
    s_add_u32 s33, s62, 23552
    buffer_load_dwordx4 v238, s[16:19], s33 offen sc1 lds
    s_mov_b32 s33, 5120
    buffer_load_dwordx4 a[80:83], v9, s[20:23], s33 offen sc1
    s_mov_b32 s33, 136192
    buffer_load_dwordx4 a[84:87], v9, s[20:23], s33 offen sc1
    s_mov_b32 s33, 267264
    buffer_load_dwordx4 a[88:91], v9, s[20:23], s33 offen sc1
    s_mov_b32 s33, 398336
    buffer_load_dwordx4 a[92:95], v9, s[20:23], s33 offen sc1
    s_add_u32 m0, s61, 24576
    s_add_u32 s33, s62, 24576
    buffer_load_dwordx4 v238, s[16:19], s33 offen sc1 lds
    s_add_u32 m0, s61, 25600
    s_add_u32 s33, s62, 25600
    buffer_load_dwordx4 v238, s[16:19], s33 offen sc1 lds
    s_add_u32 m0, s61, 26624
    s_add_u32 s33, s62, 26624
    buffer_load_dwordx4 v238, s[16:19], s33 offen sc1 lds
    s_add_u32 m0, s61, 27648
    s_add_u32 s33, s62, 27648
    buffer_load_dwordx4 v238, s[16:19], s33 offen sc1 lds
    s_mov_b32 s33, 6144
    buffer_load_dwordx4 a[96:99], v9, s[20:23], s33 offen sc1
    s_mov_b32 s33, 137216
    buffer_load_dwordx4 a[100:103], v9, s[20:23], s33 offen sc1
    s_mov_b32 s33, 268288
    buffer_load_dwordx4 a[104:107], v9, s[20:23], s33 offen sc1
    s_mov_b32 s33, 399360
    buffer_load_dwordx4 a[108:111], v9, s[20:23], s33 offen sc1
    v_mov_b32 v96, 0
    v_mov_b32 v97, 0
    v_mov_b32 v98, 0
    v_mov_b32 v99, 0
    v_mov_b32 v100, 0
    v_mov_b32 v101, 0
    v_mov_b32 v102, 0
    v_mov_b32 v103, 0
    v_mov_b32 v104, 0
    v_mov_b32 v105, 0
    v_mov_b32 v106, 0
    v_mov_b32 v107, 0
    v_mov_b32 v108, 0
    v_mov_b32 v109, 0
    v_mov_b32 v110, 0
    v_mov_b32 v111, 0
    v_mov_b32 v112, 0
    v_mov_b32 v113, 0
    v_mov_b32 v114, 0
    v_mov_b32 v115, 0
    v_mov_b32 v116, 0
    v_mov_b32 v117, 0
    v_mov_b32 v118, 0
    v_mov_b32 v119, 0
    v_mov_b32 v120, 0
    v_mov_b32 v121, 0
    v_mov_b32 v122, 0
    v_mov_b32 v123, 0
    v_mov_b32 v124, 0
    v_mov_b32 v125, 0
    v_mov_b32 v126, 0
    v_mov_b32 v127, 0
    v_mov_b32 v128, 0
    v_mov_b32 v129, 0
    v_mov_b32 v130, 0
    v_mov_b32 v131, 0
    v_mov_b32 v132, 0
    v_mov_b32 v133, 0
    v_mov_b32 v134, 0
    v_mov_b32 v135, 0
    v_mov_b32 v136, 0
    v_mov_b32 v137, 0
    v_mov_b32 v138, 0
    v_mov_b32 v139, 0
    v_mov_b32 v140, 0
    v_mov_b32 v141, 0
    v_mov_b32 v142, 0
    v_mov_b32 v143, 0
    v_mov_b32 v144, 0
    v_mov_b32 v145, 0
    v_mov_b32 v146, 0
    v_mov_b32 v147, 0
    v_mov_b32 v148, 0
    v_mov_b32 v149, 0
    v_mov_b32 v150, 0
    v_mov_b32 v151, 0
    v_mov_b32 v152, 0
    v_mov_b32 v153, 0
    v_mov_b32 v154, 0
    v_mov_b32 v155, 0
    v_mov_b32 v156, 0
    v_mov_b32 v157, 0
    v_mov_b32 v158, 0
    v_mov_b32 v159, 0
    s_mov_b32 s26, 0
    s_waitcnt vmcnt(0)
    s_branch L_g3join
.section .rodata,"a"
.p2align 6
.amdhsa_kernel recurrent_scan__mha_block_cached__mixer_s_mlp__prompt_kernel
  .amdhsa_next_free_vgpr 512
  .amdhsa_next_free_sgpr 102
  .amdhsa_accum_offset 256
  .amdhsa_group_segment_fixed_size 0
  .amdhsa_kernarg_size 104
  .amdhsa_user_sgpr_count 2
  .amdhsa_user_sgpr_kernarg_segment_ptr 1
  .amdhsa_system_sgpr_workgroup_id_x 1
  .amdhsa_float_denorm_mode_32 3
.end_amdhsa_kernel
```
